```python
import torch

def _softmax(x, axis=-1):
    return torch.softmax(x, dim=axis)
def _gelu(x):
    return torch.nn.functional.gelu(x, approximate="tanh")
def _silu(x):
    return torch.nn.functional.silu(x)
def _sigmoid(x):
    return torch.sigmoid(x)
def _layernorm(x, axis=-1, eps=1e-5):
    m = x.mean(dim=axis, keepdim=True)
    v = x.var(dim=axis, keepdim=True, unbiased=False)
    return (x - m) / torch.sqrt(v + eps)
def _scatter_add(tgt, idx, src, axis=0):
    return tgt.clone().index_add_(axis, idx, src)
def _segment_sum(src, seg, n):
    out = torch.zeros((n,) + src.shape[1:], dtype=src.dtype)
    return out.index_add_(0, seg, src)
def _pad(x, pw):
    flat = tuple(v for pair in reversed(pw) for v in pair)
    return torch.nn.functional.pad(x, flat)

kernel_name = 'gated_mix__ssm_conv_h3__compressed_kv_cla__prompt'

def setup_inputs():

    _w = (lambda a: (lambda t: t.to(torch.bfloat16) if t.is_floating_point() else t)(torch.as_tensor(a)))
    def _A_setup():
        B, S, D = 1, 2048, 512
        ks = 4
        return {
            "q": _w((lambda *s: torch.randn(*s, dtype=torch.bfloat16) * 0.05)(B, S, D)),
            "k": _w((lambda *s: torch.randn(*s, dtype=torch.bfloat16) * 0.4)(B, S, D)),
            "v": _w((lambda *s: torch.randn(*s, dtype=torch.bfloat16) * 0.4)(B, S, D)),
            "shift_k": _w((lambda *s: torch.randn(*s, dtype=torch.bfloat16) * 0.4)(D, ks) * 0.5),
            "ssm_k": _w((lambda *s: torch.randn(*s, dtype=torch.bfloat16) * 0.8)(D, S) * (1.0 / S ** 0.5)),
            "ssm_D": _w((lambda *s: torch.randn(*s, dtype=torch.bfloat16) * 0.4)(D)),
        }
    _A_in = _A_setup()

    def _B_setup():
        B, H, Sq, Sk, D, M = 1, 32, 2048, 2048, 128, 512
        Dc = 4 * D
        return {
            "x": _w((lambda *s: torch.randn(*s, dtype=torch.bfloat16) * 0.05)(B, Sq, M)),
            "c_kv": _w((lambda *s: torch.randn(*s, dtype=torch.bfloat16) * 0.4)(B, Sk, Dc)),
            "w_q": _w((lambda *s: torch.randn(*s, dtype=torch.bfloat16) * 6.4)(M, H, D) * (M ** -0.5)),
            "w_uk": _w((lambda *s: torch.randn(*s, dtype=torch.bfloat16) * 6.4)(Dc, H, D) * (Dc ** -0.5)),
            "w_uv": _w((lambda *s: torch.randn(*s, dtype=torch.bfloat16) * 0.4)(Dc, H, D) * (Dc ** -0.5)),
            "w_o": _w((lambda *s: torch.randn(*s, dtype=torch.bfloat16) * 0.4)(H, D, M) * ((H * D) ** -0.5)),
        }
    _B_in = _B_setup()

    return {
        "A_q": _A_in["q"],
        "A_k": _A_in["k"],
        "A_v": _A_in["v"],
        "A_shift_k": _A_in["shift_k"],
        "A_ssm_k": _A_in["ssm_k"],
        "A_ssm_D": _A_in["ssm_D"],
        "B_x": _B_in["x"],
        "B_c_kv": _B_in["c_kv"],
        "B_w_q": _B_in["w_q"],
        "B_w_uk": _B_in["w_uk"],
        "B_w_uv": _B_in["w_uv"],
        "B_w_o": _B_in["w_o"],
        "gate_w": _w((lambda *s: torch.randn(*s, dtype=torch.bfloat16) * 0.05)(512) * 16.0),
    }

def reference(A_q, A_k, A_v, A_shift_k, A_ssm_k, A_ssm_D, B_x, B_c_kv, B_w_q, B_w_uk, B_w_uv, B_w_o, gate_w):
    def _A_ref(q, k, v, shift_k, ssm_k, ssm_D):
        B, S, D = q.shape
        ks = shift_k.shape[-1]
        k_pad = _pad(k, ((0, 0), (ks - 1, 0), (0, 0)))
        k_shift = torch.zeros_like(k)
        for t in range(ks):
            k_shift = k_shift + k_pad[:, t:t + S, :] * shift_k[:, ks - 1 - t][None, None, :]
        kv = k_shift * v
        L = 2 * S
        kv_pad = _pad(kv, ((0, 0), (0, S), (0, 0)))
        kf_pad = _pad(ssm_k, ((0, 0), (0, S)))
        kv_f = (lambda x, axes=(-2,-1): torch.fft.rfft2(x.float(), dim=axes))(kv_pad[:, None, :, :], axes=(1, 2))
        kf_f = (lambda x, axes=(-2,-1): torch.fft.rfft2(x.float(), dim=axes))(kf_pad[:, None, :], axes=(1, 2))
        kf_f = (lambda x, *d: x.permute(*d))(kf_f, 1, 2, 0)
        y_f = kv_f * kf_f[None, :, :, :]
        y = (lambda x, s, axes=(-2,-1): torch.fft.irfft2(x, s=s, dim=axes).to(torch.bfloat16))(y_f, (1, L), axes=(1, 2))[:, 0, :S, :]
        y = y + kv * ssm_D[None, None, :]
        return q * y

    def _B_ref(x, c_kv, w_q, w_uk, w_uv, w_o):
        B, Sq, M = x.shape[0], x.shape[1], x.shape[2]
        Sk = c_kv.shape[1]
        H, D = w_q.shape[1], w_q.shape[2]
        q = torch.einsum("bqm,mhd->bhqd", x, w_q)
        k = torch.einsum("bkc,chd->bhkd", c_kv, w_uk)
        v = torch.einsum("bkc,chd->bhkd", c_kv, w_uv)
        scores = torch.einsum("bhqd,bhkd->bhqk", q, k) * (D ** -0.5)
        off = Sk - Sq
        qi = torch.arange(Sq)[:, None]
        kj = torch.arange(Sk)[None, :]
        cmask = kj <= (qi + off)
        scores = torch.where(cmask[None, None], scores, -1e9)
        p = _softmax(scores, axis=-1)
        ctx = torch.einsum("bhqk,bhkd->bhqd", p, v)
        return torch.einsum("bhqd,hdm->bqm", ctx, w_o)

    x = A_q
    g = _sigmoid((x * gate_w).sum(-1, keepdims=True))
    a = _A_ref(x, A_k, A_v, A_shift_k, A_ssm_k, A_ssm_D)
    b = _B_ref(x, B_c_kv, B_w_q, B_w_uk, B_w_uv, B_w_o)
    return g * a + (1 - g) * b
```

```asm
; @launch grid=(256,1,1) block=(512,1,1) lds=163840
.amdgcn_target "amdgcn-amd-amdhsa--gfx950"
.text
.globl gated_mix__ssm_conv_h3__compressed_kv_cla__prompt_kernel
.p2align 8
.type gated_mix__ssm_conv_h3__compressed_kv_cla__prompt_kernel,@function
gated_mix__ssm_conv_h3__compressed_kv_cla__prompt_kernel:
    s_load_dwordx16 s[64:79], s[0:1], 0
    s_load_dwordx16 s[80:95], s[0:1], 64
    s_cmp_ge_u32 s2, 256
    s_cbranch_scc1 END_1
    v_lshrrev_b32 v1, 6, v0
    v_and_b32 v0, 63, v0
    v_readfirstlane_b32 s3, v1
    s_and_b32 s7, s2, 7
    s_lshl_b32 s7, s7, 2
    s_lshr_b32 s5, s2, 3
    s_lshr_b32 s4, s5, 3
    s_add_u32 s4, s4, s7
    s_and_b32 s5, s5, 7
    s_lshl_b32 s6, s3, 10
    s_lshl_b32 s7, s4, 3
    s_add_u32 s7, s7, s5
    v_lshrrev_b32 v13, 3, v0
    s_lshl_b32 s40, s3, 3
    v_add_u32 v13, s40, v13
    v_lshlrev_b32 v13, 10, v13
    s_lshr_b32 s41, s3, 1
    s_xor_b32 s40, s41, s3
    s_and_b32 s40, s40, 1
    s_lshl_b32 s40, s40, 2
    v_lshrrev_b32 v14, 4, v0
    v_add_u32 v15, s40, v14
    v_and_b32 v3, 7, v0
    v_xor_b32 v15, v15, v3
    v_lshl_add_u32 v10, v15, 4, v13
    s_lshl_b32 s40, s3, 2
    v_add_u32 v13, s40, v14
    v_lshlrev_b32 v13, 13, v13
    s_and_b32 s41, s41, 1
    s_lshl_b32 s41, s41, 3
    v_lshl_add_u32 v15, v14, 1, s41
    v_and_b32 v3, 15, v0
    v_xor_b32 v15, v15, v3
    v_lshl_add_u32 v13, v15, 4, v13
    s_mov_b32 s40, s4
    s_lshl_b32 s40, s40, 8
    v_add_u32 v11, s40, v13
    v_lshlrev_b32 v12, 4, v0
    s_lshl_b32 s44, s5, 18
    s_add_u32 s45, s44, 65536
    s_add_u32 s46, s44, 131072
    s_add_u32 s47, s44, 196608
    s_lshr_b32 s33, s4, 2
    s_add_u32 s33, s33, s5
    s_mov_b32 s32, s33
    s_waitcnt lgkmcnt(0)
    s_mov_b32 s8, s78
    s_mov_b32 s9, s79
    s_mov_b32 s10, 2097152
    s_mov_b32 s11, 0x00020000
    s_mov_b32 s12, s82
    s_mov_b32 s13, s83
    s_mov_b32 s14, 4194304
    s_mov_b32 s15, 0x00020000
    s_mov_b32 s16, s84
    s_mov_b32 s17, s85
    s_mov_b32 s18, 4194304
    s_mov_b32 s19, 0x00020000
    s_add_u32 s34, s33, 0
    s_and_b32 s34, s34, 7
    s_lshl_b32 s34, s34, 19
    s_add_u32 m0, s6, 65536
    s_add_u32 s41, s34, 0
    buffer_load_dwordx4 v11, s[12:15], s41 offen lds
    s_add_u32 m0, s6, 73728
    s_add_u32 s41, s34, 262144
    buffer_load_dwordx4 v11, s[12:15], s41 offen lds
    s_add_u32 s35, s33, 0
    s_and_b32 s35, s35, 7
    s_lshl_b32 s35, s35, 7
    s_add_u32 m0, s6, 32768
    s_add_u32 s41, s44, s35
    buffer_load_dwordx4 v10, s[8:11], s41 offen lds
    s_add_u32 m0, s6, 40960
    s_add_u32 s41, s45, s35
    buffer_load_dwordx4 v10, s[8:11], s41 offen lds
    s_add_u32 m0, s6, 49152
    s_add_u32 s41, s46, s35
    buffer_load_dwordx4 v10, s[8:11], s41 offen lds
    s_add_u32 m0, s6, 57344
    s_add_u32 s41, s47, s35
    buffer_load_dwordx4 v10, s[8:11], s41 offen lds
    s_mov_b32 s20, s94
    s_mov_b32 s21, s95
    s_mov_b32 s22, 73400320
    s_mov_b32 s23, 0x00020000
    s_mov_b32 s60, s92
    s_mov_b32 s61, s93
    s_mov_b32 s62, 256
    s_mov_b32 s63, 0x00020000
    s_lshl_b32 s48, s5, 17
    s_add_u32 s49, s48, 65536
    s_sub_u32 s50, 15, s5
    s_lshl_b32 s50, s50, 17
    s_add_u32 s51, s50, 65536
    s_and_b32 s42, s3, 3
    s_lshl_b32 s42, s42, 6
    s_lshr_b32 s43, s3, 2
    s_lshl_b32 s43, s43, 1
    v_and_b32 v13, 15, v0
    v_lshrrev_b32 v15, 4, v0
    v_lshrrev_b32 v14, 1, v13
    v_xor_b32 v14, v14, v15
    v_lshlrev_b32 v14, 4, v14
    v_add_u32 v3, s42, v13
    v_lshl_add_u32 v224, v3, 7, v14
    v_and_b32 v2, 8, v13
    v_add_u32 v3, v3, v2
    v_lshl_add_u32 v228, v3, 7, v14
    v_xor_b32 v225, 64, v224
    v_add_u32 v226, 0x20000, v224
    v_add_u32 v227, 0x20000, v225
    v_xor_b32 v229, 64, v228
    v_add_u32 v230, 0x20000, v228
    v_add_u32 v231, 0x20000, v229
    v_lshlrev_b32 v3, 4, v13
    v_and_b32 v2, 1, v15
    v_lshl_add_u32 v3, v2, 9, v3
    v_lshrrev_b32 v14, 1, v15
    v_lshlrev_b32 v3, 4, v13
    v_lshl_add_u32 v8, v15, 11, v3
    v_bfe_u32 v13, v0, 2, 2
    v_lshl_add_u32 v14, v15, 3, v13
    v_lshlrev_b32 v14, 8, v14
    v_and_b32 v3, 3, v0
    v_lshl_add_u32 v14, v3, 3, v14
    v_add_u32 v14, 0x10000, v14
    v_lshl_add_u32 v13, v2, 2, v13
    s_lshl_b32 s40, s43, 1
    v_xor_b32 v13, s40, v13
    v_lshl_add_u32 v4, v13, 5, v14
    v_xor_b32 v5, 32, v4
    v_xor_b32 v6, 64, v4
    v_xor_b32 v7, 96, v4
    s_lshl_b32 s54, s4, 4
    s_lshl_b32 s55, s5, 1
    s_add_u32 s54, s54, s55
    s_bfe_u32 s55, s3, 0x10001
    s_add_u32 s54, s54, s55
    s_lshl_b32 s54, s54, 16
    s_and_b32 s55, s3, 1
    s_lshl_b32 s55, s55, 14
    s_add_u32 s54, s54, s55
    s_lshl_b32 s55, s43, 9
    s_add_u32 s52, s54, s55
    s_add_u32 s52, s52, 0x8000
    s_lshl_b32 s55, s43, 8
    s_add_u32 s54, s54, s55
    s_barrier
    s_add_u32 s34, s33, 1
    s_and_b32 s34, s34, 7
    s_lshl_b32 s34, s34, 19
    s_add_u32 m0, s6, 81920
    s_add_u32 s41, s34, 0
    buffer_load_dwordx4 v11, s[12:15], s41 offen lds
    s_add_u32 m0, s6, 90112
    s_add_u32 s41, s34, 262144
    buffer_load_dwordx4 v11, s[12:15], s41 offen lds
    s_add_u32 s35, s33, 1
    s_and_b32 s35, s35, 7
    s_lshl_b32 s35, s35, 7
    s_add_u32 m0, s6, 0
    s_add_u32 s41, s44, s35
    buffer_load_dwordx4 v10, s[8:11], s41 offen lds
    s_add_u32 m0, s6, 8192
    s_add_u32 s41, s45, s35
    buffer_load_dwordx4 v10, s[8:11], s41 offen lds
    s_add_u32 m0, s6, 16384
    s_add_u32 s41, s46, s35
    buffer_load_dwordx4 v10, s[8:11], s41 offen lds
    s_add_u32 m0, s6, 24576
    s_add_u32 s41, s47, s35
    buffer_load_dwordx4 v10, s[8:11], s41 offen lds
    s_add_u32 s34, s33, 2
    s_and_b32 s34, s34, 7
    s_lshl_b32 s34, s34, 19
    s_add_u32 m0, s6, 98304
    s_add_u32 s41, s34, 0
    buffer_load_dwordx4 v11, s[12:15], s41 offen lds
    s_add_u32 m0, s6, 106496
    s_add_u32 s41, s34, 262144
    buffer_load_dwordx4 v11, s[12:15], s41 offen lds
    s_waitcnt vmcnt(8)
    s_barrier
    ds_read_b128 v[16:19], v224 offset:32768
    ds_read_b64_tr_b16 v[192:193], v4 offset:0
    ds_read_b64_tr_b16 v[194:195], v4 offset:1024
    ds_read_b128 v[20:23], v225 offset:32768
    ds_read_b64_tr_b16 v[196:197], v4 offset:8192
    ds_read_b64_tr_b16 v[198:199], v4 offset:9216
    ds_read_b64_tr_b16 v[200:201], v5 offset:0
    ds_read_b64_tr_b16 v[202:203], v5 offset:1024
    ds_read_b64_tr_b16 v[204:205], v5 offset:8192
    ds_read_b64_tr_b16 v[206:207], v5 offset:9216
    ds_read_b64_tr_b16 v[208:209], v6 offset:0
    ds_read_b64_tr_b16 v[210:211], v6 offset:1024
    ds_read_b64_tr_b16 v[212:213], v6 offset:8192
    s_waitcnt lgkmcnt(10)
    v_mfma_f32_16x16x32_bf16 v[64:67], v[192:195], v[16:19], 0
    ds_read_b64_tr_b16 v[214:215], v6 offset:9216
    ds_read_b64_tr_b16 v[216:217], v7 offset:0
    ds_read_b64_tr_b16 v[218:219], v7 offset:1024
    s_add_u32 s35, s33, 2
    s_and_b32 s35, s35, 7
    s_lshl_b32 s35, s35, 7
    s_add_u32 m0, s6, 131072
    s_add_u32 s41, s44, s35
    buffer_load_dwordx4 v10, s[8:11], s41 offen lds
    s_lshl_b32 s40, s4, 7
    s_lshl_b32 s39, s5, 2
    s_waitcnt lgkmcnt(10)
    v_mfma_f32_16x16x32_bf16 v[64:67], v[196:199], v[20:23], v[64:67]
    ds_read_b64_tr_b16 v[220:221], v7 offset:8192
    ds_read_b64_tr_b16 v[222:223], v7 offset:9216
    s_add_u32 s40, s40, s39
    s_waitcnt lgkmcnt(10)
    v_mfma_f32_16x16x32_bf16 v[68:71], v[200:203], v[16:19], 0
    ds_read_b128 v[24:27], v225 offset:34816
    s_add_u32 s40, s40, 71368704
    s_lshl_b32 s39, s7, 7
    s_waitcnt lgkmcnt(9)
    v_mfma_f32_16x16x32_bf16 v[68:71], v[204:207], v[20:23], v[68:71]
    ds_read_b128 v[28:31], v224 offset:34816
    s_add_u32 s39, s39, 71401472
    s_waitcnt lgkmcnt(8)
    v_mfma_f32_16x16x32_bf16 v[72:75], v[208:211], v[16:19], 0
    s_add_u32 m0, s6, 139264
    s_add_u32 s41, s45, s35
    buffer_load_dwordx4 v10, s[8:11], s41 offen lds
    v_and_b32 v13, 7, v0
    v_lshl_add_u32 v13, v13, 2, s39
    s_waitcnt lgkmcnt(6)
    v_mfma_f32_16x16x32_bf16 v[72:75], v[212:215], v[20:23], v[72:75]
    v_writelane_b32 v13, s40, 0
    s_waitcnt lgkmcnt(4)
    v_mfma_f32_16x16x32_bf16 v[76:79], v[216:219], v[16:19], 0
    s_lshr_b32 s39, s4, 2
    s_lshl_b32 s39, s39, 7
    s_waitcnt lgkmcnt(2)
    v_mfma_f32_16x16x32_bf16 v[76:79], v[220:223], v[20:23], v[76:79]
    s_and_b32 s40, s4, 3
    s_waitcnt lgkmcnt(1)
    v_mfma_f32_16x16x32_bf16 v[80:83], v[192:195], v[24:27], 0
    ds_read_b128 v[16:19], v224 offset:36864
    s_add_u32 m0, s6, 147456
    s_add_u32 s41, s46, s35
    buffer_load_dwordx4 v10, s[8:11], s41 offen lds
    s_lshl_b32 s40, s40, 2
    s_add_u32 s39, s39, s40
    s_waitcnt lgkmcnt(1)
    v_mfma_f32_16x16x32_bf16 v[80:83], v[196:199], v[28:31], v[80:83]
    ds_read_b128 v[20:23], v225 offset:36864
    s_lshl_b32 s40, s5, 10
    v_mfma_f32_16x16x32_bf16 v[84:87], v[200:203], v[24:27], 0
    s_add_u32 s40, s40, s39
    s_add_u32 s40, s40, 71376896
    v_mfma_f32_16x16x32_bf16 v[84:87], v[204:207], v[28:31], v[84:87]
    v_writelane_b32 v13, s40, 1
    v_mfma_f32_16x16x32_bf16 v[88:91], v[208:211], v[24:27], 0
    s_add_u32 m0, s6, 155648
    s_add_u32 s41, s47, s35
    buffer_load_dwordx4 v10, s[8:11], s41 offen lds
    s_sub_u32 s40, 15, s5
    s_lshl_b32 s40, s40, 10
    v_mfma_f32_16x16x32_bf16 v[88:91], v[212:215], v[28:31], v[88:91]
    s_add_u32 s40, s40, s39
    v_mfma_f32_16x16x32_bf16 v[92:95], v[216:219], v[24:27], 0
    s_add_u32 s40, s40, 71376896
    v_writelane_b32 v13, s40, 2
    v_mfma_f32_16x16x32_bf16 v[92:95], v[220:223], v[28:31], v[92:95]
    s_lshl_b32 s40, s7, 2
    s_waitcnt lgkmcnt(1)
    v_mfma_f32_16x16x32_bf16 v[96:99], v[192:195], v[16:19], 0
    ds_read_b128 v[24:27], v225 offset:38912
    s_add_u32 s34, s33, 3
    s_and_b32 s34, s34, 7
    s_lshl_b32 s34, s34, 19
    s_add_u32 m0, s6, 114688
    s_add_u32 s41, s34, 0
    buffer_load_dwordx4 v11, s[12:15], s41 offen lds
    s_add_u32 s40, s40, 71372800
    v_writelane_b32 v13, s40, 3
    s_waitcnt lgkmcnt(1)
    v_mfma_f32_16x16x32_bf16 v[96:99], v[196:199], v[20:23], v[96:99]
    ds_read_b128 v[28:31], v224 offset:38912
    v_mov_b32 v14, 0
    s_cmp_eq_u32 s3, 0
    s_cselect_b32 s99, 0, 1073741824
    v_add_u32 v13, s99, v13
    v_mfma_f32_16x16x32_bf16 v[100:103], v[200:203], v[16:19], 0
    buffer_store_dword v14, v13, s[20:23], 0 offen sc1
    v_mfma_f32_16x16x32_bf16 v[100:103], v[204:207], v[20:23], v[100:103]
    s_lshl_b32 s37, s2, 3
    s_add_u32 s37, s37, s3
    v_mfma_f32_16x16x32_bf16 v[104:107], v[208:211], v[16:19], 0
    s_add_u32 m0, s6, 122880
    s_add_u32 s41, s34, 262144
    buffer_load_dwordx4 v11, s[12:15], s41 offen lds
    s_lshl_b32 s38, s37, 10
    s_mov_b32 s24, s64
    s_mov_b32 s25, s65
    s_mov_b32 s26, 2097152
    s_mov_b32 s27, 0x00020000
    v_mfma_f32_16x16x32_bf16 v[104:107], v[212:215], v[20:23], v[104:107]
    s_mov_b32 s28, s80
    s_mov_b32 s29, s81
    s_mov_b32 s30, 4194304
    s_mov_b32 s31, 0x00020000
    v_mfma_f32_16x16x32_bf16 v[108:111], v[216:219], v[16:19], 0
    s_mov_b32 s56, s88
    s_mov_b32 s57, s89
    s_mov_b32 s58, 1024
    s_mov_b32 s59, 0x00020000
    buffer_load_dwordx4 v[232:235], v12, s[24:27], s38 offen
    v_mfma_f32_16x16x32_bf16 v[108:111], v[220:223], v[20:23], v[108:111]
    buffer_load_dwordx4 v[236:239], v12, s[56:59], 0 offen
    s_waitcnt lgkmcnt(0)
    s_waitcnt vmcnt(9)
    s_barrier
    v_mfma_f32_16x16x32_bf16 v[112:115], v[192:195], v[24:27], 0
    ds_read_b128 v[16:19], v224 offset:0
    ds_read_b64_tr_b16 v[32:33], v4 offset:16384
    s_add_u32 s35, s33, 3
    s_and_b32 s35, s35, 7
    s_lshl_b32 s35, s35, 7
    s_add_u32 m0, s6, 32768
    s_add_u32 s41, s44, s35
    buffer_load_dwordx4 v10, s[8:11], s41 offen lds
    v_mfma_f32_16x16x32_bf16 v[112:115], v[196:199], v[28:31], v[112:115]
    ds_read_b64_tr_b16 v[34:35], v4 offset:17408
    ds_read_b128 v[20:23], v225 offset:0
    v_mfma_f32_16x16x32_bf16 v[116:119], v[200:203], v[24:27], 0
    ds_read_b64_tr_b16 v[36:37], v4 offset:24576
    ds_read_b64_tr_b16 v[38:39], v4 offset:25600
    v_mfma_f32_16x16x32_bf16 v[116:119], v[204:207], v[28:31], v[116:119]
    ds_read_b64_tr_b16 v[40:41], v5 offset:16384
    ds_read_b64_tr_b16 v[42:43], v5 offset:17408
    v_mfma_f32_16x16x32_bf16 v[120:123], v[208:211], v[24:27], 0
    ds_read_b64_tr_b16 v[44:45], v5 offset:24576
    ds_read_b64_tr_b16 v[46:47], v5 offset:25600
    v_mfma_f32_16x16x32_bf16 v[120:123], v[212:215], v[28:31], v[120:123]
    ds_read_b64_tr_b16 v[48:49], v6 offset:16384
    ds_read_b64_tr_b16 v[50:51], v6 offset:17408
    v_mfma_f32_16x16x32_bf16 v[124:127], v[216:219], v[24:27], 0
    ds_read_b64_tr_b16 v[52:53], v6 offset:24576
    ds_read_b64_tr_b16 v[54:55], v6 offset:25600
    v_mfma_f32_16x16x32_bf16 v[124:127], v[220:223], v[28:31], v[124:127]
    ds_read_b64_tr_b16 v[56:57], v7 offset:16384
    ds_read_b64_tr_b16 v[58:59], v7 offset:17408
    s_waitcnt lgkmcnt(13)
    v_mfma_f32_16x16x32_bf16 v[64:67], v[32:35], v[16:19], v[64:67]
    ds_read_b64_tr_b16 v[60:61], v7 offset:24576
    s_add_u32 m0, s6, 40960
    s_add_u32 s41, s45, s35
    buffer_load_dwordx4 v10, s[8:11], s41 offen lds
    s_waitcnt lgkmcnt(11)
    v_mfma_f32_16x16x32_bf16 v[64:67], v[36:39], v[20:23], v[64:67]
    ds_read_b64_tr_b16 v[62:63], v7 offset:25600
    s_waitcnt lgkmcnt(10)
    v_mfma_f32_16x16x32_bf16 v[68:71], v[40:43], v[16:19], v[68:71]
    ds_read_b128 v[24:27], v225 offset:2048
    ds_read_b64_tr_b16 v[192:193], v4 offset:32768
    s_waitcnt lgkmcnt(10)
    v_mfma_f32_16x16x32_bf16 v[68:71], v[44:47], v[20:23], v[68:71]
    ds_read_b128 v[28:31], v224 offset:2048
    ds_read_b64_tr_b16 v[194:195], v4 offset:33792
    s_waitcnt lgkmcnt(10)
    v_mfma_f32_16x16x32_bf16 v[72:75], v[48:51], v[16:19], v[72:75]
    ds_read_b64_tr_b16 v[196:197], v4 offset:40960
    s_add_u32 m0, s6, 49152
    s_add_u32 s41, s46, s35
    buffer_load_dwordx4 v10, s[8:11], s41 offen lds
    s_waitcnt lgkmcnt(9)
    v_mfma_f32_16x16x32_bf16 v[72:75], v[52:55], v[20:23], v[72:75]
    ds_read_b64_tr_b16 v[198:199], v4 offset:41984
    s_waitcnt lgkmcnt(8)
    v_mfma_f32_16x16x32_bf16 v[76:79], v[56:59], v[16:19], v[76:79]
    ds_read_b64_tr_b16 v[200:201], v5 offset:32768
    s_waitcnt lgkmcnt(7)
    v_mfma_f32_16x16x32_bf16 v[76:79], v[60:63], v[20:23], v[76:79]
    ds_read_b64_tr_b16 v[202:203], v5 offset:33792
    s_waitcnt lgkmcnt(7)
    v_mfma_f32_16x16x32_bf16 v[80:83], v[32:35], v[24:27], v[80:83]
    ds_read_b128 v[16:19], v224 offset:4096
    s_add_u32 m0, s6, 57344
    s_add_u32 s41, s47, s35
    buffer_load_dwordx4 v10, s[8:11], s41 offen lds
    s_waitcnt lgkmcnt(6)
    v_mfma_f32_16x16x32_bf16 v[80:83], v[36:39], v[28:31], v[80:83]
    ds_read_b128 v[20:23], v225 offset:4096
    v_mfma_f32_16x16x32_bf16 v[84:87], v[40:43], v[24:27], v[84:87]
    ds_read_b64_tr_b16 v[204:205], v5 offset:40960
    v_mfma_f32_16x16x32_bf16 v[84:87], v[44:47], v[28:31], v[84:87]
    ds_read_b64_tr_b16 v[206:207], v5 offset:41984
    v_mfma_f32_16x16x32_bf16 v[88:91], v[48:51], v[24:27], v[88:91]
    ds_read_b64_tr_b16 v[208:209], v6 offset:32768
    s_add_u32 s34, s33, 4
    s_and_b32 s34, s34, 7
    s_lshl_b32 s34, s34, 19
    s_add_u32 m0, s6, 65536
    s_add_u32 s41, s34, 0
    buffer_load_dwordx4 v11, s[12:15], s41 offen lds
    v_mfma_f32_16x16x32_bf16 v[88:91], v[52:55], v[28:31], v[88:91]
    ds_read_b64_tr_b16 v[210:211], v6 offset:33792
    v_mfma_f32_16x16x32_bf16 v[92:95], v[56:59], v[24:27], v[92:95]
    ds_read_b64_tr_b16 v[212:213], v6 offset:40960
    v_mfma_f32_16x16x32_bf16 v[92:95], v[60:63], v[28:31], v[92:95]
    ds_read_b64_tr_b16 v[214:215], v6 offset:41984
    s_waitcnt lgkmcnt(7)
    v_mfma_f32_16x16x32_bf16 v[96:99], v[32:35], v[16:19], v[96:99]
    ds_read_b128 v[24:27], v225 offset:6144
    s_add_u32 m0, s6, 73728
    s_add_u32 s41, s34, 262144
    buffer_load_dwordx4 v11, s[12:15], s41 offen lds
    s_cmp_eq_u32 s3, 0
    s_cselect_b32 s99, 0, 1073741824
    s_mov_b32 s39, s4
    s_lshl_b32 s39, s39, 8
    s_lshl_b32 s40, s5, 19
    s_add_u32 s40, s40, s39
    s_add_u32 s40, s40, 0
    v_lshrrev_b32 v3, 1, v0
    v_lshlrev_b32 v3, 13, v3
    v_and_b32 v2, 1, v0
    v_lshl_add_u32 v3, v2, 7, v3
    v_add_u32 v3, s99, v3
    buffer_load_dword v1, v3, s[16:19], s40 offen
    s_waitcnt lgkmcnt(7)
    v_mfma_f32_16x16x32_bf16 v[96:99], v[36:39], v[20:23], v[96:99]
    ds_read_b128 v[28:31], v224 offset:6144
    v_mfma_f32_16x16x32_bf16 v[100:103], v[40:43], v[16:19], v[100:103]
    ds_read_b64_tr_b16 v[216:217], v7 offset:32768
    v_mfma_f32_16x16x32_bf16 v[100:103], v[44:47], v[20:23], v[100:103]
    ds_read_b64_tr_b16 v[218:219], v7 offset:33792
    v_mfma_f32_16x16x32_bf16 v[104:107], v[48:51], v[16:19], v[104:107]
    ds_read_b64_tr_b16 v[220:221], v7 offset:40960
    v_mfma_f32_16x16x32_bf16 v[104:107], v[52:55], v[20:23], v[104:107]
    ds_read_b64_tr_b16 v[222:223], v7 offset:41984
    v_mfma_f32_16x16x32_bf16 v[108:111], v[56:59], v[16:19], v[108:111]
    v_mfma_f32_16x16x32_bf16 v[108:111], v[60:63], v[20:23], v[108:111]
    s_waitcnt lgkmcnt(0)
    s_waitcnt vmcnt(9)
    s_barrier
    v_mfma_f32_16x16x32_bf16 v[112:115], v[32:35], v[24:27], v[112:115]
    ds_read_b128 v[16:19], v226 offset:0
    s_add_u32 s35, s33, 4
    s_and_b32 s35, s35, 7
    s_lshl_b32 s35, s35, 7
    s_add_u32 m0, s6, 0
    s_add_u32 s41, s44, s35
    buffer_load_dwordx4 v10, s[8:11], s41 offen lds
    v_mfma_f32_16x16x32_bf16 v[112:115], v[36:39], v[28:31], v[112:115]
    ds_read_b128 v[20:23], v227 offset:0
    v_mfma_f32_16x16x32_bf16 v[116:119], v[40:43], v[24:27], v[116:119]
    v_mfma_f32_16x16x32_bf16 v[116:119], v[44:47], v[28:31], v[116:119]
    v_mfma_f32_16x16x32_bf16 v[120:123], v[48:51], v[24:27], v[120:123]
    s_add_u32 m0, s6, 8192
    s_add_u32 s41, s45, s35
    buffer_load_dwordx4 v10, s[8:11], s41 offen lds
    v_mfma_f32_16x16x32_bf16 v[120:123], v[52:55], v[28:31], v[120:123]
    v_mfma_f32_16x16x32_bf16 v[124:127], v[56:59], v[24:27], v[124:127]
    v_mfma_f32_16x16x32_bf16 v[124:127], v[60:63], v[28:31], v[124:127]
    s_waitcnt lgkmcnt(1)
    v_mfma_f32_16x16x32_bf16 v[64:67], v[192:195], v[16:19], v[64:67]
    ds_read_b128 v[24:27], v227 offset:2048
    s_add_u32 m0, s6, 16384
    s_add_u32 s41, s46, s35
    buffer_load_dwordx4 v10, s[8:11], s41 offen lds
    s_waitcnt vmcnt(10)
    s_waitcnt lgkmcnt(1)
    v_mfma_f32_16x16x32_bf16 v[64:67], v[196:199], v[20:23], v[64:67]
    ds_read_b128 v[28:31], v226 offset:2048
    v_dot2_f32_bf16 v240, v232, v236, 0
    v_mfma_f32_16x16x32_bf16 v[68:71], v[200:203], v[16:19], v[68:71]
    ds_read_b64_tr_b16 v[32:33], v4 offset:49152
    v_dot2_f32_bf16 v240, v233, v237, v240
    v_mfma_f32_16x16x32_bf16 v[68:71], v[204:207], v[20:23], v[68:71]
    ds_read_b64_tr_b16 v[34:35], v4 offset:50176
    v_dot2_f32_bf16 v240, v234, v238, v240
    v_mfma_f32_16x16x32_bf16 v[72:75], v[208:211], v[16:19], v[72:75]
    ds_read_b64_tr_b16 v[36:37], v4 offset:57344
    s_add_u32 m0, s6, 24576
    s_add_u32 s41, s47, s35
    buffer_load_dwordx4 v10, s[8:11], s41 offen lds
    v_dot2_f32_bf16 v240, v235, v239, v240
    v_mfma_f32_16x16x32_bf16 v[72:75], v[212:215], v[20:23], v[72:75]
    ds_read_b64_tr_b16 v[38:39], v4 offset:58368
    s_nop 0
    v_add_f32_dpp v240, v240, v240 quad_perm:[1,0,3,2] row_mask:0xf bank_mask:0xf
    v_mfma_f32_16x16x32_bf16 v[76:79], v[216:219], v[16:19], v[76:79]
    ds_read_b64_tr_b16 v[40:41], v5 offset:49152
    v_add_f32_dpp v240, v240, v240 quad_perm:[2,3,0,1] row_mask:0xf bank_mask:0xf
    v_mfma_f32_16x16x32_bf16 v[76:79], v[220:223], v[20:23], v[76:79]
    ds_read_b64_tr_b16 v[42:43], v5 offset:50176
    s_waitcnt lgkmcnt(7)
    v_mfma_f32_16x16x32_bf16 v[80:83], v[192:195], v[24:27], v[80:83]
    ds_read_b128 v[16:19], v226 offset:4096
    s_add_u32 s34, s33, 5
    s_and_b32 s34, s34, 7
    s_lshl_b32 s34, s34, 19
    s_add_u32 m0, s6, 81920
    s_add_u32 s41, s34, 0
    buffer_load_dwordx4 v11, s[12:15], s41 offen lds
    v_add_f32_dpp v240, v240, v240 row_half_mirror row_mask:0xf bank_mask:0xf
    s_waitcnt lgkmcnt(7)
    v_mfma_f32_16x16x32_bf16 v[80:83], v[196:199], v[28:31], v[80:83]
    ds_read_b128 v[20:23], v227 offset:4096
    v_add_f32_dpp v240, v240, v240 row_mirror row_mask:0xf bank_mask:0xf
    v_mfma_f32_16x16x32_bf16 v[84:87], v[200:203], v[24:27], v[84:87]
    ds_read_b64_tr_b16 v[44:45], v5 offset:57344
    v_add_f32_dpp v240, v240, v240 row_bcast:15 row_mask:0xa bank_mask:0xf
    v_mfma_f32_16x16x32_bf16 v[84:87], v[204:207], v[28:31], v[84:87]
    ds_read_b64_tr_b16 v[46:47], v5 offset:58368
    v_add_f32_dpp v240, v240, v240 row_bcast:31 row_mask:0xc bank_mask:0xf
    v_mfma_f32_16x16x32_bf16 v[88:91], v[208:211], v[24:27], v[88:91]
    ds_read_b64_tr_b16 v[48:49], v6 offset:49152
    s_add_u32 m0, s6, 90112
    s_add_u32 s41, s34, 262144
    buffer_load_dwordx4 v11, s[12:15], s41 offen lds
    v_readlane_b32 s36, v240, 63
    v_mfma_f32_16x16x32_bf16 v[88:91], v[212:215], v[28:31], v[88:91]
    ds_read_b64_tr_b16 v[50:51], v6 offset:50176
    v_mov_b32 v241, 0xbfb8aa3b
    v_mfma_f32_16x16x32_bf16 v[92:95], v[216:219], v[24:27], v[92:95]
    ds_read_b64_tr_b16 v[52:53], v6 offset:57344
    v_mul_f32 v240, s36, v241
    v_mfma_f32_16x16x32_bf16 v[92:95], v[220:223], v[28:31], v[92:95]
    ds_read_b64_tr_b16 v[54:55], v6 offset:58368
    s_waitcnt lgkmcnt(7)
    v_mfma_f32_16x16x32_bf16 v[96:99], v[192:195], v[16:19], v[96:99]
    ds_read_b128 v[24:27], v227 offset:6144
    s_add_u32 s34, s33, 6
    s_and_b32 s34, s34, 7
    s_lshl_b32 s34, s34, 19
    s_add_u32 m0, s6, 98304
    s_add_u32 s41, s34, 0
    buffer_load_dwordx4 v11, s[12:15], s41 offen lds
    v_exp_f32 v240, v240
    s_waitcnt lgkmcnt(7)
    v_mfma_f32_16x16x32_bf16 v[96:99], v[196:199], v[20:23], v[96:99]
    ds_read_b128 v[28:31], v226 offset:6144
    v_add_f32 v240, 1.0, v240
    v_mfma_f32_16x16x32_bf16 v[100:103], v[200:203], v[16:19], v[100:103]
    ds_read_b64_tr_b16 v[56:57], v7 offset:49152
    v_rcp_f32 v240, v240
    v_mfma_f32_16x16x32_bf16 v[100:103], v[204:207], v[20:23], v[100:103]
    ds_read_b64_tr_b16 v[58:59], v7 offset:50176
    s_lshl_b32 s38, s37, 2
    v_mfma_f32_16x16x32_bf16 v[104:107], v[208:211], v[16:19], v[104:107]
    ds_read_b64_tr_b16 v[60:61], v7 offset:57344
    s_add_u32 m0, s6, 106496
    s_add_u32 s41, s34, 262144
    buffer_load_dwordx4 v11, s[12:15], s41 offen lds
    s_add_u32 s38, s38, 71303168
    v_mfma_f32_16x16x32_bf16 v[104:107], v[212:215], v[20:23], v[104:107]
    ds_read_b64_tr_b16 v[62:63], v7 offset:58368
    v_mov_b32 v241, 0
    v_mfma_f32_16x16x32_bf16 v[108:111], v[216:219], v[16:19], v[108:111]
    buffer_store_dword v240, v241, s[20:23], s38 offen sc1
    v_mfma_f32_16x16x32_bf16 v[108:111], v[220:223], v[20:23], v[108:111]
    s_cmp_eq_u32 s3, 1
    s_cselect_b32 s99, 0, 1073741824
    s_mov_b32 s39, s4
    s_lshl_b32 s39, s39, 8
    s_lshl_b32 s40, s5, 19
    s_add_u32 s40, s40, s39
    s_add_u32 s40, s40, 262144
    v_lshrrev_b32 v3, 1, v0
    v_lshlrev_b32 v3, 13, v3
    v_and_b32 v2, 1, v0
    v_lshl_add_u32 v3, v2, 7, v3
    v_add_u32 v3, s99, v3
    buffer_load_dword v1, v3, s[16:19], s40 offen
    s_waitcnt lgkmcnt(0)
    s_waitcnt vmcnt(11)
    s_barrier
    v_mfma_f32_16x16x32_bf16 v[112:115], v[192:195], v[24:27], v[112:115]
    ds_read_b128 v[16:19], v224 offset:32768
    s_add_u32 s35, s33, 5
    s_and_b32 s35, s35, 7
    s_lshl_b32 s35, s35, 7
    s_add_u32 m0, s6, 131072
    s_add_u32 s41, s44, s35
    buffer_load_dwordx4 v10, s[8:11], s41 offen lds
    v_mfma_f32_16x16x32_bf16 v[112:115], v[196:199], v[28:31], v[112:115]
    ds_read_b128 v[20:23], v225 offset:32768
    v_mfma_f32_16x16x32_bf16 v[116:119], v[200:203], v[24:27], v[116:119]
    v_mfma_f32_16x16x32_bf16 v[116:119], v[204:207], v[28:31], v[116:119]
    v_mfma_f32_16x16x32_bf16 v[120:123], v[208:211], v[24:27], v[120:123]
    v_mfma_f32_16x16x32_bf16 v[120:123], v[212:215], v[28:31], v[120:123]
    v_mfma_f32_16x16x32_bf16 v[124:127], v[216:219], v[24:27], v[124:127]
    v_mfma_f32_16x16x32_bf16 v[124:127], v[220:223], v[28:31], v[124:127]
    s_waitcnt lgkmcnt(1)
    v_mfma_f32_16x16x32_bf16 v[64:67], v[32:35], v[16:19], v[64:67]
    ds_read_b128 v[24:27], v225 offset:34816
    s_add_u32 m0, s6, 139264
    s_add_u32 s41, s45, s35
    buffer_load_dwordx4 v10, s[8:11], s41 offen lds
    s_waitcnt lgkmcnt(1)
    v_mfma_f32_16x16x32_bf16 v[64:67], v[36:39], v[20:23], v[64:67]
    ds_read_b128 v[28:31], v224 offset:34816
    v_mfma_f32_16x16x32_bf16 v[68:71], v[40:43], v[16:19], v[68:71]
    ds_read_b64_tr_b16 v[192:193], v4 offset:0
    v_mfma_f32_16x16x32_bf16 v[68:71], v[44:47], v[20:23], v[68:71]
    ds_read_b64_tr_b16 v[194:195], v4 offset:1024
    v_mfma_f32_16x16x32_bf16 v[72:75], v[48:51], v[16:19], v[72:75]
    ds_read_b64_tr_b16 v[196:197], v4 offset:8192
    s_add_u32 m0, s6, 147456
    s_add_u32 s41, s46, s35
    buffer_load_dwordx4 v10, s[8:11], s41 offen lds
    v_mfma_f32_16x16x32_bf16 v[72:75], v[52:55], v[20:23], v[72:75]
    ds_read_b64_tr_b16 v[198:199], v4 offset:9216
    v_mfma_f32_16x16x32_bf16 v[76:79], v[56:59], v[16:19], v[76:79]
    ds_read_b64_tr_b16 v[200:201], v5 offset:0
    v_mfma_f32_16x16x32_bf16 v[76:79], v[60:63], v[20:23], v[76:79]
    ds_read_b64_tr_b16 v[202:203], v5 offset:1024
    s_waitcnt lgkmcnt(7)
    v_mfma_f32_16x16x32_bf16 v[80:83], v[32:35], v[24:27], v[80:83]
    ds_read_b128 v[16:19], v224 offset:36864
    s_add_u32 m0, s6, 155648
    s_add_u32 s41, s47, s35
    buffer_load_dwordx4 v10, s[8:11], s41 offen lds
    s_waitcnt lgkmcnt(7)
    v_mfma_f32_16x16x32_bf16 v[80:83], v[36:39], v[28:31], v[80:83]
    ds_read_b128 v[20:23], v225 offset:36864
    v_mfma_f32_16x16x32_bf16 v[84:87], v[40:43], v[24:27], v[84:87]
    ds_read_b64_tr_b16 v[204:205], v5 offset:8192
    v_mfma_f32_16x16x32_bf16 v[84:87], v[44:47], v[28:31], v[84:87]
    ds_read_b64_tr_b16 v[206:207], v5 offset:9216
    v_mfma_f32_16x16x32_bf16 v[88:91], v[48:51], v[24:27], v[88:91]
    ds_read_b64_tr_b16 v[208:209], v6 offset:0
    s_add_u32 s34, s33, 7
    s_and_b32 s34, s34, 7
    s_lshl_b32 s34, s34, 19
    s_add_u32 m0, s6, 114688
    s_add_u32 s41, s34, 0
    buffer_load_dwordx4 v11, s[12:15], s41 offen lds
    v_mfma_f32_16x16x32_bf16 v[88:91], v[52:55], v[28:31], v[88:91]
    ds_read_b64_tr_b16 v[210:211], v6 offset:1024
    v_mfma_f32_16x16x32_bf16 v[92:95], v[56:59], v[24:27], v[92:95]
    ds_read_b64_tr_b16 v[212:213], v6 offset:8192
    v_mfma_f32_16x16x32_bf16 v[92:95], v[60:63], v[28:31], v[92:95]
    ds_read_b64_tr_b16 v[214:215], v6 offset:9216
    s_waitcnt lgkmcnt(7)
    v_mfma_f32_16x16x32_bf16 v[96:99], v[32:35], v[16:19], v[96:99]
    ds_read_b128 v[24:27], v225 offset:38912
    s_add_u32 m0, s6, 122880
    s_add_u32 s41, s34, 262144
    buffer_load_dwordx4 v11, s[12:15], s41 offen lds
    s_cmp_eq_u32 s3, 0
    s_cselect_b32 s99, 0, 1073741824
    s_mov_b32 s39, s4
    s_lshl_b32 s39, s39, 8
    s_lshl_b32 s40, s5, 19
    s_add_u32 s40, s40, s39
    s_add_u32 s40, s40, 0
    v_lshrrev_b32 v3, 1, v0
    v_lshlrev_b32 v3, 13, v3
    v_and_b32 v2, 1, v0
    v_lshl_add_u32 v3, v2, 7, v3
    v_add_u32 v3, s99, v3
    buffer_load_dword v1, v3, s[28:31], s40 offen
    s_waitcnt lgkmcnt(7)
    v_mfma_f32_16x16x32_bf16 v[96:99], v[36:39], v[20:23], v[96:99]
    ds_read_b128 v[28:31], v224 offset:38912
    v_mfma_f32_16x16x32_bf16 v[100:103], v[40:43], v[16:19], v[100:103]
    ds_read_b64_tr_b16 v[216:217], v7 offset:0
    v_mfma_f32_16x16x32_bf16 v[100:103], v[44:47], v[20:23], v[100:103]
    ds_read_b64_tr_b16 v[218:219], v7 offset:1024
    v_mfma_f32_16x16x32_bf16 v[104:107], v[48:51], v[16:19], v[104:107]
    ds_read_b64_tr_b16 v[220:221], v7 offset:8192
    v_mfma_f32_16x16x32_bf16 v[104:107], v[52:55], v[20:23], v[104:107]
    ds_read_b64_tr_b16 v[222:223], v7 offset:9216
    v_mfma_f32_16x16x32_bf16 v[108:111], v[56:59], v[16:19], v[108:111]
    v_mfma_f32_16x16x32_bf16 v[108:111], v[60:63], v[20:23], v[108:111]
    s_waitcnt lgkmcnt(0)
    s_waitcnt vmcnt(11)
    s_barrier
    v_mfma_f32_16x16x32_bf16 v[112:115], v[32:35], v[24:27], v[112:115]
    ds_read_b128 v[16:19], v224 offset:0
    s_add_u32 s35, s33, 6
    s_and_b32 s35, s35, 7
    s_lshl_b32 s35, s35, 7
    s_add_u32 m0, s6, 32768
    s_add_u32 s41, s44, s35
    buffer_load_dwordx4 v10, s[8:11], s41 offen lds
    v_mfma_f32_16x16x32_bf16 v[112:115], v[36:39], v[28:31], v[112:115]
    ds_read_b128 v[20:23], v225 offset:0
    v_mfma_f32_16x16x32_bf16 v[116:119], v[40:43], v[24:27], v[116:119]
    v_mfma_f32_16x16x32_bf16 v[116:119], v[44:47], v[28:31], v[116:119]
    v_mfma_f32_16x16x32_bf16 v[120:123], v[48:51], v[24:27], v[120:123]
    v_mfma_f32_16x16x32_bf16 v[120:123], v[52:55], v[28:31], v[120:123]
    v_mfma_f32_16x16x32_bf16 v[124:127], v[56:59], v[24:27], v[124:127]
    v_mfma_f32_16x16x32_bf16 v[124:127], v[60:63], v[28:31], v[124:127]
    s_waitcnt lgkmcnt(1)
    v_mfma_f32_16x16x32_bf16 v[64:67], v[192:195], v[16:19], v[64:67]
    ds_read_b128 v[24:27], v225 offset:2048
    s_add_u32 m0, s6, 40960
    s_add_u32 s41, s45, s35
    buffer_load_dwordx4 v10, s[8:11], s41 offen lds
    s_waitcnt lgkmcnt(1)
    v_mfma_f32_16x16x32_bf16 v[64:67], v[196:199], v[20:23], v[64:67]
    ds_read_b128 v[28:31], v224 offset:2048
    v_mfma_f32_16x16x32_bf16 v[68:71], v[200:203], v[16:19], v[68:71]
    ds_read_b64_tr_b16 v[32:33], v4 offset:16384
    v_mfma_f32_16x16x32_bf16 v[68:71], v[204:207], v[20:23], v[68:71]
    ds_read_b64_tr_b16 v[34:35], v4 offset:17408
    v_mfma_f32_16x16x32_bf16 v[72:75], v[208:211], v[16:19], v[72:75]
    ds_read_b64_tr_b16 v[36:37], v4 offset:24576
    s_add_u32 m0, s6, 49152
    s_add_u32 s41, s46, s35
    buffer_load_dwordx4 v10, s[8:11], s41 offen lds
    v_mfma_f32_16x16x32_bf16 v[72:75], v[212:215], v[20:23], v[72:75]
    ds_read_b64_tr_b16 v[38:39], v4 offset:25600
    v_mfma_f32_16x16x32_bf16 v[76:79], v[216:219], v[16:19], v[76:79]
    ds_read_b64_tr_b16 v[40:41], v5 offset:16384
    v_mfma_f32_16x16x32_bf16 v[76:79], v[220:223], v[20:23], v[76:79]
    ds_read_b64_tr_b16 v[42:43], v5 offset:17408
    s_waitcnt lgkmcnt(7)
    v_mfma_f32_16x16x32_bf16 v[80:83], v[192:195], v[24:27], v[80:83]
    ds_read_b128 v[16:19], v224 offset:4096
    s_add_u32 m0, s6, 57344
    s_add_u32 s41, s47, s35
    buffer_load_dwordx4 v10, s[8:11], s41 offen lds
    s_waitcnt lgkmcnt(7)
    v_mfma_f32_16x16x32_bf16 v[80:83], v[196:199], v[28:31], v[80:83]
    ds_read_b128 v[20:23], v225 offset:4096
    v_mfma_f32_16x16x32_bf16 v[84:87], v[200:203], v[24:27], v[84:87]
    ds_read_b64_tr_b16 v[44:45], v5 offset:24576
    v_mfma_f32_16x16x32_bf16 v[84:87], v[204:207], v[28:31], v[84:87]
    ds_read_b64_tr_b16 v[46:47], v5 offset:25600
    v_mfma_f32_16x16x32_bf16 v[88:91], v[208:211], v[24:27], v[88:91]
    ds_read_b64_tr_b16 v[48:49], v6 offset:16384
    s_add_u32 s34, s33, 7
    s_and_b32 s34, s34, 7
    s_lshl_b32 s34, s34, 19
    s_add_u32 m0, s6, 65536
    s_add_u32 s41, s34, 0
    buffer_load_dwordx4 v11, s[16:19], s41 offen lds
    v_mfma_f32_16x16x32_bf16 v[88:91], v[212:215], v[28:31], v[88:91]
    ds_read_b64_tr_b16 v[50:51], v6 offset:17408
    v_mfma_f32_16x16x32_bf16 v[92:95], v[216:219], v[24:27], v[92:95]
    ds_read_b64_tr_b16 v[52:53], v6 offset:24576
    v_mfma_f32_16x16x32_bf16 v[92:95], v[220:223], v[28:31], v[92:95]
    ds_read_b64_tr_b16 v[54:55], v6 offset:25600
    s_waitcnt lgkmcnt(7)
    v_mfma_f32_16x16x32_bf16 v[96:99], v[192:195], v[16:19], v[96:99]
    ds_read_b128 v[24:27], v225 offset:6144
    s_add_u32 m0, s6, 73728
    s_add_u32 s41, s34, 262144
    buffer_load_dwordx4 v11, s[16:19], s41 offen lds
    s_cmp_eq_u32 s3, 1
    s_cselect_b32 s99, 0, 1073741824
    s_mov_b32 s39, s4
    s_lshl_b32 s39, s39, 8
    s_lshl_b32 s40, s5, 19
    s_add_u32 s40, s40, s39
    s_add_u32 s40, s40, 262144
    v_lshrrev_b32 v3, 1, v0
    v_lshlrev_b32 v3, 13, v3
    v_and_b32 v2, 1, v0
    v_lshl_add_u32 v3, v2, 7, v3
    v_add_u32 v3, s99, v3
    buffer_load_dword v1, v3, s[28:31], s40 offen
    s_waitcnt lgkmcnt(7)
    v_mfma_f32_16x16x32_bf16 v[96:99], v[196:199], v[20:23], v[96:99]
    ds_read_b128 v[28:31], v224 offset:6144
    v_mfma_f32_16x16x32_bf16 v[100:103], v[200:203], v[16:19], v[100:103]
    ds_read_b64_tr_b16 v[56:57], v7 offset:16384
    v_mfma_f32_16x16x32_bf16 v[100:103], v[204:207], v[20:23], v[100:103]
    ds_read_b64_tr_b16 v[58:59], v7 offset:17408
    v_mfma_f32_16x16x32_bf16 v[104:107], v[208:211], v[16:19], v[104:107]
    ds_read_b64_tr_b16 v[60:61], v7 offset:24576
    v_mfma_f32_16x16x32_bf16 v[104:107], v[212:215], v[20:23], v[104:107]
    ds_read_b64_tr_b16 v[62:63], v7 offset:25600
    v_mfma_f32_16x16x32_bf16 v[108:111], v[216:219], v[16:19], v[108:111]
    v_mfma_f32_16x16x32_bf16 v[108:111], v[220:223], v[20:23], v[108:111]
    s_waitcnt lgkmcnt(0)
    s_waitcnt vmcnt(10)
    s_barrier
    v_mfma_f32_16x16x32_bf16 v[112:115], v[192:195], v[24:27], v[112:115]
    ds_read_b128 v[16:19], v226 offset:0
    s_add_u32 s35, s33, 7
    s_and_b32 s35, s35, 7
    s_lshl_b32 s35, s35, 7
    s_add_u32 m0, s6, 0
    s_add_u32 s41, s44, s35
    buffer_load_dwordx4 v10, s[8:11], s41 offen lds
    v_mfma_f32_16x16x32_bf16 v[112:115], v[196:199], v[28:31], v[112:115]
    ds_read_b128 v[20:23], v227 offset:0
    s_cmp_eq_u32 s3, 0
    s_cselect_b32 s99, 0, 1073741824
    s_and_b32 s98, s5, 3
    s_cmp_eq_u32 s98, 0
    s_cselect_b32 s99, s99, 1073741824
    v_mov_b32 v2, 1
    v_mov_b32 v3, s99
    buffer_store_byte v2, v3, s[60:63], s7 offen sc1
    v_mfma_f32_16x16x32_bf16 v[116:119], v[200:203], v[24:27], v[116:119]
    v_mfma_f32_16x16x32_bf16 v[116:119], v[204:207], v[28:31], v[116:119]
    v_mfma_f32_16x16x32_bf16 v[120:123], v[208:211], v[24:27], v[120:123]
    v_mfma_f32_16x16x32_bf16 v[120:123], v[212:215], v[28:31], v[120:123]
    v_mfma_f32_16x16x32_bf16 v[124:127], v[216:219], v[24:27], v[124:127]
    v_mfma_f32_16x16x32_bf16 v[124:127], v[220:223], v[28:31], v[124:127]
    s_waitcnt lgkmcnt(1)
    v_mfma_f32_16x16x32_bf16 v[64:67], v[32:35], v[16:19], v[64:67]
    ds_read_b128 v[24:27], v227 offset:2048
    s_add_u32 m0, s6, 8192
    s_add_u32 s41, s45, s35
    buffer_load_dwordx4 v10, s[8:11], s41 offen lds
    s_waitcnt lgkmcnt(1)
    v_mfma_f32_16x16x32_bf16 v[64:67], v[36:39], v[20:23], v[64:67]
    ds_read_b128 v[28:31], v226 offset:2048
    v_mfma_f32_16x16x32_bf16 v[68:71], v[40:43], v[16:19], v[68:71]
    ds_read_b64_tr_b16 v[192:193], v4 offset:32768
    v_mfma_f32_16x16x32_bf16 v[68:71], v[44:47], v[20:23], v[68:71]
    ds_read_b64_tr_b16 v[194:195], v4 offset:33792
    v_mfma_f32_16x16x32_bf16 v[72:75], v[48:51], v[16:19], v[72:75]
    ds_read_b64_tr_b16 v[196:197], v4 offset:40960
    s_add_u32 m0, s6, 16384
    s_add_u32 s41, s46, s35
    buffer_load_dwordx4 v10, s[8:11], s41 offen lds
    v_mfma_f32_16x16x32_bf16 v[72:75], v[52:55], v[20:23], v[72:75]
    ds_read_b64_tr_b16 v[198:199], v4 offset:41984
    v_mfma_f32_16x16x32_bf16 v[76:79], v[56:59], v[16:19], v[76:79]
    ds_read_b64_tr_b16 v[200:201], v5 offset:32768
    v_mfma_f32_16x16x32_bf16 v[76:79], v[60:63], v[20:23], v[76:79]
    ds_read_b64_tr_b16 v[202:203], v5 offset:33792
    s_waitcnt lgkmcnt(7)
    v_mfma_f32_16x16x32_bf16 v[80:83], v[32:35], v[24:27], v[80:83]
    ds_read_b128 v[16:19], v226 offset:4096
    s_add_u32 m0, s6, 24576
    s_add_u32 s41, s47, s35
    buffer_load_dwordx4 v10, s[8:11], s41 offen lds
    s_waitcnt lgkmcnt(7)
    v_mfma_f32_16x16x32_bf16 v[80:83], v[36:39], v[28:31], v[80:83]
    ds_read_b128 v[20:23], v227 offset:4096
    v_mfma_f32_16x16x32_bf16 v[84:87], v[40:43], v[24:27], v[84:87]
    ds_read_b64_tr_b16 v[204:205], v5 offset:40960
    v_mfma_f32_16x16x32_bf16 v[84:87], v[44:47], v[28:31], v[84:87]
    ds_read_b64_tr_b16 v[206:207], v5 offset:41984
    v_mfma_f32_16x16x32_bf16 v[88:91], v[48:51], v[24:27], v[88:91]
    ds_read_b64_tr_b16 v[208:209], v6 offset:32768
    s_add_u32 s34, s33, 6
    s_and_b32 s34, s34, 7
    s_lshl_b32 s34, s34, 19
    s_add_u32 m0, s6, 81920
    s_add_u32 s41, s34, 0
    buffer_load_dwordx4 v11, s[16:19], s41 offen lds
    v_mfma_f32_16x16x32_bf16 v[88:91], v[52:55], v[28:31], v[88:91]
    ds_read_b64_tr_b16 v[210:211], v6 offset:33792
    v_mfma_f32_16x16x32_bf16 v[92:95], v[56:59], v[24:27], v[92:95]
    ds_read_b64_tr_b16 v[212:213], v6 offset:40960
    v_mfma_f32_16x16x32_bf16 v[92:95], v[60:63], v[28:31], v[92:95]
    ds_read_b64_tr_b16 v[214:215], v6 offset:41984
    s_waitcnt lgkmcnt(7)
    v_mfma_f32_16x16x32_bf16 v[96:99], v[32:35], v[16:19], v[96:99]
    ds_read_b128 v[24:27], v227 offset:6144
    s_add_u32 m0, s6, 90112
    s_add_u32 s41, s34, 262144
    buffer_load_dwordx4 v11, s[16:19], s41 offen lds
    s_waitcnt lgkmcnt(7)
    v_mfma_f32_16x16x32_bf16 v[96:99], v[36:39], v[20:23], v[96:99]
    ds_read_b128 v[28:31], v226 offset:6144
    v_mfma_f32_16x16x32_bf16 v[100:103], v[40:43], v[16:19], v[100:103]
    ds_read_b64_tr_b16 v[216:217], v7 offset:32768
    v_mfma_f32_16x16x32_bf16 v[100:103], v[44:47], v[20:23], v[100:103]
    ds_read_b64_tr_b16 v[218:219], v7 offset:33792
    v_mfma_f32_16x16x32_bf16 v[104:107], v[48:51], v[16:19], v[104:107]
    ds_read_b64_tr_b16 v[220:221], v7 offset:40960
    v_mfma_f32_16x16x32_bf16 v[104:107], v[52:55], v[20:23], v[104:107]
    ds_read_b64_tr_b16 v[222:223], v7 offset:41984
    v_mfma_f32_16x16x32_bf16 v[108:111], v[56:59], v[16:19], v[108:111]
    v_mfma_f32_16x16x32_bf16 v[108:111], v[60:63], v[20:23], v[108:111]
    s_waitcnt lgkmcnt(0)
    s_waitcnt vmcnt(10)
    s_barrier
    v_mfma_f32_16x16x32_bf16 v[112:115], v[32:35], v[24:27], v[112:115]
    ds_read_b128 v[16:19], v224 offset:32768
    v_mfma_f32_16x16x32_bf16 v[112:115], v[36:39], v[28:31], v[112:115]
    ds_read_b128 v[20:23], v225 offset:32768
    s_cmp_eq_u32 s3, 0
    s_cselect_b32 s99, 0, 1073741824
    s_and_b32 s98, s5, 3
    s_cmp_eq_u32 s98, 1
    s_cselect_b32 s99, s99, 1073741824
    v_mov_b32 v2, 1
    v_mov_b32 v3, s99
    buffer_store_byte v2, v3, s[60:63], s7 offen sc1
    v_mfma_f32_16x16x32_bf16 v[116:119], v[40:43], v[24:27], v[116:119]
    v_mfma_f32_16x16x32_bf16 v[116:119], v[44:47], v[28:31], v[116:119]
    v_mfma_f32_16x16x32_bf16 v[120:123], v[48:51], v[24:27], v[120:123]
    v_mfma_f32_16x16x32_bf16 v[120:123], v[52:55], v[28:31], v[120:123]
    v_mfma_f32_16x16x32_bf16 v[124:127], v[56:59], v[24:27], v[124:127]
    v_mfma_f32_16x16x32_bf16 v[124:127], v[60:63], v[28:31], v[124:127]
    s_waitcnt lgkmcnt(1)
    v_mfma_f32_16x16x32_bf16 v[64:67], v[192:195], v[16:19], v[64:67]
    ds_read_b128 v[24:27], v225 offset:34816
    s_add_u32 s34, s33, 5
    s_and_b32 s34, s34, 7
    s_lshl_b32 s34, s34, 19
    s_add_u32 m0, s6, 98304
    s_add_u32 s41, s34, 0
    buffer_load_dwordx4 v11, s[16:19], s41 offen lds
    s_waitcnt lgkmcnt(1)
    v_mfma_f32_16x16x32_bf16 v[64:67], v[196:199], v[20:23], v[64:67]
    ds_read_b128 v[28:31], v224 offset:34816
    v_mfma_f32_16x16x32_bf16 v[68:71], v[200:203], v[16:19], v[68:71]
    ds_read_b64_tr_b16 v[32:33], v4 offset:49152
    v_mfma_f32_16x16x32_bf16 v[68:71], v[204:207], v[20:23], v[68:71]
    ds_read_b64_tr_b16 v[34:35], v4 offset:50176
    v_mfma_f32_16x16x32_bf16 v[72:75], v[208:211], v[16:19], v[72:75]
    ds_read_b64_tr_b16 v[36:37], v4 offset:57344
    v_mfma_f32_16x16x32_bf16 v[72:75], v[212:215], v[20:23], v[72:75]
    ds_read_b64_tr_b16 v[38:39], v4 offset:58368
    v_mfma_f32_16x16x32_bf16 v[76:79], v[216:219], v[16:19], v[76:79]
    ds_read_b64_tr_b16 v[40:41], v5 offset:49152
    v_mfma_f32_16x16x32_bf16 v[76:79], v[220:223], v[20:23], v[76:79]
    ds_read_b64_tr_b16 v[42:43], v5 offset:50176
    s_waitcnt lgkmcnt(7)
    v_mfma_f32_16x16x32_bf16 v[80:83], v[192:195], v[24:27], v[80:83]
    ds_read_b128 v[16:19], v224 offset:36864
    s_add_u32 m0, s6, 106496
    s_add_u32 s41, s34, 262144
    buffer_load_dwordx4 v11, s[16:19], s41 offen lds
    s_waitcnt lgkmcnt(7)
    v_mfma_f32_16x16x32_bf16 v[80:83], v[196:199], v[28:31], v[80:83]
    ds_read_b128 v[20:23], v225 offset:36864
    v_mfma_f32_16x16x32_bf16 v[84:87], v[200:203], v[24:27], v[84:87]
    ds_read_b64_tr_b16 v[44:45], v5 offset:57344
    v_mfma_f32_16x16x32_bf16 v[84:87], v[204:207], v[28:31], v[84:87]
    ds_read_b64_tr_b16 v[46:47], v5 offset:58368
    v_mfma_f32_16x16x32_bf16 v[88:91], v[208:211], v[24:27], v[88:91]
    ds_read_b64_tr_b16 v[48:49], v6 offset:49152
    v_mfma_f32_16x16x32_bf16 v[88:91], v[212:215], v[28:31], v[88:91]
    ds_read_b64_tr_b16 v[50:51], v6 offset:50176
    v_mfma_f32_16x16x32_bf16 v[92:95], v[216:219], v[24:27], v[92:95]
    ds_read_b64_tr_b16 v[52:53], v6 offset:57344
    v_mfma_f32_16x16x32_bf16 v[92:95], v[220:223], v[28:31], v[92:95]
    ds_read_b64_tr_b16 v[54:55], v6 offset:58368
    s_waitcnt lgkmcnt(7)
    v_mfma_f32_16x16x32_bf16 v[96:99], v[192:195], v[16:19], v[96:99]
    ds_read_b128 v[24:27], v225 offset:38912
    s_waitcnt lgkmcnt(7)
    v_mfma_f32_16x16x32_bf16 v[96:99], v[196:199], v[20:23], v[96:99]
    ds_read_b128 v[28:31], v224 offset:38912
    v_mfma_f32_16x16x32_bf16 v[100:103], v[200:203], v[16:19], v[100:103]
    ds_read_b64_tr_b16 v[56:57], v7 offset:49152
    v_mfma_f32_16x16x32_bf16 v[100:103], v[204:207], v[20:23], v[100:103]
    ds_read_b64_tr_b16 v[58:59], v7 offset:50176
    v_mfma_f32_16x16x32_bf16 v[104:107], v[208:211], v[16:19], v[104:107]
    ds_read_b64_tr_b16 v[60:61], v7 offset:57344
    v_mfma_f32_16x16x32_bf16 v[104:107], v[212:215], v[20:23], v[104:107]
    ds_read_b64_tr_b16 v[62:63], v7 offset:58368
    v_mfma_f32_16x16x32_bf16 v[108:111], v[216:219], v[16:19], v[108:111]
    v_mfma_f32_16x16x32_bf16 v[108:111], v[220:223], v[20:23], v[108:111]
    s_waitcnt lgkmcnt(0)
    s_waitcnt vmcnt(5)
    s_barrier
    v_mfma_f32_16x16x32_bf16 v[112:115], v[192:195], v[24:27], v[112:115]
    ds_read_b128 v[16:19], v224 offset:0
    v_mfma_f32_16x16x32_bf16 v[112:115], v[196:199], v[28:31], v[112:115]
    ds_read_b128 v[20:23], v225 offset:0
    s_cmp_eq_u32 s3, 0
    s_cselect_b32 s99, 0, 1073741824
    s_and_b32 s98, s5, 3
    s_cmp_eq_u32 s98, 2
    s_cselect_b32 s99, s99, 1073741824
    v_mov_b32 v2, 1
    v_mov_b32 v3, s99
    buffer_store_byte v2, v3, s[60:63], s7 offen sc1
    v_mfma_f32_16x16x32_bf16 v[116:119], v[200:203], v[24:27], v[116:119]
    v_mfma_f32_16x16x32_bf16 v[116:119], v[204:207], v[28:31], v[116:119]
    v_mfma_f32_16x16x32_bf16 v[120:123], v[208:211], v[24:27], v[120:123]
    v_mfma_f32_16x16x32_bf16 v[120:123], v[212:215], v[28:31], v[120:123]
    v_mfma_f32_16x16x32_bf16 v[124:127], v[216:219], v[24:27], v[124:127]
    v_mfma_f32_16x16x32_bf16 v[124:127], v[220:223], v[28:31], v[124:127]
    s_waitcnt lgkmcnt(1)
    v_mfma_f32_16x16x32_bf16 v[64:67], v[32:35], v[16:19], v[64:67]
    ds_read_b128 v[24:27], v225 offset:2048
    s_add_u32 s34, s33, 4
    s_and_b32 s34, s34, 7
    s_lshl_b32 s34, s34, 19
    s_add_u32 m0, s6, 114688
    s_add_u32 s41, s34, 0
    buffer_load_dwordx4 v11, s[16:19], s41 offen lds
    s_waitcnt lgkmcnt(1)
    v_mfma_f32_16x16x32_bf16 v[64:67], v[36:39], v[20:23], v[64:67]
    ds_read_b128 v[28:31], v224 offset:2048
    v_mfma_f32_16x16x32_bf16 v[68:71], v[40:43], v[16:19], v[68:71]
    ds_read_b64_tr_b16 v[192:193], v4 offset:0
    v_mfma_f32_16x16x32_bf16 v[68:71], v[44:47], v[20:23], v[68:71]
    ds_read_b64_tr_b16 v[194:195], v4 offset:1024
    v_mfma_f32_16x16x32_bf16 v[72:75], v[48:51], v[16:19], v[72:75]
    ds_read_b64_tr_b16 v[196:197], v4 offset:8192
    v_mfma_f32_16x16x32_bf16 v[72:75], v[52:55], v[20:23], v[72:75]
    ds_read_b64_tr_b16 v[198:199], v4 offset:9216
    v_mfma_f32_16x16x32_bf16 v[76:79], v[56:59], v[16:19], v[76:79]
    ds_read_b64_tr_b16 v[200:201], v5 offset:0
    v_mfma_f32_16x16x32_bf16 v[76:79], v[60:63], v[20:23], v[76:79]
    ds_read_b64_tr_b16 v[202:203], v5 offset:1024
    s_waitcnt lgkmcnt(7)
    v_mfma_f32_16x16x32_bf16 v[80:83], v[32:35], v[24:27], v[80:83]
    ds_read_b128 v[16:19], v224 offset:4096
    s_add_u32 m0, s6, 122880
    s_add_u32 s41, s34, 262144
    buffer_load_dwordx4 v11, s[16:19], s41 offen lds
    s_waitcnt lgkmcnt(7)
    v_mfma_f32_16x16x32_bf16 v[80:83], v[36:39], v[28:31], v[80:83]
    ds_read_b128 v[20:23], v225 offset:4096
    v_mfma_f32_16x16x32_bf16 v[84:87], v[40:43], v[24:27], v[84:87]
    ds_read_b64_tr_b16 v[204:205], v5 offset:8192
    v_mfma_f32_16x16x32_bf16 v[84:87], v[44:47], v[28:31], v[84:87]
    ds_read_b64_tr_b16 v[206:207], v5 offset:9216
    v_mfma_f32_16x16x32_bf16 v[88:91], v[48:51], v[24:27], v[88:91]
    ds_read_b64_tr_b16 v[208:209], v6 offset:0
    v_mfma_f32_16x16x32_bf16 v[88:91], v[52:55], v[28:31], v[88:91]
    ds_read_b64_tr_b16 v[210:211], v6 offset:1024
    v_mfma_f32_16x16x32_bf16 v[92:95], v[56:59], v[24:27], v[92:95]
    ds_read_b64_tr_b16 v[212:213], v6 offset:8192
    v_mfma_f32_16x16x32_bf16 v[92:95], v[60:63], v[28:31], v[92:95]
    ds_read_b64_tr_b16 v[214:215], v6 offset:9216
    s_waitcnt lgkmcnt(7)
    v_mfma_f32_16x16x32_bf16 v[96:99], v[32:35], v[16:19], v[96:99]
    ds_read_b128 v[24:27], v225 offset:6144
    s_waitcnt lgkmcnt(7)
    v_mfma_f32_16x16x32_bf16 v[96:99], v[36:39], v[20:23], v[96:99]
    ds_read_b128 v[28:31], v224 offset:6144
    v_mfma_f32_16x16x32_bf16 v[100:103], v[40:43], v[16:19], v[100:103]
    ds_read_b64_tr_b16 v[216:217], v7 offset:0
    v_mfma_f32_16x16x32_bf16 v[100:103], v[44:47], v[20:23], v[100:103]
    ds_read_b64_tr_b16 v[218:219], v7 offset:1024
    v_mfma_f32_16x16x32_bf16 v[104:107], v[48:51], v[16:19], v[104:107]
    ds_read_b64_tr_b16 v[220:221], v7 offset:8192
    v_mfma_f32_16x16x32_bf16 v[104:107], v[52:55], v[20:23], v[104:107]
    ds_read_b64_tr_b16 v[222:223], v7 offset:9216
    v_mfma_f32_16x16x32_bf16 v[108:111], v[56:59], v[16:19], v[108:111]
    v_mfma_f32_16x16x32_bf16 v[108:111], v[60:63], v[20:23], v[108:111]
    s_waitcnt lgkmcnt(0)
    s_waitcnt vmcnt(6)
    s_barrier
    v_mfma_f32_16x16x32_bf16 v[112:115], v[32:35], v[24:27], v[112:115]
    ds_read_b128 v[16:19], v224 offset:0
    v_mfma_f32_16x16x32_bf16 v[112:115], v[36:39], v[28:31], v[112:115]
    ds_read_b128 v[20:23], v225 offset:0
    s_cmp_eq_u32 s3, 0
    s_cselect_b32 s99, 0, 1073741824
    s_and_b32 s98, s5, 3
    s_cmp_eq_u32 s98, 3
    s_cselect_b32 s99, s99, 1073741824
    v_mov_b32 v2, 1
    v_mov_b32 v3, s99
    buffer_store_byte v2, v3, s[60:63], s7 offen sc1
    v_mfma_f32_16x16x32_bf16 v[116:119], v[40:43], v[24:27], v[116:119]
    v_mfma_f32_16x16x32_bf16 v[116:119], v[44:47], v[28:31], v[116:119]
    v_mfma_f32_16x16x32_bf16 v[120:123], v[48:51], v[24:27], v[120:123]
    v_mfma_f32_16x16x32_bf16 v[120:123], v[52:55], v[28:31], v[120:123]
    v_mfma_f32_16x16x32_bf16 v[124:127], v[56:59], v[24:27], v[124:127]
    v_mfma_f32_16x16x32_bf16 v[124:127], v[60:63], v[28:31], v[124:127]
    s_waitcnt lgkmcnt(1)
    v_mfma_f32_16x16x32_bf16 v[128:131], v[16:19], v[192:195], 0
    ds_read_b128 v[24:27], v225 offset:2048
    s_add_u32 s34, s33, 3
    s_and_b32 s34, s34, 7
    s_lshl_b32 s34, s34, 19
    s_add_u32 m0, s6, 65536
    s_add_u32 s41, s34, 0
    buffer_load_dwordx4 v11, s[16:19], s41 offen lds
    v_mul_f32 v64, 0x3e0293ee, v64
    v_mul_f32 v65, 0x3e0293ee, v65
    v_mul_f32 v66, 0x3e0293ee, v66
    s_waitcnt lgkmcnt(1)
    v_mfma_f32_16x16x32_bf16 v[128:131], v[20:23], v[196:199], v[128:131]
    ds_read_b128 v[28:31], v224 offset:2048
    v_mul_f32 v67, 0x3e0293ee, v67
    v_mul_f32 v68, 0x3e0293ee, v68
    v_mul_f32 v69, 0x3e0293ee, v69
    v_mfma_f32_16x16x32_bf16 v[136:139], v[16:19], v[200:203], 0
    ds_read_b64_tr_b16 v[32:33], v4 offset:16384
    v_mul_f32 v70, 0x3e0293ee, v70
    v_mul_f32 v71, 0x3e0293ee, v71
    v_cvt_pk_bf16_f32 v64, v64, v65
    v_mfma_f32_16x16x32_bf16 v[136:139], v[20:23], v[204:207], v[136:139]
    ds_read_b64_tr_b16 v[34:35], v4 offset:17408
    v_cvt_pk_bf16_f32 v65, v66, v67
    v_cvt_pk_bf16_f32 v66, v68, v69
    v_cvt_pk_bf16_f32 v67, v70, v71
    v_mfma_f32_16x16x32_bf16 v[144:147], v[16:19], v[208:211], 0
    ds_read_b64_tr_b16 v[36:37], v4 offset:24576
    v_mul_f32 v72, 0x3e0293ee, v72
    v_mul_f32 v73, 0x3e0293ee, v73
    v_mul_f32 v74, 0x3e0293ee, v74
    v_mfma_f32_16x16x32_bf16 v[144:147], v[20:23], v[212:215], v[144:147]
    ds_read_b64_tr_b16 v[38:39], v4 offset:25600
    v_mul_f32 v75, 0x3e0293ee, v75
    v_mul_f32 v76, 0x3e0293ee, v76
    v_mul_f32 v77, 0x3e0293ee, v77
    v_mfma_f32_16x16x32_bf16 v[152:155], v[16:19], v[216:219], 0
    ds_read_b64_tr_b16 v[40:41], v5 offset:16384
    v_mul_f32 v78, 0x3e0293ee, v78
    v_mul_f32 v79, 0x3e0293ee, v79
    v_cvt_pk_bf16_f32 v72, v72, v73
    v_mfma_f32_16x16x32_bf16 v[152:155], v[20:23], v[220:223], v[152:155]
    ds_read_b64_tr_b16 v[42:43], v5 offset:17408
    v_cvt_pk_bf16_f32 v73, v74, v75
    v_cvt_pk_bf16_f32 v74, v76, v77
    v_cvt_pk_bf16_f32 v75, v78, v79
    s_waitcnt lgkmcnt(7)
    v_mfma_f32_16x16x32_bf16 v[132:135], v[24:27], v[192:195], 0
    ds_read_b128 v[16:19], v224 offset:4096
    s_add_u32 m0, s6, 73728
    s_add_u32 s41, s34, 262144
    buffer_load_dwordx4 v11, s[16:19], s41 offen lds
    v_mul_f32 v80, 0x3e0293ee, v80
    v_mul_f32 v81, 0x3e0293ee, v81
    v_mul_f32 v82, 0x3e0293ee, v82
    s_waitcnt lgkmcnt(7)
    v_mfma_f32_16x16x32_bf16 v[132:135], v[28:31], v[196:199], v[132:135]
    ds_read_b128 v[20:23], v225 offset:4096
    v_mul_f32 v83, 0x3e0293ee, v83
    v_mul_f32 v84, 0x3e0293ee, v84
    v_mul_f32 v85, 0x3e0293ee, v85
    v_mfma_f32_16x16x32_bf16 v[140:143], v[24:27], v[200:203], 0
    ds_read_b64_tr_b16 v[44:45], v5 offset:24576
    v_mul_f32 v86, 0x3e0293ee, v86
    v_mul_f32 v87, 0x3e0293ee, v87
    v_cvt_pk_bf16_f32 v80, v80, v81
    v_mfma_f32_16x16x32_bf16 v[140:143], v[28:31], v[204:207], v[140:143]
    ds_read_b64_tr_b16 v[46:47], v5 offset:25600
    v_cvt_pk_bf16_f32 v81, v82, v83
    v_cvt_pk_bf16_f32 v82, v84, v85
    v_cvt_pk_bf16_f32 v83, v86, v87
    v_mfma_f32_16x16x32_bf16 v[148:151], v[24:27], v[208:211], 0
    ds_read_b64_tr_b16 v[48:49], v6 offset:16384
    v_mul_f32 v88, 0x3e0293ee, v88
    v_mul_f32 v89, 0x3e0293ee, v89
    v_mul_f32 v90, 0x3e0293ee, v90
    v_mfma_f32_16x16x32_bf16 v[148:151], v[28:31], v[212:215], v[148:151]
    ds_read_b64_tr_b16 v[50:51], v6 offset:17408
    v_mul_f32 v91, 0x3e0293ee, v91
    v_mul_f32 v92, 0x3e0293ee, v92
    v_mul_f32 v93, 0x3e0293ee, v93
    v_mfma_f32_16x16x32_bf16 v[156:159], v[24:27], v[216:219], 0
    ds_read_b64_tr_b16 v[52:53], v6 offset:24576
    v_mul_f32 v94, 0x3e0293ee, v94
    v_mul_f32 v95, 0x3e0293ee, v95
    v_cvt_pk_bf16_f32 v88, v88, v89
    v_mfma_f32_16x16x32_bf16 v[156:159], v[28:31], v[220:223], v[156:159]
    ds_read_b64_tr_b16 v[54:55], v6 offset:25600
    v_cvt_pk_bf16_f32 v89, v90, v91
    v_cvt_pk_bf16_f32 v90, v92, v93
    v_cvt_pk_bf16_f32 v91, v94, v95
    s_waitcnt lgkmcnt(7)
    v_mfma_f32_16x16x32_bf16 v[160:163], v[16:19], v[192:195], 0
    ds_read_b128 v[24:27], v225 offset:6144
    s_waitcnt lgkmcnt(7)
    v_mfma_f32_16x16x32_bf16 v[160:163], v[20:23], v[196:199], v[160:163]
    ds_read_b128 v[28:31], v224 offset:6144
    v_mfma_f32_16x16x32_bf16 v[168:171], v[16:19], v[200:203], 0
    ds_read_b64_tr_b16 v[56:57], v7 offset:16384
    v_mfma_f32_16x16x32_bf16 v[168:171], v[20:23], v[204:207], v[168:171]
    ds_read_b64_tr_b16 v[58:59], v7 offset:17408
    v_mfma_f32_16x16x32_bf16 v[176:179], v[16:19], v[208:211], 0
    ds_read_b64_tr_b16 v[60:61], v7 offset:24576
    v_mfma_f32_16x16x32_bf16 v[176:179], v[20:23], v[212:215], v[176:179]
    ds_read_b64_tr_b16 v[62:63], v7 offset:25600
    v_mfma_f32_16x16x32_bf16 v[184:187], v[16:19], v[216:219], 0
    s_add_u32 s41, s54, 0
    buffer_store_dwordx4 v[64:67], v8, s[20:23], s41 offen sc1
    v_mfma_f32_16x16x32_bf16 v[184:187], v[20:23], v[220:223], v[184:187]
    s_waitcnt lgkmcnt(0)
    s_waitcnt vmcnt(7)
    s_barrier
    v_mfma_f32_16x16x32_bf16 v[164:167], v[24:27], v[192:195], 0
    ds_read_b128 v[16:19], v224 offset:32768
    s_add_u32 s35, s33, 4
    s_and_b32 s35, s35, 7
    s_lshl_b32 s35, s35, 7
    s_add_u32 m0, s6, 0
    s_add_u32 s41, s44, s35
    buffer_load_dwordx4 v10, s[8:11], s41 offen lds
    v_mfma_f32_16x16x32_bf16 v[164:167], v[28:31], v[196:199], v[164:167]
    ds_read_b128 v[20:23], v225 offset:32768
    v_mfma_f32_16x16x32_bf16 v[172:175], v[24:27], v[200:203], 0
    v_mfma_f32_16x16x32_bf16 v[172:175], v[28:31], v[204:207], v[172:175]
    v_mfma_f32_16x16x32_bf16 v[180:183], v[24:27], v[208:211], 0
    v_mfma_f32_16x16x32_bf16 v[180:183], v[28:31], v[212:215], v[180:183]
    v_mfma_f32_16x16x32_bf16 v[188:191], v[24:27], v[216:219], 0
    v_mfma_f32_16x16x32_bf16 v[188:191], v[28:31], v[220:223], v[188:191]
    s_waitcnt lgkmcnt(1)
    v_mfma_f32_16x16x32_bf16 v[128:131], v[16:19], v[32:35], v[128:131]
    ds_read_b128 v[24:27], v225 offset:34816
    s_add_u32 m0, s6, 8192
    s_add_u32 s41, s45, s35
    buffer_load_dwordx4 v10, s[8:11], s41 offen lds
    v_mul_f32 v96, 0x3e0293ee, v96
    v_mul_f32 v97, 0x3e0293ee, v97
    v_mul_f32 v98, 0x3e0293ee, v98
    s_waitcnt lgkmcnt(1)
    v_mfma_f32_16x16x32_bf16 v[128:131], v[20:23], v[36:39], v[128:131]
    ds_read_b128 v[28:31], v224 offset:34816
    v_mul_f32 v99, 0x3e0293ee, v99
    v_mul_f32 v100, 0x3e0293ee, v100
    v_mul_f32 v101, 0x3e0293ee, v101
    v_mfma_f32_16x16x32_bf16 v[136:139], v[16:19], v[40:43], v[136:139]
    ds_read_b64_tr_b16 v[192:193], v4 offset:32768
    v_mul_f32 v102, 0x3e0293ee, v102
    v_mul_f32 v103, 0x3e0293ee, v103
    v_cvt_pk_bf16_f32 v96, v96, v97
    v_mfma_f32_16x16x32_bf16 v[136:139], v[20:23], v[44:47], v[136:139]
    ds_read_b64_tr_b16 v[194:195], v4 offset:33792
    v_cvt_pk_bf16_f32 v97, v98, v99
    v_cvt_pk_bf16_f32 v98, v100, v101
    v_cvt_pk_bf16_f32 v99, v102, v103
    v_mfma_f32_16x16x32_bf16 v[144:147], v[16:19], v[48:51], v[144:147]
    ds_read_b64_tr_b16 v[196:197], v4 offset:40960
    s_add_u32 m0, s6, 16384
    s_add_u32 s41, s46, s35
    buffer_load_dwordx4 v10, s[8:11], s41 offen lds
    v_mul_f32 v104, 0x3e0293ee, v104
    v_mul_f32 v105, 0x3e0293ee, v105
    v_mul_f32 v106, 0x3e0293ee, v106
    v_mfma_f32_16x16x32_bf16 v[144:147], v[20:23], v[52:55], v[144:147]
    ds_read_b64_tr_b16 v[198:199], v4 offset:41984
    v_mul_f32 v107, 0x3e0293ee, v107
    v_mul_f32 v108, 0x3e0293ee, v108
    v_mul_f32 v109, 0x3e0293ee, v109
    v_mfma_f32_16x16x32_bf16 v[152:155], v[16:19], v[56:59], v[152:155]
    ds_read_b64_tr_b16 v[200:201], v5 offset:32768
    v_mul_f32 v110, 0x3e0293ee, v110
    v_mul_f32 v111, 0x3e0293ee, v111
    v_cvt_pk_bf16_f32 v104, v104, v105
    v_mfma_f32_16x16x32_bf16 v[152:155], v[20:23], v[60:63], v[152:155]
    ds_read_b64_tr_b16 v[202:203], v5 offset:33792
    v_cvt_pk_bf16_f32 v105, v106, v107
    v_cvt_pk_bf16_f32 v106, v108, v109
    v_cvt_pk_bf16_f32 v107, v110, v111
    s_waitcnt lgkmcnt(7)
    v_mfma_f32_16x16x32_bf16 v[132:135], v[24:27], v[32:35], v[132:135]
    ds_read_b128 v[16:19], v224 offset:36864
    s_add_u32 m0, s6, 24576
    s_add_u32 s41, s47, s35
    buffer_load_dwordx4 v10, s[8:11], s41 offen lds
    v_mul_f32 v112, 0x3e0293ee, v112
    v_mul_f32 v113, 0x3e0293ee, v113
    v_mul_f32 v114, 0x3e0293ee, v114
    s_waitcnt lgkmcnt(7)
    v_mfma_f32_16x16x32_bf16 v[132:135], v[28:31], v[36:39], v[132:135]
    ds_read_b128 v[20:23], v225 offset:36864
    v_mul_f32 v115, 0x3e0293ee, v115
    v_mul_f32 v116, 0x3e0293ee, v116
    v_mul_f32 v117, 0x3e0293ee, v117
    v_mfma_f32_16x16x32_bf16 v[140:143], v[24:27], v[40:43], v[140:143]
    ds_read_b64_tr_b16 v[204:205], v5 offset:40960
    v_mul_f32 v118, 0x3e0293ee, v118
    v_mul_f32 v119, 0x3e0293ee, v119
    v_cvt_pk_bf16_f32 v112, v112, v113
    v_mfma_f32_16x16x32_bf16 v[140:143], v[28:31], v[44:47], v[140:143]
    ds_read_b64_tr_b16 v[206:207], v5 offset:41984
    v_cvt_pk_bf16_f32 v113, v114, v115
    v_cvt_pk_bf16_f32 v114, v116, v117
    v_cvt_pk_bf16_f32 v115, v118, v119
    v_mfma_f32_16x16x32_bf16 v[148:151], v[24:27], v[48:51], v[148:151]
    ds_read_b64_tr_b16 v[208:209], v6 offset:32768
    s_add_u32 s34, s33, 2
    s_and_b32 s34, s34, 7
    s_lshl_b32 s34, s34, 19
    s_add_u32 m0, s6, 81920
    s_add_u32 s41, s34, 0
    buffer_load_dwordx4 v11, s[16:19], s41 offen lds
    v_mul_f32 v120, 0x3e0293ee, v120
    v_mul_f32 v121, 0x3e0293ee, v121
    v_mul_f32 v122, 0x3e0293ee, v122
    v_mfma_f32_16x16x32_bf16 v[148:151], v[28:31], v[52:55], v[148:151]
    ds_read_b64_tr_b16 v[210:211], v6 offset:33792
    v_mul_f32 v123, 0x3e0293ee, v123
    v_mul_f32 v124, 0x3e0293ee, v124
    v_mul_f32 v125, 0x3e0293ee, v125
    v_mfma_f32_16x16x32_bf16 v[156:159], v[24:27], v[56:59], v[156:159]
    ds_read_b64_tr_b16 v[212:213], v6 offset:40960
    v_mul_f32 v126, 0x3e0293ee, v126
    v_mul_f32 v127, 0x3e0293ee, v127
    v_cvt_pk_bf16_f32 v120, v120, v121
    v_mfma_f32_16x16x32_bf16 v[156:159], v[28:31], v[60:63], v[156:159]
    ds_read_b64_tr_b16 v[214:215], v6 offset:41984
    v_cvt_pk_bf16_f32 v121, v122, v123
    v_cvt_pk_bf16_f32 v122, v124, v125
    v_cvt_pk_bf16_f32 v123, v126, v127
    s_waitcnt lgkmcnt(7)
    v_mfma_f32_16x16x32_bf16 v[160:163], v[16:19], v[32:35], v[160:163]
    ds_read_b128 v[24:27], v225 offset:38912
    s_add_u32 m0, s6, 90112
    s_add_u32 s41, s34, 262144
    buffer_load_dwordx4 v11, s[16:19], s41 offen lds
    s_waitcnt lgkmcnt(7)
    v_mfma_f32_16x16x32_bf16 v[160:163], v[20:23], v[36:39], v[160:163]
    ds_read_b128 v[28:31], v224 offset:38912
    v_mfma_f32_16x16x32_bf16 v[168:171], v[16:19], v[40:43], v[168:171]
    ds_read_b64_tr_b16 v[216:217], v7 offset:32768
    v_mfma_f32_16x16x32_bf16 v[168:171], v[20:23], v[44:47], v[168:171]
    ds_read_b64_tr_b16 v[218:219], v7 offset:33792
    v_mfma_f32_16x16x32_bf16 v[176:179], v[16:19], v[48:51], v[176:179]
    ds_read_b64_tr_b16 v[220:221], v7 offset:40960
    v_mfma_f32_16x16x32_bf16 v[176:179], v[20:23], v[52:55], v[176:179]
    ds_read_b64_tr_b16 v[222:223], v7 offset:41984
    v_mfma_f32_16x16x32_bf16 v[184:187], v[16:19], v[56:59], v[184:187]
    s_add_u32 s41, s54, 256
    buffer_store_dwordx4 v[72:75], v8, s[20:23], s41 offen sc1
    v_mfma_f32_16x16x32_bf16 v[184:187], v[20:23], v[60:63], v[184:187]
    s_waitcnt lgkmcnt(0)
    s_waitcnt vmcnt(11)
    s_barrier
    v_mfma_f32_16x16x32_bf16 v[164:167], v[24:27], v[32:35], v[164:167]
    ds_read_b128 v[16:19], v226 offset:0
    s_add_u32 s35, s33, 3
    s_and_b32 s35, s35, 7
    s_lshl_b32 s35, s35, 7
    s_add_u32 m0, s6, 32768
    s_add_u32 s41, s44, s35
    buffer_load_dwordx4 v10, s[8:11], s41 offen lds
    v_mfma_f32_16x16x32_bf16 v[164:167], v[28:31], v[36:39], v[164:167]
    ds_read_b128 v[20:23], v227 offset:0
    v_mfma_f32_16x16x32_bf16 v[172:175], v[24:27], v[40:43], v[172:175]
    v_mfma_f32_16x16x32_bf16 v[172:175], v[28:31], v[44:47], v[172:175]
    v_mfma_f32_16x16x32_bf16 v[180:183], v[24:27], v[48:51], v[180:183]
    v_mfma_f32_16x16x32_bf16 v[180:183], v[28:31], v[52:55], v[180:183]
    v_mfma_f32_16x16x32_bf16 v[188:191], v[24:27], v[56:59], v[188:191]
    v_mfma_f32_16x16x32_bf16 v[188:191], v[28:31], v[60:63], v[188:191]
    s_waitcnt lgkmcnt(1)
    v_mfma_f32_16x16x32_bf16 v[128:131], v[16:19], v[192:195], v[128:131]
    ds_read_b128 v[24:27], v227 offset:2048
    s_add_u32 m0, s6, 40960
    s_add_u32 s41, s45, s35
    buffer_load_dwordx4 v10, s[8:11], s41 offen lds
    s_waitcnt lgkmcnt(1)
    v_mfma_f32_16x16x32_bf16 v[128:131], v[20:23], v[196:199], v[128:131]
    ds_read_b128 v[28:31], v226 offset:2048
    v_mfma_f32_16x16x32_bf16 v[136:139], v[16:19], v[200:203], v[136:139]
    ds_read_b64_tr_b16 v[32:33], v4 offset:49152
    v_mfma_f32_16x16x32_bf16 v[136:139], v[20:23], v[204:207], v[136:139]
    ds_read_b64_tr_b16 v[34:35], v4 offset:50176
    v_mfma_f32_16x16x32_bf16 v[144:147], v[16:19], v[208:211], v[144:147]
    ds_read_b64_tr_b16 v[36:37], v4 offset:57344
    s_add_u32 m0, s6, 49152
    s_add_u32 s41, s46, s35
    buffer_load_dwordx4 v10, s[8:11], s41 offen lds
    v_mfma_f32_16x16x32_bf16 v[144:147], v[20:23], v[212:215], v[144:147]
    ds_read_b64_tr_b16 v[38:39], v4 offset:58368
    v_mfma_f32_16x16x32_bf16 v[152:155], v[16:19], v[216:219], v[152:155]
    ds_read_b64_tr_b16 v[40:41], v5 offset:49152
    v_mfma_f32_16x16x32_bf16 v[152:155], v[20:23], v[220:223], v[152:155]
    ds_read_b64_tr_b16 v[42:43], v5 offset:50176
    s_cmp_eq_u32 s3, 0
    s_cselect_b32 s99, 0, 1073741824
    v_lshl_add_u32 v13, v0, 2, s99
    buffer_load_dword v14, v13, s[60:63], 0 offen sc1
    s_waitcnt lgkmcnt(7)
    v_mfma_f32_16x16x32_bf16 v[132:135], v[24:27], v[192:195], v[132:135]
    ds_read_b128 v[16:19], v226 offset:4096
    s_add_u32 m0, s6, 57344
    s_add_u32 s41, s47, s35
    buffer_load_dwordx4 v10, s[8:11], s41 offen lds
    s_waitcnt lgkmcnt(7)
    v_mfma_f32_16x16x32_bf16 v[132:135], v[28:31], v[196:199], v[132:135]
    ds_read_b128 v[20:23], v227 offset:4096
    v_mfma_f32_16x16x32_bf16 v[140:143], v[24:27], v[200:203], v[140:143]
    ds_read_b64_tr_b16 v[44:45], v5 offset:57344
    v_mfma_f32_16x16x32_bf16 v[140:143], v[28:31], v[204:207], v[140:143]
    ds_read_b64_tr_b16 v[46:47], v5 offset:58368
    v_mfma_f32_16x16x32_bf16 v[148:151], v[24:27], v[208:211], v[148:151]
    ds_read_b64_tr_b16 v[48:49], v6 offset:49152
    s_add_u32 s34, s33, 1
    s_and_b32 s34, s34, 7
    s_lshl_b32 s34, s34, 19
    s_add_u32 m0, s6, 98304
    s_add_u32 s41, s34, 0
    buffer_load_dwordx4 v11, s[16:19], s41 offen lds
    v_mfma_f32_16x16x32_bf16 v[148:151], v[28:31], v[212:215], v[148:151]
    ds_read_b64_tr_b16 v[50:51], v6 offset:50176
    v_mfma_f32_16x16x32_bf16 v[156:159], v[24:27], v[216:219], v[156:159]
    ds_read_b64_tr_b16 v[52:53], v6 offset:57344
    v_mfma_f32_16x16x32_bf16 v[156:159], v[28:31], v[220:223], v[156:159]
    ds_read_b64_tr_b16 v[54:55], v6 offset:58368
    s_waitcnt lgkmcnt(7)
    v_mfma_f32_16x16x32_bf16 v[160:163], v[16:19], v[192:195], v[160:163]
    ds_read_b128 v[24:27], v227 offset:6144
    s_add_u32 m0, s6, 106496
    s_add_u32 s41, s34, 262144
    buffer_load_dwordx4 v11, s[16:19], s41 offen lds
    s_waitcnt lgkmcnt(7)
    v_mfma_f32_16x16x32_bf16 v[160:163], v[20:23], v[196:199], v[160:163]
    ds_read_b128 v[28:31], v226 offset:6144
    v_mfma_f32_16x16x32_bf16 v[168:171], v[16:19], v[200:203], v[168:171]
    ds_read_b64_tr_b16 v[56:57], v7 offset:49152
    v_mfma_f32_16x16x32_bf16 v[168:171], v[20:23], v[204:207], v[168:171]
    ds_read_b64_tr_b16 v[58:59], v7 offset:50176
    v_mfma_f32_16x16x32_bf16 v[176:179], v[16:19], v[208:211], v[176:179]
    ds_read_b64_tr_b16 v[60:61], v7 offset:57344
    v_mfma_f32_16x16x32_bf16 v[176:179], v[20:23], v[212:215], v[176:179]
    ds_read_b64_tr_b16 v[62:63], v7 offset:58368
    v_mfma_f32_16x16x32_bf16 v[184:187], v[16:19], v[216:219], v[184:187]
    s_add_u32 s41, s54, 1024
    buffer_store_dwordx4 v[80:83], v8, s[20:23], s41 offen sc1
    v_mfma_f32_16x16x32_bf16 v[184:187], v[20:23], v[220:223], v[184:187]
    s_waitcnt lgkmcnt(0)
    s_waitcnt vmcnt(11)
    s_barrier
    v_mfma_f32_16x16x32_bf16 v[164:167], v[24:27], v[192:195], v[164:167]
    ds_read_b128 v[16:19], v224 offset:0
    s_add_u32 s35, s33, 2
    s_and_b32 s35, s35, 7
    s_lshl_b32 s35, s35, 7
    s_add_u32 m0, s6, 131072
    s_add_u32 s41, s44, s35
    buffer_load_dwordx4 v10, s[8:11], s41 offen lds
    v_mfma_f32_16x16x32_bf16 v[164:167], v[28:31], v[196:199], v[164:167]
    ds_read_b128 v[20:23], v225 offset:0
    v_mfma_f32_16x16x32_bf16 v[172:175], v[24:27], v[200:203], v[172:175]
    v_mfma_f32_16x16x32_bf16 v[172:175], v[28:31], v[204:207], v[172:175]
    v_mfma_f32_16x16x32_bf16 v[180:183], v[24:27], v[208:211], v[180:183]
    v_mfma_f32_16x16x32_bf16 v[180:183], v[28:31], v[212:215], v[180:183]
    v_mfma_f32_16x16x32_bf16 v[188:191], v[24:27], v[216:219], v[188:191]
    v_mfma_f32_16x16x32_bf16 v[188:191], v[28:31], v[220:223], v[188:191]
    s_waitcnt lgkmcnt(1)
    v_mfma_f32_16x16x32_bf16 v[128:131], v[16:19], v[32:35], v[128:131]
    ds_read_b128 v[24:27], v225 offset:2048
    s_add_u32 m0, s6, 139264
    s_add_u32 s41, s45, s35
    buffer_load_dwordx4 v10, s[8:11], s41 offen lds
    s_waitcnt lgkmcnt(1)
    v_mfma_f32_16x16x32_bf16 v[128:131], v[20:23], v[36:39], v[128:131]
    ds_read_b128 v[28:31], v224 offset:2048
    v_mfma_f32_16x16x32_bf16 v[136:139], v[16:19], v[40:43], v[136:139]
    ds_read_b64_tr_b16 v[192:193], v4 offset:0
    v_mfma_f32_16x16x32_bf16 v[136:139], v[20:23], v[44:47], v[136:139]
    ds_read_b64_tr_b16 v[194:195], v4 offset:1024
    v_mfma_f32_16x16x32_bf16 v[144:147], v[16:19], v[48:51], v[144:147]
    ds_read_b64_tr_b16 v[196:197], v4 offset:8192
    s_add_u32 m0, s6, 147456
    s_add_u32 s41, s46, s35
    buffer_load_dwordx4 v10, s[8:11], s41 offen lds
    v_mfma_f32_16x16x32_bf16 v[144:147], v[20:23], v[52:55], v[144:147]
    ds_read_b64_tr_b16 v[198:199], v4 offset:9216
    v_mfma_f32_16x16x32_bf16 v[152:155], v[16:19], v[56:59], v[152:155]
    ds_read_b64_tr_b16 v[200:201], v5 offset:0
    v_mfma_f32_16x16x32_bf16 v[152:155], v[20:23], v[60:63], v[152:155]
    ds_read_b64_tr_b16 v[202:203], v5 offset:1024
    s_waitcnt lgkmcnt(7)
    v_mfma_f32_16x16x32_bf16 v[132:135], v[24:27], v[32:35], v[132:135]
    ds_read_b128 v[16:19], v224 offset:4096
    s_add_u32 m0, s6, 155648
    s_add_u32 s41, s47, s35
    buffer_load_dwordx4 v10, s[8:11], s41 offen lds
    s_waitcnt lgkmcnt(7)
    v_mfma_f32_16x16x32_bf16 v[132:135], v[28:31], v[36:39], v[132:135]
    ds_read_b128 v[20:23], v225 offset:4096
    v_mfma_f32_16x16x32_bf16 v[140:143], v[24:27], v[40:43], v[140:143]
    ds_read_b64_tr_b16 v[204:205], v5 offset:8192
    v_mfma_f32_16x16x32_bf16 v[140:143], v[28:31], v[44:47], v[140:143]
    ds_read_b64_tr_b16 v[206:207], v5 offset:9216
    v_mfma_f32_16x16x32_bf16 v[148:151], v[24:27], v[48:51], v[148:151]
    ds_read_b64_tr_b16 v[208:209], v6 offset:0
    s_add_u32 s34, s33, 0
    s_and_b32 s34, s34, 7
    s_lshl_b32 s34, s34, 19
    s_add_u32 m0, s6, 114688
    s_add_u32 s41, s34, 0
    buffer_load_dwordx4 v11, s[16:19], s41 offen lds
    v_mfma_f32_16x16x32_bf16 v[148:151], v[28:31], v[52:55], v[148:151]
    ds_read_b64_tr_b16 v[210:211], v6 offset:1024
    v_mfma_f32_16x16x32_bf16 v[156:159], v[24:27], v[56:59], v[156:159]
    ds_read_b64_tr_b16 v[212:213], v6 offset:8192
    v_mfma_f32_16x16x32_bf16 v[156:159], v[28:31], v[60:63], v[156:159]
    ds_read_b64_tr_b16 v[214:215], v6 offset:9216
    s_waitcnt lgkmcnt(7)
    v_mfma_f32_16x16x32_bf16 v[160:163], v[16:19], v[32:35], v[160:163]
    ds_read_b128 v[24:27], v225 offset:6144
    s_add_u32 m0, s6, 122880
    s_add_u32 s41, s34, 262144
    buffer_load_dwordx4 v11, s[16:19], s41 offen lds
    s_waitcnt lgkmcnt(7)
    v_mfma_f32_16x16x32_bf16 v[160:163], v[20:23], v[36:39], v[160:163]
    ds_read_b128 v[28:31], v224 offset:6144
    v_mfma_f32_16x16x32_bf16 v[168:171], v[16:19], v[40:43], v[168:171]
    ds_read_b64_tr_b16 v[216:217], v7 offset:0
    v_mfma_f32_16x16x32_bf16 v[168:171], v[20:23], v[44:47], v[168:171]
    ds_read_b64_tr_b16 v[218:219], v7 offset:1024
    v_mfma_f32_16x16x32_bf16 v[176:179], v[16:19], v[48:51], v[176:179]
    ds_read_b64_tr_b16 v[220:221], v7 offset:8192
    v_mfma_f32_16x16x32_bf16 v[176:179], v[20:23], v[52:55], v[176:179]
    ds_read_b64_tr_b16 v[222:223], v7 offset:9216
    v_mfma_f32_16x16x32_bf16 v[184:187], v[16:19], v[56:59], v[184:187]
    s_add_u32 s41, s54, 1280
    buffer_store_dwordx4 v[88:91], v8, s[20:23], s41 offen sc1
    v_mfma_f32_16x16x32_bf16 v[184:187], v[20:23], v[60:63], v[184:187]
    s_waitcnt lgkmcnt(0)
    s_waitcnt vmcnt(10)
    s_barrier
    v_mfma_f32_16x16x32_bf16 v[164:167], v[24:27], v[32:35], v[164:167]
    ds_read_b128 v[16:19], v224 offset:32768
    s_add_u32 s35, s33, 1
    s_and_b32 s35, s35, 7
    s_lshl_b32 s35, s35, 7
    s_add_u32 m0, s6, 0
    s_add_u32 s41, s44, s35
    buffer_load_dwordx4 v10, s[8:11], s41 offen lds
    v_mfma_f32_16x16x32_bf16 v[164:167], v[28:31], v[36:39], v[164:167]
    ds_read_b128 v[20:23], v225 offset:32768
    v_mfma_f32_16x16x32_bf16 v[172:175], v[24:27], v[40:43], v[172:175]
    v_mfma_f32_16x16x32_bf16 v[172:175], v[28:31], v[44:47], v[172:175]
    v_mfma_f32_16x16x32_bf16 v[180:183], v[24:27], v[48:51], v[180:183]
    v_mfma_f32_16x16x32_bf16 v[180:183], v[28:31], v[52:55], v[180:183]
    v_mfma_f32_16x16x32_bf16 v[188:191], v[24:27], v[56:59], v[188:191]
    v_mfma_f32_16x16x32_bf16 v[188:191], v[28:31], v[60:63], v[188:191]
    s_waitcnt lgkmcnt(1)
    v_mfma_f32_16x16x32_bf16 v[128:131], v[16:19], v[192:195], v[128:131]
    ds_read_b128 v[24:27], v225 offset:34816
    s_add_u32 m0, s6, 8192
    s_add_u32 s41, s45, s35
    buffer_load_dwordx4 v10, s[8:11], s41 offen lds
    s_waitcnt lgkmcnt(1)
    v_mfma_f32_16x16x32_bf16 v[128:131], v[20:23], v[196:199], v[128:131]
    ds_read_b128 v[28:31], v224 offset:34816
    v_mfma_f32_16x16x32_bf16 v[136:139], v[16:19], v[200:203], v[136:139]
    ds_read_b64_tr_b16 v[32:33], v4 offset:16384
    v_mfma_f32_16x16x32_bf16 v[136:139], v[20:23], v[204:207], v[136:139]
    ds_read_b64_tr_b16 v[34:35], v4 offset:17408
    v_mfma_f32_16x16x32_bf16 v[144:147], v[16:19], v[208:211], v[144:147]
    ds_read_b64_tr_b16 v[36:37], v4 offset:24576
    s_add_u32 m0, s6, 16384
    s_add_u32 s41, s46, s35
    buffer_load_dwordx4 v10, s[8:11], s41 offen lds
    v_mfma_f32_16x16x32_bf16 v[144:147], v[20:23], v[212:215], v[144:147]
    ds_read_b64_tr_b16 v[38:39], v4 offset:25600
    v_mfma_f32_16x16x32_bf16 v[152:155], v[16:19], v[216:219], v[152:155]
    ds_read_b64_tr_b16 v[40:41], v5 offset:16384
    v_mfma_f32_16x16x32_bf16 v[152:155], v[20:23], v[220:223], v[152:155]
    ds_read_b64_tr_b16 v[42:43], v5 offset:17408
    s_waitcnt lgkmcnt(7)
    v_mfma_f32_16x16x32_bf16 v[132:135], v[24:27], v[192:195], v[132:135]
    ds_read_b128 v[16:19], v224 offset:36864
    s_add_u32 m0, s6, 24576
    s_add_u32 s41, s47, s35
    buffer_load_dwordx4 v10, s[8:11], s41 offen lds
    s_waitcnt lgkmcnt(7)
    v_mfma_f32_16x16x32_bf16 v[132:135], v[28:31], v[196:199], v[132:135]
    ds_read_b128 v[20:23], v225 offset:36864
    v_mfma_f32_16x16x32_bf16 v[140:143], v[24:27], v[200:203], v[140:143]
    ds_read_b64_tr_b16 v[44:45], v5 offset:24576
    v_mfma_f32_16x16x32_bf16 v[140:143], v[28:31], v[204:207], v[140:143]
    ds_read_b64_tr_b16 v[46:47], v5 offset:25600
    v_mfma_f32_16x16x32_bf16 v[148:151], v[24:27], v[208:211], v[148:151]
    ds_read_b64_tr_b16 v[48:49], v6 offset:16384
    s_add_u32 s34, s32, 0
    s_and_b32 s34, s34, 7
    s_lshl_b32 s34, s34, 19
    s_add_u32 m0, s6, 65536
    s_add_u32 s41, s34, 0
    buffer_load_dwordx4 v11, s[28:31], s41 offen lds
    v_mfma_f32_16x16x32_bf16 v[148:151], v[28:31], v[212:215], v[148:151]
    ds_read_b64_tr_b16 v[50:51], v6 offset:17408
    v_mfma_f32_16x16x32_bf16 v[156:159], v[24:27], v[216:219], v[156:159]
    ds_read_b64_tr_b16 v[52:53], v6 offset:24576
    v_mfma_f32_16x16x32_bf16 v[156:159], v[28:31], v[220:223], v[156:159]
    ds_read_b64_tr_b16 v[54:55], v6 offset:25600
    s_waitcnt lgkmcnt(7)
    v_mfma_f32_16x16x32_bf16 v[160:163], v[16:19], v[192:195], v[160:163]
    ds_read_b128 v[24:27], v225 offset:38912
    s_add_u32 m0, s6, 73728
    s_add_u32 s41, s34, 262144
    buffer_load_dwordx4 v11, s[28:31], s41 offen lds
    s_waitcnt lgkmcnt(7)
    v_mfma_f32_16x16x32_bf16 v[160:163], v[20:23], v[196:199], v[160:163]
    ds_read_b128 v[28:31], v224 offset:38912
    v_mfma_f32_16x16x32_bf16 v[168:171], v[16:19], v[200:203], v[168:171]
    ds_read_b64_tr_b16 v[56:57], v7 offset:16384
    v_mfma_f32_16x16x32_bf16 v[168:171], v[20:23], v[204:207], v[168:171]
    ds_read_b64_tr_b16 v[58:59], v7 offset:17408
    v_mfma_f32_16x16x32_bf16 v[176:179], v[16:19], v[208:211], v[176:179]
    ds_read_b64_tr_b16 v[60:61], v7 offset:24576
    v_mfma_f32_16x16x32_bf16 v[176:179], v[20:23], v[212:215], v[176:179]
    ds_read_b64_tr_b16 v[62:63], v7 offset:25600
    v_mfma_f32_16x16x32_bf16 v[184:187], v[16:19], v[216:219], v[184:187]
    s_add_u32 s41, s54, 8192
    buffer_store_dwordx4 v[96:99], v8, s[20:23], s41 offen sc1
    v_mfma_f32_16x16x32_bf16 v[184:187], v[20:23], v[220:223], v[184:187]
    s_cmp_lg_u32 s3, 0
    s_cbranch_scc1 NP_2
    s_mov_b32 s98, 16843009
    s_mov_b32 s99, 20000
POLL_4:
    v_and_b32 v14, s98, v14
    v_cmp_ne_u32 vcc, s98, v14
    s_cbranch_vccz PCK_3
    s_sleep 2
    buffer_load_dword v14, v13, s[60:63], 0 offen sc1
    s_sub_u32 s99, s99, 1
    s_cmp_lg_u32 s99, 0
    s_waitcnt vmcnt(0)
    s_cbranch_scc1 POLL_4
PCK_3:
NP_2:
    s_waitcnt lgkmcnt(0)
    s_waitcnt vmcnt(10)
    s_barrier
    v_mfma_f32_16x16x32_bf16 v[164:167], v[24:27], v[192:195], v[164:167]
    ds_read_b128 v[16:19], v226 offset:0
    s_add_u32 s35, s33, 0
    s_and_b32 s35, s35, 7
    s_lshl_b32 s35, s35, 7
    s_add_u32 m0, s6, 32768
    s_add_u32 s41, s44, s35
    buffer_load_dwordx4 v10, s[8:11], s41 offen lds
    v_mfma_f32_16x16x32_bf16 v[164:167], v[28:31], v[196:199], v[164:167]
    ds_read_b128 v[20:23], v227 offset:0
    v_mfma_f32_16x16x32_bf16 v[172:175], v[24:27], v[200:203], v[172:175]
    v_mfma_f32_16x16x32_bf16 v[172:175], v[28:31], v[204:207], v[172:175]
    v_mfma_f32_16x16x32_bf16 v[180:183], v[24:27], v[208:211], v[180:183]
    v_mfma_f32_16x16x32_bf16 v[180:183], v[28:31], v[212:215], v[180:183]
    v_mfma_f32_16x16x32_bf16 v[188:191], v[24:27], v[216:219], v[188:191]
    v_mfma_f32_16x16x32_bf16 v[188:191], v[28:31], v[220:223], v[188:191]
    s_waitcnt lgkmcnt(1)
    v_mfma_f32_16x16x32_bf16 v[128:131], v[16:19], v[32:35], v[128:131]
    ds_read_b128 v[24:27], v227 offset:2048
    s_add_u32 m0, s6, 40960
    s_add_u32 s41, s45, s35
    buffer_load_dwordx4 v10, s[8:11], s41 offen lds
    s_waitcnt lgkmcnt(1)
    v_mfma_f32_16x16x32_bf16 v[128:131], v[20:23], v[36:39], v[128:131]
    ds_read_b128 v[28:31], v226 offset:2048
    v_mfma_f32_16x16x32_bf16 v[136:139], v[16:19], v[40:43], v[136:139]
    ds_read_b64_tr_b16 v[192:193], v4 offset:32768
    v_mfma_f32_16x16x32_bf16 v[136:139], v[20:23], v[44:47], v[136:139]
    ds_read_b64_tr_b16 v[194:195], v4 offset:33792
    v_mfma_f32_16x16x32_bf16 v[144:147], v[16:19], v[48:51], v[144:147]
    ds_read_b64_tr_b16 v[196:197], v4 offset:40960
    s_add_u32 m0, s6, 49152
    s_add_u32 s41, s46, s35
    buffer_load_dwordx4 v10, s[8:11], s41 offen lds
    v_mfma_f32_16x16x32_bf16 v[144:147], v[20:23], v[52:55], v[144:147]
    ds_read_b64_tr_b16 v[198:199], v4 offset:41984
    v_mfma_f32_16x16x32_bf16 v[152:155], v[16:19], v[56:59], v[152:155]
    ds_read_b64_tr_b16 v[200:201], v5 offset:32768
    v_mfma_f32_16x16x32_bf16 v[152:155], v[20:23], v[60:63], v[152:155]
    ds_read_b64_tr_b16 v[202:203], v5 offset:33792
    s_waitcnt lgkmcnt(7)
    v_mfma_f32_16x16x32_bf16 v[132:135], v[24:27], v[32:35], v[132:135]
    ds_read_b128 v[16:19], v226 offset:4096
    s_add_u32 m0, s6, 57344
    s_add_u32 s41, s47, s35
    buffer_load_dwordx4 v10, s[8:11], s41 offen lds
    s_waitcnt lgkmcnt(7)
    v_mfma_f32_16x16x32_bf16 v[132:135], v[28:31], v[36:39], v[132:135]
    ds_read_b128 v[20:23], v227 offset:4096
    v_mfma_f32_16x16x32_bf16 v[140:143], v[24:27], v[40:43], v[140:143]
    ds_read_b64_tr_b16 v[204:205], v5 offset:40960
    v_mfma_f32_16x16x32_bf16 v[140:143], v[28:31], v[44:47], v[140:143]
    ds_read_b64_tr_b16 v[206:207], v5 offset:41984
    v_mfma_f32_16x16x32_bf16 v[148:151], v[24:27], v[48:51], v[148:151]
    ds_read_b64_tr_b16 v[208:209], v6 offset:32768
    s_add_u32 s34, s32, 1
    s_and_b32 s34, s34, 7
    s_lshl_b32 s34, s34, 19
    s_add_u32 m0, s6, 81920
    s_add_u32 s41, s34, 0
    buffer_load_dwordx4 v11, s[28:31], s41 offen lds
    v_mfma_f32_16x16x32_bf16 v[148:151], v[28:31], v[52:55], v[148:151]
    ds_read_b64_tr_b16 v[210:211], v6 offset:33792
    v_mfma_f32_16x16x32_bf16 v[156:159], v[24:27], v[56:59], v[156:159]
    ds_read_b64_tr_b16 v[212:213], v6 offset:40960
    v_mfma_f32_16x16x32_bf16 v[156:159], v[28:31], v[60:63], v[156:159]
    ds_read_b64_tr_b16 v[214:215], v6 offset:41984
    s_waitcnt lgkmcnt(7)
    v_mfma_f32_16x16x32_bf16 v[160:163], v[16:19], v[32:35], v[160:163]
    ds_read_b128 v[24:27], v227 offset:6144
    s_add_u32 m0, s6, 90112
    s_add_u32 s41, s34, 262144
    buffer_load_dwordx4 v11, s[28:31], s41 offen lds
    s_waitcnt lgkmcnt(7)
    v_mfma_f32_16x16x32_bf16 v[160:163], v[20:23], v[36:39], v[160:163]
    ds_read_b128 v[28:31], v226 offset:6144
    v_mfma_f32_16x16x32_bf16 v[168:171], v[16:19], v[40:43], v[168:171]
    ds_read_b64_tr_b16 v[216:217], v7 offset:32768
    v_mfma_f32_16x16x32_bf16 v[168:171], v[20:23], v[44:47], v[168:171]
    ds_read_b64_tr_b16 v[218:219], v7 offset:33792
    v_mfma_f32_16x16x32_bf16 v[176:179], v[16:19], v[48:51], v[176:179]
    ds_read_b64_tr_b16 v[220:221], v7 offset:40960
    v_mfma_f32_16x16x32_bf16 v[176:179], v[20:23], v[52:55], v[176:179]
    ds_read_b64_tr_b16 v[222:223], v7 offset:41984
    v_mfma_f32_16x16x32_bf16 v[184:187], v[16:19], v[56:59], v[184:187]
    s_add_u32 s41, s54, 8448
    buffer_store_dwordx4 v[104:107], v8, s[20:23], s41 offen sc1
    v_mfma_f32_16x16x32_bf16 v[184:187], v[20:23], v[60:63], v[184:187]
    s_waitcnt lgkmcnt(0)
    s_waitcnt vmcnt(10)
    s_barrier
    v_mfma_f32_16x16x32_bf16 v[164:167], v[24:27], v[32:35], v[164:167]
    ds_read_b128 v[16:19], v224 offset:0
    s_add_u32 s35, s32, 0
    s_and_b32 s35, s35, 7
    s_lshl_b32 s35, s35, 7
    s_add_u32 m0, s6, 131072
    s_add_u32 s41, s48, s35
    buffer_load_dwordx4 v10, s[24:27], s41 offen lds
    v_mfma_f32_16x16x32_bf16 v[164:167], v[28:31], v[36:39], v[164:167]
    ds_read_b128 v[20:23], v225 offset:0
    v_mfma_f32_16x16x32_bf16 v[172:175], v[24:27], v[40:43], v[172:175]
    v_mfma_f32_16x16x32_bf16 v[172:175], v[28:31], v[44:47], v[172:175]
    v_mfma_f32_16x16x32_bf16 v[180:183], v[24:27], v[48:51], v[180:183]
    v_mfma_f32_16x16x32_bf16 v[180:183], v[28:31], v[52:55], v[180:183]
    v_mfma_f32_16x16x32_bf16 v[188:191], v[24:27], v[56:59], v[188:191]
    v_mfma_f32_16x16x32_bf16 v[188:191], v[28:31], v[60:63], v[188:191]
    s_waitcnt lgkmcnt(1)
    v_mfma_f32_16x16x32_bf16 v[128:131], v[16:19], v[192:195], v[128:131]
    ds_read_b128 v[24:27], v225 offset:2048
    s_add_u32 m0, s6, 139264
    s_add_u32 s41, s49, s35
    buffer_load_dwordx4 v10, s[24:27], s41 offen lds
    s_waitcnt lgkmcnt(1)
    v_mfma_f32_16x16x32_bf16 v[128:131], v[20:23], v[196:199], v[128:131]
    ds_read_b128 v[28:31], v224 offset:2048
    v_mfma_f32_16x16x32_bf16 v[136:139], v[16:19], v[200:203], v[136:139]
    ds_read_b64_tr_b16 v[32:33], v4 offset:49152
    v_mfma_f32_16x16x32_bf16 v[136:139], v[20:23], v[204:207], v[136:139]
    ds_read_b64_tr_b16 v[34:35], v4 offset:50176
    v_mfma_f32_16x16x32_bf16 v[144:147], v[16:19], v[208:211], v[144:147]
    ds_read_b64_tr_b16 v[36:37], v4 offset:57344
    s_add_u32 m0, s6, 147456
    s_add_u32 s41, s50, s35
    buffer_load_dwordx4 v10, s[24:27], s41 offen lds
    v_mfma_f32_16x16x32_bf16 v[144:147], v[20:23], v[212:215], v[144:147]
    ds_read_b64_tr_b16 v[38:39], v4 offset:58368
    v_mfma_f32_16x16x32_bf16 v[152:155], v[16:19], v[216:219], v[152:155]
    ds_read_b64_tr_b16 v[40:41], v5 offset:49152
    v_mfma_f32_16x16x32_bf16 v[152:155], v[20:23], v[220:223], v[152:155]
    ds_read_b64_tr_b16 v[42:43], v5 offset:50176
    s_waitcnt lgkmcnt(7)
    v_mfma_f32_16x16x32_bf16 v[132:135], v[24:27], v[192:195], v[132:135]
    ds_read_b128 v[16:19], v224 offset:4096
    s_add_u32 m0, s6, 155648
    s_add_u32 s41, s51, s35
    buffer_load_dwordx4 v10, s[24:27], s41 offen lds
    s_waitcnt lgkmcnt(7)
    v_mfma_f32_16x16x32_bf16 v[132:135], v[28:31], v[196:199], v[132:135]
    ds_read_b128 v[20:23], v225 offset:4096
    v_mfma_f32_16x16x32_bf16 v[140:143], v[24:27], v[200:203], v[140:143]
    ds_read_b64_tr_b16 v[44:45], v5 offset:57344
    v_mfma_f32_16x16x32_bf16 v[140:143], v[28:31], v[204:207], v[140:143]
    ds_read_b64_tr_b16 v[46:47], v5 offset:58368
    v_mfma_f32_16x16x32_bf16 v[148:151], v[24:27], v[208:211], v[148:151]
    ds_read_b64_tr_b16 v[48:49], v6 offset:49152
    s_add_u32 s34, s32, 2
    s_and_b32 s34, s34, 7
    s_lshl_b32 s34, s34, 19
    s_add_u32 m0, s6, 98304
    s_add_u32 s41, s34, 0
    buffer_load_dwordx4 v11, s[28:31], s41 offen lds
    v_mfma_f32_16x16x32_bf16 v[148:151], v[28:31], v[212:215], v[148:151]
    ds_read_b64_tr_b16 v[50:51], v6 offset:50176
    v_mfma_f32_16x16x32_bf16 v[156:159], v[24:27], v[216:219], v[156:159]
    ds_read_b64_tr_b16 v[52:53], v6 offset:57344
    v_mfma_f32_16x16x32_bf16 v[156:159], v[28:31], v[220:223], v[156:159]
    ds_read_b64_tr_b16 v[54:55], v6 offset:58368
    s_waitcnt lgkmcnt(7)
    v_mfma_f32_16x16x32_bf16 v[160:163], v[16:19], v[192:195], v[160:163]
    ds_read_b128 v[24:27], v225 offset:6144
    s_add_u32 m0, s6, 106496
    s_add_u32 s41, s34, 262144
    buffer_load_dwordx4 v11, s[28:31], s41 offen lds
    s_waitcnt lgkmcnt(7)
    v_mfma_f32_16x16x32_bf16 v[160:163], v[20:23], v[196:199], v[160:163]
    ds_read_b128 v[28:31], v224 offset:6144
    v_mfma_f32_16x16x32_bf16 v[168:171], v[16:19], v[200:203], v[168:171]
    ds_read_b64_tr_b16 v[56:57], v7 offset:49152
    v_mfma_f32_16x16x32_bf16 v[168:171], v[20:23], v[204:207], v[168:171]
    ds_read_b64_tr_b16 v[58:59], v7 offset:50176
    v_mfma_f32_16x16x32_bf16 v[176:179], v[16:19], v[208:211], v[176:179]
    ds_read_b64_tr_b16 v[60:61], v7 offset:57344
    v_mfma_f32_16x16x32_bf16 v[176:179], v[20:23], v[212:215], v[176:179]
    ds_read_b64_tr_b16 v[62:63], v7 offset:58368
    v_mfma_f32_16x16x32_bf16 v[184:187], v[16:19], v[216:219], v[184:187]
    s_add_u32 s41, s54, 9216
    buffer_store_dwordx4 v[112:115], v8, s[20:23], s41 offen sc1
    v_mfma_f32_16x16x32_bf16 v[184:187], v[20:23], v[220:223], v[184:187]
    s_waitcnt lgkmcnt(0)
    s_waitcnt vmcnt(10)
    s_barrier
    v_mfma_f32_16x16x32_bf16 v[164:167], v[24:27], v[192:195], v[164:167]
    ds_read_b128 v[16:19], v224 offset:32768
    s_add_u32 s35, s32, 1
    s_and_b32 s35, s35, 7
    s_lshl_b32 s35, s35, 7
    s_add_u32 m0, s6, 0
    s_add_u32 s41, s48, s35
    buffer_load_dwordx4 v10, s[24:27], s41 offen lds
    v_mfma_f32_16x16x32_bf16 v[164:167], v[28:31], v[196:199], v[164:167]
    ds_read_b128 v[20:23], v225 offset:32768
    v_mfma_f32_16x16x32_bf16 v[172:175], v[24:27], v[200:203], v[172:175]
    v_mfma_f32_16x16x32_bf16 v[172:175], v[28:31], v[204:207], v[172:175]
    v_mfma_f32_16x16x32_bf16 v[180:183], v[24:27], v[208:211], v[180:183]
    v_mfma_f32_16x16x32_bf16 v[180:183], v[28:31], v[212:215], v[180:183]
    v_mfma_f32_16x16x32_bf16 v[188:191], v[24:27], v[216:219], v[188:191]
    v_mfma_f32_16x16x32_bf16 v[188:191], v[28:31], v[220:223], v[188:191]
    s_waitcnt lgkmcnt(1)
    v_mfma_f32_16x16x32_bf16 v[128:131], v[16:19], v[32:35], v[128:131]
    ds_read_b128 v[24:27], v225 offset:34816
    s_add_u32 m0, s6, 8192
    s_add_u32 s41, s49, s35
    buffer_load_dwordx4 v10, s[24:27], s41 offen lds
    s_waitcnt lgkmcnt(1)
    v_mfma_f32_16x16x32_bf16 v[128:131], v[20:23], v[36:39], v[128:131]
    ds_read_b128 v[28:31], v224 offset:34816
    v_mfma_f32_16x16x32_bf16 v[136:139], v[16:19], v[40:43], v[136:139]
    ds_read_b64_tr_b16 v[192:193], v4 offset:0
    v_mfma_f32_16x16x32_bf16 v[136:139], v[20:23], v[44:47], v[136:139]
    ds_read_b64_tr_b16 v[194:195], v4 offset:1024
    v_mfma_f32_16x16x32_bf16 v[144:147], v[16:19], v[48:51], v[144:147]
    ds_read_b64_tr_b16 v[196:197], v4 offset:8192
    s_add_u32 m0, s6, 16384
    s_add_u32 s41, s50, s35
    buffer_load_dwordx4 v10, s[24:27], s41 offen lds
    v_mfma_f32_16x16x32_bf16 v[144:147], v[20:23], v[52:55], v[144:147]
    ds_read_b64_tr_b16 v[198:199], v4 offset:9216
    v_mfma_f32_16x16x32_bf16 v[152:155], v[16:19], v[56:59], v[152:155]
    ds_read_b64_tr_b16 v[200:201], v5 offset:0
    v_mfma_f32_16x16x32_bf16 v[152:155], v[20:23], v[60:63], v[152:155]
    ds_read_b64_tr_b16 v[202:203], v5 offset:1024
    s_waitcnt lgkmcnt(7)
    v_mfma_f32_16x16x32_bf16 v[132:135], v[24:27], v[32:35], v[132:135]
    ds_read_b128 v[16:19], v224 offset:36864
    s_add_u32 m0, s6, 24576
    s_add_u32 s41, s51, s35
    buffer_load_dwordx4 v10, s[24:27], s41 offen lds
    s_waitcnt lgkmcnt(7)
    v_mfma_f32_16x16x32_bf16 v[132:135], v[28:31], v[36:39], v[132:135]
    ds_read_b128 v[20:23], v225 offset:36864
    v_mfma_f32_16x16x32_bf16 v[140:143], v[24:27], v[40:43], v[140:143]
    ds_read_b64_tr_b16 v[204:205], v5 offset:8192
    v_mfma_f32_16x16x32_bf16 v[140:143], v[28:31], v[44:47], v[140:143]
    ds_read_b64_tr_b16 v[206:207], v5 offset:9216
    v_mfma_f32_16x16x32_bf16 v[148:151], v[24:27], v[48:51], v[148:151]
    ds_read_b64_tr_b16 v[208:209], v6 offset:0
    s_add_u32 s34, s32, 3
    s_and_b32 s34, s34, 7
    s_lshl_b32 s34, s34, 19
    s_add_u32 m0, s6, 114688
    s_add_u32 s41, s34, 0
    buffer_load_dwordx4 v11, s[28:31], s41 offen lds
    v_mfma_f32_16x16x32_bf16 v[148:151], v[28:31], v[52:55], v[148:151]
    ds_read_b64_tr_b16 v[210:211], v6 offset:1024
    v_mfma_f32_16x16x32_bf16 v[156:159], v[24:27], v[56:59], v[156:159]
    ds_read_b64_tr_b16 v[212:213], v6 offset:8192
    v_mfma_f32_16x16x32_bf16 v[156:159], v[28:31], v[60:63], v[156:159]
    ds_read_b64_tr_b16 v[214:215], v6 offset:9216
    s_waitcnt lgkmcnt(7)
    v_mfma_f32_16x16x32_bf16 v[160:163], v[16:19], v[32:35], v[160:163]
    ds_read_b128 v[24:27], v225 offset:38912
    s_add_u32 m0, s6, 122880
    s_add_u32 s41, s34, 262144
    buffer_load_dwordx4 v11, s[28:31], s41 offen lds
    s_waitcnt lgkmcnt(7)
    v_mfma_f32_16x16x32_bf16 v[160:163], v[20:23], v[36:39], v[160:163]
    ds_read_b128 v[28:31], v224 offset:38912
    v_mfma_f32_16x16x32_bf16 v[168:171], v[16:19], v[40:43], v[168:171]
    ds_read_b64_tr_b16 v[216:217], v7 offset:0
    v_mfma_f32_16x16x32_bf16 v[168:171], v[20:23], v[44:47], v[168:171]
    ds_read_b64_tr_b16 v[218:219], v7 offset:1024
    v_mfma_f32_16x16x32_bf16 v[176:179], v[16:19], v[48:51], v[176:179]
    ds_read_b64_tr_b16 v[220:221], v7 offset:8192
    v_mfma_f32_16x16x32_bf16 v[176:179], v[20:23], v[52:55], v[176:179]
    ds_read_b64_tr_b16 v[222:223], v7 offset:9216
    v_mfma_f32_16x16x32_bf16 v[184:187], v[16:19], v[56:59], v[184:187]
    s_add_u32 s41, s54, 9472
    buffer_store_dwordx4 v[120:123], v8, s[20:23], s41 offen sc1
    v_mfma_f32_16x16x32_bf16 v[184:187], v[20:23], v[60:63], v[184:187]
    s_waitcnt lgkmcnt(0)
    s_waitcnt vmcnt(10)
    s_barrier
    v_mfma_f32_16x16x32_bf16 v[164:167], v[24:27], v[32:35], v[164:167]
    ds_read_b128 v[16:19], v226 offset:0
    s_add_u32 s35, s32, 2
    s_and_b32 s35, s35, 7
    s_lshl_b32 s35, s35, 7
    s_add_u32 m0, s6, 32768
    s_add_u32 s41, s48, s35
    buffer_load_dwordx4 v10, s[24:27], s41 offen lds
    v_mfma_f32_16x16x32_bf16 v[164:167], v[28:31], v[36:39], v[164:167]
    ds_read_b128 v[20:23], v227 offset:0
    v_mfma_f32_16x16x32_bf16 v[172:175], v[24:27], v[40:43], v[172:175]
    v_mfma_f32_16x16x32_bf16 v[172:175], v[28:31], v[44:47], v[172:175]
    v_mfma_f32_16x16x32_bf16 v[180:183], v[24:27], v[48:51], v[180:183]
    v_mfma_f32_16x16x32_bf16 v[180:183], v[28:31], v[52:55], v[180:183]
    v_mfma_f32_16x16x32_bf16 v[188:191], v[24:27], v[56:59], v[188:191]
    v_mfma_f32_16x16x32_bf16 v[188:191], v[28:31], v[60:63], v[188:191]
    s_waitcnt lgkmcnt(1)
    v_mfma_f32_16x16x32_bf16 v[64:67], v[192:195], v[16:19], 0
    ds_read_b128 v[24:27], v227 offset:2048
    s_add_u32 m0, s6, 40960
    s_add_u32 s41, s49, s35
    buffer_load_dwordx4 v10, s[24:27], s41 offen lds
    v_cvt_pk_bf16_f32 v128, v128, v129
    v_cvt_pk_bf16_f32 v129, v130, v131
    s_waitcnt lgkmcnt(1)
    v_mfma_f32_16x16x32_bf16 v[64:67], v[196:199], v[20:23], v[64:67]
    ds_read_b128 v[28:31], v226 offset:2048
    v_cvt_pk_bf16_f32 v130, v132, v133
    v_cvt_pk_bf16_f32 v131, v134, v135
    v_mfma_f32_16x16x32_bf16 v[68:71], v[200:203], v[16:19], 0
    ds_read_b64_tr_b16 v[32:33], v4 offset:16384
    v_cvt_pk_bf16_f32 v136, v136, v137
    v_cvt_pk_bf16_f32 v137, v138, v139
    v_mfma_f32_16x16x32_bf16 v[68:71], v[204:207], v[20:23], v[68:71]
    ds_read_b64_tr_b16 v[34:35], v4 offset:17408
    v_cvt_pk_bf16_f32 v138, v140, v141
    v_cvt_pk_bf16_f32 v139, v142, v143
    v_mfma_f32_16x16x32_bf16 v[72:75], v[208:211], v[16:19], 0
    ds_read_b64_tr_b16 v[36:37], v4 offset:24576
    s_add_u32 m0, s6, 49152
    s_add_u32 s41, s50, s35
    buffer_load_dwordx4 v10, s[24:27], s41 offen lds
    v_cvt_pk_bf16_f32 v144, v144, v145
    v_cvt_pk_bf16_f32 v145, v146, v147
    v_mfma_f32_16x16x32_bf16 v[72:75], v[212:215], v[20:23], v[72:75]
    ds_read_b64_tr_b16 v[38:39], v4 offset:25600
    v_cvt_pk_bf16_f32 v146, v148, v149
    v_cvt_pk_bf16_f32 v147, v150, v151
    v_mfma_f32_16x16x32_bf16 v[76:79], v[216:219], v[16:19], 0
    ds_read_b64_tr_b16 v[40:41], v5 offset:16384
    v_cvt_pk_bf16_f32 v152, v152, v153
    v_cvt_pk_bf16_f32 v153, v154, v155
    v_mfma_f32_16x16x32_bf16 v[76:79], v[220:223], v[20:23], v[76:79]
    ds_read_b64_tr_b16 v[42:43], v5 offset:17408
    v_cvt_pk_bf16_f32 v154, v156, v157
    v_cvt_pk_bf16_f32 v155, v158, v159
    s_waitcnt lgkmcnt(7)
    v_mfma_f32_16x16x32_bf16 v[80:83], v[192:195], v[24:27], 0
    ds_read_b128 v[16:19], v226 offset:4096
    s_add_u32 m0, s6, 57344
    s_add_u32 s41, s51, s35
    buffer_load_dwordx4 v10, s[24:27], s41 offen lds
    v_cvt_pk_bf16_f32 v160, v160, v161
    v_cvt_pk_bf16_f32 v161, v162, v163
    s_waitcnt lgkmcnt(7)
    v_mfma_f32_16x16x32_bf16 v[80:83], v[196:199], v[28:31], v[80:83]
    ds_read_b128 v[20:23], v227 offset:4096
    v_cvt_pk_bf16_f32 v162, v164, v165
    v_cvt_pk_bf16_f32 v163, v166, v167
    v_mfma_f32_16x16x32_bf16 v[84:87], v[200:203], v[24:27], 0
    ds_read_b64_tr_b16 v[44:45], v5 offset:24576
    v_cvt_pk_bf16_f32 v168, v168, v169
    v_cvt_pk_bf16_f32 v169, v170, v171
    v_mfma_f32_16x16x32_bf16 v[84:87], v[204:207], v[28:31], v[84:87]
    ds_read_b64_tr_b16 v[46:47], v5 offset:25600
    v_cvt_pk_bf16_f32 v170, v172, v173
    v_cvt_pk_bf16_f32 v171, v174, v175
    v_mfma_f32_16x16x32_bf16 v[88:91], v[208:211], v[24:27], 0
    ds_read_b64_tr_b16 v[48:49], v6 offset:16384
    s_add_u32 s34, s32, 4
    s_and_b32 s34, s34, 7
    s_lshl_b32 s34, s34, 19
    s_add_u32 m0, s6, 65536
    s_add_u32 s41, s34, 0
    buffer_load_dwordx4 v11, s[28:31], s41 offen lds
    v_cvt_pk_bf16_f32 v176, v176, v177
    v_cvt_pk_bf16_f32 v177, v178, v179
    v_mfma_f32_16x16x32_bf16 v[88:91], v[212:215], v[28:31], v[88:91]
    ds_read_b64_tr_b16 v[50:51], v6 offset:17408
    v_cvt_pk_bf16_f32 v178, v180, v181
    v_cvt_pk_bf16_f32 v179, v182, v183
    v_mfma_f32_16x16x32_bf16 v[92:95], v[216:219], v[24:27], 0
    ds_read_b64_tr_b16 v[52:53], v6 offset:24576
    v_cvt_pk_bf16_f32 v184, v184, v185
    v_cvt_pk_bf16_f32 v185, v186, v187
    v_mfma_f32_16x16x32_bf16 v[92:95], v[220:223], v[28:31], v[92:95]
    ds_read_b64_tr_b16 v[54:55], v6 offset:25600
    v_cvt_pk_bf16_f32 v186, v188, v189
    v_cvt_pk_bf16_f32 v187, v190, v191
    s_waitcnt lgkmcnt(7)
    v_mfma_f32_16x16x32_bf16 v[96:99], v[192:195], v[16:19], 0
    ds_read_b128 v[24:27], v227 offset:6144
    s_add_u32 m0, s6, 73728
    s_add_u32 s41, s34, 262144
    buffer_load_dwordx4 v11, s[28:31], s41 offen lds
    s_waitcnt lgkmcnt(7)
    v_mfma_f32_16x16x32_bf16 v[96:99], v[196:199], v[20:23], v[96:99]
    ds_read_b128 v[28:31], v226 offset:6144
    v_mfma_f32_16x16x32_bf16 v[100:103], v[200:203], v[16:19], 0
    ds_read_b64_tr_b16 v[56:57], v7 offset:16384
    v_mfma_f32_16x16x32_bf16 v[100:103], v[204:207], v[20:23], v[100:103]
    ds_read_b64_tr_b16 v[58:59], v7 offset:17408
    v_mfma_f32_16x16x32_bf16 v[104:107], v[208:211], v[16:19], 0
    ds_read_b64_tr_b16 v[60:61], v7 offset:24576
    v_mfma_f32_16x16x32_bf16 v[104:107], v[212:215], v[20:23], v[104:107]
    ds_read_b64_tr_b16 v[62:63], v7 offset:25600
    v_mfma_f32_16x16x32_bf16 v[108:111], v[216:219], v[16:19], 0
    s_add_u32 s41, s52, 0
    buffer_store_dwordx4 v[128:131], v8, s[20:23], s41 offen sc1
    v_mfma_f32_16x16x32_bf16 v[108:111], v[220:223], v[20:23], v[108:111]
    s_waitcnt lgkmcnt(0)
    s_waitcnt vmcnt(10)
    s_barrier
    v_mfma_f32_16x16x32_bf16 v[112:115], v[192:195], v[24:27], 0
    ds_read_b128 v[16:19], v224 offset:0
    s_add_u32 s35, s32, 3
    s_and_b32 s35, s35, 7
    s_lshl_b32 s35, s35, 7
    s_add_u32 m0, s6, 131072
    s_add_u32 s41, s48, s35
    buffer_load_dwordx4 v10, s[24:27], s41 offen lds
    v_mfma_f32_16x16x32_bf16 v[112:115], v[196:199], v[28:31], v[112:115]
    ds_read_b128 v[20:23], v225 offset:0
    v_mfma_f32_16x16x32_bf16 v[116:119], v[200:203], v[24:27], 0
    v_mfma_f32_16x16x32_bf16 v[116:119], v[204:207], v[28:31], v[116:119]
    v_mfma_f32_16x16x32_bf16 v[120:123], v[208:211], v[24:27], 0
    v_mfma_f32_16x16x32_bf16 v[120:123], v[212:215], v[28:31], v[120:123]
    v_mfma_f32_16x16x32_bf16 v[124:127], v[216:219], v[24:27], 0
    v_mfma_f32_16x16x32_bf16 v[124:127], v[220:223], v[28:31], v[124:127]
    s_waitcnt lgkmcnt(1)
    v_mfma_f32_16x16x32_bf16 v[64:67], v[32:35], v[16:19], v[64:67]
    ds_read_b128 v[24:27], v225 offset:2048
    s_add_u32 m0, s6, 139264
    s_add_u32 s41, s49, s35
    buffer_load_dwordx4 v10, s[24:27], s41 offen lds
    s_waitcnt lgkmcnt(1)
    v_mfma_f32_16x16x32_bf16 v[64:67], v[36:39], v[20:23], v[64:67]
    ds_read_b128 v[28:31], v224 offset:2048
    v_mfma_f32_16x16x32_bf16 v[68:71], v[40:43], v[16:19], v[68:71]
    ds_read_b64_tr_b16 v[192:193], v4 offset:32768
    v_mfma_f32_16x16x32_bf16 v[68:71], v[44:47], v[20:23], v[68:71]
    ds_read_b64_tr_b16 v[194:195], v4 offset:33792
    v_mfma_f32_16x16x32_bf16 v[72:75], v[48:51], v[16:19], v[72:75]
    ds_read_b64_tr_b16 v[196:197], v4 offset:40960
    s_add_u32 m0, s6, 147456
    s_add_u32 s41, s50, s35
    buffer_load_dwordx4 v10, s[24:27], s41 offen lds
    v_mfma_f32_16x16x32_bf16 v[72:75], v[52:55], v[20:23], v[72:75]
    ds_read_b64_tr_b16 v[198:199], v4 offset:41984
    v_mfma_f32_16x16x32_bf16 v[76:79], v[56:59], v[16:19], v[76:79]
    ds_read_b64_tr_b16 v[200:201], v5 offset:32768
    v_mfma_f32_16x16x32_bf16 v[76:79], v[60:63], v[20:23], v[76:79]
    ds_read_b64_tr_b16 v[202:203], v5 offset:33792
    s_waitcnt lgkmcnt(7)
    v_mfma_f32_16x16x32_bf16 v[80:83], v[32:35], v[24:27], v[80:83]
    ds_read_b128 v[16:19], v224 offset:4096
    s_add_u32 m0, s6, 155648
    s_add_u32 s41, s51, s35
    buffer_load_dwordx4 v10, s[24:27], s41 offen lds
    s_waitcnt lgkmcnt(7)
    v_mfma_f32_16x16x32_bf16 v[80:83], v[36:39], v[28:31], v[80:83]
    ds_read_b128 v[20:23], v225 offset:4096
    v_mfma_f32_16x16x32_bf16 v[84:87], v[40:43], v[24:27], v[84:87]
    ds_read_b64_tr_b16 v[204:205], v5 offset:40960
    v_mfma_f32_16x16x32_bf16 v[84:87], v[44:47], v[28:31], v[84:87]
    ds_read_b64_tr_b16 v[206:207], v5 offset:41984
    v_mfma_f32_16x16x32_bf16 v[88:91], v[48:51], v[24:27], v[88:91]
    ds_read_b64_tr_b16 v[208:209], v6 offset:32768
    s_add_u32 s34, s32, 5
    s_and_b32 s34, s34, 7
    s_lshl_b32 s34, s34, 19
    s_add_u32 m0, s6, 81920
    s_add_u32 s41, s34, 0
    buffer_load_dwordx4 v11, s[28:31], s41 offen lds
    v_mfma_f32_16x16x32_bf16 v[88:91], v[52:55], v[28:31], v[88:91]
    ds_read_b64_tr_b16 v[210:211], v6 offset:33792
    v_mfma_f32_16x16x32_bf16 v[92:95], v[56:59], v[24:27], v[92:95]
    ds_read_b64_tr_b16 v[212:213], v6 offset:40960
    v_mfma_f32_16x16x32_bf16 v[92:95], v[60:63], v[28:31], v[92:95]
    ds_read_b64_tr_b16 v[214:215], v6 offset:41984
    s_waitcnt lgkmcnt(7)
    v_mfma_f32_16x16x32_bf16 v[96:99], v[32:35], v[16:19], v[96:99]
    ds_read_b128 v[24:27], v225 offset:6144
    s_add_u32 m0, s6, 90112
    s_add_u32 s41, s34, 262144
    buffer_load_dwordx4 v11, s[28:31], s41 offen lds
    s_waitcnt lgkmcnt(7)
    v_mfma_f32_16x16x32_bf16 v[96:99], v[36:39], v[20:23], v[96:99]
    ds_read_b128 v[28:31], v224 offset:6144
    v_mfma_f32_16x16x32_bf16 v[100:103], v[40:43], v[16:19], v[100:103]
    ds_read_b64_tr_b16 v[216:217], v7 offset:32768
    v_mfma_f32_16x16x32_bf16 v[100:103], v[44:47], v[20:23], v[100:103]
    ds_read_b64_tr_b16 v[218:219], v7 offset:33792
    v_mfma_f32_16x16x32_bf16 v[104:107], v[48:51], v[16:19], v[104:107]
    ds_read_b64_tr_b16 v[220:221], v7 offset:40960
    v_mfma_f32_16x16x32_bf16 v[104:107], v[52:55], v[20:23], v[104:107]
    ds_read_b64_tr_b16 v[222:223], v7 offset:41984
    v_mfma_f32_16x16x32_bf16 v[108:111], v[56:59], v[16:19], v[108:111]
    s_add_u32 s41, s52, 256
    buffer_store_dwordx4 v[136:139], v8, s[20:23], s41 offen sc1
    v_mfma_f32_16x16x32_bf16 v[108:111], v[60:63], v[20:23], v[108:111]
    s_add_u32 s41, s52, 512
    buffer_store_dwordx4 v[144:147], v8, s[20:23], s41 offen sc1
    s_waitcnt lgkmcnt(0)
    s_waitcnt vmcnt(11)
    s_barrier
    v_mfma_f32_16x16x32_bf16 v[112:115], v[32:35], v[24:27], v[112:115]
    ds_read_b128 v[16:19], v224 offset:32768
    s_add_u32 s35, s32, 4
    s_and_b32 s35, s35, 7
    s_lshl_b32 s35, s35, 7
    s_add_u32 m0, s6, 0
    s_add_u32 s41, s48, s35
    buffer_load_dwordx4 v10, s[24:27], s41 offen lds
    v_mfma_f32_16x16x32_bf16 v[112:115], v[36:39], v[28:31], v[112:115]
    ds_read_b128 v[20:23], v225 offset:32768
    s_lshl_b32 s40, s4, 7
    s_lshl_b32 s41, s5, 2
    s_add_u32 s40, s40, s41
    s_add_u32 s40, s40, 71368704
    s_cmp_eq_u32 s3, 0
    s_cselect_b32 s99, 0, 1073741824
    v_mov_b32 v2, 1
    v_mov_b32 v3, s99
    buffer_store_dword v2, v3, s[20:23], s40 offen sc1
    v_mfma_f32_16x16x32_bf16 v[116:119], v[40:43], v[24:27], v[116:119]
    v_mfma_f32_16x16x32_bf16 v[116:119], v[44:47], v[28:31], v[116:119]
    v_mfma_f32_16x16x32_bf16 v[120:123], v[48:51], v[24:27], v[120:123]
    v_mfma_f32_16x16x32_bf16 v[120:123], v[52:55], v[28:31], v[120:123]
    v_mfma_f32_16x16x32_bf16 v[124:127], v[56:59], v[24:27], v[124:127]
    v_mfma_f32_16x16x32_bf16 v[124:127], v[60:63], v[28:31], v[124:127]
    s_waitcnt lgkmcnt(1)
    v_mfma_f32_16x16x32_bf16 v[64:67], v[192:195], v[16:19], v[64:67]
    ds_read_b128 v[24:27], v225 offset:34816
    s_add_u32 m0, s6, 8192
    s_add_u32 s41, s49, s35
    buffer_load_dwordx4 v10, s[24:27], s41 offen lds
    s_waitcnt lgkmcnt(1)
    v_mfma_f32_16x16x32_bf16 v[64:67], v[196:199], v[20:23], v[64:67]
    ds_read_b128 v[28:31], v224 offset:34816
    v_mfma_f32_16x16x32_bf16 v[68:71], v[200:203], v[16:19], v[68:71]
    ds_read_b64_tr_b16 v[32:33], v4 offset:49152
    v_mfma_f32_16x16x32_bf16 v[68:71], v[204:207], v[20:23], v[68:71]
    ds_read_b64_tr_b16 v[34:35], v4 offset:50176
    v_mfma_f32_16x16x32_bf16 v[72:75], v[208:211], v[16:19], v[72:75]
    ds_read_b64_tr_b16 v[36:37], v4 offset:57344
    s_add_u32 m0, s6, 16384
    s_add_u32 s41, s50, s35
    buffer_load_dwordx4 v10, s[24:27], s41 offen lds
    v_mfma_f32_16x16x32_bf16 v[72:75], v[212:215], v[20:23], v[72:75]
    ds_read_b64_tr_b16 v[38:39], v4 offset:58368
    v_mfma_f32_16x16x32_bf16 v[76:79], v[216:219], v[16:19], v[76:79]
    ds_read_b64_tr_b16 v[40:41], v5 offset:49152
    v_mfma_f32_16x16x32_bf16 v[76:79], v[220:223], v[20:23], v[76:79]
    ds_read_b64_tr_b16 v[42:43], v5 offset:50176
    s_waitcnt lgkmcnt(7)
    v_mfma_f32_16x16x32_bf16 v[80:83], v[192:195], v[24:27], v[80:83]
    ds_read_b128 v[16:19], v224 offset:36864
    s_add_u32 m0, s6, 24576
    s_add_u32 s41, s51, s35
    buffer_load_dwordx4 v10, s[24:27], s41 offen lds
    s_waitcnt lgkmcnt(7)
    v_mfma_f32_16x16x32_bf16 v[80:83], v[196:199], v[28:31], v[80:83]
    ds_read_b128 v[20:23], v225 offset:36864
    v_mfma_f32_16x16x32_bf16 v[84:87], v[200:203], v[24:27], v[84:87]
    ds_read_b64_tr_b16 v[44:45], v5 offset:57344
    v_mfma_f32_16x16x32_bf16 v[84:87], v[204:207], v[28:31], v[84:87]
    ds_read_b64_tr_b16 v[46:47], v5 offset:58368
    v_mfma_f32_16x16x32_bf16 v[88:91], v[208:211], v[24:27], v[88:91]
    ds_read_b64_tr_b16 v[48:49], v6 offset:49152
    s_add_u32 s34, s32, 6
    s_and_b32 s34, s34, 7
    s_lshl_b32 s34, s34, 19
    s_add_u32 m0, s6, 98304
    s_add_u32 s41, s34, 0
    buffer_load_dwordx4 v11, s[28:31], s41 offen lds
    v_mfma_f32_16x16x32_bf16 v[88:91], v[212:215], v[28:31], v[88:91]
    ds_read_b64_tr_b16 v[50:51], v6 offset:50176
    v_mfma_f32_16x16x32_bf16 v[92:95], v[216:219], v[24:27], v[92:95]
    ds_read_b64_tr_b16 v[52:53], v6 offset:57344
    v_mfma_f32_16x16x32_bf16 v[92:95], v[220:223], v[28:31], v[92:95]
    ds_read_b64_tr_b16 v[54:55], v6 offset:58368
    s_waitcnt lgkmcnt(7)
    v_mfma_f32_16x16x32_bf16 v[96:99], v[192:195], v[16:19], v[96:99]
    ds_read_b128 v[24:27], v225 offset:38912
    s_add_u32 m0, s6, 106496
    s_add_u32 s41, s34, 262144
    buffer_load_dwordx4 v11, s[28:31], s41 offen lds
    s_waitcnt lgkmcnt(7)
    v_mfma_f32_16x16x32_bf16 v[96:99], v[196:199], v[20:23], v[96:99]
    ds_read_b128 v[28:31], v224 offset:38912
    v_mfma_f32_16x16x32_bf16 v[100:103], v[200:203], v[16:19], v[100:103]
    ds_read_b64_tr_b16 v[56:57], v7 offset:49152
    v_mfma_f32_16x16x32_bf16 v[100:103], v[204:207], v[20:23], v[100:103]
    ds_read_b64_tr_b16 v[58:59], v7 offset:50176
    v_mfma_f32_16x16x32_bf16 v[104:107], v[208:211], v[16:19], v[104:107]
    ds_read_b64_tr_b16 v[60:61], v7 offset:57344
    v_mfma_f32_16x16x32_bf16 v[104:107], v[212:215], v[20:23], v[104:107]
    ds_read_b64_tr_b16 v[62:63], v7 offset:58368
    v_mfma_f32_16x16x32_bf16 v[108:111], v[216:219], v[16:19], v[108:111]
    s_add_u32 s41, s52, 768
    buffer_store_dwordx4 v[152:155], v8, s[20:23], s41 offen sc1
    v_mfma_f32_16x16x32_bf16 v[108:111], v[220:223], v[20:23], v[108:111]
    s_waitcnt lgkmcnt(0)
    s_waitcnt vmcnt(12)
    s_barrier
    v_mfma_f32_16x16x32_bf16 v[112:115], v[192:195], v[24:27], v[112:115]
    ds_read_b128 v[16:19], v226 offset:0
    s_add_u32 s35, s32, 5
    s_and_b32 s35, s35, 7
    s_lshl_b32 s35, s35, 7
    s_add_u32 m0, s6, 32768
    s_add_u32 s41, s48, s35
    buffer_load_dwordx4 v10, s[24:27], s41 offen lds
    v_mfma_f32_16x16x32_bf16 v[112:115], v[196:199], v[28:31], v[112:115]
    ds_read_b128 v[20:23], v227 offset:0
    v_mfma_f32_16x16x32_bf16 v[116:119], v[200:203], v[24:27], v[116:119]
    v_mfma_f32_16x16x32_bf16 v[116:119], v[204:207], v[28:31], v[116:119]
    v_mfma_f32_16x16x32_bf16 v[120:123], v[208:211], v[24:27], v[120:123]
    v_mfma_f32_16x16x32_bf16 v[120:123], v[212:215], v[28:31], v[120:123]
    v_mfma_f32_16x16x32_bf16 v[124:127], v[216:219], v[24:27], v[124:127]
    v_mfma_f32_16x16x32_bf16 v[124:127], v[220:223], v[28:31], v[124:127]
    s_waitcnt lgkmcnt(1)
    v_mfma_f32_16x16x32_bf16 v[64:67], v[32:35], v[16:19], v[64:67]
    ds_read_b128 v[24:27], v227 offset:2048
    s_add_u32 m0, s6, 40960
    s_add_u32 s41, s49, s35
    buffer_load_dwordx4 v10, s[24:27], s41 offen lds
    s_waitcnt lgkmcnt(1)
    v_mfma_f32_16x16x32_bf16 v[64:67], v[36:39], v[20:23], v[64:67]
    ds_read_b128 v[28:31], v226 offset:2048
    v_mfma_f32_16x16x32_bf16 v[68:71], v[40:43], v[16:19], v[68:71]
    ds_read_b64_tr_b16 v[192:193], v4 offset:0
    v_mfma_f32_16x16x32_bf16 v[68:71], v[44:47], v[20:23], v[68:71]
    ds_read_b64_tr_b16 v[194:195], v4 offset:1024
    v_mfma_f32_16x16x32_bf16 v[72:75], v[48:51], v[16:19], v[72:75]
    ds_read_b64_tr_b16 v[196:197], v4 offset:8192
    s_add_u32 m0, s6, 49152
    s_add_u32 s41, s50, s35
    buffer_load_dwordx4 v10, s[24:27], s41 offen lds
    v_mfma_f32_16x16x32_bf16 v[72:75], v[52:55], v[20:23], v[72:75]
    ds_read_b64_tr_b16 v[198:199], v4 offset:9216
    v_mfma_f32_16x16x32_bf16 v[76:79], v[56:59], v[16:19], v[76:79]
    ds_read_b64_tr_b16 v[200:201], v5 offset:0
    v_mfma_f32_16x16x32_bf16 v[76:79], v[60:63], v[20:23], v[76:79]
    ds_read_b64_tr_b16 v[202:203], v5 offset:1024
    s_waitcnt lgkmcnt(7)
    v_mfma_f32_16x16x32_bf16 v[80:83], v[32:35], v[24:27], v[80:83]
    ds_read_b128 v[16:19], v226 offset:4096
    s_add_u32 m0, s6, 57344
    s_add_u32 s41, s51, s35
    buffer_load_dwordx4 v10, s[24:27], s41 offen lds
    s_waitcnt lgkmcnt(7)
    v_mfma_f32_16x16x32_bf16 v[80:83], v[36:39], v[28:31], v[80:83]
    ds_read_b128 v[20:23], v227 offset:4096
    v_mfma_f32_16x16x32_bf16 v[84:87], v[40:43], v[24:27], v[84:87]
    ds_read_b64_tr_b16 v[204:205], v5 offset:8192
    v_mfma_f32_16x16x32_bf16 v[84:87], v[44:47], v[28:31], v[84:87]
    ds_read_b64_tr_b16 v[206:207], v5 offset:9216
    v_mfma_f32_16x16x32_bf16 v[88:91], v[48:51], v[24:27], v[88:91]
    ds_read_b64_tr_b16 v[208:209], v6 offset:0
    s_add_u32 s34, s32, 7
    s_and_b32 s34, s34, 7
    s_lshl_b32 s34, s34, 19
    s_add_u32 m0, s6, 114688
    s_add_u32 s41, s34, 0
    buffer_load_dwordx4 v11, s[28:31], s41 offen lds
    v_mfma_f32_16x16x32_bf16 v[88:91], v[52:55], v[28:31], v[88:91]
    ds_read_b64_tr_b16 v[210:211], v6 offset:1024
    v_mfma_f32_16x16x32_bf16 v[92:95], v[56:59], v[24:27], v[92:95]
    ds_read_b64_tr_b16 v[212:213], v6 offset:8192
    v_mfma_f32_16x16x32_bf16 v[92:95], v[60:63], v[28:31], v[92:95]
    ds_read_b64_tr_b16 v[214:215], v6 offset:9216
    s_waitcnt lgkmcnt(7)
    v_mfma_f32_16x16x32_bf16 v[96:99], v[32:35], v[16:19], v[96:99]
    ds_read_b128 v[24:27], v227 offset:6144
    s_add_u32 m0, s6, 122880
    s_add_u32 s41, s34, 262144
    buffer_load_dwordx4 v11, s[28:31], s41 offen lds
    s_waitcnt lgkmcnt(7)
    v_mfma_f32_16x16x32_bf16 v[96:99], v[36:39], v[20:23], v[96:99]
    ds_read_b128 v[28:31], v226 offset:6144
    v_mfma_f32_16x16x32_bf16 v[100:103], v[40:43], v[16:19], v[100:103]
    ds_read_b64_tr_b16 v[216:217], v7 offset:0
    v_mfma_f32_16x16x32_bf16 v[100:103], v[44:47], v[20:23], v[100:103]
    ds_read_b64_tr_b16 v[218:219], v7 offset:1024
    v_mfma_f32_16x16x32_bf16 v[104:107], v[48:51], v[16:19], v[104:107]
    ds_read_b64_tr_b16 v[220:221], v7 offset:8192
    v_mfma_f32_16x16x32_bf16 v[104:107], v[52:55], v[20:23], v[104:107]
    ds_read_b64_tr_b16 v[222:223], v7 offset:9216
    v_mfma_f32_16x16x32_bf16 v[108:111], v[56:59], v[16:19], v[108:111]
    s_add_u32 s41, s52, 8192
    buffer_store_dwordx4 v[160:163], v8, s[20:23], s41 offen sc1
    v_mfma_f32_16x16x32_bf16 v[108:111], v[60:63], v[20:23], v[108:111]
    s_add_u32 s41, s52, 8448
    buffer_store_dwordx4 v[168:171], v8, s[20:23], s41 offen sc1
    s_waitcnt lgkmcnt(0)
    s_waitcnt vmcnt(11)
    s_barrier
    v_mfma_f32_16x16x32_bf16 v[112:115], v[32:35], v[24:27], v[112:115]
    ds_read_b128 v[16:19], v224 offset:0
    s_add_u32 s35, s32, 6
    s_and_b32 s35, s35, 7
    s_lshl_b32 s35, s35, 7
    s_add_u32 m0, s6, 131072
    s_add_u32 s41, s48, s35
    buffer_load_dwordx4 v10, s[24:27], s41 offen lds
    v_mfma_f32_16x16x32_bf16 v[112:115], v[36:39], v[28:31], v[112:115]
    ds_read_b128 v[20:23], v225 offset:0
    v_mfma_f32_16x16x32_bf16 v[116:119], v[40:43], v[24:27], v[116:119]
    v_mfma_f32_16x16x32_bf16 v[116:119], v[44:47], v[28:31], v[116:119]
    v_mfma_f32_16x16x32_bf16 v[120:123], v[48:51], v[24:27], v[120:123]
    v_mfma_f32_16x16x32_bf16 v[120:123], v[52:55], v[28:31], v[120:123]
    v_mfma_f32_16x16x32_bf16 v[124:127], v[56:59], v[24:27], v[124:127]
    v_mfma_f32_16x16x32_bf16 v[124:127], v[60:63], v[28:31], v[124:127]
    s_waitcnt lgkmcnt(1)
    v_mfma_f32_16x16x32_bf16 v[64:67], v[192:195], v[16:19], v[64:67]
    ds_read_b128 v[24:27], v225 offset:2048
    s_add_u32 m0, s6, 139264
    s_add_u32 s41, s49, s35
    buffer_load_dwordx4 v10, s[24:27], s41 offen lds
    s_waitcnt lgkmcnt(1)
    v_mfma_f32_16x16x32_bf16 v[64:67], v[196:199], v[20:23], v[64:67]
    ds_read_b128 v[28:31], v224 offset:2048
    v_mfma_f32_16x16x32_bf16 v[68:71], v[200:203], v[16:19], v[68:71]
    ds_read_b64_tr_b16 v[32:33], v4 offset:16384
    v_mfma_f32_16x16x32_bf16 v[68:71], v[204:207], v[20:23], v[68:71]
    ds_read_b64_tr_b16 v[34:35], v4 offset:17408
    v_mfma_f32_16x16x32_bf16 v[72:75], v[208:211], v[16:19], v[72:75]
    ds_read_b64_tr_b16 v[36:37], v4 offset:24576
    v_mfma_f32_16x16x32_bf16 v[72:75], v[212:215], v[20:23], v[72:75]
    ds_read_b64_tr_b16 v[38:39], v4 offset:25600
    v_mfma_f32_16x16x32_bf16 v[76:79], v[216:219], v[16:19], v[76:79]
    ds_read_b64_tr_b16 v[40:41], v5 offset:16384
    v_mfma_f32_16x16x32_bf16 v[76:79], v[220:223], v[20:23], v[76:79]
    ds_read_b64_tr_b16 v[42:43], v5 offset:17408
    s_cmp_eq_u32 s3, 0
    s_cselect_b32 s99, 0, 1073741824
    v_and_b32 v13, 7, v0
    v_lshl_add_u32 v13, v13, 2, s99
    s_lshl_b32 s53, s4, 7
    s_add_u32 s53, s53, 71368704
    buffer_load_dword v15, v13, s[20:23], s53 offen sc1
    s_waitcnt lgkmcnt(7)
    v_mfma_f32_16x16x32_bf16 v[80:83], v[192:195], v[24:27], v[80:83]
    ds_read_b128 v[16:19], v224 offset:4096
    s_add_u32 m0, s6, 147456
    s_add_u32 s41, s50, s35
    buffer_load_dwordx4 v10, s[24:27], s41 offen lds
    s_waitcnt lgkmcnt(7)
    v_mfma_f32_16x16x32_bf16 v[80:83], v[196:199], v[28:31], v[80:83]
    ds_read_b128 v[20:23], v225 offset:4096
    v_mfma_f32_16x16x32_bf16 v[84:87], v[200:203], v[24:27], v[84:87]
    ds_read_b64_tr_b16 v[44:45], v5 offset:24576
    v_mfma_f32_16x16x32_bf16 v[84:87], v[204:207], v[28:31], v[84:87]
    ds_read_b64_tr_b16 v[46:47], v5 offset:25600
    v_mfma_f32_16x16x32_bf16 v[88:91], v[208:211], v[24:27], v[88:91]
    ds_read_b64_tr_b16 v[48:49], v6 offset:16384
    v_mfma_f32_16x16x32_bf16 v[88:91], v[212:215], v[28:31], v[88:91]
    ds_read_b64_tr_b16 v[50:51], v6 offset:17408
    v_mfma_f32_16x16x32_bf16 v[92:95], v[216:219], v[24:27], v[92:95]
    ds_read_b64_tr_b16 v[52:53], v6 offset:24576
    v_mfma_f32_16x16x32_bf16 v[92:95], v[220:223], v[28:31], v[92:95]
    ds_read_b64_tr_b16 v[54:55], v6 offset:25600
    s_waitcnt lgkmcnt(7)
    v_mfma_f32_16x16x32_bf16 v[96:99], v[192:195], v[16:19], v[96:99]
    ds_read_b128 v[24:27], v225 offset:6144
    s_add_u32 m0, s6, 155648
    s_add_u32 s41, s51, s35
    buffer_load_dwordx4 v10, s[24:27], s41 offen lds
    s_waitcnt lgkmcnt(7)
    v_mfma_f32_16x16x32_bf16 v[96:99], v[196:199], v[20:23], v[96:99]
    ds_read_b128 v[28:31], v224 offset:6144
    v_mfma_f32_16x16x32_bf16 v[100:103], v[200:203], v[16:19], v[100:103]
    ds_read_b64_tr_b16 v[56:57], v7 offset:16384
    v_mfma_f32_16x16x32_bf16 v[100:103], v[204:207], v[20:23], v[100:103]
    ds_read_b64_tr_b16 v[58:59], v7 offset:17408
    v_mfma_f32_16x16x32_bf16 v[104:107], v[208:211], v[16:19], v[104:107]
    ds_read_b64_tr_b16 v[60:61], v7 offset:24576
    v_mfma_f32_16x16x32_bf16 v[104:107], v[212:215], v[20:23], v[104:107]
    ds_read_b64_tr_b16 v[62:63], v7 offset:25600
    v_mfma_f32_16x16x32_bf16 v[108:111], v[216:219], v[16:19], v[108:111]
    s_add_u32 s41, s52, 8704
    buffer_store_dwordx4 v[176:179], v8, s[20:23], s41 offen sc1
    v_mfma_f32_16x16x32_bf16 v[108:111], v[220:223], v[20:23], v[108:111]
    s_add_u32 s41, s52, 8960
    buffer_store_dwordx4 v[184:187], v8, s[20:23], s41 offen sc1
    s_waitcnt lgkmcnt(0)
    s_waitcnt vmcnt(11)
    s_barrier
    v_mfma_f32_16x16x32_bf16 v[112:115], v[192:195], v[24:27], v[112:115]
    ds_read_b128 v[16:19], v224 offset:32768
    s_add_u32 s35, s32, 7
    s_and_b32 s35, s35, 7
    s_lshl_b32 s35, s35, 7
    s_add_u32 m0, s6, 0
    s_add_u32 s41, s48, s35
    buffer_load_dwordx4 v10, s[24:27], s41 offen lds
    v_mfma_f32_16x16x32_bf16 v[112:115], v[196:199], v[28:31], v[112:115]
    ds_read_b128 v[20:23], v225 offset:32768
    v_mfma_f32_16x16x32_bf16 v[116:119], v[200:203], v[24:27], v[116:119]
    v_mfma_f32_16x16x32_bf16 v[116:119], v[204:207], v[28:31], v[116:119]
    v_mfma_f32_16x16x32_bf16 v[120:123], v[208:211], v[24:27], v[120:123]
    v_mfma_f32_16x16x32_bf16 v[120:123], v[212:215], v[28:31], v[120:123]
    v_mfma_f32_16x16x32_bf16 v[124:127], v[216:219], v[24:27], v[124:127]
    v_mfma_f32_16x16x32_bf16 v[124:127], v[220:223], v[28:31], v[124:127]
    s_waitcnt lgkmcnt(1)
    v_mfma_f32_16x16x32_bf16 v[64:67], v[32:35], v[16:19], v[64:67]
    ds_read_b128 v[24:27], v225 offset:34816
    s_add_u32 m0, s6, 8192
    s_add_u32 s41, s49, s35
    buffer_load_dwordx4 v10, s[24:27], s41 offen lds
    s_waitcnt lgkmcnt(1)
    v_mfma_f32_16x16x32_bf16 v[64:67], v[36:39], v[20:23], v[64:67]
    ds_read_b128 v[28:31], v224 offset:34816
    v_mfma_f32_16x16x32_bf16 v[68:71], v[40:43], v[16:19], v[68:71]
    ds_read_b64_tr_b16 v[192:193], v4 offset:32768
    v_mfma_f32_16x16x32_bf16 v[68:71], v[44:47], v[20:23], v[68:71]
    ds_read_b64_tr_b16 v[194:195], v4 offset:33792
    v_mfma_f32_16x16x32_bf16 v[72:75], v[48:51], v[16:19], v[72:75]
    ds_read_b64_tr_b16 v[196:197], v4 offset:40960
    v_mfma_f32_16x16x32_bf16 v[72:75], v[52:55], v[20:23], v[72:75]
    ds_read_b64_tr_b16 v[198:199], v4 offset:41984
    v_mfma_f32_16x16x32_bf16 v[76:79], v[56:59], v[16:19], v[76:79]
    ds_read_b64_tr_b16 v[200:201], v5 offset:32768
    v_mfma_f32_16x16x32_bf16 v[76:79], v[60:63], v[20:23], v[76:79]
    ds_read_b64_tr_b16 v[202:203], v5 offset:33792
    s_waitcnt lgkmcnt(7)
    v_mfma_f32_16x16x32_bf16 v[80:83], v[32:35], v[24:27], v[80:83]
    ds_read_b128 v[16:19], v224 offset:36864
    s_add_u32 m0, s6, 16384
    s_add_u32 s41, s50, s35
    buffer_load_dwordx4 v10, s[24:27], s41 offen lds
    s_getpc_b64 s[36:37]
PC_5:
    s_and_b32 s40, s5, 7
    s_lshl_b32 s40, s40, 13
    s_add_u32 s40, s40, s6
    v_and_b32 v2, 7, v0
    v_lshl_add_u32 v2, v2, 7, s40
    v_min_u32 v2, HOT_END-PC_5-4, v2
    v_mov_b32 v3, s37
    v_add_co_u32 v2, vcc, s36, v2
    s_nop 1
    v_addc_co_u32 v3, vcc, 0, v3, vcc
    global_load_dword v1, v[2:3], off
    s_waitcnt lgkmcnt(7)
    v_mfma_f32_16x16x32_bf16 v[80:83], v[36:39], v[28:31], v[80:83]
    ds_read_b128 v[20:23], v225 offset:36864
    v_mfma_f32_16x16x32_bf16 v[84:87], v[40:43], v[24:27], v[84:87]
    ds_read_b64_tr_b16 v[204:205], v5 offset:40960
    v_mfma_f32_16x16x32_bf16 v[84:87], v[44:47], v[28:31], v[84:87]
    ds_read_b64_tr_b16 v[206:207], v5 offset:41984
    v_mfma_f32_16x16x32_bf16 v[88:91], v[48:51], v[24:27], v[88:91]
    ds_read_b64_tr_b16 v[208:209], v6 offset:32768
    v_mfma_f32_16x16x32_bf16 v[88:91], v[52:55], v[28:31], v[88:91]
    ds_read_b64_tr_b16 v[210:211], v6 offset:33792
    v_mfma_f32_16x16x32_bf16 v[92:95], v[56:59], v[24:27], v[92:95]
    ds_read_b64_tr_b16 v[212:213], v6 offset:40960
    v_mfma_f32_16x16x32_bf16 v[92:95], v[60:63], v[28:31], v[92:95]
    ds_read_b64_tr_b16 v[214:215], v6 offset:41984
    s_waitcnt lgkmcnt(7)
    v_mfma_f32_16x16x32_bf16 v[96:99], v[32:35], v[16:19], v[96:99]
    ds_read_b128 v[24:27], v225 offset:38912
    s_add_u32 m0, s6, 24576
    s_add_u32 s41, s51, s35
    buffer_load_dwordx4 v10, s[24:27], s41 offen lds
    s_waitcnt lgkmcnt(7)
    v_mfma_f32_16x16x32_bf16 v[96:99], v[36:39], v[20:23], v[96:99]
    ds_read_b128 v[28:31], v224 offset:38912
    v_mfma_f32_16x16x32_bf16 v[100:103], v[40:43], v[16:19], v[100:103]
    ds_read_b64_tr_b16 v[216:217], v7 offset:32768
    v_mfma_f32_16x16x32_bf16 v[100:103], v[44:47], v[20:23], v[100:103]
    ds_read_b64_tr_b16 v[218:219], v7 offset:33792
    v_mfma_f32_16x16x32_bf16 v[104:107], v[48:51], v[16:19], v[104:107]
    ds_read_b64_tr_b16 v[220:221], v7 offset:40960
    v_mfma_f32_16x16x32_bf16 v[104:107], v[52:55], v[20:23], v[104:107]
    ds_read_b64_tr_b16 v[222:223], v7 offset:41984
    v_mfma_f32_16x16x32_bf16 v[108:111], v[56:59], v[16:19], v[108:111]
    v_mfma_f32_16x16x32_bf16 v[108:111], v[60:63], v[20:23], v[108:111]
    s_waitcnt vmcnt(9)
    s_cmp_lg_u32 s3, 0
    s_cbranch_scc1 NP_6
    s_mov_b32 s98, 1
    s_mov_b32 s99, 20000
POLL_8:
    v_and_b32 v15, s98, v15
    v_cmp_ne_u32 vcc, s98, v15
    s_cbranch_vccz PCK_7
    s_sleep 2
    buffer_load_dword v15, v13, s[20:23], s53 offen sc1
    s_sub_u32 s99, s99, 1
    s_cmp_lg_u32 s99, 0
    s_waitcnt vmcnt(0)
    s_cbranch_scc1 POLL_8
PCK_7:
NP_6:
    s_waitcnt lgkmcnt(0)
    s_waitcnt vmcnt(7)
    s_waitcnt vmcnt(5)
    s_barrier
    v_mfma_f32_16x16x32_bf16 v[112:115], v[32:35], v[24:27], v[112:115]
    ds_read_b128 v[16:19], v226 offset:0
    s_lshl_b32 s40, s3, 12
    s_add_u32 m0, s40, 0x8000
    s_lshl_b32 s41, s4, 20
    s_add_u32 s41, s41, s40
    buffer_load_dwordx4 v12, s[20:23], s41 offen offset:0 sc1 lds
    v_mfma_f32_16x16x32_bf16 v[112:115], v[36:39], v[28:31], v[112:115]
    ds_read_b128 v[20:23], v227 offset:0
    s_lshl_b32 s40, s4, 7
    s_lshl_b32 s41, s5, 2
    s_add_u32 s40, s40, s41
    s_add_u32 s40, s40, 71368704
    s_cmp_eq_u32 s3, 0
    s_cselect_b32 s99, 0, 1073741824
    v_mov_b32 v2, 3
    v_mov_b32 v3, s99
    buffer_store_dword v2, v3, s[20:23], s40 offen sc1
    v_mfma_f32_16x16x32_bf16 v[116:119], v[40:43], v[24:27], v[116:119]
    v_mfma_f32_16x16x32_bf16 v[116:119], v[44:47], v[28:31], v[116:119]
    v_mfma_f32_16x16x32_bf16 v[120:123], v[48:51], v[24:27], v[120:123]
    v_mfma_f32_16x16x32_bf16 v[120:123], v[52:55], v[28:31], v[120:123]
    v_mfma_f32_16x16x32_bf16 v[124:127], v[56:59], v[24:27], v[124:127]
    v_mfma_f32_16x16x32_bf16 v[124:127], v[60:63], v[28:31], v[124:127]
    s_waitcnt lgkmcnt(1)
    v_mfma_f32_16x16x32_bf16 v[64:67], v[192:195], v[16:19], v[64:67]
    ds_read_b128 v[24:27], v227 offset:2048
    s_lshl_b32 s40, s3, 12
    s_add_u32 m0, s40, 0x8000
    s_lshl_b32 s41, s4, 20
    s_add_u32 s41, s41, s40
    buffer_load_dwordx4 v12, s[20:23], s41 offen offset:1024 sc1 lds
    s_mov_b32 s12, s72
    s_mov_b32 s13, s73
    s_mov_b32 s14, 2097152
    s_mov_b32 s15, 0x00020000
    s_waitcnt lgkmcnt(1)
    v_mfma_f32_16x16x32_bf16 v[64:67], v[196:199], v[20:23], v[64:67]
    ds_read_b128 v[28:31], v226 offset:2048
    v_mfma_f32_16x16x32_bf16 v[68:71], v[200:203], v[16:19], v[68:71]
    ds_read_b64_tr_b16 v[32:33], v4 offset:49152
    v_mfma_f32_16x16x32_bf16 v[68:71], v[204:207], v[20:23], v[68:71]
    ds_read_b64_tr_b16 v[34:35], v4 offset:50176
    v_mfma_f32_16x16x32_bf16 v[72:75], v[208:211], v[16:19], v[72:75]
    ds_read_b64_tr_b16 v[36:37], v4 offset:57344
    v_mfma_f32_16x16x32_bf16 v[72:75], v[212:215], v[20:23], v[72:75]
    ds_read_b64_tr_b16 v[38:39], v4 offset:58368
    v_mfma_f32_16x16x32_bf16 v[76:79], v[216:219], v[16:19], v[76:79]
    ds_read_b64_tr_b16 v[40:41], v5 offset:49152
    v_mfma_f32_16x16x32_bf16 v[76:79], v[220:223], v[20:23], v[76:79]
    ds_read_b64_tr_b16 v[42:43], v5 offset:50176
    s_waitcnt lgkmcnt(7)
    v_mfma_f32_16x16x32_bf16 v[80:83], v[192:195], v[24:27], v[80:83]
    ds_read_b128 v[16:19], v226 offset:4096
    s_lshl_b32 s40, s3, 12
    s_add_u32 m0, s40, 0x8000
    s_lshl_b32 s41, s4, 20
    s_add_u32 s41, s41, s40
    buffer_load_dwordx4 v12, s[20:23], s41 offen offset:2048 sc1 lds
    s_mov_b32 s8, s66
    s_mov_b32 s9, s67
    s_mov_b32 s10, 2097152
    s_mov_b32 s11, 0x00020000
    s_waitcnt lgkmcnt(7)
    v_mfma_f32_16x16x32_bf16 v[80:83], v[196:199], v[28:31], v[80:83]
    ds_read_b128 v[20:23], v227 offset:4096
    v_mfma_f32_16x16x32_bf16 v[84:87], v[200:203], v[24:27], v[84:87]
    ds_read_b64_tr_b16 v[44:45], v5 offset:57344
    v_mfma_f32_16x16x32_bf16 v[84:87], v[204:207], v[28:31], v[84:87]
    ds_read_b64_tr_b16 v[46:47], v5 offset:58368
    v_mfma_f32_16x16x32_bf16 v[88:91], v[208:211], v[24:27], v[88:91]
    ds_read_b64_tr_b16 v[48:49], v6 offset:49152
    s_mov_b32 s16, s68
    s_mov_b32 s17, s69
    s_mov_b32 s18, 2097152
    s_mov_b32 s19, 0x00020000
    v_mfma_f32_16x16x32_bf16 v[88:91], v[212:215], v[28:31], v[88:91]
    ds_read_b64_tr_b16 v[50:51], v6 offset:50176
    v_mfma_f32_16x16x32_bf16 v[92:95], v[216:219], v[24:27], v[92:95]
    ds_read_b64_tr_b16 v[52:53], v6 offset:57344
    v_mfma_f32_16x16x32_bf16 v[92:95], v[220:223], v[28:31], v[92:95]
    ds_read_b64_tr_b16 v[54:55], v6 offset:58368
    s_waitcnt lgkmcnt(7)
    v_mfma_f32_16x16x32_bf16 v[96:99], v[192:195], v[16:19], v[96:99]
    ds_read_b128 v[24:27], v227 offset:6144
    s_lshl_b32 s40, s3, 12
    s_add_u32 m0, s40, 0x8000
    s_lshl_b32 s41, s4, 20
    s_add_u32 s41, s41, s40
    buffer_load_dwordx4 v12, s[20:23], s41 offen offset:3072 sc1 lds
    s_mov_b32 s24, s70
    s_mov_b32 s25, s71
    s_mov_b32 s26, 4096
    s_mov_b32 s27, 0x00020000
    s_waitcnt lgkmcnt(7)
    v_mfma_f32_16x16x32_bf16 v[96:99], v[196:199], v[20:23], v[96:99]
    ds_read_b128 v[28:31], v226 offset:6144
    v_mfma_f32_16x16x32_bf16 v[100:103], v[200:203], v[16:19], v[100:103]
    ds_read_b64_tr_b16 v[56:57], v7 offset:49152
    v_mfma_f32_16x16x32_bf16 v[100:103], v[204:207], v[20:23], v[100:103]
    ds_read_b64_tr_b16 v[58:59], v7 offset:50176
    v_mfma_f32_16x16x32_bf16 v[104:107], v[208:211], v[16:19], v[104:107]
    ds_read_b64_tr_b16 v[60:61], v7 offset:57344
    s_mov_b32 s28, s86
    s_mov_b32 s29, s87
    s_mov_b32 s30, 4194304
    s_mov_b32 s31, 0x00020000
    v_mfma_f32_16x16x32_bf16 v[104:107], v[212:215], v[20:23], v[104:107]
    ds_read_b64_tr_b16 v[62:63], v7 offset:58368
    v_mfma_f32_16x16x32_bf16 v[108:111], v[216:219], v[16:19], v[108:111]
    v_mfma_f32_16x16x32_bf16 v[108:111], v[220:223], v[20:23], v[108:111]
    s_waitcnt lgkmcnt(0)
    s_waitcnt vmcnt(5)
    s_barrier
    v_mfma_f32_16x16x32_bf16 v[112:115], v[192:195], v[24:27], v[112:115]
    ds_read_b128 v[16:19], v224 offset:0
    v_mfma_f32_16x16x32_bf16 v[112:115], v[196:199], v[28:31], v[112:115]
    ds_read_b128 v[20:23], v225 offset:0
    v_mfma_f32_16x16x32_bf16 v[116:119], v[200:203], v[24:27], v[116:119]
    v_mfma_f32_16x16x32_bf16 v[116:119], v[204:207], v[28:31], v[116:119]
    v_mfma_f32_16x16x32_bf16 v[120:123], v[208:211], v[24:27], v[120:123]
    v_mfma_f32_16x16x32_bf16 v[120:123], v[212:215], v[28:31], v[120:123]
    v_mfma_f32_16x16x32_bf16 v[124:127], v[216:219], v[24:27], v[124:127]
    v_mfma_f32_16x16x32_bf16 v[124:127], v[220:223], v[28:31], v[124:127]
    s_waitcnt lgkmcnt(1)
    v_mfma_f32_16x16x32_bf16 v[64:67], v[32:35], v[16:19], v[64:67]
    ds_read_b128 v[24:27], v225 offset:2048
    s_and_b32 s55, s3, 2
    s_lshl_b32 s55, s55, 15
    s_waitcnt lgkmcnt(1)
    v_mfma_f32_16x16x32_bf16 v[64:67], v[36:39], v[20:23], v[64:67]
    ds_read_b128 v[28:31], v224 offset:2048
    s_add_u32 s55, s55, 65536
    v_mfma_f32_16x16x32_bf16 v[68:71], v[40:43], v[16:19], v[68:71]
    v_mov_b64 v[192:193], 0
    v_mov_b64 v[194:195], 0
    v_mfma_f32_16x16x32_bf16 v[68:71], v[44:47], v[20:23], v[68:71]
    v_mov_b64 v[196:197], 0
    v_mfma_f32_16x16x32_bf16 v[72:75], v[48:51], v[16:19], v[72:75]
    v_mov_b64 v[198:199], 0
    v_mov_b64 v[200:201], 0
    v_mfma_f32_16x16x32_bf16 v[72:75], v[52:55], v[20:23], v[72:75]
    v_mov_b64 v[202:203], 0
    v_mfma_f32_16x16x32_bf16 v[76:79], v[56:59], v[16:19], v[76:79]
    v_mov_b64 v[204:205], 0
    v_mov_b64 v[206:207], 0
    v_mfma_f32_16x16x32_bf16 v[76:79], v[60:63], v[20:23], v[76:79]
    v_mov_b64 v[208:209], 0
    s_waitcnt lgkmcnt(1)
    v_mfma_f32_16x16x32_bf16 v[80:83], v[32:35], v[24:27], v[80:83]
    ds_read_b128 v[16:19], v224 offset:4096
    s_and_b32 s54, s3, 1
    s_lshl_b32 s54, s54, 14
    s_waitcnt lgkmcnt(1)
    v_mfma_f32_16x16x32_bf16 v[80:83], v[36:39], v[28:31], v[80:83]
    ds_read_b128 v[20:23], v225 offset:4096
    s_add_u32 s55, s55, s54
    v_mfma_f32_16x16x32_bf16 v[84:87], v[40:43], v[24:27], v[84:87]
    v_mov_b64 v[210:211], 0
    v_mov_b64 v[212:213], 0
    v_mfma_f32_16x16x32_bf16 v[84:87], v[44:47], v[28:31], v[84:87]
    v_mov_b64 v[214:215], 0
    v_mfma_f32_16x16x32_bf16 v[88:91], v[48:51], v[24:27], v[88:91]
    v_mov_b64 v[216:217], 0
    v_mov_b64 v[218:219], 0
    v_mfma_f32_16x16x32_bf16 v[88:91], v[52:55], v[28:31], v[88:91]
    v_mov_b64 v[220:221], 0
    v_mfma_f32_16x16x32_bf16 v[92:95], v[56:59], v[24:27], v[92:95]
    v_mov_b64 v[222:223], 0
    v_mov_b64 v[232:233], 0
    v_mfma_f32_16x16x32_bf16 v[92:95], v[60:63], v[28:31], v[92:95]
    v_mov_b64 v[234:235], 0
    s_waitcnt lgkmcnt(1)
    v_mfma_f32_16x16x32_bf16 v[96:99], v[32:35], v[16:19], v[96:99]
    ds_read_b128 v[24:27], v225 offset:6144
    s_lshl_b32 s54, s43, 10
    s_add_u32 s55, s55, s54
    s_waitcnt lgkmcnt(1)
    v_mfma_f32_16x16x32_bf16 v[96:99], v[36:39], v[20:23], v[96:99]
    ds_read_b128 v[28:31], v224 offset:6144
    v_add_u32 v14, s55, v12
    v_mov_b64 v[236:237], 0
    v_mfma_f32_16x16x32_bf16 v[100:103], v[40:43], v[16:19], v[100:103]
    v_mov_b64 v[238:239], 0
    v_mfma_f32_16x16x32_bf16 v[100:103], v[44:47], v[20:23], v[100:103]
    v_mov_b64 v[240:241], 0
    v_mov_b64 v[242:243], 0
    v_mfma_f32_16x16x32_bf16 v[104:107], v[48:51], v[16:19], v[104:107]
    v_mov_b64 v[244:245], 0
    v_mov_b64 v[246:247], 0
    v_mfma_f32_16x16x32_bf16 v[104:107], v[52:55], v[20:23], v[104:107]
    v_mov_b64 v[248:249], 0
    v_mfma_f32_16x16x32_bf16 v[108:111], v[56:59], v[16:19], v[108:111]
    v_mov_b64 v[250:251], 0
    v_mov_b64 v[252:253], 0
    v_mfma_f32_16x16x32_bf16 v[108:111], v[60:63], v[20:23], v[108:111]
    v_mov_b64 v[254:255], 0
    buffer_load_dword v15, v13, s[20:23], s53 offen sc1
    s_waitcnt lgkmcnt(1)
    v_mfma_f32_16x16x32_bf16 v[112:115], v[32:35], v[24:27], v[112:115]
    v_mov_b64 v[224:225], 0
    s_waitcnt lgkmcnt(0)
    v_mfma_f32_16x16x32_bf16 v[112:115], v[36:39], v[28:31], v[112:115]
    v_mfma_f32_16x16x32_bf16 v[116:119], v[40:43], v[24:27], v[116:119]
    v_mov_b64 v[226:227], 0
    v_mfma_f32_16x16x32_bf16 v[116:119], v[44:47], v[28:31], v[116:119]
    v_mfma_f32_16x16x32_bf16 v[120:123], v[48:51], v[24:27], v[120:123]
    v_mov_b64 v[228:229], 0
    v_mfma_f32_16x16x32_bf16 v[120:123], v[52:55], v[28:31], v[120:123]
    v_mfma_f32_16x16x32_bf16 v[124:127], v[56:59], v[24:27], v[124:127]
    v_mov_b64 v[230:231], 0
    v_mfma_f32_16x16x32_bf16 v[124:127], v[60:63], v[28:31], v[124:127]
    v_mov_b32 v16, v13
    v_cvt_pk_bf16_f32 v64, v64, v65
    v_cvt_pk_bf16_f32 v65, v66, v67
    v_cvt_pk_bf16_f32 v66, v68, v69
    v_cvt_pk_bf16_f32 v67, v70, v71
    ds_write_b128 v14, v[64:67] offset:0
    v_cvt_pk_bf16_f32 v72, v72, v73
    v_cvt_pk_bf16_f32 v73, v74, v75
    v_cvt_pk_bf16_f32 v74, v76, v77
    v_cvt_pk_bf16_f32 v75, v78, v79
    ds_write_b128 v14, v[72:75] offset:1024
    v_cvt_pk_bf16_f32 v80, v80, v81
    v_cvt_pk_bf16_f32 v81, v82, v83
    v_cvt_pk_bf16_f32 v82, v84, v85
    v_cvt_pk_bf16_f32 v83, v86, v87
    ds_write_b128 v14, v[80:83] offset:4096
    v_cvt_pk_bf16_f32 v88, v88, v89
    v_cvt_pk_bf16_f32 v89, v90, v91
    v_cvt_pk_bf16_f32 v90, v92, v93
    v_cvt_pk_bf16_f32 v91, v94, v95
    ds_write_b128 v14, v[88:91] offset:5120
    v_cvt_pk_bf16_f32 v96, v96, v97
    v_cvt_pk_bf16_f32 v97, v98, v99
    v_cvt_pk_bf16_f32 v98, v100, v101
    v_cvt_pk_bf16_f32 v99, v102, v103
    ds_write_b128 v14, v[96:99] offset:8192
    v_cvt_pk_bf16_f32 v104, v104, v105
    v_cvt_pk_bf16_f32 v105, v106, v107
    v_cvt_pk_bf16_f32 v106, v108, v109
    v_cvt_pk_bf16_f32 v107, v110, v111
    ds_write_b128 v14, v[104:107] offset:9216
    v_cvt_pk_bf16_f32 v112, v112, v113
    v_cvt_pk_bf16_f32 v113, v114, v115
    v_cvt_pk_bf16_f32 v114, v116, v117
    v_cvt_pk_bf16_f32 v115, v118, v119
    ds_write_b128 v14, v[112:115] offset:12288
    v_cvt_pk_bf16_f32 v120, v120, v121
    v_cvt_pk_bf16_f32 v121, v122, v123
    v_cvt_pk_bf16_f32 v122, v124, v125
    v_cvt_pk_bf16_f32 v123, v126, v127
    ds_write_b128 v14, v[120:123] offset:13312
    s_lshr_b32 s33, s3, 2
    s_and_b32 s32, s3, 3
    v_lshlrev_b32 v6, 4, v0
    s_lshl_b32 s44, s32, 12
    s_add_u32 s44, s44, 131072
    v_add_u32 v11, s44, v6
    s_lshl_b32 s45, s33, 16
    v_subrev_u32 v13, s45, v11
    v_xor_b32 v8, 0x7000, v13
    s_mov_b32 s34, s5
    s_lshl_b32 s35, s5, 1
    s_sub_u32 s35, 14, s35
    s_cmp_eq_u32 s33, 1
    s_cselect_b32 s58, 0, -1
    s_lshl_b32 s43, s3, 12
    s_lshl_b32 s37, s4, 20
    s_add_u32 s37, s37, s43
    s_add_u32 s36, s37, 0x10000
    s_add_u32 s37, s37, 0x8000
    s_mov_b32 s38, s43
    s_add_u32 s39, s43, 0x18000
    s_mov_b32 s42, 0x40004000
    v_mov_b32 v10, 0xff800000
    v_mov_b32 v60, 0x3f803f80
    v_mov_b64 v[152:153], 0
    v_mov_b32 v61, 0x3f803f80
    v_mov_b64 v[154:155], 0
    v_mov_b32 v62, 0x3f803f80
    v_mov_b64 v[156:157], 0
    v_mov_b32 v63, 0x3f803f80
    v_mov_b64 v[158:159], 0
    v_and_b32 v9, 15, v0
    v_lshrrev_b32 v12, 4, v0
    v_lshlrev_b32 v12, 2, v12
    v_sub_u32 v9, v9, v12
    s_lshl_b32 s44, s32, 4
    s_sub_u32 s45, 112, s44
    v_add_u32 v7, s45, v9
    v_add_u32 v9, s44, v9
    v_and_b32 v4, 15, v0
    v_lshlrev_b32 v4, 4, v4
    v_lshrrev_b32 v12, 4, v0
    v_lshl_add_u32 v4, v12, 11, v4
    v_add_u32 v4, 0x8000, v4
    s_lshr_b32 s44, s32, 1
    s_lshl_b32 s44, s44, 18
    s_and_b32 s45, s32, 1
    s_lshl_b32 s45, s45, 10
    s_add_u32 s44, s44, s45
    s_lshl_b32 s45, s4, 13
    s_add_u32 s43, s44, s45
    s_add_u32 s43, s43, 50331648
    s_lshl_b32 s59, s5, 20
    s_add_u32 s59, s59, s43
    s_mov_b32 s55, 0
    s_lshr_b32 s56, s7, 6
    s_lshl_b32 s56, s56, 2
    s_bfe_u32 s44, s7, 0x20003
    s_add_u32 s56, s56, s44
    s_lshl_b32 s56, s56, 1
    s_bfe_u32 s44, s7, 0x10005
    s_add_u32 s56, s56, s44
    s_and_b32 s57, s7, 7
    s_mov_b32 s41, 0
    s_lshr_b32 s40, 1024, s33
    s_or_b32 s40, s40, 256
    s_lshl_b32 s44, 2, s3
    s_and_b32 s44, s44, 30
    s_or_b32 s40, s40, s44
    s_cmp_eq_u32 s3, 0
    s_cselect_b32 s44, 4128, 0
    s_or_b32 s40, s40, s44
    s_cmp_eq_u32 s33, 1
    s_cbranch_scc0 PR_9
    s_setprio 1
PR_9:
    s_waitcnt vmcnt(0)
    s_cmp_lg_u32 s3, 0
    s_cbranch_scc1 NP_10
    s_mov_b32 s98, 3
    s_mov_b32 s99, 20000
POLL_12:
    v_and_b32 v15, s98, v15
    v_cmp_ne_u32 vcc, s98, v15
    s_cbranch_vccz PCK_11
    s_sleep 2
    buffer_load_dword v15, v16, s[20:23], s53 offen sc1
    s_sub_u32 s99, s99, 1
    s_cmp_lg_u32 s99, 0
    s_waitcnt vmcnt(0)
    s_cbranch_scc1 POLL_12
PCK_11:
NP_10:
    s_waitcnt lgkmcnt(0)
    s_barrier
ATT_START:
    ds_read_b128 v[160:163], v13 offset:0
    ds_read_b128 v[64:67], v4 offset:0
    ds_read_b128 v[164:167], v13 offset:1024
    ds_read_b128 v[68:71], v4 offset:256
    ds_read_b128 v[168:171], v13 offset:2048
    ds_read_b128 v[72:75], v4 offset:512
    ds_read_b128 v[172:175], v13 offset:3072
    ds_read_b128 v[76:79], v4 offset:768
    ds_read_b128 v[176:179], v8 offset:0
    ds_read_b128 v[180:183], v8 offset:1024
    ds_read_b128 v[184:187], v8 offset:2048
    ds_read_b128 v[188:191], v8 offset:3072
    s_waitcnt lgkmcnt(4)
    v_mfma_f32_16x16x32_bf16 v[112:115], v[64:67], v[160:163], 0
    ds_read_b128 v[80:83], v4 offset:1024
    s_mov_b32 m0, s39
    s_xor_b32 s39, s39, 0x8000
    buffer_load_dwordx4 v6, s[20:23], s37 offen offset:0 sc1 lds
    v_mfma_f32_16x16x32_bf16 v[112:115], v[68:71], v[164:167], v[112:115]
    ds_read_b128 v[84:87], v4 offset:1280
    v_mfma_f32_16x16x32_bf16 v[112:115], v[72:75], v[168:171], v[112:115]
    ds_read_b128 v[88:91], v4 offset:1536
    buffer_load_dwordx4 v6, s[20:23], s37 offen offset:1024 sc1 lds
    v_mfma_f32_16x16x32_bf16 v[112:115], v[76:79], v[172:175], v[112:115]
    ds_read_b128 v[92:95], v4 offset:1792
    s_waitcnt lgkmcnt(4)
    v_mfma_f32_16x16x32_bf16 v[120:123], v[64:67], v[176:179], 0
    buffer_load_dwordx4 v6, s[20:23], s37 offen offset:2048 sc1 lds
    v_mfma_f32_16x16x32_bf16 v[120:123], v[68:71], v[180:183], v[120:123]
    ds_read_b128 v[64:67], v4 offset:8192
    v_mfma_f32_16x16x32_bf16 v[120:123], v[72:75], v[184:187], v[120:123]
    ds_read_b128 v[68:71], v4 offset:8448
    buffer_load_dwordx4 v6, s[20:23], s37 offen offset:3072 sc1 lds
    s_add_u32 s37, s37, 0x10000
    v_mfma_f32_16x16x32_bf16 v[120:123], v[76:79], v[188:191], v[120:123]
    ds_read_b128 v[72:75], v4 offset:8704
    s_waitcnt lgkmcnt(3)
    v_mfma_f32_16x16x32_bf16 v[116:119], v[80:83], v[160:163], 0
    ds_read_b128 v[76:79], v4 offset:8960
    s_mov_b32 m0, s38
    s_xor_b32 s38, s38, 0x8000
    buffer_load_dwordx4 v6, s[20:23], s36 offen offset:0 sc1 lds
    v_mfma_f32_16x16x32_bf16 v[116:119], v[84:87], v[164:167], v[116:119]
    v_mfma_f32_16x16x32_bf16 v[116:119], v[88:91], v[168:171], v[116:119]
    buffer_load_dwordx4 v6, s[20:23], s36 offen offset:1024 sc1 lds
    v_mfma_f32_16x16x32_bf16 v[116:119], v[92:95], v[172:175], v[116:119]
    v_mfma_f32_16x16x32_bf16 v[124:127], v[80:83], v[176:179], 0
    buffer_load_dwordx4 v6, s[20:23], s36 offen offset:2048 sc1 lds
    v_mfma_f32_16x16x32_bf16 v[124:127], v[84:87], v[180:183], v[124:127]
    ds_read_b128 v[80:83], v4 offset:9216
    v_mfma_f32_16x16x32_bf16 v[124:127], v[88:91], v[184:187], v[124:127]
    ds_read_b128 v[84:87], v4 offset:9472
    buffer_load_dwordx4 v6, s[20:23], s36 offen offset:3072 sc1 lds
    s_add_u32 s36, s36, 0x10000
    v_mfma_f32_16x16x32_bf16 v[124:127], v[92:95], v[188:191], v[124:127]
    ds_read_b128 v[88:91], v4 offset:9728
    s_cmp_eq_u32 s34, s58
    s_cbranch_scc1 OOL_20
RET_21:
    v_max3_f32 v12, v112, v113, v114
    v_max3_f32 v12, v12, v115, v116
    v_max3_f32 v12, v12, v117, v118
    v_max_f32 v12, v12, v119
    v_max3_f32 v13, v120, v121, v122
    v_max3_f32 v13, v13, v123, v124
    v_max3_f32 v13, v13, v125, v126
    v_max_f32 v13, v13, v127
    v_mov_b32 v14, v12
    v_mov_b32 v15, v13
    s_nop 0
    v_permlane16_swap_b32 v14, v12
    v_permlane16_swap_b32 v15, v13
    v_max_f32 v12, v12, v14
    v_max_f32 v13, v13, v15
    v_mov_b32 v14, v12
    v_mov_b32 v15, v13
    s_nop 0
    v_permlane32_swap_b32 v14, v12
    v_permlane32_swap_b32 v15, v13
    v_max_f32 v12, v12, v14
    v_max_f32 v13, v13, v15
    v_max_f32 v12, 0xf149f2ca, v12
    v_add_f32 v12, 0x41300000, v12
    v_max_f32 v13, 0xf149f2ca, v13
    v_add_f32 v13, 0x41300000, v13
    v_sub_f32 v144, 0, v12
    v_sub_f32 v145, 0, v12
    v_sub_f32 v146, 0, v12
    v_sub_f32 v147, 0, v12
    v_sub_f32 v148, 0, v13
    v_sub_f32 v149, 0, v13
    v_sub_f32 v150, 0, v13
    v_sub_f32 v151, 0, v13
    s_waitcnt lgkmcnt(3)
    v_mfma_f32_16x16x32_bf16 v[128:131], v[64:67], v[160:163], v[144:147]
    ds_read_b128 v[92:95], v4 offset:9984
    v_sub_f32 v112, v112, v12
    v_sub_f32 v113, v113, v12
    v_mfma_f32_16x16x32_bf16 v[128:131], v[68:71], v[164:167], v[128:131]
    v_sub_f32 v114, v114, v12
    v_sub_f32 v115, v115, v12
    v_sub_f32 v116, v116, v12
    v_mfma_f32_16x16x32_bf16 v[128:131], v[72:75], v[168:171], v[128:131]
    v_sub_f32 v117, v117, v12
    v_sub_f32 v118, v118, v12
    v_sub_f32 v119, v119, v12
    v_mfma_f32_16x16x32_bf16 v[128:131], v[76:79], v[172:175], v[128:131]
    v_sub_f32 v120, v120, v13
    v_sub_f32 v121, v121, v13
    v_sub_f32 v122, v122, v13
    v_mfma_f32_16x16x32_bf16 v[136:139], v[64:67], v[176:179], v[148:151]
    v_sub_f32 v123, v123, v13
    v_sub_f32 v124, v124, v13
    v_sub_f32 v125, v125, v13
    v_mfma_f32_16x16x32_bf16 v[136:139], v[68:71], v[180:183], v[136:139]
    v_sub_f32 v126, v126, v13
    v_sub_f32 v127, v127, v13
    v_mfma_f32_16x16x32_bf16 v[136:139], v[72:75], v[184:187], v[136:139]
    v_exp_f32 v56, v112
    v_exp_f32 v57, v113
    v_mfma_f32_16x16x32_bf16 v[136:139], v[76:79], v[188:191], v[136:139]
    v_exp_f32 v58, v114
    v_cvt_pk_bf16_f32 v96, v56, v57
    s_waitcnt lgkmcnt(0)
    v_mfma_f32_16x16x32_bf16 v[132:135], v[80:83], v[160:163], v[144:147]
    v_xor_b32 v5, 0x10000, v4
    v_xor_b32 v4, 0x4000, v4
    v_exp_f32 v59, v115
    v_mfma_f32_16x16x32_bf16 v[132:135], v[84:87], v[164:167], v[132:135]
    v_exp_f32 v56, v116
    v_cvt_pk_bf16_f32 v97, v58, v59
    v_mfma_f32_16x16x32_bf16 v[132:135], v[88:91], v[168:171], v[132:135]
    v_exp_f32 v57, v117
    v_mfma_f32_16x16x32_bf16 v[132:135], v[92:95], v[172:175], v[132:135]
    v_exp_f32 v58, v118
    v_cvt_pk_bf16_f32 v98, v56, v57
    v_mfma_f32_16x16x32_bf16 v[140:143], v[80:83], v[176:179], v[148:151]
    v_exp_f32 v59, v119
    v_or3_b32 v8, v96, v97, v98
    v_mfma_f32_16x16x32_bf16 v[140:143], v[84:87], v[180:183], v[140:143]
    v_exp_f32 v56, v120
    v_cvt_pk_bf16_f32 v99, v58, v59
    v_mfma_f32_16x16x32_bf16 v[140:143], v[88:91], v[184:187], v[140:143]
    v_exp_f32 v57, v121
    v_exp_f32 v58, v122
    v_mfma_f32_16x16x32_bf16 v[140:143], v[92:95], v[188:191], v[140:143]
    v_cvt_pk_bf16_f32 v100, v56, v57
    v_exp_f32 v59, v123
    v_or3_b32 v8, v8, v99, v100
    v_exp_f32 v56, v124
    v_cvt_pk_bf16_f32 v101, v58, v59
    v_exp_f32 v57, v125
    s_waitcnt vmcnt(4)
    s_waitcnt lgkmcnt(0)
    s_barrier
    ds_read_b128 v[64:67], v4 offset:0
    ds_read_b128 v[68:71], v4 offset:256
    ds_read_b128 v[72:75], v4 offset:512
    ds_read_b128 v[76:79], v4 offset:768
    ds_read_b128 v[80:83], v4 offset:1024
    v_exp_f32 v58, v126
    v_cvt_pk_bf16_f32 v102, v56, v57
    ds_read_b128 v[84:87], v4 offset:1280
    v_exp_f32 v59, v127
    v_or3_b32 v8, v8, v101, v102
    v_cvt_pk_bf16_f32 v103, v58, v59
    v_or_b32 v8, v8, v103
    ds_read_b128 v[88:91], v4 offset:1536
    v_and_b32 v8, s42, v8
    v_cmp_ne_u32 vcc, 0, v8
    s_cbranch_vccnz RARE_22
BACK_23:
    s_cmp_eq_u32 s34, s58
    s_cbranch_scc1 OOL_24
RET_25:
    s_cmp_eq_u32 s33, 1
    s_cbranch_scc1 ODD1_27
    s_branch ODD0_26
EVEN_33:
    s_waitcnt lgkmcnt(4)
    v_mfma_f32_16x16x32_bf16 v[208:211], v[72:75], v[104:107], v[208:211]
    v_or3_b32 v8, v8, v99, v100
    v_mfma_f32_16x16x32_bf16 v[216:219], v[72:75], v[108:111], v[216:219]
    v_exp_f32 v56, v124
    v_mfma_f32_16x16x32_bf16 v[212:215], v[76:79], v[104:107], v[212:215]
    v_cvt_pk_bf16_f32 v101, v58, v59
    v_mfma_f32_16x16x32_bf16 v[220:223], v[76:79], v[108:111], v[220:223]
    v_exp_f32 v57, v125
    s_waitcnt vmcnt(4)
    s_waitcnt lgkmcnt(0)
    s_barrier
    v_mfma_f32_16x16x32_bf16 v[224:227], v[80:83], v[104:107], v[224:227]
    ds_read_b128 v[64:67], v4 offset:0
    ds_read_b128 v[68:71], v4 offset:256
    v_mfma_f32_16x16x32_bf16 v[232:235], v[80:83], v[108:111], v[232:235]
    ds_read_b128 v[72:75], v4 offset:512
    ds_read_b128 v[76:79], v4 offset:768
    v_mfma_f32_16x16x32_bf16 v[228:231], v[84:87], v[104:107], v[228:231]
    ds_read_b128 v[80:83], v4 offset:1024
    v_exp_f32 v58, v126
    v_mfma_f32_16x16x32_bf16 v[236:239], v[84:87], v[108:111], v[236:239]
    v_cvt_pk_bf16_f32 v102, v56, v57
    v_mfma_f32_16x16x32_bf16 v[240:243], v[88:91], v[104:107], v[240:243]
    ds_read_b128 v[84:87], v4 offset:1280
    v_exp_f32 v59, v127
    v_mfma_f32_16x16x32_bf16 v[248:251], v[88:91], v[108:111], v[248:251]
    v_or3_b32 v8, v8, v101, v102
    v_cvt_pk_bf16_f32 v103, v58, v59
    v_or_b32 v8, v8, v103
    v_mfma_f32_16x16x32_bf16 v[244:247], v[92:95], v[104:107], v[244:247]
    ds_read_b128 v[88:91], v4 offset:1536
    v_and_b32 v8, s42, v8
    v_mfma_f32_16x16x32_bf16 v[252:255], v[92:95], v[108:111], v[252:255]
    v_cmp_ne_u32 vcc, 0, v8
    s_cbranch_vccnz RARE_36
BACK_37:
    s_waitcnt lgkmcnt(3)
    v_mfma_f32_16x16x32_bf16 v[112:115], v[64:67], v[160:163], v[144:147]
    ds_read_b128 v[92:95], v4 offset:1792
    v_mfma_f32_16x16x32_bf16 v[112:115], v[68:71], v[164:167], v[112:115]
    s_add_u32 s41, s41, 1
    s_bitcmp1_b32 s40, s41
    s_cbranch_scc1 STUB_38
RET_39:
    v_mfma_f32_16x16x32_bf16 v[112:115], v[72:75], v[168:171], v[112:115]
    v_exp_f32 v56, v128
    v_mfma_f32_16x16x32_bf16 v[112:115], v[76:79], v[172:175], v[112:115]
    v_exp_f32 v57, v129
    v_mfma_f32_16x16x32_bf16 v[120:123], v[64:67], v[176:179], v[148:151]
    v_exp_f32 v58, v130
    v_cvt_pk_bf16_f32 v104, v56, v57
    v_mfma_f32_16x16x32_bf16 v[120:123], v[68:71], v[180:183], v[120:123]
    ds_read_b128 v[64:67], v5 offset:0
    v_mfma_f32_16x16x32_bf16 v[120:123], v[72:75], v[184:187], v[120:123]
    ds_read_b128 v[68:71], v5 offset:256
    s_mov_b32 m0, s38
    s_xor_b32 s38, s38, 0x8000
    buffer_load_dwordx4 v6, s[20:23], s36 offen offset:0 sc1 lds
    v_mfma_f32_16x16x32_bf16 v[120:123], v[76:79], v[188:191], v[120:123]
    ds_read_b128 v[72:75], v5 offset:512
    v_exp_f32 v59, v131
    s_waitcnt lgkmcnt(3)
    v_mfma_f32_16x16x32_bf16 v[116:119], v[80:83], v[160:163], v[144:147]
    ds_read_b128 v[76:79], v5 offset:768
    v_mfma_f32_16x16x32_bf16 v[116:119], v[84:87], v[164:167], v[116:119]
    v_exp_f32 v56, v132
    v_cvt_pk_bf16_f32 v105, v58, v59
    v_mfma_f32_16x16x32_bf16 v[116:119], v[88:91], v[168:171], v[116:119]
    v_exp_f32 v57, v133
    v_mfma_f32_16x16x32_bf16 v[116:119], v[92:95], v[172:175], v[116:119]
    v_exp_f32 v58, v134
    v_mfma_f32_16x16x32_bf16 v[124:127], v[80:83], v[176:179], v[148:151]
    v_cvt_pk_bf16_f32 v106, v56, v57
    v_mfma_f32_16x16x32_bf16 v[124:127], v[84:87], v[180:183], v[124:127]
    ds_read_b128 v[80:83], v5 offset:1024
    v_exp_f32 v59, v135
    v_mfma_f32_16x16x32_bf16 v[124:127], v[88:91], v[184:187], v[124:127]
    ds_read_b128 v[84:87], v5 offset:1280
    buffer_load_dwordx4 v6, s[20:23], s36 offen offset:1024 sc1 lds
    v_mfma_f32_16x16x32_bf16 v[124:127], v[92:95], v[188:191], v[124:127]
    ds_read_b128 v[88:91], v5 offset:1536
    v_or3_b32 v8, v104, v105, v106
    v_mfma_f32_16x16x32_bf16 v[152:155], v[60:63], v[96:99], v[152:155]
    ds_read_b128 v[92:95], v5 offset:1792
    v_exp_f32 v56, v136
    v_mfma_f32_16x16x32_bf16 v[156:159], v[60:63], v[100:103], v[156:159]
    v_cvt_pk_bf16_f32 v107, v58, v59
    s_waitcnt lgkmcnt(4)
    v_mfma_f32_16x16x32_bf16 v[192:195], v[64:67], v[96:99], v[192:195]
    v_exp_f32 v57, v137
    v_mfma_f32_16x16x32_bf16 v[200:203], v[64:67], v[100:103], v[200:203]
    v_exp_f32 v58, v138
    v_cvt_pk_bf16_f32 v108, v56, v57
    v_mfma_f32_16x16x32_bf16 v[196:199], v[68:71], v[96:99], v[196:199]
    ds_read_b128 v[64:67], v4 offset:8192
    v_mfma_f32_16x16x32_bf16 v[204:207], v[68:71], v[100:103], v[204:207]
    v_exp_f32 v59, v139
    v_or3_b32 v8, v8, v107, v108
    v_mfma_f32_16x16x32_bf16 v[208:211], v[72:75], v[96:99], v[208:211]
    ds_read_b128 v[68:71], v4 offset:8448
    buffer_load_dwordx4 v6, s[20:23], s36 offen offset:2048 sc1 lds
    v_mfma_f32_16x16x32_bf16 v[216:219], v[72:75], v[100:103], v[216:219]
    v_exp_f32 v56, v140
    v_mfma_f32_16x16x32_bf16 v[212:215], v[76:79], v[96:99], v[212:215]
    ds_read_b128 v[72:75], v4 offset:8704
    v_cvt_pk_bf16_f32 v109, v58, v59
    v_mfma_f32_16x16x32_bf16 v[220:223], v[76:79], v[100:103], v[220:223]
    v_exp_f32 v57, v141
    s_waitcnt lgkmcnt(3)
    v_mfma_f32_16x16x32_bf16 v[224:227], v[80:83], v[96:99], v[224:227]
    ds_read_b128 v[76:79], v4 offset:8960
    v_mfma_f32_16x16x32_bf16 v[232:235], v[80:83], v[100:103], v[232:235]
    v_exp_f32 v58, v142
    v_cvt_pk_bf16_f32 v110, v56, v57
    v_mfma_f32_16x16x32_bf16 v[228:231], v[84:87], v[96:99], v[228:231]
    ds_read_b128 v[80:83], v4 offset:9216
    v_mfma_f32_16x16x32_bf16 v[236:239], v[84:87], v[100:103], v[236:239]
    v_exp_f32 v59, v143
    v_or3_b32 v8, v8, v109, v110
    v_mfma_f32_16x16x32_bf16 v[240:243], v[88:91], v[96:99], v[240:243]
    ds_read_b128 v[84:87], v4 offset:9472
    buffer_load_dwordx4 v6, s[20:23], s36 offen offset:3072 sc1 lds
    s_add_u32 s36, s36, 0x10000
    v_mfma_f32_16x16x32_bf16 v[248:251], v[88:91], v[100:103], v[248:251]
    v_cvt_pk_bf16_f32 v111, v58, v59
    v_or_b32 v8, v8, v111
    v_mfma_f32_16x16x32_bf16 v[244:247], v[92:95], v[96:99], v[244:247]
    ds_read_b128 v[88:91], v4 offset:9728
    v_and_b32 v8, s42, v8
    v_mfma_f32_16x16x32_bf16 v[252:255], v[92:95], v[100:103], v[252:255]
    v_cmp_ne_u32 vcc, 0, v8
    s_cbranch_vccnz RARE_40
BACK_41:
    s_cmp_eq_u32 s34, s58
    s_cbranch_scc1 OOL_42
RET_43:
    s_waitcnt lgkmcnt(3)
    v_mfma_f32_16x16x32_bf16 v[128:131], v[64:67], v[160:163], v[144:147]
    ds_read_b128 v[92:95], v4 offset:9984
    v_mfma_f32_16x16x32_bf16 v[128:131], v[68:71], v[164:167], v[128:131]
    v_exp_f32 v56, v112
    v_mfma_f32_16x16x32_bf16 v[128:131], v[72:75], v[168:171], v[128:131]
    v_exp_f32 v57, v113
    v_mfma_f32_16x16x32_bf16 v[128:131], v[76:79], v[172:175], v[128:131]
    v_exp_f32 v58, v114
    v_cvt_pk_bf16_f32 v96, v56, v57
    v_mfma_f32_16x16x32_bf16 v[136:139], v[64:67], v[176:179], v[148:151]
    v_exp_f32 v59, v115
    v_mfma_f32_16x16x32_bf16 v[136:139], v[68:71], v[180:183], v[136:139]
    ds_read_b128 v[64:67], v5 offset:8192
    v_mfma_f32_16x16x32_bf16 v[136:139], v[72:75], v[184:187], v[136:139]
    ds_read_b128 v[68:71], v5 offset:8448
    v_exp_f32 v56, v116
    v_mfma_f32_16x16x32_bf16 v[136:139], v[76:79], v[188:191], v[136:139]
    ds_read_b128 v[72:75], v5 offset:8704
    v_cvt_pk_bf16_f32 v97, v58, v59
    s_waitcnt lgkmcnt(3)
    v_mfma_f32_16x16x32_bf16 v[132:135], v[80:83], v[160:163], v[144:147]
    ds_read_b128 v[76:79], v5 offset:8960
    v_mfma_f32_16x16x32_bf16 v[132:135], v[84:87], v[164:167], v[132:135]
    v_exp_f32 v57, v117
    v_mfma_f32_16x16x32_bf16 v[132:135], v[88:91], v[168:171], v[132:135]
    v_exp_f32 v58, v118
    v_mfma_f32_16x16x32_bf16 v[132:135], v[92:95], v[172:175], v[132:135]
    v_cvt_pk_bf16_f32 v98, v56, v57
    v_mfma_f32_16x16x32_bf16 v[140:143], v[80:83], v[176:179], v[148:151]
    v_exp_f32 v59, v119
    v_or3_b32 v8, v96, v97, v98
    v_mfma_f32_16x16x32_bf16 v[140:143], v[84:87], v[180:183], v[140:143]
    ds_read_b128 v[80:83], v5 offset:9216
    v_mfma_f32_16x16x32_bf16 v[140:143], v[88:91], v[184:187], v[140:143]
    ds_read_b128 v[84:87], v5 offset:9472
    v_exp_f32 v56, v120
    v_mfma_f32_16x16x32_bf16 v[140:143], v[92:95], v[188:191], v[140:143]
    ds_read_b128 v[88:91], v5 offset:9728
    v_cvt_pk_bf16_f32 v99, v58, v59
    v_mfma_f32_16x16x32_bf16 v[152:155], v[60:63], v[104:107], v[152:155]
    ds_read_b128 v[92:95], v5 offset:9984
    v_mfma_f32_16x16x32_bf16 v[156:159], v[60:63], v[108:111], v[156:159]
    v_exp_f32 v57, v121
    s_waitcnt lgkmcnt(4)
    v_mfma_f32_16x16x32_bf16 v[192:195], v[64:67], v[104:107], v[192:195]
    v_xor_b32 v5, 0x10000, v4
    v_xor_b32 v4, 0x4000, v4
    v_mfma_f32_16x16x32_bf16 v[200:203], v[64:67], v[108:111], v[200:203]
    v_exp_f32 v58, v122
    v_cvt_pk_bf16_f32 v100, v56, v57
    v_mfma_f32_16x16x32_bf16 v[196:199], v[68:71], v[104:107], v[196:199]
    v_exp_f32 v59, v123
    v_mfma_f32_16x16x32_bf16 v[204:207], v[68:71], v[108:111], v[204:207]
    s_waitcnt lgkmcnt(4)
    v_mfma_f32_16x16x32_bf16 v[208:211], v[72:75], v[104:107], v[208:211]
    v_or3_b32 v8, v8, v99, v100
    v_mfma_f32_16x16x32_bf16 v[216:219], v[72:75], v[108:111], v[216:219]
    v_exp_f32 v56, v124
    v_mfma_f32_16x16x32_bf16 v[212:215], v[76:79], v[104:107], v[212:215]
    v_cvt_pk_bf16_f32 v101, v58, v59
    v_mfma_f32_16x16x32_bf16 v[220:223], v[76:79], v[108:111], v[220:223]
    v_exp_f32 v57, v125
    s_waitcnt vmcnt(4)
    s_waitcnt lgkmcnt(0)
    s_barrier
    v_mfma_f32_16x16x32_bf16 v[224:227], v[80:83], v[104:107], v[224:227]
    ds_read_b128 v[64:67], v4 offset:0
    ds_read_b128 v[68:71], v4 offset:256
    v_mfma_f32_16x16x32_bf16 v[232:235], v[80:83], v[108:111], v[232:235]
    ds_read_b128 v[72:75], v4 offset:512
    ds_read_b128 v[76:79], v4 offset:768
    v_mfma_f32_16x16x32_bf16 v[228:231], v[84:87], v[104:107], v[228:231]
    ds_read_b128 v[80:83], v4 offset:1024
    v_exp_f32 v58, v126
    v_mfma_f32_16x16x32_bf16 v[236:239], v[84:87], v[108:111], v[236:239]
    v_cvt_pk_bf16_f32 v102, v56, v57
    v_mfma_f32_16x16x32_bf16 v[240:243], v[88:91], v[104:107], v[240:243]
    ds_read_b128 v[84:87], v4 offset:1280
    v_exp_f32 v59, v127
    v_mfma_f32_16x16x32_bf16 v[248:251], v[88:91], v[108:111], v[248:251]
    v_or3_b32 v8, v8, v101, v102
    v_cvt_pk_bf16_f32 v103, v58, v59
    v_or_b32 v8, v8, v103
    v_mfma_f32_16x16x32_bf16 v[244:247], v[92:95], v[104:107], v[244:247]
    ds_read_b128 v[88:91], v4 offset:1536
    v_and_b32 v8, s42, v8
    v_mfma_f32_16x16x32_bf16 v[252:255], v[92:95], v[108:111], v[252:255]
    v_cmp_ne_u32 vcc, 0, v8
    s_cbranch_vccnz RARE_44
BACK_45:
    s_cmp_eq_u32 s34, s58
    s_cbranch_scc1 OOL_46
RET_47:
ODD1_27:
    s_cmp_eq_u32 s34, 0
    s_cbranch_scc1 OLAST_35
    s_waitcnt lgkmcnt(3)
    v_mfma_f32_16x16x32_bf16 v[112:115], v[64:67], v[160:163], v[144:147]
    ds_read_b128 v[92:95], v4 offset:1792
    v_mfma_f32_16x16x32_bf16 v[112:115], v[68:71], v[164:167], v[112:115]
    s_add_u32 s41, s41, 1
    s_bitcmp1_b32 s40, s41
    s_cbranch_scc1 STUB_48
RET_49:
    v_mfma_f32_16x16x32_bf16 v[112:115], v[72:75], v[168:171], v[112:115]
    v_exp_f32 v56, v128
    v_mfma_f32_16x16x32_bf16 v[112:115], v[76:79], v[172:175], v[112:115]
    v_exp_f32 v57, v129
    v_mfma_f32_16x16x32_bf16 v[120:123], v[64:67], v[176:179], v[148:151]
    v_exp_f32 v58, v130
    v_cvt_pk_bf16_f32 v104, v56, v57
    v_mfma_f32_16x16x32_bf16 v[120:123], v[68:71], v[180:183], v[120:123]
    ds_read_b128 v[64:67], v5 offset:0
    v_mfma_f32_16x16x32_bf16 v[120:123], v[72:75], v[184:187], v[120:123]
    ds_read_b128 v[68:71], v5 offset:256
    s_mov_b32 m0, s39
    s_xor_b32 s39, s39, 0x8000
    buffer_load_dwordx4 v6, s[20:23], s37 offen offset:0 sc1 lds
    v_mfma_f32_16x16x32_bf16 v[120:123], v[76:79], v[188:191], v[120:123]
    ds_read_b128 v[72:75], v5 offset:512
    v_exp_f32 v59, v131
    s_waitcnt lgkmcnt(3)
    v_mfma_f32_16x16x32_bf16 v[116:119], v[80:83], v[160:163], v[144:147]
    ds_read_b128 v[76:79], v5 offset:768
    v_mfma_f32_16x16x32_bf16 v[116:119], v[84:87], v[164:167], v[116:119]
    v_exp_f32 v56, v132
    v_cvt_pk_bf16_f32 v105, v58, v59
    v_mfma_f32_16x16x32_bf16 v[116:119], v[88:91], v[168:171], v[116:119]
    v_exp_f32 v57, v133
    v_mfma_f32_16x16x32_bf16 v[116:119], v[92:95], v[172:175], v[116:119]
    v_exp_f32 v58, v134
    v_mfma_f32_16x16x32_bf16 v[124:127], v[80:83], v[176:179], v[148:151]
    v_cvt_pk_bf16_f32 v106, v56, v57
    v_mfma_f32_16x16x32_bf16 v[124:127], v[84:87], v[180:183], v[124:127]
    ds_read_b128 v[80:83], v5 offset:1024
    v_exp_f32 v59, v135
    v_mfma_f32_16x16x32_bf16 v[124:127], v[88:91], v[184:187], v[124:127]
    ds_read_b128 v[84:87], v5 offset:1280
    buffer_load_dwordx4 v6, s[20:23], s37 offen offset:1024 sc1 lds
    v_mfma_f32_16x16x32_bf16 v[124:127], v[92:95], v[188:191], v[124:127]
    ds_read_b128 v[88:91], v5 offset:1536
    v_or3_b32 v8, v104, v105, v106
    v_mfma_f32_16x16x32_bf16 v[152:155], v[60:63], v[96:99], v[152:155]
    ds_read_b128 v[92:95], v5 offset:1792
    v_exp_f32 v56, v136
    v_mfma_f32_16x16x32_bf16 v[156:159], v[60:63], v[100:103], v[156:159]
    v_cvt_pk_bf16_f32 v107, v58, v59
    s_waitcnt lgkmcnt(4)
    v_mfma_f32_16x16x32_bf16 v[192:195], v[64:67], v[96:99], v[192:195]
    v_exp_f32 v57, v137
    v_mfma_f32_16x16x32_bf16 v[200:203], v[64:67], v[100:103], v[200:203]
    v_exp_f32 v58, v138
    v_cvt_pk_bf16_f32 v108, v56, v57
    v_mfma_f32_16x16x32_bf16 v[196:199], v[68:71], v[96:99], v[196:199]
    ds_read_b128 v[64:67], v4 offset:8192
    v_mfma_f32_16x16x32_bf16 v[204:207], v[68:71], v[100:103], v[204:207]
    v_exp_f32 v59, v139
    v_or3_b32 v8, v8, v107, v108
    v_mfma_f32_16x16x32_bf16 v[208:211], v[72:75], v[96:99], v[208:211]
    ds_read_b128 v[68:71], v4 offset:8448
    buffer_load_dwordx4 v6, s[20:23], s37 offen offset:2048 sc1 lds
    v_mfma_f32_16x16x32_bf16 v[216:219], v[72:75], v[100:103], v[216:219]
    v_exp_f32 v56, v140
    v_mfma_f32_16x16x32_bf16 v[212:215], v[76:79], v[96:99], v[212:215]
    ds_read_b128 v[72:75], v4 offset:8704
    v_cvt_pk_bf16_f32 v109, v58, v59
    v_mfma_f32_16x16x32_bf16 v[220:223], v[76:79], v[100:103], v[220:223]
    v_exp_f32 v57, v141
    s_waitcnt lgkmcnt(3)
    v_mfma_f32_16x16x32_bf16 v[224:227], v[80:83], v[96:99], v[224:227]
    ds_read_b128 v[76:79], v4 offset:8960
    v_mfma_f32_16x16x32_bf16 v[232:235], v[80:83], v[100:103], v[232:235]
    v_exp_f32 v58, v142
    v_cvt_pk_bf16_f32 v110, v56, v57
    v_mfma_f32_16x16x32_bf16 v[228:231], v[84:87], v[96:99], v[228:231]
    ds_read_b128 v[80:83], v4 offset:9216
    v_mfma_f32_16x16x32_bf16 v[236:239], v[84:87], v[100:103], v[236:239]
    v_exp_f32 v59, v143
    v_or3_b32 v8, v8, v109, v110
    v_mfma_f32_16x16x32_bf16 v[240:243], v[88:91], v[96:99], v[240:243]
    ds_read_b128 v[84:87], v4 offset:9472
    buffer_load_dwordx4 v6, s[20:23], s37 offen offset:3072 sc1 lds
    s_add_u32 s37, s37, 0x10000
    v_mfma_f32_16x16x32_bf16 v[248:251], v[88:91], v[100:103], v[248:251]
    v_cvt_pk_bf16_f32 v111, v58, v59
    v_or_b32 v8, v8, v111
    v_mfma_f32_16x16x32_bf16 v[244:247], v[92:95], v[96:99], v[244:247]
    ds_read_b128 v[88:91], v4 offset:9728
    v_and_b32 v8, s42, v8
    v_mfma_f32_16x16x32_bf16 v[252:255], v[92:95], v[100:103], v[252:255]
    v_cmp_ne_u32 vcc, 0, v8
    s_cbranch_vccnz RARE_50
BACK_51:
    s_waitcnt lgkmcnt(3)
    v_mfma_f32_16x16x32_bf16 v[128:131], v[64:67], v[160:163], v[144:147]
    ds_read_b128 v[92:95], v4 offset:9984
    v_mfma_f32_16x16x32_bf16 v[128:131], v[68:71], v[164:167], v[128:131]
    v_exp_f32 v56, v112
    v_mfma_f32_16x16x32_bf16 v[128:131], v[72:75], v[168:171], v[128:131]
    v_exp_f32 v57, v113
    v_mfma_f32_16x16x32_bf16 v[128:131], v[76:79], v[172:175], v[128:131]
    v_exp_f32 v58, v114
    v_cvt_pk_bf16_f32 v96, v56, v57
    v_mfma_f32_16x16x32_bf16 v[136:139], v[64:67], v[176:179], v[148:151]
    v_exp_f32 v59, v115
    v_mfma_f32_16x16x32_bf16 v[136:139], v[68:71], v[180:183], v[136:139]
    ds_read_b128 v[64:67], v5 offset:8192
    v_mfma_f32_16x16x32_bf16 v[136:139], v[72:75], v[184:187], v[136:139]
    ds_read_b128 v[68:71], v5 offset:8448
    v_exp_f32 v56, v116
    v_mfma_f32_16x16x32_bf16 v[136:139], v[76:79], v[188:191], v[136:139]
    ds_read_b128 v[72:75], v5 offset:8704
    v_cvt_pk_bf16_f32 v97, v58, v59
    s_waitcnt lgkmcnt(3)
    v_mfma_f32_16x16x32_bf16 v[132:135], v[80:83], v[160:163], v[144:147]
    ds_read_b128 v[76:79], v5 offset:8960
    v_mfma_f32_16x16x32_bf16 v[132:135], v[84:87], v[164:167], v[132:135]
    v_exp_f32 v57, v117
    v_mfma_f32_16x16x32_bf16 v[132:135], v[88:91], v[168:171], v[132:135]
    v_exp_f32 v58, v118
    v_cvt_pk_bf16_f32 v98, v56, v57
    v_mfma_f32_16x16x32_bf16 v[132:135], v[92:95], v[172:175], v[132:135]
    s_sub_u32 s34, s34, 1
    v_mfma_f32_16x16x32_bf16 v[140:143], v[80:83], v[176:179], v[148:151]
    v_exp_f32 v59, v119
    v_or3_b32 v8, v96, v97, v98
    v_mfma_f32_16x16x32_bf16 v[140:143], v[84:87], v[180:183], v[140:143]
    ds_read_b128 v[80:83], v5 offset:9216
    v_mfma_f32_16x16x32_bf16 v[140:143], v[88:91], v[184:187], v[140:143]
    ds_read_b128 v[84:87], v5 offset:9472
    v_exp_f32 v56, v120
    v_mfma_f32_16x16x32_bf16 v[140:143], v[92:95], v[188:191], v[140:143]
    ds_read_b128 v[88:91], v5 offset:9728
    v_cvt_pk_bf16_f32 v99, v58, v59
    v_mfma_f32_16x16x32_bf16 v[152:155], v[60:63], v[104:107], v[152:155]
    ds_read_b128 v[92:95], v5 offset:9984
    v_mfma_f32_16x16x32_bf16 v[156:159], v[60:63], v[108:111], v[156:159]
    v_exp_f32 v57, v121
    s_waitcnt lgkmcnt(4)
    v_mfma_f32_16x16x32_bf16 v[192:195], v[64:67], v[104:107], v[192:195]
    v_xor_b32 v5, 0x10000, v4
    v_xor_b32 v4, 0xc000, v4
    v_mfma_f32_16x16x32_bf16 v[200:203], v[64:67], v[108:111], v[200:203]
    v_exp_f32 v58, v122
    v_cvt_pk_bf16_f32 v100, v56, v57
    v_mfma_f32_16x16x32_bf16 v[196:199], v[68:71], v[104:107], v[196:199]
    v_exp_f32 v59, v123
    v_mfma_f32_16x16x32_bf16 v[204:207], v[68:71], v[108:111], v[204:207]
    s_branch EVEN_33
OLAST_35:
    ds_read_b128 v[92:95], v4 offset:1792
    s_add_u32 s41, s41, 1
    s_bitcmp1_b32 s40, s41
    s_cbranch_scc1 STUB_52
RET_53:
    v_exp_f32 v56, v128
    v_exp_f32 v57, v129
    s_waitcnt lgkmcnt(4)
    v_mfma_f32_16x16x32_bf16 v[120:123], v[64:67], v[176:179], v[148:151]
    v_exp_f32 v58, v130
    v_cvt_pk_bf16_f32 v104, v56, v57
    v_mfma_f32_16x16x32_bf16 v[120:123], v[68:71], v[180:183], v[120:123]
    ds_read_b128 v[64:67], v5 offset:0
    v_mfma_f32_16x16x32_bf16 v[120:123], v[72:75], v[184:187], v[120:123]
    ds_read_b128 v[68:71], v5 offset:256
    s_mov_b32 m0, s39
    s_xor_b32 s39, s39, 0x8000
    buffer_load_dwordx4 v6, s[20:23], s37 offen offset:0 sc1 lds
    v_mfma_f32_16x16x32_bf16 v[120:123], v[76:79], v[188:191], v[120:123]
    ds_read_b128 v[72:75], v5 offset:512
    v_exp_f32 v59, v131
    ds_read_b128 v[76:79], v5 offset:768
    v_exp_f32 v56, v132
    v_cvt_pk_bf16_f32 v105, v58, v59
    v_exp_f32 v57, v133
    v_exp_f32 v58, v134
    s_waitcnt lgkmcnt(4)
    v_mfma_f32_16x16x32_bf16 v[124:127], v[80:83], v[176:179], v[148:151]
    v_cvt_pk_bf16_f32 v106, v56, v57
    v_mfma_f32_16x16x32_bf16 v[124:127], v[84:87], v[180:183], v[124:127]
    ds_read_b128 v[80:83], v5 offset:1024
    v_exp_f32 v59, v135
    v_mfma_f32_16x16x32_bf16 v[124:127], v[88:91], v[184:187], v[124:127]
    ds_read_b128 v[84:87], v5 offset:1280
    buffer_load_dwordx4 v6, s[20:23], s37 offen offset:1024 sc1 lds
    v_mfma_f32_16x16x32_bf16 v[124:127], v[92:95], v[188:191], v[124:127]
    ds_read_b128 v[88:91], v5 offset:1536
    v_or3_b32 v8, v104, v105, v106
    v_mfma_f32_16x16x32_bf16 v[152:155], v[60:63], v[96:99], v[152:155]
    ds_read_b128 v[92:95], v5 offset:1792
    v_exp_f32 v56, v136
    v_mfma_f32_16x16x32_bf16 v[156:159], v[60:63], v[100:103], v[156:159]
    v_cvt_pk_bf16_f32 v107, v58, v59
    s_waitcnt lgkmcnt(4)
    v_mfma_f32_16x16x32_bf16 v[192:195], v[64:67], v[96:99], v[192:195]
    v_exp_f32 v57, v137
    v_mfma_f32_16x16x32_bf16 v[200:203], v[64:67], v[100:103], v[200:203]
    v_exp_f32 v58, v138
    v_cvt_pk_bf16_f32 v108, v56, v57
    v_mfma_f32_16x16x32_bf16 v[196:199], v[68:71], v[96:99], v[196:199]
    ds_read_b128 v[64:67], v4 offset:8192
    v_mfma_f32_16x16x32_bf16 v[204:207], v[68:71], v[100:103], v[204:207]
    v_exp_f32 v59, v139
    v_or3_b32 v8, v8, v107, v108
    v_mfma_f32_16x16x32_bf16 v[208:211], v[72:75], v[96:99], v[208:211]
    ds_read_b128 v[68:71], v4 offset:8448
    buffer_load_dwordx4 v6, s[20:23], s37 offen offset:2048 sc1 lds
    v_mfma_f32_16x16x32_bf16 v[216:219], v[72:75], v[100:103], v[216:219]
    v_exp_f32 v56, v140
    v_mfma_f32_16x16x32_bf16 v[212:215], v[76:79], v[96:99], v[212:215]
    ds_read_b128 v[72:75], v4 offset:8704
    v_cvt_pk_bf16_f32 v109, v58, v59
    v_mfma_f32_16x16x32_bf16 v[220:223], v[76:79], v[100:103], v[220:223]
    v_exp_f32 v57, v141
    s_waitcnt lgkmcnt(3)
    v_mfma_f32_16x16x32_bf16 v[224:227], v[80:83], v[96:99], v[224:227]
    ds_read_b128 v[76:79], v4 offset:8960
    v_mfma_f32_16x16x32_bf16 v[232:235], v[80:83], v[100:103], v[232:235]
    v_exp_f32 v58, v142
    v_cvt_pk_bf16_f32 v110, v56, v57
    v_mfma_f32_16x16x32_bf16 v[228:231], v[84:87], v[96:99], v[228:231]
    ds_read_b128 v[80:83], v4 offset:9216
    v_mfma_f32_16x16x32_bf16 v[236:239], v[84:87], v[100:103], v[236:239]
    v_exp_f32 v59, v143
    v_or3_b32 v8, v8, v109, v110
    v_mfma_f32_16x16x32_bf16 v[240:243], v[88:91], v[96:99], v[240:243]
    ds_read_b128 v[84:87], v4 offset:9472
    buffer_load_dwordx4 v6, s[20:23], s37 offen offset:3072 sc1 lds
    s_add_u32 s37, s37, 0x10000
    v_mfma_f32_16x16x32_bf16 v[248:251], v[88:91], v[100:103], v[248:251]
    v_cvt_pk_bf16_f32 v111, v58, v59
    v_or_b32 v8, v8, v111
    v_mfma_f32_16x16x32_bf16 v[244:247], v[92:95], v[96:99], v[244:247]
    ds_read_b128 v[88:91], v4 offset:9728
    v_and_b32 v8, s42, v8
    v_mfma_f32_16x16x32_bf16 v[252:255], v[92:95], v[100:103], v[252:255]
    v_cmp_ne_u32 vcc, 0, v8
    s_cbranch_vccnz RARE_54
BACK_55:
    v_mov_b32 v112, v10
    v_mov_b32 v113, v10
    v_mov_b32 v114, v10
    v_mov_b32 v115, v10
    v_mov_b32 v116, v10
    v_mov_b32 v117, v10
    v_mov_b32 v118, v10
    v_mov_b32 v119, v10
    v_subrev_u32 v15, 64, v7
    v_cmp_lt_i32 s[46:47], v15, 0
    v_cmp_lt_i32 s[48:49], v15, 1
    v_cmp_lt_i32 s[50:51], v15, 2
    v_cmp_lt_i32 s[52:53], v15, 3
    v_cndmask_b32 v120, v120, v10, s[46:47]
    v_cndmask_b32 v121, v121, v10, s[48:49]
    v_cndmask_b32 v122, v122, v10, s[50:51]
    v_cndmask_b32 v123, v123, v10, s[52:53]
    v_cmp_lt_i32 s[46:47], v15, 16
    v_cmp_lt_i32 s[48:49], v15, 17
    v_cmp_lt_i32 s[50:51], v15, 18
    v_cmp_lt_i32 s[52:53], v15, 19
    v_cndmask_b32 v124, v124, v10, s[46:47]
    v_cndmask_b32 v125, v125, v10, s[48:49]
    v_cndmask_b32 v126, v126, v10, s[50:51]
    v_cndmask_b32 v127, v127, v10, s[52:53]
    ds_read_b128 v[92:95], v4 offset:9984
    v_exp_f32 v56, v120
    v_exp_f32 v57, v121
    s_waitcnt lgkmcnt(4)
    v_mfma_f32_16x16x32_bf16 v[136:139], v[64:67], v[176:179], v[148:151]
    v_mfma_f32_16x16x32_bf16 v[136:139], v[68:71], v[180:183], v[136:139]
    ds_read_b128 v[64:67], v5 offset:8192
    v_exp_f32 v58, v122
    v_mfma_f32_16x16x32_bf16 v[136:139], v[72:75], v[184:187], v[136:139]
    ds_read_b128 v[68:71], v5 offset:8448
    v_mfma_f32_16x16x32_bf16 v[136:139], v[76:79], v[188:191], v[136:139]
    ds_read_b128 v[72:75], v5 offset:8704
    ds_read_b128 v[76:79], v5 offset:8960
    v_cvt_pk_bf16_f32 v100, v56, v57
    v_exp_f32 v59, v123
    s_waitcnt lgkmcnt(4)
    v_mfma_f32_16x16x32_bf16 v[140:143], v[80:83], v[176:179], v[148:151]
    v_exp_f32 v56, v124
    v_mfma_f32_16x16x32_bf16 v[140:143], v[84:87], v[180:183], v[140:143]
    ds_read_b128 v[80:83], v5 offset:9216
    v_cvt_pk_bf16_f32 v101, v58, v59
    v_mfma_f32_16x16x32_bf16 v[140:143], v[88:91], v[184:187], v[140:143]
    ds_read_b128 v[84:87], v5 offset:9472
    v_mfma_f32_16x16x32_bf16 v[140:143], v[92:95], v[188:191], v[140:143]
    ds_read_b128 v[88:91], v5 offset:9728
    v_mfma_f32_16x16x32_bf16 v[152:155], v[60:63], v[104:107], v[152:155]
    ds_read_b128 v[92:95], v5 offset:9984
    v_mfma_f32_16x16x32_bf16 v[156:159], v[60:63], v[108:111], v[156:159]
    v_exp_f32 v57, v125
    s_waitcnt lgkmcnt(4)
    v_mfma_f32_16x16x32_bf16 v[192:195], v[64:67], v[104:107], v[192:195]
    v_xor_b32 v5, 0x10000, v4
    v_xor_b32 v4, 0x8000, v4
    v_mfma_f32_16x16x32_bf16 v[200:203], v[64:67], v[108:111], v[200:203]
    v_mfma_f32_16x16x32_bf16 v[196:199], v[68:71], v[104:107], v[196:199]
    v_exp_f32 v58, v126
    v_mfma_f32_16x16x32_bf16 v[204:207], v[68:71], v[108:111], v[204:207]
    v_xor_b32 v12, 0x7000, v11
    ds_read_b128 v[160:163], v11 offset:0
    ds_read_b128 v[164:167], v11 offset:1024
    ds_read_b128 v[168:171], v11 offset:2048
    ds_read_b128 v[172:175], v11 offset:3072
    ds_read_b128 v[176:179], v12 offset:0
    ds_read_b128 v[180:183], v12 offset:1024
    ds_read_b128 v[184:187], v12 offset:2048
    ds_read_b128 v[188:191], v12 offset:3072
    s_waitcnt lgkmcnt(0)
    s_waitcnt lgkmcnt(4)
    v_mfma_f32_16x16x32_bf16 v[208:211], v[72:75], v[104:107], v[208:211]
    v_cvt_pk_bf16_f32 v102, v56, v57
    v_exp_f32 v59, v127
    v_mfma_f32_16x16x32_bf16 v[216:219], v[72:75], v[108:111], v[216:219]
    v_or3_b32 v8, v100, v101, v102
    v_cvt_pk_bf16_f32 v103, v58, v59
    v_mov_b32 v128, v10
    v_mov_b32 v129, v10
    v_mfma_f32_16x16x32_bf16 v[212:215], v[76:79], v[104:107], v[212:215]
    v_mov_b32 v130, v10
    v_mov_b32 v131, v10
    v_mov_b32 v132, v10
    v_mfma_f32_16x16x32_bf16 v[220:223], v[76:79], v[108:111], v[220:223]
    v_mov_b32 v133, v10
    v_mov_b32 v134, v10
    v_mov_b32 v135, v10
    s_waitcnt vmcnt(4)
    s_waitcnt lgkmcnt(0)
    s_barrier
    v_mfma_f32_16x16x32_bf16 v[224:227], v[80:83], v[104:107], v[224:227]
    ds_read_b128 v[64:67], v4 offset:0
    ds_read_b128 v[68:71], v4 offset:256
    v_or_b32 v8, v8, v103
    v_and_b32 v8, s42, v8
    v_mfma_f32_16x16x32_bf16 v[232:235], v[80:83], v[108:111], v[232:235]
    ds_read_b128 v[72:75], v4 offset:512
    ds_read_b128 v[76:79], v4 offset:768
    v_subrev_u32 v15, 0x60, v7
    v_mfma_f32_16x16x32_bf16 v[228:231], v[84:87], v[104:107], v[228:231]
    ds_read_b128 v[80:83], v4 offset:1024
    v_cmp_lt_i32 s[46:47], v15, 0
    v_cmp_lt_i32 s[48:49], v15, 1
    v_cmp_lt_i32 s[50:51], v15, 2
    v_mfma_f32_16x16x32_bf16 v[236:239], v[84:87], v[108:111], v[236:239]
    v_cmp_lt_i32 s[52:53], v15, 3
    v_cndmask_b32 v136, v136, v10, s[46:47]
    v_cndmask_b32 v137, v137, v10, s[48:49]
    v_mfma_f32_16x16x32_bf16 v[240:243], v[88:91], v[104:107], v[240:243]
    ds_read_b128 v[84:87], v4 offset:1280
    v_cndmask_b32 v138, v138, v10, s[50:51]
    v_cndmask_b32 v139, v139, v10, s[52:53]
    v_cmp_lt_i32 s[46:47], v15, 16
    v_mfma_f32_16x16x32_bf16 v[248:251], v[88:91], v[108:111], v[248:251]
    v_cmp_lt_i32 s[48:49], v15, 17
    v_cmp_lt_i32 s[50:51], v15, 18
    v_cmp_lt_i32 s[52:53], v15, 19
    v_mfma_f32_16x16x32_bf16 v[244:247], v[92:95], v[104:107], v[244:247]
    ds_read_b128 v[88:91], v4 offset:1536
    v_cndmask_b32 v140, v140, v10, s[46:47]
    v_cndmask_b32 v141, v141, v10, s[48:49]
    v_cndmask_b32 v142, v142, v10, s[50:51]
    v_mfma_f32_16x16x32_bf16 v[252:255], v[92:95], v[108:111], v[252:255]
    v_cndmask_b32 v143, v143, v10, s[52:53]
    v_cmp_ne_u32 vcc, 0, v8
    s_cbranch_vccnz RARE_56
BACK_57:
    s_waitcnt lgkmcnt(3)
    v_mfma_f32_16x16x32_bf16 v[112:115], v[64:67], v[160:163], 0
    ds_read_b128 v[92:95], v4 offset:1792
    v_mfma_f32_16x16x32_bf16 v[112:115], v[68:71], v[164:167], v[112:115]
    s_add_u32 s41, s41, 1
    s_bitcmp1_b32 s40, s41
    s_cbranch_scc1 STUB_58
RET_59:
    v_mfma_f32_16x16x32_bf16 v[112:115], v[72:75], v[168:171], v[112:115]
    v_mov_b64 v[104:105], 0
    v_mov_b64 v[106:107], 0
    v_mfma_f32_16x16x32_bf16 v[112:115], v[76:79], v[172:175], v[112:115]
    v_mfma_f32_16x16x32_bf16 v[120:123], v[64:67], v[176:179], 0
    v_exp_f32 v56, v136
    v_mfma_f32_16x16x32_bf16 v[120:123], v[68:71], v[180:183], v[120:123]
    ds_read_b128 v[64:67], v5 offset:0
    v_mfma_f32_16x16x32_bf16 v[120:123], v[72:75], v[184:187], v[120:123]
    ds_read_b128 v[68:71], v5 offset:256
    s_mov_b32 m0, s38
    s_xor_b32 s38, s38, 0x8000
    buffer_load_dwordx4 v6, s[20:23], s36 offen offset:0 sc1 lds
    v_mfma_f32_16x16x32_bf16 v[120:123], v[76:79], v[188:191], v[120:123]
    ds_read_b128 v[72:75], v5 offset:512
    s_waitcnt lgkmcnt(3)
    v_mfma_f32_16x16x32_bf16 v[116:119], v[80:83], v[160:163], 0
    ds_read_b128 v[76:79], v5 offset:768
    v_mfma_f32_16x16x32_bf16 v[116:119], v[84:87], v[164:167], v[116:119]
    v_exp_f32 v57, v137
    v_mfma_f32_16x16x32_bf16 v[116:119], v[88:91], v[168:171], v[116:119]
    v_exp_f32 v58, v138
    v_mfma_f32_16x16x32_bf16 v[116:119], v[92:95], v[172:175], v[116:119]
    v_cvt_pk_bf16_f32 v108, v56, v57
    v_mfma_f32_16x16x32_bf16 v[124:127], v[80:83], v[176:179], 0
    v_exp_f32 v59, v139
    v_mfma_f32_16x16x32_bf16 v[124:127], v[84:87], v[180:183], v[124:127]
    ds_read_b128 v[80:83], v5 offset:1024
    v_mfma_f32_16x16x32_bf16 v[124:127], v[88:91], v[184:187], v[124:127]
    ds_read_b128 v[84:87], v5 offset:1280
    buffer_load_dwordx4 v6, s[20:23], s36 offen offset:1024 sc1 lds
    v_mfma_f32_16x16x32_bf16 v[124:127], v[92:95], v[188:191], v[124:127]
    ds_read_b128 v[88:91], v5 offset:1536
    ds_read_b128 v[92:95], v5 offset:1792
    v_mfma_f32_16x16x32_bf16 v[156:159], v[60:63], v[100:103], v[156:159]
    v_exp_f32 v56, v140
    v_cvt_pk_bf16_f32 v109, v58, v59
    s_waitcnt lgkmcnt(4)
    v_mfma_f32_16x16x32_bf16 v[200:203], v[64:67], v[100:103], v[200:203]
    ds_read_b128 v[64:67], v4 offset:8192
    v_exp_f32 v57, v141
    v_mfma_f32_16x16x32_bf16 v[204:207], v[68:71], v[100:103], v[204:207]
    ds_read_b128 v[68:71], v4 offset:8448
    buffer_load_dwordx4 v6, s[20:23], s36 offen offset:2048 sc1 lds
    v_mfma_f32_16x16x32_bf16 v[216:219], v[72:75], v[100:103], v[216:219]
    v_exp_f32 v58, v142
    ds_read_b128 v[72:75], v4 offset:8704
    v_cvt_pk_bf16_f32 v110, v56, v57
    v_mfma_f32_16x16x32_bf16 v[220:223], v[76:79], v[100:103], v[220:223]
    ds_read_b128 v[76:79], v4 offset:8960
    s_waitcnt lgkmcnt(4)
    v_mfma_f32_16x16x32_bf16 v[232:235], v[80:83], v[100:103], v[232:235]
    v_exp_f32 v59, v143
    v_or3_b32 v8, v108, v109, v110
    ds_read_b128 v[80:83], v4 offset:9216
    v_mfma_f32_16x16x32_bf16 v[236:239], v[84:87], v[100:103], v[236:239]
    v_cvt_pk_bf16_f32 v111, v58, v59
    ds_read_b128 v[84:87], v4 offset:9472
    buffer_load_dwordx4 v6, s[20:23], s36 offen offset:3072 sc1 lds
    s_add_u32 s36, s36, 0x10000
    v_mfma_f32_16x16x32_bf16 v[248:251], v[88:91], v[100:103], v[248:251]
    v_or_b32 v8, v8, v111
    v_and_b32 v8, s42, v8
    ds_read_b128 v[88:91], v4 offset:9728
    v_mfma_f32_16x16x32_bf16 v[252:255], v[92:95], v[100:103], v[252:255]
    v_cmp_ne_u32 vcc, 0, v8
    s_cbranch_vccnz RARE_60
BACK_61:
    s_cmp_eq_u32 s35, 0
    s_cbranch_scc1 OOL_62
RET_63:
    s_mov_b32 s55, 1
    v_max3_f32 v12, v112, v113, v114
    v_max3_f32 v12, v12, v115, v116
    v_max3_f32 v12, v12, v117, v118
    v_max_f32 v12, v12, v119
    v_max3_f32 v13, v120, v121, v122
    v_max3_f32 v13, v13, v123, v124
    v_max3_f32 v13, v13, v125, v126
    v_max_f32 v13, v13, v127
    v_mov_b32 v14, v12
    v_mov_b32 v15, v13
    s_nop 0
    v_permlane16_swap_b32 v14, v12
    v_permlane16_swap_b32 v15, v13
    v_max_f32 v12, v12, v14
    v_max_f32 v13, v13, v15
    v_mov_b32 v14, v12
    v_mov_b32 v15, v13
    s_nop 0
    v_permlane32_swap_b32 v14, v12
    v_permlane32_swap_b32 v15, v13
    v_max_f32 v12, v12, v14
    v_max_f32 v13, v13, v15
    v_max_f32 v12, 0xf149f2ca, v12
    v_add_f32 v12, 0x41300000, v12
    v_max_f32 v13, 0xf149f2ca, v13
    v_add_f32 v13, 0x41300000, v13
    v_sub_f32 v144, 0, v12
    v_sub_f32 v145, 0, v12
    v_sub_f32 v146, 0, v12
    v_sub_f32 v147, 0, v12
    v_sub_f32 v148, 0, v13
    v_sub_f32 v149, 0, v13
    v_sub_f32 v150, 0, v13
    v_sub_f32 v151, 0, v13
    s_waitcnt lgkmcnt(3)
    v_mfma_f32_16x16x32_bf16 v[128:131], v[64:67], v[160:163], v[144:147]
    ds_read_b128 v[92:95], v4 offset:9984
    v_sub_f32 v112, v112, v12
    v_sub_f32 v113, v113, v12
    v_mfma_f32_16x16x32_bf16 v[128:131], v[68:71], v[164:167], v[128:131]
    v_sub_f32 v114, v114, v12
    v_sub_f32 v115, v115, v12
    v_mfma_f32_16x16x32_bf16 v[128:131], v[72:75], v[168:171], v[128:131]
    v_sub_f32 v116, v116, v12
    v_sub_f32 v117, v117, v12
    v_sub_f32 v118, v118, v12
    v_mfma_f32_16x16x32_bf16 v[128:131], v[76:79], v[172:175], v[128:131]
    v_sub_f32 v119, v119, v12
    v_sub_f32 v120, v120, v13
    v_sub_f32 v121, v121, v13
    v_mfma_f32_16x16x32_bf16 v[136:139], v[64:67], v[176:179], v[148:151]
    v_sub_f32 v122, v122, v13
    v_sub_f32 v123, v123, v13
    v_sub_f32 v124, v124, v13
    v_mfma_f32_16x16x32_bf16 v[136:139], v[68:71], v[180:183], v[136:139]
    ds_read_b128 v[64:67], v5 offset:8192
    v_sub_f32 v125, v125, v13
    v_mfma_f32_16x16x32_bf16 v[136:139], v[72:75], v[184:187], v[136:139]
    ds_read_b128 v[68:71], v5 offset:8448
    v_sub_f32 v126, v126, v13
    v_sub_f32 v127, v127, v13
    v_mfma_f32_16x16x32_bf16 v[136:139], v[76:79], v[188:191], v[136:139]
    ds_read_b128 v[72:75], v5 offset:8704
    v_exp_f32 v56, v112
    s_waitcnt lgkmcnt(3)
    v_mfma_f32_16x16x32_bf16 v[132:135], v[80:83], v[160:163], v[144:147]
    ds_read_b128 v[76:79], v5 offset:8960
    v_mfma_f32_16x16x32_bf16 v[132:135], v[84:87], v[164:167], v[132:135]
    v_exp_f32 v57, v113
    v_exp_f32 v58, v114
    v_mfma_f32_16x16x32_bf16 v[132:135], v[88:91], v[168:171], v[132:135]
    v_cvt_pk_bf16_f32 v96, v56, v57
    v_exp_f32 v59, v115
    v_mfma_f32_16x16x32_bf16 v[132:135], v[92:95], v[172:175], v[132:135]
    v_exp_f32 v56, v116
    v_cvt_pk_bf16_f32 v97, v58, v59
    v_mfma_f32_16x16x32_bf16 v[140:143], v[80:83], v[176:179], v[148:151]
    v_exp_f32 v57, v117
    v_mfma_f32_16x16x32_bf16 v[140:143], v[84:87], v[180:183], v[140:143]
    ds_read_b128 v[80:83], v5 offset:9216
    v_exp_f32 v58, v118
    v_mfma_f32_16x16x32_bf16 v[140:143], v[88:91], v[184:187], v[140:143]
    ds_read_b128 v[84:87], v5 offset:9472
    v_cvt_pk_bf16_f32 v98, v56, v57
    v_mfma_f32_16x16x32_bf16 v[140:143], v[92:95], v[188:191], v[140:143]
    ds_read_b128 v[88:91], v5 offset:9728
    v_exp_f32 v59, v119
    ds_read_b128 v[92:95], v5 offset:9984
    v_or3_b32 v8, v96, v97, v98
    v_mfma_f32_16x16x32_bf16 v[156:159], v[60:63], v[108:111], v[156:159]
    v_exp_f32 v56, v120
    v_cvt_pk_bf16_f32 v99, v58, v59
    v_xor_b32 v5, 0x10000, v4
    v_xor_b32 v4, 0x8000, v4
    v_exp_f32 v57, v121
    s_waitcnt lgkmcnt(4)
    v_mfma_f32_16x16x32_bf16 v[200:203], v[64:67], v[108:111], v[200:203]
    v_exp_f32 v58, v122
    v_cvt_pk_bf16_f32 v100, v56, v57
    v_exp_f32 v59, v123
    v_mfma_f32_16x16x32_bf16 v[204:207], v[68:71], v[108:111], v[204:207]
    s_cmp_eq_u32 s35, 0
    s_cbranch_scc1 DR1F_30
P2_34:
    s_waitcnt lgkmcnt(4)
    v_mfma_f32_16x16x32_bf16 v[208:211], v[72:75], v[104:107], v[208:211]
    v_or3_b32 v8, v8, v99, v100
    v_mfma_f32_16x16x32_bf16 v[216:219], v[72:75], v[108:111], v[216:219]
    v_exp_f32 v56, v124
    v_mfma_f32_16x16x32_bf16 v[212:215], v[76:79], v[104:107], v[212:215]
    v_cvt_pk_bf16_f32 v101, v58, v59
    v_mfma_f32_16x16x32_bf16 v[220:223], v[76:79], v[108:111], v[220:223]
    v_exp_f32 v57, v125
    s_cmp_eq_u32 s55, 3
    s_cbranch_scc1 W8_64
    s_waitcnt vmcnt(0)
W8R_65:
    s_waitcnt lgkmcnt(0)
    s_barrier
    v_mfma_f32_16x16x32_bf16 v[224:227], v[80:83], v[104:107], v[224:227]
    ds_read_b128 v[64:67], v4 offset:0
    ds_read_b128 v[68:71], v4 offset:256
    v_mfma_f32_16x16x32_bf16 v[232:235], v[80:83], v[108:111], v[232:235]
    ds_read_b128 v[72:75], v4 offset:512
    ds_read_b128 v[76:79], v4 offset:768
    v_mfma_f32_16x16x32_bf16 v[228:231], v[84:87], v[104:107], v[228:231]
    ds_read_b128 v[80:83], v4 offset:1024
    v_exp_f32 v58, v126
    v_mfma_f32_16x16x32_bf16 v[236:239], v[84:87], v[108:111], v[236:239]
    v_cvt_pk_bf16_f32 v102, v56, v57
    v_mfma_f32_16x16x32_bf16 v[240:243], v[88:91], v[104:107], v[240:243]
    ds_read_b128 v[84:87], v4 offset:1280
    v_exp_f32 v59, v127
    v_mfma_f32_16x16x32_bf16 v[248:251], v[88:91], v[108:111], v[248:251]
    v_or3_b32 v8, v8, v101, v102
    v_cvt_pk_bf16_f32 v103, v58, v59
    v_or_b32 v8, v8, v103
    v_mfma_f32_16x16x32_bf16 v[244:247], v[92:95], v[104:107], v[244:247]
    ds_read_b128 v[88:91], v4 offset:1536
    v_and_b32 v8, s42, v8
    v_mfma_f32_16x16x32_bf16 v[252:255], v[92:95], v[108:111], v[252:255]
    v_cmp_ne_u32 vcc, 0, v8
    s_cbranch_vccnz RARE_66
BACK_67:
    s_waitcnt lgkmcnt(3)
    v_mfma_f32_16x16x32_bf16 v[112:115], v[64:67], v[160:163], v[144:147]
    ds_read_b128 v[92:95], v4 offset:1792
    v_mfma_f32_16x16x32_bf16 v[112:115], v[68:71], v[164:167], v[112:115]
    s_add_u32 s41, s41, 1
    s_bitcmp1_b32 s40, s41
    s_cbranch_scc1 STUB_68
RET_69:
    v_mfma_f32_16x16x32_bf16 v[112:115], v[72:75], v[168:171], v[112:115]
    v_exp_f32 v56, v128
    v_exp_f32 v57, v129
    v_mfma_f32_16x16x32_bf16 v[112:115], v[76:79], v[172:175], v[112:115]
    s_cmp_eq_u32 s55, 1
    s_cbranch_scc1 OOL_70
RET_71:
    v_mfma_f32_16x16x32_bf16 v[120:123], v[64:67], v[176:179], v[148:151]
    s_mov_b32 m0, s38
    s_xor_b32 s38, s38, 0x8000
    buffer_load_dwordx4 v6, s[20:23], s36 offen offset:0 sc1 lds
    v_mfma_f32_16x16x32_bf16 v[120:123], v[68:71], v[180:183], v[120:123]
    ds_read_b128 v[64:67], v5 offset:0
    v_exp_f32 v58, v130
    v_mfma_f32_16x16x32_bf16 v[120:123], v[72:75], v[184:187], v[120:123]
    ds_read_b128 v[68:71], v5 offset:256
    v_cvt_pk_bf16_f32 v104, v56, v57
    v_mfma_f32_16x16x32_bf16 v[120:123], v[76:79], v[188:191], v[120:123]
    ds_read_b128 v[72:75], v5 offset:512
    v_exp_f32 v59, v131
    s_waitcnt lgkmcnt(3)
    v_mfma_f32_16x16x32_bf16 v[116:119], v[80:83], v[160:163], v[144:147]
    ds_read_b128 v[76:79], v5 offset:768
    buffer_load_dwordx4 v6, s[20:23], s36 offen offset:1024 sc1 lds
    v_mfma_f32_16x16x32_bf16 v[116:119], v[84:87], v[164:167], v[116:119]
    s_sub_u32 s35, s35, 1
    v_mfma_f32_16x16x32_bf16 v[116:119], v[88:91], v[168:171], v[116:119]
    v_exp_f32 v56, v132
    v_cvt_pk_bf16_f32 v105, v58, v59
    v_mfma_f32_16x16x32_bf16 v[116:119], v[92:95], v[172:175], v[116:119]
    v_exp_f32 v57, v133
    v_mfma_f32_16x16x32_bf16 v[124:127], v[80:83], v[176:179], v[148:151]
    buffer_load_dwordx4 v6, s[20:23], s36 offen offset:2048 sc1 lds
    v_mfma_f32_16x16x32_bf16 v[124:127], v[84:87], v[180:183], v[124:127]
    ds_read_b128 v[80:83], v5 offset:1024
    v_exp_f32 v58, v134
    v_mfma_f32_16x16x32_bf16 v[124:127], v[88:91], v[184:187], v[124:127]
    ds_read_b128 v[84:87], v5 offset:1280
    v_cvt_pk_bf16_f32 v106, v56, v57
    v_mfma_f32_16x16x32_bf16 v[124:127], v[92:95], v[188:191], v[124:127]
    ds_read_b128 v[88:91], v5 offset:1536
    v_exp_f32 v59, v135
    v_mfma_f32_16x16x32_bf16 v[152:155], v[60:63], v[96:99], v[152:155]
    ds_read_b128 v[92:95], v5 offset:1792
    buffer_load_dwordx4 v6, s[20:23], s36 offen offset:3072 sc1 lds
    s_add_u32 s36, s36, 0x10000
    v_mfma_f32_16x16x32_bf16 v[156:159], v[60:63], v[100:103], v[156:159]
    v_or3_b32 v8, v104, v105, v106
    s_waitcnt lgkmcnt(4)
    v_mfma_f32_16x16x32_bf16 v[192:195], v[64:67], v[96:99], v[192:195]
    v_exp_f32 v56, v136
    v_cvt_pk_bf16_f32 v107, v58, v59
    v_mfma_f32_16x16x32_bf16 v[200:203], v[64:67], v[100:103], v[200:203]
    v_exp_f32 v57, v137
    v_mfma_f32_16x16x32_bf16 v[196:199], v[68:71], v[96:99], v[196:199]
    ds_read_b128 v[64:67], v4 offset:8192
    s_mov_b32 m0, s39
    s_xor_b32 s39, s39, 0x8000
    buffer_load_dwordx4 v6, s[20:23], s37 offen offset:0 sc1 lds
    v_mfma_f32_16x16x32_bf16 v[204:207], v[68:71], v[100:103], v[204:207]
    v_exp_f32 v58, v138
    v_cvt_pk_bf16_f32 v108, v56, v57
    v_mfma_f32_16x16x32_bf16 v[208:211], v[72:75], v[96:99], v[208:211]
    ds_read_b128 v[68:71], v4 offset:8448
    v_exp_f32 v59, v139
    v_mfma_f32_16x16x32_bf16 v[216:219], v[72:75], v[100:103], v[216:219]
    v_or3_b32 v8, v8, v107, v108
    v_exp_f32 v56, v140
    v_mfma_f32_16x16x32_bf16 v[212:215], v[76:79], v[96:99], v[212:215]
    ds_read_b128 v[72:75], v4 offset:8704
    buffer_load_dwordx4 v6, s[20:23], s37 offen offset:1024 sc1 lds
    v_mfma_f32_16x16x32_bf16 v[220:223], v[76:79], v[100:103], v[220:223]
    v_cvt_pk_bf16_f32 v109, v58, v59
    s_waitcnt lgkmcnt(3)
    v_mfma_f32_16x16x32_bf16 v[224:227], v[80:83], v[96:99], v[224:227]
    ds_read_b128 v[76:79], v4 offset:8960
    v_exp_f32 v57, v141
    v_mfma_f32_16x16x32_bf16 v[232:235], v[80:83], v[100:103], v[232:235]
    v_exp_f32 v58, v142
    v_cvt_pk_bf16_f32 v110, v56, v57
    v_mfma_f32_16x16x32_bf16 v[228:231], v[84:87], v[96:99], v[228:231]
    ds_read_b128 v[80:83], v4 offset:9216
    buffer_load_dwordx4 v6, s[20:23], s37 offen offset:2048 sc1 lds
    v_mfma_f32_16x16x32_bf16 v[236:239], v[84:87], v[100:103], v[236:239]
    v_exp_f32 v59, v143
    v_mfma_f32_16x16x32_bf16 v[240:243], v[88:91], v[96:99], v[240:243]
    ds_read_b128 v[84:87], v4 offset:9472
    v_or3_b32 v8, v8, v109, v110
    v_cvt_pk_bf16_f32 v111, v58, v59
    v_mfma_f32_16x16x32_bf16 v[248:251], v[88:91], v[100:103], v[248:251]
    v_or_b32 v8, v8, v111
    v_and_b32 v8, s42, v8
    v_mfma_f32_16x16x32_bf16 v[244:247], v[92:95], v[96:99], v[244:247]
    ds_read_b128 v[88:91], v4 offset:9728
    buffer_load_dwordx4 v6, s[20:23], s37 offen offset:3072 sc1 lds
    s_add_u32 s37, s37, 0x10000
    v_mfma_f32_16x16x32_bf16 v[252:255], v[92:95], v[100:103], v[252:255]
    v_cmp_ne_u32 vcc, 0, v8
    s_cbranch_vccnz RARE_72
BACK_73:
    s_waitcnt lgkmcnt(3)
    v_mfma_f32_16x16x32_bf16 v[128:131], v[64:67], v[160:163], v[144:147]
    ds_read_b128 v[92:95], v4 offset:9984
    v_mfma_f32_16x16x32_bf16 v[128:131], v[68:71], v[164:167], v[128:131]
    v_exp_f32 v56, v112
    v_mfma_f32_16x16x32_bf16 v[128:131], v[72:75], v[168:171], v[128:131]
    v_exp_f32 v57, v113
    v_mfma_f32_16x16x32_bf16 v[128:131], v[76:79], v[172:175], v[128:131]
    v_exp_f32 v58, v114
    v_cvt_pk_bf16_f32 v96, v56, v57
    v_mfma_f32_16x16x32_bf16 v[136:139], v[64:67], v[176:179], v[148:151]
    v_exp_f32 v59, v115
    v_mfma_f32_16x16x32_bf16 v[136:139], v[68:71], v[180:183], v[136:139]
    ds_read_b128 v[64:67], v5 offset:8192
    v_mfma_f32_16x16x32_bf16 v[136:139], v[72:75], v[184:187], v[136:139]
    ds_read_b128 v[68:71], v5 offset:8448
    v_exp_f32 v56, v116
    v_mfma_f32_16x16x32_bf16 v[136:139], v[76:79], v[188:191], v[136:139]
    ds_read_b128 v[72:75], v5 offset:8704
    v_cvt_pk_bf16_f32 v97, v58, v59
    s_waitcnt lgkmcnt(3)
    v_mfma_f32_16x16x32_bf16 v[132:135], v[80:83], v[160:163], v[144:147]
    ds_read_b128 v[76:79], v5 offset:8960
    v_mfma_f32_16x16x32_bf16 v[132:135], v[84:87], v[164:167], v[132:135]
    v_exp_f32 v57, v117
    v_mfma_f32_16x16x32_bf16 v[132:135], v[88:91], v[168:171], v[132:135]
    v_exp_f32 v58, v118
    v_cvt_pk_bf16_f32 v98, v56, v57
    v_mfma_f32_16x16x32_bf16 v[132:135], v[92:95], v[172:175], v[132:135]
    s_cmp_eq_u32 s55, 2
    s_cbranch_scc1 OOL_74
RET_75:
    v_mfma_f32_16x16x32_bf16 v[140:143], v[80:83], v[176:179], v[148:151]
    v_exp_f32 v59, v119
    v_or3_b32 v8, v96, v97, v98
    v_mfma_f32_16x16x32_bf16 v[140:143], v[84:87], v[180:183], v[140:143]
    ds_read_b128 v[80:83], v5 offset:9216
    v_mfma_f32_16x16x32_bf16 v[140:143], v[88:91], v[184:187], v[140:143]
    ds_read_b128 v[84:87], v5 offset:9472
    v_exp_f32 v56, v120
    v_mfma_f32_16x16x32_bf16 v[140:143], v[92:95], v[188:191], v[140:143]
    ds_read_b128 v[88:91], v5 offset:9728
    v_cvt_pk_bf16_f32 v99, v58, v59
    v_mfma_f32_16x16x32_bf16 v[152:155], v[60:63], v[104:107], v[152:155]
    ds_read_b128 v[92:95], v5 offset:9984
    v_mfma_f32_16x16x32_bf16 v[156:159], v[60:63], v[108:111], v[156:159]
    v_exp_f32 v57, v121
    s_waitcnt lgkmcnt(4)
    v_mfma_f32_16x16x32_bf16 v[192:195], v[64:67], v[104:107], v[192:195]
    v_xor_b32 v5, 0x10000, v4
    v_xor_b32 v4, 0x8000, v4
    v_mfma_f32_16x16x32_bf16 v[200:203], v[64:67], v[108:111], v[200:203]
    v_exp_f32 v58, v122
    v_cvt_pk_bf16_f32 v100, v56, v57
    v_mfma_f32_16x16x32_bf16 v[196:199], v[68:71], v[104:107], v[196:199]
    v_exp_f32 v59, v123
    v_mfma_f32_16x16x32_bf16 v[204:207], v[68:71], v[108:111], v[204:207]
    s_cmp_lg_u32 s35, 1
    s_cbranch_scc1 P2_34
    s_waitcnt lgkmcnt(4)
    v_mfma_f32_16x16x32_bf16 v[208:211], v[72:75], v[104:107], v[208:211]
    v_or3_b32 v8, v8, v99, v100
    v_mfma_f32_16x16x32_bf16 v[216:219], v[72:75], v[108:111], v[216:219]
    v_exp_f32 v56, v124
    v_mfma_f32_16x16x32_bf16 v[212:215], v[76:79], v[104:107], v[212:215]
    v_cvt_pk_bf16_f32 v101, v58, v59
    v_mfma_f32_16x16x32_bf16 v[220:223], v[76:79], v[108:111], v[220:223]
    v_exp_f32 v57, v125
    s_cmp_eq_u32 s55, 3
    s_cbranch_scc1 W8_76
    s_waitcnt vmcnt(0)
W8R_77:
    s_waitcnt lgkmcnt(0)
    s_barrier
    v_mfma_f32_16x16x32_bf16 v[224:227], v[80:83], v[104:107], v[224:227]
    ds_read_b128 v[64:67], v4 offset:0
    ds_read_b128 v[68:71], v4 offset:256
    v_mfma_f32_16x16x32_bf16 v[232:235], v[80:83], v[108:111], v[232:235]
    ds_read_b128 v[72:75], v4 offset:512
    ds_read_b128 v[76:79], v4 offset:768
    v_mfma_f32_16x16x32_bf16 v[228:231], v[84:87], v[104:107], v[228:231]
    ds_read_b128 v[80:83], v4 offset:1024
    v_exp_f32 v58, v126
    v_mfma_f32_16x16x32_bf16 v[236:239], v[84:87], v[108:111], v[236:239]
    v_cvt_pk_bf16_f32 v102, v56, v57
    v_mfma_f32_16x16x32_bf16 v[240:243], v[88:91], v[104:107], v[240:243]
    ds_read_b128 v[84:87], v4 offset:1280
    v_exp_f32 v59, v127
    v_mfma_f32_16x16x32_bf16 v[248:251], v[88:91], v[108:111], v[248:251]
    v_or3_b32 v8, v8, v101, v102
    v_cvt_pk_bf16_f32 v103, v58, v59
    v_or_b32 v8, v8, v103
    v_mfma_f32_16x16x32_bf16 v[244:247], v[92:95], v[104:107], v[244:247]
    ds_read_b128 v[88:91], v4 offset:1536
    v_and_b32 v8, s42, v8
    v_mfma_f32_16x16x32_bf16 v[252:255], v[92:95], v[108:111], v[252:255]
    v_cmp_ne_u32 vcc, 0, v8
    s_cbranch_vccnz RARE_78
BACK_79:
    ds_read_b128 v[92:95], v4 offset:1792
    v_exp_f32 v56, v128
    v_exp_f32 v57, v129
    v_exp_f32 v58, v130
    v_cvt_pk_bf16_f32 v104, v56, v57
    s_waitcnt lgkmcnt(4)
    v_mfma_f32_16x16x32_bf16 v[120:123], v[64:67], v[176:179], v[148:151]
    s_mov_b32 m0, s38
    s_xor_b32 s38, s38, 0x8000
    buffer_load_dwordx4 v6, s[20:23], s36 offen offset:0 sc1 lds
    v_mfma_f32_16x16x32_bf16 v[120:123], v[68:71], v[180:183], v[120:123]
    ds_read_b128 v[64:67], v5 offset:0
    v_exp_f32 v59, v131
    v_mfma_f32_16x16x32_bf16 v[120:123], v[72:75], v[184:187], v[120:123]
    ds_read_b128 v[68:71], v5 offset:256
    v_mfma_f32_16x16x32_bf16 v[120:123], v[76:79], v[188:191], v[120:123]
    ds_read_b128 v[72:75], v5 offset:512
    v_exp_f32 v56, v132
    ds_read_b128 v[76:79], v5 offset:768
    buffer_load_dwordx4 v6, s[20:23], s36 offen offset:1024 sc1 lds
    v_cvt_pk_bf16_f32 v105, v58, v59
    v_exp_f32 v57, v133
    v_exp_f32 v58, v134
    v_cvt_pk_bf16_f32 v106, v56, v57
    s_waitcnt lgkmcnt(4)
    v_mfma_f32_16x16x32_bf16 v[124:127], v[80:83], v[176:179], v[148:151]
    buffer_load_dwordx4 v6, s[20:23], s36 offen offset:2048 sc1 lds
    v_mfma_f32_16x16x32_bf16 v[124:127], v[84:87], v[180:183], v[124:127]
    ds_read_b128 v[80:83], v5 offset:1024
    v_exp_f32 v59, v135
    v_mfma_f32_16x16x32_bf16 v[124:127], v[88:91], v[184:187], v[124:127]
    ds_read_b128 v[84:87], v5 offset:1280
    v_or3_b32 v8, v104, v105, v106
    v_mfma_f32_16x16x32_bf16 v[124:127], v[92:95], v[188:191], v[124:127]
    ds_read_b128 v[88:91], v5 offset:1536
    v_exp_f32 v56, v136
    v_mfma_f32_16x16x32_bf16 v[152:155], v[60:63], v[96:99], v[152:155]
    ds_read_b128 v[92:95], v5 offset:1792
    buffer_load_dwordx4 v6, s[20:23], s36 offen offset:3072 sc1 lds
    s_add_u32 s36, s36, 0x10000
    v_mfma_f32_16x16x32_bf16 v[156:159], v[60:63], v[100:103], v[156:159]
    v_cvt_pk_bf16_f32 v107, v58, v59
    s_waitcnt lgkmcnt(4)
    v_mfma_f32_16x16x32_bf16 v[192:195], v[64:67], v[96:99], v[192:195]
    v_exp_f32 v57, v137
    v_mfma_f32_16x16x32_bf16 v[200:203], v[64:67], v[100:103], v[200:203]
    v_exp_f32 v58, v138
    v_cvt_pk_bf16_f32 v108, v56, v57
    v_mfma_f32_16x16x32_bf16 v[196:199], v[68:71], v[96:99], v[196:199]
    ds_read_b128 v[64:67], v4 offset:8192
    s_mov_b32 m0, s39
    s_xor_b32 s39, s39, 0x8000
    buffer_load_dwordx4 v6, s[20:23], s37 offen offset:0 sc1 lds
    v_mfma_f32_16x16x32_bf16 v[204:207], v[68:71], v[100:103], v[204:207]
    v_exp_f32 v59, v139
    v_mfma_f32_16x16x32_bf16 v[208:211], v[72:75], v[96:99], v[208:211]
    ds_read_b128 v[68:71], v4 offset:8448
    v_or3_b32 v8, v8, v107, v108
    v_mfma_f32_16x16x32_bf16 v[216:219], v[72:75], v[100:103], v[216:219]
    v_exp_f32 v56, v140
    v_cvt_pk_bf16_f32 v109, v58, v59
    v_mfma_f32_16x16x32_bf16 v[212:215], v[76:79], v[96:99], v[212:215]
    ds_read_b128 v[72:75], v4 offset:8704
    buffer_load_dwordx4 v6, s[20:23], s37 offen offset:1024 sc1 lds
    v_mfma_f32_16x16x32_bf16 v[220:223], v[76:79], v[100:103], v[220:223]
    v_exp_f32 v57, v141
    s_waitcnt lgkmcnt(3)
    v_mfma_f32_16x16x32_bf16 v[224:227], v[80:83], v[96:99], v[224:227]
    ds_read_b128 v[76:79], v4 offset:8960
    v_mfma_f32_16x16x32_bf16 v[232:235], v[80:83], v[100:103], v[232:235]
    v_exp_f32 v58, v142
    v_cvt_pk_bf16_f32 v110, v56, v57
    v_mfma_f32_16x16x32_bf16 v[228:231], v[84:87], v[96:99], v[228:231]
    ds_read_b128 v[80:83], v4 offset:9216
    buffer_load_dwordx4 v6, s[20:23], s37 offen offset:2048 sc1 lds
    v_mfma_f32_16x16x32_bf16 v[236:239], v[84:87], v[100:103], v[236:239]
    v_exp_f32 v59, v143
    v_or3_b32 v8, v8, v109, v110
    v_mfma_f32_16x16x32_bf16 v[240:243], v[88:91], v[96:99], v[240:243]
    ds_read_b128 v[84:87], v4 offset:9472
    v_cvt_pk_bf16_f32 v111, v58, v59
    v_mfma_f32_16x16x32_bf16 v[248:251], v[88:91], v[100:103], v[248:251]
    v_or_b32 v8, v8, v111
    v_and_b32 v8, s42, v8
    v_mfma_f32_16x16x32_bf16 v[244:247], v[92:95], v[96:99], v[244:247]
    ds_read_b128 v[88:91], v4 offset:9728
    buffer_load_dwordx4 v6, s[20:23], s37 offen offset:3072 sc1 lds
    s_add_u32 s37, s37, 0x10000
    v_mfma_f32_16x16x32_bf16 v[252:255], v[92:95], v[100:103], v[252:255]
    v_cmp_ne_u32 vcc, 0, v8
    s_cbranch_vccnz RARE_80
BACK_81:
    s_mov_b32 s61, 71372800
    buffer_load_dwordx4 v[52:55], v6, s[20:23], s61 offen sc1
    v_mov_b32 v112, v10
    v_mov_b32 v113, v10
    v_mov_b32 v114, v10
    v_mov_b32 v115, v10
    v_mov_b32 v116, v10
    v_mov_b32 v117, v10
    v_mov_b32 v118, v10
    v_mov_b32 v119, v10
    v_subrev_u32 v15, 64, v7
    v_cmp_lt_i32 s[46:47], v15, 0
    v_cmp_lt_i32 s[48:49], v15, 1
    v_cmp_lt_i32 s[50:51], v15, 2
    v_cmp_lt_i32 s[52:53], v15, 3
    v_cndmask_b32 v120, v120, v10, s[46:47]
    v_cndmask_b32 v121, v121, v10, s[48:49]
    v_cndmask_b32 v122, v122, v10, s[50:51]
    v_cndmask_b32 v123, v123, v10, s[52:53]
    v_cmp_lt_i32 s[46:47], v15, 16
    v_cmp_lt_i32 s[48:49], v15, 17
    v_cmp_lt_i32 s[50:51], v15, 18
    v_cmp_lt_i32 s[52:53], v15, 19
    v_cndmask_b32 v124, v124, v10, s[46:47]
    v_cndmask_b32 v125, v125, v10, s[48:49]
    v_cndmask_b32 v126, v126, v10, s[50:51]
    v_cndmask_b32 v127, v127, v10, s[52:53]
    ds_read_b128 v[92:95], v4 offset:9984
    v_exp_f32 v56, v120
    v_exp_f32 v57, v121
    s_waitcnt lgkmcnt(4)
    v_mfma_f32_16x16x32_bf16 v[136:139], v[64:67], v[176:179], v[148:151]
    v_mfma_f32_16x16x32_bf16 v[136:139], v[68:71], v[180:183], v[136:139]
    ds_read_b128 v[64:67], v5 offset:8192
    v_exp_f32 v58, v122
    v_mfma_f32_16x16x32_bf16 v[136:139], v[72:75], v[184:187], v[136:139]
    ds_read_b128 v[68:71], v5 offset:8448
    v_mfma_f32_16x16x32_bf16 v[136:139], v[76:79], v[188:191], v[136:139]
    ds_read_b128 v[72:75], v5 offset:8704
    ds_read_b128 v[76:79], v5 offset:8960
    v_cvt_pk_bf16_f32 v100, v56, v57
    v_exp_f32 v59, v123
    s_waitcnt lgkmcnt(4)
    v_mfma_f32_16x16x32_bf16 v[140:143], v[80:83], v[176:179], v[148:151]
    v_exp_f32 v56, v124
    v_mfma_f32_16x16x32_bf16 v[140:143], v[84:87], v[180:183], v[140:143]
    ds_read_b128 v[80:83], v5 offset:9216
    v_cvt_pk_bf16_f32 v101, v58, v59
    v_mfma_f32_16x16x32_bf16 v[140:143], v[88:91], v[184:187], v[140:143]
    ds_read_b128 v[84:87], v5 offset:9472
    v_mfma_f32_16x16x32_bf16 v[140:143], v[92:95], v[188:191], v[140:143]
    ds_read_b128 v[88:91], v5 offset:9728
    v_mfma_f32_16x16x32_bf16 v[152:155], v[60:63], v[104:107], v[152:155]
    ds_read_b128 v[92:95], v5 offset:9984
    v_mfma_f32_16x16x32_bf16 v[156:159], v[60:63], v[108:111], v[156:159]
    v_exp_f32 v57, v125
    s_waitcnt lgkmcnt(4)
    v_mfma_f32_16x16x32_bf16 v[192:195], v[64:67], v[104:107], v[192:195]
    v_xor_b32 v5, 0x10000, v4
    v_xor_b32 v4, 0x8000, v4
    v_mfma_f32_16x16x32_bf16 v[200:203], v[64:67], v[108:111], v[200:203]
    v_mfma_f32_16x16x32_bf16 v[196:199], v[68:71], v[104:107], v[196:199]
    v_exp_f32 v58, v126
    v_mfma_f32_16x16x32_bf16 v[204:207], v[68:71], v[108:111], v[204:207]
DR1_29:
    s_waitcnt lgkmcnt(4)
    v_mfma_f32_16x16x32_bf16 v[208:211], v[72:75], v[104:107], v[208:211]
    v_cvt_pk_bf16_f32 v102, v56, v57
    v_exp_f32 v59, v127
    v_mfma_f32_16x16x32_bf16 v[216:219], v[72:75], v[108:111], v[216:219]
    v_or3_b32 v8, v100, v101, v102
    v_cvt_pk_bf16_f32 v103, v58, v59
    s_lshr_b32 s34, s3, 2
    s_and_b32 s35, s3, 3
    v_mfma_f32_16x16x32_bf16 v[212:215], v[76:79], v[104:107], v[212:215]
    s_lshl_b32 s37, s7, 1
    s_add_u32 s37, s37, s34
    s_lshl_b32 s37, s37, 12
    v_mfma_f32_16x16x32_bf16 v[220:223], v[76:79], v[108:111], v[220:223]
    s_lshl_b32 s60, s35, 10
    v_add_u32 v50, s60, v6
    v_subrev_u32 v51, 16, v50
    s_waitcnt vmcnt(0)
    v_and_b32 v52, v52, v53
    v_and_b32 v54, v54, v55
    v_and_b32 v52, v52, v54
    v_and_b32 v52, 2, v52
    v_cmp_ne_u32 vcc, 2, v52
    s_cbranch_vccnz SCK_82
SCR_83:
    buffer_load_dwordx4 v[160:163], v51, s[12:15], s37 offen
    buffer_load_dwordx4 v[164:167], v50, s[12:15], s37 offen
    s_waitcnt lgkmcnt(0)
    s_barrier
    v_mfma_f32_16x16x32_bf16 v[224:227], v[80:83], v[104:107], v[224:227]
    ds_read_b128 v[64:67], v5 offset:0
    ds_read_b128 v[68:71], v5 offset:256
    v_or_b32 v8, v8, v103
    v_and_b32 v8, s42, v8
    s_lshl_b32 s63, s3, 18
    s_lshl_b32 s62, s7, 5
    v_mfma_f32_16x16x32_bf16 v[232:235], v[80:83], v[108:111], v[232:235]
    ds_read_b128 v[72:75], v5 offset:512
    ds_read_b128 v[76:79], v5 offset:768
    s_add_u32 s63, s63, s62
    s_add_u32 s63, s63, 67108864
    v_lshrrev_b32 v48, 1, v0
    v_and_b32 v3, 1, v0
    v_mfma_f32_16x16x32_bf16 v[228:231], v[84:87], v[104:107], v[228:231]
    ds_read_b128 v[80:83], v5 offset:1024
    v_lshlrev_b32 v49, 13, v48
    v_lshl_add_u32 v49, v3, 4, v49
    v_mfma_f32_16x16x32_bf16 v[236:239], v[84:87], v[108:111], v[236:239]
    buffer_load_dwordx4 v[168:171], v49, s[20:23], s63 offen sc1
    v_mov_b32 v128, v10
    v_mov_b32 v129, v10
    v_mov_b32 v130, v10
    v_mov_b32 v131, v10
    v_mov_b32 v132, v10
    v_mfma_f32_16x16x32_bf16 v[240:243], v[88:91], v[104:107], v[240:243]
    ds_read_b128 v[84:87], v5 offset:1280
    v_mov_b32 v133, v10
    v_mov_b32 v134, v10
    v_mov_b32 v135, v10
    v_subrev_u32 v15, 0x60, v7
    v_cmp_lt_i32 s[46:47], v15, 0
    v_mfma_f32_16x16x32_bf16 v[248:251], v[88:91], v[108:111], v[248:251]
    v_cmp_lt_i32 s[48:49], v15, 1
    v_cmp_lt_i32 s[50:51], v15, 2
    v_cmp_lt_i32 s[52:53], v15, 3
    v_cndmask_b32 v136, v136, v10, s[46:47]
    v_cndmask_b32 v137, v137, v10, s[48:49]
    v_cndmask_b32 v138, v138, v10, s[50:51]
    v_mfma_f32_16x16x32_bf16 v[244:247], v[92:95], v[104:107], v[244:247]
    ds_read_b128 v[88:91], v5 offset:1536
    v_cndmask_b32 v139, v139, v10, s[52:53]
    v_cmp_lt_i32 s[46:47], v15, 16
    v_cmp_lt_i32 s[48:49], v15, 17
    v_cmp_lt_i32 s[50:51], v15, 18
    v_cmp_lt_i32 s[52:53], v15, 19
    v_mfma_f32_16x16x32_bf16 v[252:255], v[92:95], v[108:111], v[252:255]
    v_cndmask_b32 v140, v140, v10, s[46:47]
    v_cndmask_b32 v141, v141, v10, s[48:49]
    v_cndmask_b32 v142, v142, v10, s[50:51]
    v_cndmask_b32 v143, v143, v10, s[52:53]
    v_cmp_ne_u32 vcc, 0, v8
    s_cbranch_vccnz RARE_84
BACK_85:
DH1_32:
    s_lshl_b32 s39, s57, 19
    s_lshl_b32 s60, s3, 15
    s_add_u32 s39, s39, s60
    s_add_u32 s39, s39, 33554432
    s_and_b32 s60, s56, 1
    s_lshl_b32 s60, s60, 18
    s_add_u32 s39, s39, s60
    s_mov_b32 s58, s57
    s_add_u32 s44, s6, 155648
    v_add_u32 v54, s44, v6
    ds_read_b128 v[92:95], v5 offset:1792
    v_mfma_f32_16x16x32_bf16 v[156:159], v[60:63], v[100:103], v[156:159]
    s_lshl_b32 s46, s3, 13
    v_add_u32 v55, s46, v6
    s_add_u32 s59, s58, 0
    s_and_b32 s59, s59, 7
    s_lshl_b32 s59, s59, 12
    s_add_u32 s59, s59, s39
    buffer_load_dwordx4 v[16:19], v6, s[20:23], s59 offen offset:0 sc1
    s_sub_u32 s46, 15, s5
    s_lshl_b32 s46, s46, 20
    v_exp_f32 v56, v136
    s_waitcnt lgkmcnt(4)
    v_mfma_f32_16x16x32_bf16 v[200:203], v[64:67], v[100:103], v[200:203]
    s_add_u32 s46, s46, s43
    s_add_u32 s46, s46, 4096
    buffer_load_dwordx4 v[20:23], v6, s[20:23], s59 offen offset:1024 sc1
    s_xor_b32 s47, s46, 787456
    s_mul_i32 s36, s34, 6144
    ds_read_b128 v[64:67], v5 offset:8192
    v_mfma_f32_16x16x32_bf16 v[204:207], v[68:71], v[100:103], v[204:207]
    s_add_u32 s36, s36, 136192
    s_mul_i32 s38, s34, 35328
    v_exp_f32 v57, v137
    s_add_u32 s38, s38, 65536
    s_xor_b32 s40, s56, 1
    buffer_load_dwordx4 v[24:27], v6, s[20:23], s59 offen offset:2048 sc1
    ds_read_b128 v[68:71], v5 offset:8448
    v_mfma_f32_16x16x32_bf16 v[216:219], v[72:75], v[100:103], v[216:219]
    s_lshl_b32 s40, s40, 19
    s_lshl_b32 s60, s3, 14
    v_exp_f32 v58, v138
    s_add_u32 s40, s40, s60
    s_add_u32 s40, s40, 50331648
    ds_read_b128 v[72:75], v5 offset:8704
    v_mfma_f32_16x16x32_bf16 v[220:223], v[76:79], v[100:103], v[220:223]
    s_and_b32 s60, s56, 1
    s_lshl_b32 s60, s60, 17
    buffer_load_dwordx4 v[28:31], v6, s[20:23], s59 offen offset:3072 sc1
    s_add_u32 s40, s40, s60
    ds_read_b128 v[76:79], v5 offset:8960
    v_cvt_pk_bf16_f32 v108, v56, v57
    s_waitcnt lgkmcnt(4)
    v_mfma_f32_16x16x32_bf16 v[232:235], v[80:83], v[100:103], v[232:235]
    v_exp_f32 v59, v139
    v_exp_f32 v56, v140
    s_add_u32 s59, s58, 1
    s_and_b32 s59, s59, 7
    s_lshl_b32 s59, s59, 12
    s_add_u32 s59, s59, s39
    buffer_load_dwordx4 v[32:35], v6, s[20:23], s59 offen offset:0 sc1
    ds_read_b128 v[80:83], v5 offset:9216
    v_mfma_f32_16x16x32_bf16 v[236:239], v[84:87], v[100:103], v[236:239]
    v_cvt_pk_bf16_f32 v109, v58, v59
    v_exp_f32 v57, v141
    ds_read_b128 v[84:87], v5 offset:9472
    v_exp_f32 v58, v142
    v_cvt_pk_bf16_f32 v110, v56, v57
    v_mfma_f32_16x16x32_bf16 v[248:251], v[88:91], v[100:103], v[248:251]
    buffer_load_dwordx4 v[36:39], v6, s[20:23], s59 offen offset:1024 sc1
    ds_read_b128 v[88:91], v5 offset:9728
    v_exp_f32 v59, v143
    v_or3_b32 v8, v108, v109, v110
    v_mfma_f32_16x16x32_bf16 v[252:255], v[92:95], v[100:103], v[252:255]
    v_cvt_pk_bf16_f32 v111, v58, v59
    v_or_b32 v8, v8, v111
    v_and_b32 v8, s42, v8
    v_cmp_ne_u32 vcc, 0, v8
    s_cbranch_vccnz RARE_86
BACK_87:
    ds_read_b128 v[92:95], v5 offset:9984
    buffer_load_dwordx4 v[40:43], v6, s[20:23], s59 offen offset:2048 sc1
    s_add_u32 s60, s38, 64
    v_mfma_f32_16x16x32_bf16 v[156:159], v[60:63], v[108:111], v[156:159]
    buffer_load_dwordx4 v[44:47], v6, s[20:23], s59 offen offset:3072 sc1
    v_add_u32 v138, s60, v50
    v_and_b32 v51, 3, v48
    v_mul_u32_u24 v139, 1536, v51
    v_lshrrev_b32 v53, 2, v48
    v_lshl_add_u32 v139, v53, 4, v139
    v_and_b32 v53, 1, v0
    v_mul_u32_u24 v53, 6144, v53
    s_waitcnt lgkmcnt(7)
    v_mfma_f32_16x16x32_bf16 v[200:203], v[64:67], v[108:111], v[200:203]
    s_add_u32 s59, s58, 2
    s_and_b32 s59, s59, 7
    s_lshl_b32 s59, s59, 12
    s_add_u32 s59, s59, s39
    buffer_load_dwordx4 v[176:179], v6, s[20:23], s59 offen offset:0 sc1
    s_lshl_b32 s60, s3, 7
    s_add_u32 s60, s60, 136704
    v_add3_u32 v139, v139, v53, s60
    v_and_b32 v51, 3, v0
    v_mov_b64 v[172:173], 0
    v_mov_b64 v[174:175], 0
    v_bfe_u32 v140, v0, 2, 3
    s_waitcnt lgkmcnt(6)
    v_mfma_f32_16x16x32_bf16 v[204:207], v[68:71], v[108:111], v[204:207]
    buffer_load_dwordx4 v[180:183], v6, s[20:23], s59 offen offset:1024 sc1
    v_mul_u32_u24 v140, 4416, v140
    v_lshl_add_u32 v140, v51, 4, v140
    buffer_load_dwordx4 v[184:187], v6, s[20:23], s59 offen offset:2048 sc1
    v_add_u32 v140, s38, v140
    s_waitcnt lgkmcnt(5)
    v_mfma_f32_16x16x32_bf16 v[216:219], v[72:75], v[108:111], v[216:219]
    s_mul_i32 s60, s35, 1536
    s_add_u32 s60, s60, s36
    v_lshl_add_u32 v141, v0, 3, s60
    s_waitcnt vmcnt(12)
    v_alignbit_b32 v122, v161, v160, 16
    v_alignbit_b32 v123, v162, v161, 16
    v_mov_b32 v150, v144
    v_mov_b32 v153, v156
    ds_write_b128 v54, v[150:153]
    buffer_load_dwordx4 v[188:191], v6, s[20:23], s59 offen offset:3072 sc1
    s_waitcnt lgkmcnt(5)
    v_mfma_f32_16x16x32_bf16 v[220:223], v[76:79], v[108:111], v[220:223]
    v_alignbit_b32 v124, v163, v162, 16
    v_alignbit_b32 v125, v164, v163, 16
    v_alignbit_b32 v126, v165, v164, 16
    v_alignbit_b32 v127, v166, v165, 16
    v_alignbit_b32 v128, v167, v166, 16
    ds_write_b128 v55, v[192:195] offset:0
    v_alignbit_b32 v132, v162, v161, 16
    v_alignbit_b32 v133, v163, v162, 16
    s_waitcnt lgkmcnt(5)
    v_mfma_f32_16x16x32_bf16 v[232:235], v[80:83], v[108:111], v[232:235]
    ds_write_b128 v55, v[196:199] offset:1024
    v_alignbit_b32 v134, v164, v163, 16
    ds_write_b128 v55, v[200:203] offset:2048
    v_alignbit_b32 v135, v165, v164, 16
    v_alignbit_b32 v136, v166, v165, 16
    s_waitcnt lgkmcnt(6)
    v_mfma_f32_16x16x32_bf16 v[236:239], v[84:87], v[108:111], v[236:239]
    ds_write_b128 v55, v[204:207] offset:3072
    v_alignbit_b32 v137, v167, v166, 16
    ds_write_b128 v55, v[208:211] offset:4096
    v_mov_b32 v114, v161
    v_mov_b32 v115, v162
    s_waitcnt lgkmcnt(7)
    v_mfma_f32_16x16x32_bf16 v[248:251], v[88:91], v[108:111], v[248:251]
    ds_write_b128 v55, v[212:215] offset:5120
    v_mov_b32 v116, v163
    ds_write_b128 v55, v[216:219] offset:6144
    v_mov_b32 v117, v164
    v_mov_b32 v118, v165
    s_waitcnt lgkmcnt(8)
    v_mfma_f32_16x16x32_bf16 v[252:255], v[92:95], v[108:111], v[252:255]
    ds_write_b128 v55, v[220:223] offset:7168
    v_mov_b32 v119, v166
    v_xor_b32 v54, 0x1000, v54
    v_xor_b32 v55, 0x8000, v55
    s_waitcnt lgkmcnt(0)
    s_barrier
    ds_read_b128 v[96:99], v54
    ds_read_b128 v[64:67], v55 offset:0
    ds_read_b128 v[68:71], v55 offset:1024
    ds_read_b128 v[72:75], v55 offset:2048
    ds_read_b128 v[76:79], v55 offset:3072
    ds_read_b128 v[80:83], v55 offset:4096
    ds_read_b128 v[84:87], v55 offset:5120
    ds_read_b128 v[88:91], v55 offset:6144
    ds_read_b128 v[92:95], v55 offset:7168
    s_waitcnt lgkmcnt(8)
    v_min_f32 v100, v150, v96
    v_sub_f32 v101, v100, v150
    v_sub_f32 v102, v100, v96
    v_exp_f32 v101, v101
    v_exp_f32 v102, v102
    v_mul_f32 v103, v101, v152
    v_fmac_f32 v103, v102, v98
    v_rcp_f32 v103, v103
    s_nop 0
    v_mul_f32 v104, v101, v103
    v_mul_f32 v105, v101, v103
    v_mul_f32 v106, v102, v103
    v_mul_f32 v107, v102, v103
    v_min_f32 v100, v151, v97
    v_sub_f32 v101, v100, v151
    v_sub_f32 v102, v100, v97
    v_exp_f32 v101, v101
    v_exp_f32 v102, v102
    v_mul_f32 v103, v101, v153
    v_fmac_f32 v103, v102, v99
    v_rcp_f32 v103, v103
    s_nop 0
    v_mul_f32 v108, v101, v103
    v_mul_f32 v109, v101, v103
    v_mul_f32 v110, v102, v103
    v_mul_f32 v111, v102, v103
    v_pk_mul_f32 v[224:225], v[224:225], v[104:105]
    v_pk_mul_f32 v[226:227], v[226:227], v[104:105]
    v_pk_mul_f32 v[228:229], v[228:229], v[104:105]
    v_pk_mul_f32 v[230:231], v[230:231], v[104:105]
    s_waitcnt lgkmcnt(6)
    ds_write_b128 v138, v[122:125] offset:0
    ds_write_b128 v138, v[114:117] offset:4416
    ds_write_b128 v138, v[132:135] offset:8832
    v_pk_fma_f32 v[224:225], v[64:65], v[106:107], v[224:225]
    v_pk_fma_f32 v[226:227], v[66:67], v[106:107], v[226:227]
    v_pk_fma_f32 v[228:229], v[68:69], v[106:107], v[228:229]
    v_pk_fma_f32 v[230:231], v[70:71], v[106:107], v[230:231]
    v_cvt_pk_bf16_f32 v192, v224, v225
    v_cvt_pk_bf16_f32 v193, v226, v227
    v_cvt_pk_bf16_f32 v194, v228, v229
    v_cvt_pk_bf16_f32 v195, v230, v231
    buffer_store_dwordx4 v[192:195], v6, s[20:23], s46 offen offset:0 sc1
    v_pk_mul_f32 v[232:233], v[232:233], v[108:109]
    v_pk_mul_f32 v[234:235], v[234:235], v[108:109]
    v_pk_mul_f32 v[236:237], v[236:237], v[108:109]
    v_pk_mul_f32 v[238:239], v[238:239], v[108:109]
    s_waitcnt lgkmcnt(7)
    ds_write_b128 v138, v[162:165] offset:13248
    ds_write_b128 v138, v[124:127] offset:17664
    ds_write_b128 v138, v[116:119] offset:22080
    v_pk_fma_f32 v[232:233], v[72:73], v[110:111], v[232:233]
    v_pk_fma_f32 v[234:235], v[74:75], v[110:111], v[234:235]
    v_pk_fma_f32 v[236:237], v[76:77], v[110:111], v[236:237]
    v_pk_fma_f32 v[238:239], v[78:79], v[110:111], v[238:239]
    v_cvt_pk_bf16_f32 v196, v232, v233
    v_cvt_pk_bf16_f32 v197, v234, v235
    v_cvt_pk_bf16_f32 v198, v236, v237
    v_cvt_pk_bf16_f32 v199, v238, v239
    buffer_store_dwordx4 v[196:199], v6, s[20:23], s47 offen offset:0 sc1
    v_pk_mul_f32 v[240:241], v[240:241], v[104:105]
    v_pk_mul_f32 v[242:243], v[242:243], v[104:105]
    v_pk_mul_f32 v[244:245], v[244:245], v[104:105]
    v_pk_mul_f32 v[246:247], v[246:247], v[104:105]
    s_waitcnt lgkmcnt(8)
    ds_write_b128 v138, v[134:137] offset:26496
    ds_write_b128 v138, v[164:167] offset:30912
    ds_write_b128 v140, v[172:175]
    v_pk_fma_f32 v[240:241], v[80:81], v[106:107], v[240:241]
    v_pk_fma_f32 v[242:243], v[82:83], v[106:107], v[242:243]
    v_pk_fma_f32 v[244:245], v[84:85], v[106:107], v[244:245]
    v_pk_fma_f32 v[246:247], v[86:87], v[106:107], v[246:247]
    v_cvt_pk_bf16_f32 v200, v240, v241
    v_cvt_pk_bf16_f32 v201, v242, v243
    v_cvt_pk_bf16_f32 v202, v244, v245
    v_cvt_pk_bf16_f32 v203, v246, v247
    buffer_store_dwordx4 v[200:203], v6, s[20:23], s46 offen offset:2048 sc1
    v_pk_mul_f32 v[248:249], v[248:249], v[108:109]
    v_pk_mul_f32 v[250:251], v[250:251], v[108:109]
    v_pk_mul_f32 v[252:253], v[252:253], v[108:109]
    v_pk_mul_f32 v[254:255], v[254:255], v[108:109]
    s_waitcnt lgkmcnt(9)
    ds_write_b64 v141, v[172:173]
    s_waitcnt vmcnt(15)
    ds_write_b128 v139, v[168:171]
    v_pk_fma_f32 v[248:249], v[88:89], v[110:111], v[248:249]
    v_pk_fma_f32 v[250:251], v[90:91], v[110:111], v[250:251]
    v_pk_fma_f32 v[252:253], v[92:93], v[110:111], v[252:253]
    v_pk_fma_f32 v[254:255], v[94:95], v[110:111], v[254:255]
    v_cvt_pk_bf16_f32 v204, v248, v249
    v_cvt_pk_bf16_f32 v205, v250, v251
    v_cvt_pk_bf16_f32 v206, v252, v253
    v_cvt_pk_bf16_f32 v207, v254, v255
    buffer_store_dwordx4 v[204:207], v6, s[20:23], s47 offen offset:2048 sc1
    s_branch MGJ_31
EVEN_88:
    s_waitcnt lgkmcnt(4)
    v_mfma_f32_16x16x32_bf16 v[208:211], v[72:75], v[104:107], v[208:211]
    v_or3_b32 v8, v8, v99, v100
    v_mfma_f32_16x16x32_bf16 v[216:219], v[72:75], v[108:111], v[216:219]
    v_exp_f32 v56, v124
    v_mfma_f32_16x16x32_bf16 v[212:215], v[76:79], v[104:107], v[212:215]
    v_cvt_pk_bf16_f32 v101, v58, v59
    v_mfma_f32_16x16x32_bf16 v[220:223], v[76:79], v[108:111], v[220:223]
    v_exp_f32 v57, v125
    s_waitcnt vmcnt(4)
    s_waitcnt lgkmcnt(0)
    s_barrier
    v_mfma_f32_16x16x32_bf16 v[224:227], v[80:83], v[104:107], v[224:227]
    ds_read_b128 v[64:67], v4 offset:0
    ds_read_b128 v[68:71], v4 offset:256
    v_mfma_f32_16x16x32_bf16 v[232:235], v[80:83], v[108:111], v[232:235]
    ds_read_b128 v[72:75], v4 offset:512
    ds_read_b128 v[76:79], v4 offset:768
    v_mfma_f32_16x16x32_bf16 v[228:231], v[84:87], v[104:107], v[228:231]
    ds_read_b128 v[80:83], v4 offset:1024
    v_exp_f32 v58, v126
    v_mfma_f32_16x16x32_bf16 v[236:239], v[84:87], v[108:111], v[236:239]
    v_cvt_pk_bf16_f32 v102, v56, v57
    v_mfma_f32_16x16x32_bf16 v[240:243], v[88:91], v[104:107], v[240:243]
    ds_read_b128 v[84:87], v4 offset:1280
    v_exp_f32 v59, v127
    v_mfma_f32_16x16x32_bf16 v[248:251], v[88:91], v[108:111], v[248:251]
    v_or3_b32 v8, v8, v101, v102
    v_cvt_pk_bf16_f32 v103, v58, v59
    v_or_b32 v8, v8, v103
    v_mfma_f32_16x16x32_bf16 v[244:247], v[92:95], v[104:107], v[244:247]
    ds_read_b128 v[88:91], v4 offset:1536
    v_and_b32 v8, s42, v8
    v_mfma_f32_16x16x32_bf16 v[252:255], v[92:95], v[108:111], v[252:255]
    v_cmp_ne_u32 vcc, 0, v8
    s_cbranch_vccnz RARE_91
BACK_92:
    s_waitcnt lgkmcnt(3)
    v_mfma_f32_16x16x32_bf16 v[112:115], v[64:67], v[160:163], v[144:147]
    ds_read_b128 v[92:95], v4 offset:1792
    v_mfma_f32_16x16x32_bf16 v[112:115], v[68:71], v[164:167], v[112:115]
    s_add_u32 s41, s41, 1
    s_bitcmp1_b32 s40, s41
    s_cbranch_scc1 STUB_93
RET_94:
    v_mfma_f32_16x16x32_bf16 v[112:115], v[72:75], v[168:171], v[112:115]
    s_mov_b32 m0, s38
    s_xor_b32 s38, s38, 0x8000
    buffer_load_dwordx4 v6, s[20:23], s36 offen offset:0 sc1 lds
    v_mfma_f32_16x16x32_bf16 v[112:115], v[76:79], v[172:175], v[112:115]
    v_exp_f32 v56, v128
    v_mfma_f32_16x16x32_bf16 v[120:123], v[64:67], v[176:179], v[148:151]
    v_exp_f32 v57, v129
    v_mfma_f32_16x16x32_bf16 v[120:123], v[68:71], v[180:183], v[120:123]
    ds_read_b128 v[64:67], v5 offset:0
    v_exp_f32 v58, v130
    v_cvt_pk_bf16_f32 v104, v56, v57
    v_mfma_f32_16x16x32_bf16 v[120:123], v[72:75], v[184:187], v[120:123]
    ds_read_b128 v[68:71], v5 offset:256
    v_mfma_f32_16x16x32_bf16 v[120:123], v[76:79], v[188:191], v[120:123]
    ds_read_b128 v[72:75], v5 offset:512
    v_exp_f32 v59, v131
    s_waitcnt lgkmcnt(3)
    v_mfma_f32_16x16x32_bf16 v[116:119], v[80:83], v[160:163], v[144:147]
    ds_read_b128 v[76:79], v5 offset:768
    v_mfma_f32_16x16x32_bf16 v[116:119], v[84:87], v[164:167], v[116:119]
    v_exp_f32 v56, v132
    v_cvt_pk_bf16_f32 v105, v58, v59
    v_mfma_f32_16x16x32_bf16 v[116:119], v[88:91], v[168:171], v[116:119]
    buffer_load_dwordx4 v6, s[20:23], s36 offen offset:1024 sc1 lds
    v_mfma_f32_16x16x32_bf16 v[116:119], v[92:95], v[172:175], v[116:119]
    v_exp_f32 v57, v133
    v_mfma_f32_16x16x32_bf16 v[124:127], v[80:83], v[176:179], v[148:151]
    v_exp_f32 v58, v134
    v_mfma_f32_16x16x32_bf16 v[124:127], v[84:87], v[180:183], v[124:127]
    ds_read_b128 v[80:83], v5 offset:1024
    v_cvt_pk_bf16_f32 v106, v56, v57
    v_mfma_f32_16x16x32_bf16 v[124:127], v[88:91], v[184:187], v[124:127]
    ds_read_b128 v[84:87], v5 offset:1280
    v_exp_f32 v59, v135
    v_mfma_f32_16x16x32_bf16 v[124:127], v[92:95], v[188:191], v[124:127]
    ds_read_b128 v[88:91], v5 offset:1536
    v_or3_b32 v8, v104, v105, v106
    v_mfma_f32_16x16x32_bf16 v[152:155], v[60:63], v[96:99], v[152:155]
    ds_read_b128 v[92:95], v5 offset:1792
    v_mfma_f32_16x16x32_bf16 v[156:159], v[60:63], v[100:103], v[156:159]
    v_exp_f32 v56, v136
    v_cvt_pk_bf16_f32 v107, v58, v59
    s_waitcnt lgkmcnt(4)
    v_mfma_f32_16x16x32_bf16 v[192:195], v[64:67], v[96:99], v[192:195]
    buffer_load_dwordx4 v6, s[20:23], s36 offen offset:2048 sc1 lds
    v_mfma_f32_16x16x32_bf16 v[200:203], v[64:67], v[100:103], v[200:203]
    v_exp_f32 v57, v137
    v_mfma_f32_16x16x32_bf16 v[196:199], v[68:71], v[96:99], v[196:199]
    ds_read_b128 v[64:67], v4 offset:8192
    v_mfma_f32_16x16x32_bf16 v[204:207], v[68:71], v[100:103], v[204:207]
    v_exp_f32 v58, v138
    v_cvt_pk_bf16_f32 v108, v56, v57
    v_mfma_f32_16x16x32_bf16 v[208:211], v[72:75], v[96:99], v[208:211]
    ds_read_b128 v[68:71], v4 offset:8448
    v_exp_f32 v59, v139
    v_mfma_f32_16x16x32_bf16 v[216:219], v[72:75], v[100:103], v[216:219]
    v_or3_b32 v8, v8, v107, v108
    v_mfma_f32_16x16x32_bf16 v[212:215], v[76:79], v[96:99], v[212:215]
    ds_read_b128 v[72:75], v4 offset:8704
    v_exp_f32 v56, v140
    v_mfma_f32_16x16x32_bf16 v[220:223], v[76:79], v[100:103], v[220:223]
    v_cvt_pk_bf16_f32 v109, v58, v59
    s_waitcnt lgkmcnt(3)
    v_mfma_f32_16x16x32_bf16 v[224:227], v[80:83], v[96:99], v[224:227]
    ds_read_b128 v[76:79], v4 offset:8960
    buffer_load_dwordx4 v6, s[20:23], s36 offen offset:3072 sc1 lds
    s_add_u32 s36, s36, 0x10000
    v_mfma_f32_16x16x32_bf16 v[232:235], v[80:83], v[100:103], v[232:235]
    v_exp_f32 v57, v141
    v_mfma_f32_16x16x32_bf16 v[228:231], v[84:87], v[96:99], v[228:231]
    ds_read_b128 v[80:83], v4 offset:9216
    v_exp_f32 v58, v142
    v_mfma_f32_16x16x32_bf16 v[236:239], v[84:87], v[100:103], v[236:239]
    v_cvt_pk_bf16_f32 v110, v56, v57
    v_exp_f32 v59, v143
    v_mfma_f32_16x16x32_bf16 v[240:243], v[88:91], v[96:99], v[240:243]
    ds_read_b128 v[84:87], v4 offset:9472
    v_or3_b32 v8, v8, v109, v110
    v_mfma_f32_16x16x32_bf16 v[248:251], v[88:91], v[100:103], v[248:251]
    v_cvt_pk_bf16_f32 v111, v58, v59
    v_or_b32 v8, v8, v111
    v_mfma_f32_16x16x32_bf16 v[244:247], v[92:95], v[96:99], v[244:247]
    ds_read_b128 v[88:91], v4 offset:9728
    v_and_b32 v8, s42, v8
    v_mfma_f32_16x16x32_bf16 v[252:255], v[92:95], v[100:103], v[252:255]
    v_cmp_ne_u32 vcc, 0, v8
    s_cbranch_vccnz RARE_95
BACK_96:
    s_waitcnt lgkmcnt(3)
    v_mfma_f32_16x16x32_bf16 v[128:131], v[64:67], v[160:163], v[144:147]
    ds_read_b128 v[92:95], v4 offset:9984
    v_mfma_f32_16x16x32_bf16 v[128:131], v[68:71], v[164:167], v[128:131]
    v_exp_f32 v56, v112
    v_mfma_f32_16x16x32_bf16 v[128:131], v[72:75], v[168:171], v[128:131]
    v_exp_f32 v57, v113
    v_mfma_f32_16x16x32_bf16 v[128:131], v[76:79], v[172:175], v[128:131]
    v_exp_f32 v58, v114
    v_cvt_pk_bf16_f32 v96, v56, v57
    v_mfma_f32_16x16x32_bf16 v[136:139], v[64:67], v[176:179], v[148:151]
    v_exp_f32 v59, v115
    v_mfma_f32_16x16x32_bf16 v[136:139], v[68:71], v[180:183], v[136:139]
    ds_read_b128 v[64:67], v5 offset:8192
    v_mfma_f32_16x16x32_bf16 v[136:139], v[72:75], v[184:187], v[136:139]
    ds_read_b128 v[68:71], v5 offset:8448
    v_exp_f32 v56, v116
    v_mfma_f32_16x16x32_bf16 v[136:139], v[76:79], v[188:191], v[136:139]
    ds_read_b128 v[72:75], v5 offset:8704
    v_cvt_pk_bf16_f32 v97, v58, v59
    s_waitcnt lgkmcnt(3)
    v_mfma_f32_16x16x32_bf16 v[132:135], v[80:83], v[160:163], v[144:147]
    ds_read_b128 v[76:79], v5 offset:8960
    v_mfma_f32_16x16x32_bf16 v[132:135], v[84:87], v[164:167], v[132:135]
    v_exp_f32 v57, v117
    v_mfma_f32_16x16x32_bf16 v[132:135], v[88:91], v[168:171], v[132:135]
    v_exp_f32 v58, v118
    v_mfma_f32_16x16x32_bf16 v[132:135], v[92:95], v[172:175], v[132:135]
    v_cvt_pk_bf16_f32 v98, v56, v57
    v_mfma_f32_16x16x32_bf16 v[140:143], v[80:83], v[176:179], v[148:151]
    v_exp_f32 v59, v119
    v_or3_b32 v8, v96, v97, v98
    v_mfma_f32_16x16x32_bf16 v[140:143], v[84:87], v[180:183], v[140:143]
    ds_read_b128 v[80:83], v5 offset:9216
    v_mfma_f32_16x16x32_bf16 v[140:143], v[88:91], v[184:187], v[140:143]
    ds_read_b128 v[84:87], v5 offset:9472
    v_exp_f32 v56, v120
    v_mfma_f32_16x16x32_bf16 v[140:143], v[92:95], v[188:191], v[140:143]
    ds_read_b128 v[88:91], v5 offset:9728
    v_cvt_pk_bf16_f32 v99, v58, v59
    v_mfma_f32_16x16x32_bf16 v[152:155], v[60:63], v[104:107], v[152:155]
    ds_read_b128 v[92:95], v5 offset:9984
    v_mfma_f32_16x16x32_bf16 v[156:159], v[60:63], v[108:111], v[156:159]
    v_exp_f32 v57, v121
    s_waitcnt lgkmcnt(4)
    v_mfma_f32_16x16x32_bf16 v[192:195], v[64:67], v[104:107], v[192:195]
    v_xor_b32 v5, 0x10000, v4
    v_xor_b32 v4, 0x4000, v4
    v_mfma_f32_16x16x32_bf16 v[200:203], v[64:67], v[108:111], v[200:203]
    v_exp_f32 v58, v122
    v_cvt_pk_bf16_f32 v100, v56, v57
    v_mfma_f32_16x16x32_bf16 v[196:199], v[68:71], v[104:107], v[196:199]
    v_exp_f32 v59, v123
    v_mfma_f32_16x16x32_bf16 v[204:207], v[68:71], v[108:111], v[204:207]
    s_waitcnt lgkmcnt(4)
    v_mfma_f32_16x16x32_bf16 v[208:211], v[72:75], v[104:107], v[208:211]
    v_or3_b32 v8, v8, v99, v100
    v_mfma_f32_16x16x32_bf16 v[216:219], v[72:75], v[108:111], v[216:219]
    v_exp_f32 v56, v124
    v_mfma_f32_16x16x32_bf16 v[212:215], v[76:79], v[104:107], v[212:215]
    v_cvt_pk_bf16_f32 v101, v58, v59
    v_mfma_f32_16x16x32_bf16 v[220:223], v[76:79], v[108:111], v[220:223]
    v_exp_f32 v57, v125
    s_waitcnt vmcnt(4)
    s_waitcnt lgkmcnt(0)
    s_barrier
    v_mfma_f32_16x16x32_bf16 v[224:227], v[80:83], v[104:107], v[224:227]
    ds_read_b128 v[64:67], v4 offset:0
    ds_read_b128 v[68:71], v4 offset:256
    v_mfma_f32_16x16x32_bf16 v[232:235], v[80:83], v[108:111], v[232:235]
    ds_read_b128 v[72:75], v4 offset:512
    ds_read_b128 v[76:79], v4 offset:768
    v_mfma_f32_16x16x32_bf16 v[228:231], v[84:87], v[104:107], v[228:231]
    ds_read_b128 v[80:83], v4 offset:1024
    v_exp_f32 v58, v126
    v_mfma_f32_16x16x32_bf16 v[236:239], v[84:87], v[108:111], v[236:239]
    v_cvt_pk_bf16_f32 v102, v56, v57
    v_mfma_f32_16x16x32_bf16 v[240:243], v[88:91], v[104:107], v[240:243]
    ds_read_b128 v[84:87], v4 offset:1280
    v_exp_f32 v59, v127
    v_mfma_f32_16x16x32_bf16 v[248:251], v[88:91], v[108:111], v[248:251]
    v_or3_b32 v8, v8, v101, v102
    v_cvt_pk_bf16_f32 v103, v58, v59
    v_or_b32 v8, v8, v103
    v_mfma_f32_16x16x32_bf16 v[244:247], v[92:95], v[104:107], v[244:247]
    ds_read_b128 v[88:91], v4 offset:1536
    v_and_b32 v8, s42, v8
    v_mfma_f32_16x16x32_bf16 v[252:255], v[92:95], v[108:111], v[252:255]
    v_cmp_ne_u32 vcc, 0, v8
    s_cbranch_vccnz RARE_97
BACK_98:
ODD0_26:
    s_waitcnt lgkmcnt(3)
    v_mfma_f32_16x16x32_bf16 v[112:115], v[64:67], v[160:163], v[144:147]
    ds_read_b128 v[92:95], v4 offset:1792
    v_mfma_f32_16x16x32_bf16 v[112:115], v[68:71], v[164:167], v[112:115]
    s_add_u32 s41, s41, 1
    s_bitcmp1_b32 s40, s41
    s_cbranch_scc1 STUB_99
RET_100:
    v_mfma_f32_16x16x32_bf16 v[112:115], v[72:75], v[168:171], v[112:115]
    s_mov_b32 m0, s39
    s_xor_b32 s39, s39, 0x8000
    buffer_load_dwordx4 v6, s[20:23], s37 offen offset:0 sc1 lds
    v_mfma_f32_16x16x32_bf16 v[112:115], v[76:79], v[172:175], v[112:115]
    v_exp_f32 v56, v128
    v_mfma_f32_16x16x32_bf16 v[120:123], v[64:67], v[176:179], v[148:151]
    v_exp_f32 v57, v129
    v_mfma_f32_16x16x32_bf16 v[120:123], v[68:71], v[180:183], v[120:123]
    ds_read_b128 v[64:67], v5 offset:0
    v_exp_f32 v58, v130
    v_cvt_pk_bf16_f32 v104, v56, v57
    v_mfma_f32_16x16x32_bf16 v[120:123], v[72:75], v[184:187], v[120:123]
    ds_read_b128 v[68:71], v5 offset:256
    v_mfma_f32_16x16x32_bf16 v[120:123], v[76:79], v[188:191], v[120:123]
    ds_read_b128 v[72:75], v5 offset:512
    v_exp_f32 v59, v131
    s_waitcnt lgkmcnt(3)
    v_mfma_f32_16x16x32_bf16 v[116:119], v[80:83], v[160:163], v[144:147]
    ds_read_b128 v[76:79], v5 offset:768
    v_mfma_f32_16x16x32_bf16 v[116:119], v[84:87], v[164:167], v[116:119]
    v_exp_f32 v56, v132
    v_cvt_pk_bf16_f32 v105, v58, v59
    v_mfma_f32_16x16x32_bf16 v[116:119], v[88:91], v[168:171], v[116:119]
    buffer_load_dwordx4 v6, s[20:23], s37 offen offset:1024 sc1 lds
    v_mfma_f32_16x16x32_bf16 v[116:119], v[92:95], v[172:175], v[116:119]
    v_exp_f32 v57, v133
    v_mfma_f32_16x16x32_bf16 v[124:127], v[80:83], v[176:179], v[148:151]
    v_exp_f32 v58, v134
    v_mfma_f32_16x16x32_bf16 v[124:127], v[84:87], v[180:183], v[124:127]
    ds_read_b128 v[80:83], v5 offset:1024
    v_cvt_pk_bf16_f32 v106, v56, v57
    v_mfma_f32_16x16x32_bf16 v[124:127], v[88:91], v[184:187], v[124:127]
    ds_read_b128 v[84:87], v5 offset:1280
    v_exp_f32 v59, v135
    v_mfma_f32_16x16x32_bf16 v[124:127], v[92:95], v[188:191], v[124:127]
    ds_read_b128 v[88:91], v5 offset:1536
    v_or3_b32 v8, v104, v105, v106
    v_mfma_f32_16x16x32_bf16 v[152:155], v[60:63], v[96:99], v[152:155]
    ds_read_b128 v[92:95], v5 offset:1792
    v_mfma_f32_16x16x32_bf16 v[156:159], v[60:63], v[100:103], v[156:159]
    v_exp_f32 v56, v136
    v_cvt_pk_bf16_f32 v107, v58, v59
    s_waitcnt lgkmcnt(4)
    v_mfma_f32_16x16x32_bf16 v[192:195], v[64:67], v[96:99], v[192:195]
    buffer_load_dwordx4 v6, s[20:23], s37 offen offset:2048 sc1 lds
    v_mfma_f32_16x16x32_bf16 v[200:203], v[64:67], v[100:103], v[200:203]
    v_exp_f32 v57, v137
    v_mfma_f32_16x16x32_bf16 v[196:199], v[68:71], v[96:99], v[196:199]
    ds_read_b128 v[64:67], v4 offset:8192
    v_mfma_f32_16x16x32_bf16 v[204:207], v[68:71], v[100:103], v[204:207]
    v_exp_f32 v58, v138
    v_cvt_pk_bf16_f32 v108, v56, v57
    v_mfma_f32_16x16x32_bf16 v[208:211], v[72:75], v[96:99], v[208:211]
    ds_read_b128 v[68:71], v4 offset:8448
    v_exp_f32 v59, v139
    v_mfma_f32_16x16x32_bf16 v[216:219], v[72:75], v[100:103], v[216:219]
    v_or3_b32 v8, v8, v107, v108
    v_mfma_f32_16x16x32_bf16 v[212:215], v[76:79], v[96:99], v[212:215]
    ds_read_b128 v[72:75], v4 offset:8704
    v_exp_f32 v56, v140
    v_mfma_f32_16x16x32_bf16 v[220:223], v[76:79], v[100:103], v[220:223]
    v_cvt_pk_bf16_f32 v109, v58, v59
    s_waitcnt lgkmcnt(3)
    v_mfma_f32_16x16x32_bf16 v[224:227], v[80:83], v[96:99], v[224:227]
    ds_read_b128 v[76:79], v4 offset:8960
    buffer_load_dwordx4 v6, s[20:23], s37 offen offset:3072 sc1 lds
    s_add_u32 s37, s37, 0x10000
    v_mfma_f32_16x16x32_bf16 v[232:235], v[80:83], v[100:103], v[232:235]
    v_exp_f32 v57, v141
    v_mfma_f32_16x16x32_bf16 v[228:231], v[84:87], v[96:99], v[228:231]
    ds_read_b128 v[80:83], v4 offset:9216
    v_exp_f32 v58, v142
    v_mfma_f32_16x16x32_bf16 v[236:239], v[84:87], v[100:103], v[236:239]
    v_cvt_pk_bf16_f32 v110, v56, v57
    v_exp_f32 v59, v143
    v_mfma_f32_16x16x32_bf16 v[240:243], v[88:91], v[96:99], v[240:243]
    ds_read_b128 v[84:87], v4 offset:9472
    v_or3_b32 v8, v8, v109, v110
    v_mfma_f32_16x16x32_bf16 v[248:251], v[88:91], v[100:103], v[248:251]
    v_cvt_pk_bf16_f32 v111, v58, v59
    v_or_b32 v8, v8, v111
    v_mfma_f32_16x16x32_bf16 v[244:247], v[92:95], v[96:99], v[244:247]
    ds_read_b128 v[88:91], v4 offset:9728
    v_and_b32 v8, s42, v8
    v_mfma_f32_16x16x32_bf16 v[252:255], v[92:95], v[100:103], v[252:255]
    v_cmp_ne_u32 vcc, 0, v8
    s_cbranch_vccnz RARE_101
BACK_102:
    s_waitcnt lgkmcnt(3)
    v_mfma_f32_16x16x32_bf16 v[128:131], v[64:67], v[160:163], v[144:147]
    ds_read_b128 v[92:95], v4 offset:9984
    v_mfma_f32_16x16x32_bf16 v[128:131], v[68:71], v[164:167], v[128:131]
    v_exp_f32 v56, v112
    v_mfma_f32_16x16x32_bf16 v[128:131], v[72:75], v[168:171], v[128:131]
    v_exp_f32 v57, v113
    v_mfma_f32_16x16x32_bf16 v[128:131], v[76:79], v[172:175], v[128:131]
    v_exp_f32 v58, v114
    v_cvt_pk_bf16_f32 v96, v56, v57
    v_mfma_f32_16x16x32_bf16 v[136:139], v[64:67], v[176:179], v[148:151]
    v_exp_f32 v59, v115
    v_mfma_f32_16x16x32_bf16 v[136:139], v[68:71], v[180:183], v[136:139]
    ds_read_b128 v[64:67], v5 offset:8192
    v_mfma_f32_16x16x32_bf16 v[136:139], v[72:75], v[184:187], v[136:139]
    ds_read_b128 v[68:71], v5 offset:8448
    v_exp_f32 v56, v116
    v_mfma_f32_16x16x32_bf16 v[136:139], v[76:79], v[188:191], v[136:139]
    ds_read_b128 v[72:75], v5 offset:8704
    v_cvt_pk_bf16_f32 v97, v58, v59
    s_waitcnt lgkmcnt(3)
    v_mfma_f32_16x16x32_bf16 v[132:135], v[80:83], v[160:163], v[144:147]
    ds_read_b128 v[76:79], v5 offset:8960
    v_mfma_f32_16x16x32_bf16 v[132:135], v[84:87], v[164:167], v[132:135]
    v_exp_f32 v57, v117
    v_mfma_f32_16x16x32_bf16 v[132:135], v[88:91], v[168:171], v[132:135]
    v_exp_f32 v58, v118
    v_cvt_pk_bf16_f32 v98, v56, v57
    v_mfma_f32_16x16x32_bf16 v[132:135], v[92:95], v[172:175], v[132:135]
    s_sub_u32 s34, s34, 1
    v_mfma_f32_16x16x32_bf16 v[140:143], v[80:83], v[176:179], v[148:151]
    v_exp_f32 v59, v119
    v_or3_b32 v8, v96, v97, v98
    v_mfma_f32_16x16x32_bf16 v[140:143], v[84:87], v[180:183], v[140:143]
    ds_read_b128 v[80:83], v5 offset:9216
    v_mfma_f32_16x16x32_bf16 v[140:143], v[88:91], v[184:187], v[140:143]
    ds_read_b128 v[84:87], v5 offset:9472
    v_exp_f32 v56, v120
    v_mfma_f32_16x16x32_bf16 v[140:143], v[92:95], v[188:191], v[140:143]
    ds_read_b128 v[88:91], v5 offset:9728
    v_cvt_pk_bf16_f32 v99, v58, v59
    v_mfma_f32_16x16x32_bf16 v[152:155], v[60:63], v[104:107], v[152:155]
    ds_read_b128 v[92:95], v5 offset:9984
    v_mfma_f32_16x16x32_bf16 v[156:159], v[60:63], v[108:111], v[156:159]
    v_exp_f32 v57, v121
    s_waitcnt lgkmcnt(4)
    v_mfma_f32_16x16x32_bf16 v[192:195], v[64:67], v[104:107], v[192:195]
    v_xor_b32 v5, 0x10000, v4
    v_xor_b32 v4, 0xc000, v4
    v_mfma_f32_16x16x32_bf16 v[200:203], v[64:67], v[108:111], v[200:203]
    v_exp_f32 v58, v122
    v_cvt_pk_bf16_f32 v100, v56, v57
    v_mfma_f32_16x16x32_bf16 v[196:199], v[68:71], v[104:107], v[196:199]
    v_exp_f32 v59, v123
    v_mfma_f32_16x16x32_bf16 v[204:207], v[68:71], v[108:111], v[204:207]
    s_cmp_lg_u32 s34, -1
    s_cbranch_scc1 EVEN_88
    s_waitcnt lgkmcnt(4)
    v_mfma_f32_16x16x32_bf16 v[208:211], v[72:75], v[104:107], v[208:211]
    v_or3_b32 v8, v8, v99, v100
    v_mfma_f32_16x16x32_bf16 v[216:219], v[72:75], v[108:111], v[216:219]
    v_exp_f32 v56, v124
    v_mfma_f32_16x16x32_bf16 v[212:215], v[76:79], v[104:107], v[212:215]
    v_cvt_pk_bf16_f32 v101, v58, v59
    v_mfma_f32_16x16x32_bf16 v[220:223], v[76:79], v[108:111], v[220:223]
    v_exp_f32 v57, v125
    s_waitcnt vmcnt(4)
    s_waitcnt lgkmcnt(0)
    s_barrier
    v_mfma_f32_16x16x32_bf16 v[224:227], v[80:83], v[104:107], v[224:227]
    ds_read_b128 v[64:67], v4 offset:0
    ds_read_b128 v[68:71], v4 offset:256
    v_mfma_f32_16x16x32_bf16 v[232:235], v[80:83], v[108:111], v[232:235]
    ds_read_b128 v[72:75], v4 offset:512
    ds_read_b128 v[76:79], v4 offset:768
    v_mfma_f32_16x16x32_bf16 v[228:231], v[84:87], v[104:107], v[228:231]
    ds_read_b128 v[80:83], v4 offset:1024
    v_exp_f32 v58, v126
    v_mfma_f32_16x16x32_bf16 v[236:239], v[84:87], v[108:111], v[236:239]
    v_cvt_pk_bf16_f32 v102, v56, v57
    v_mfma_f32_16x16x32_bf16 v[240:243], v[88:91], v[104:107], v[240:243]
    ds_read_b128 v[84:87], v4 offset:1280
    v_exp_f32 v59, v127
    v_mfma_f32_16x16x32_bf16 v[248:251], v[88:91], v[108:111], v[248:251]
    v_or3_b32 v8, v8, v101, v102
    v_cvt_pk_bf16_f32 v103, v58, v59
    v_or_b32 v8, v8, v103
    v_mfma_f32_16x16x32_bf16 v[244:247], v[92:95], v[104:107], v[244:247]
    ds_read_b128 v[88:91], v4 offset:1536
    v_and_b32 v8, s42, v8
    v_mfma_f32_16x16x32_bf16 v[252:255], v[92:95], v[108:111], v[252:255]
    v_cmp_ne_u32 vcc, 0, v8
    s_cbranch_vccnz RARE_103
BACK_104:
    s_waitcnt lgkmcnt(3)
    v_mfma_f32_16x16x32_bf16 v[112:115], v[64:67], v[160:163], v[144:147]
    ds_read_b128 v[92:95], v4 offset:1792
    v_mfma_f32_16x16x32_bf16 v[112:115], v[68:71], v[164:167], v[112:115]
    s_add_u32 s41, s41, 1
    s_bitcmp1_b32 s40, s41
    s_cbranch_scc1 STUB_105
RET_106:
    v_mfma_f32_16x16x32_bf16 v[112:115], v[72:75], v[168:171], v[112:115]
    s_mov_b32 m0, s38
    s_xor_b32 s38, s38, 0x8000
    buffer_load_dwordx4 v6, s[20:23], s36 offen offset:0 sc1 lds
    v_mfma_f32_16x16x32_bf16 v[112:115], v[76:79], v[172:175], v[112:115]
    v_exp_f32 v56, v128
    v_mfma_f32_16x16x32_bf16 v[120:123], v[64:67], v[176:179], v[148:151]
    v_exp_f32 v57, v129
    v_mfma_f32_16x16x32_bf16 v[120:123], v[68:71], v[180:183], v[120:123]
    ds_read_b128 v[64:67], v5 offset:0
    v_exp_f32 v58, v130
    v_cvt_pk_bf16_f32 v104, v56, v57
    v_mfma_f32_16x16x32_bf16 v[120:123], v[72:75], v[184:187], v[120:123]
    ds_read_b128 v[68:71], v5 offset:256
    v_mfma_f32_16x16x32_bf16 v[120:123], v[76:79], v[188:191], v[120:123]
    ds_read_b128 v[72:75], v5 offset:512
    v_exp_f32 v59, v131
    s_waitcnt lgkmcnt(3)
    v_mfma_f32_16x16x32_bf16 v[116:119], v[80:83], v[160:163], v[144:147]
    ds_read_b128 v[76:79], v5 offset:768
    v_mfma_f32_16x16x32_bf16 v[116:119], v[84:87], v[164:167], v[116:119]
    v_exp_f32 v56, v132
    v_cvt_pk_bf16_f32 v105, v58, v59
    v_mfma_f32_16x16x32_bf16 v[116:119], v[88:91], v[168:171], v[116:119]
    buffer_load_dwordx4 v6, s[20:23], s36 offen offset:1024 sc1 lds
    v_mfma_f32_16x16x32_bf16 v[116:119], v[92:95], v[172:175], v[116:119]
    v_exp_f32 v57, v133
    v_mfma_f32_16x16x32_bf16 v[124:127], v[80:83], v[176:179], v[148:151]
    v_exp_f32 v58, v134
    v_mfma_f32_16x16x32_bf16 v[124:127], v[84:87], v[180:183], v[124:127]
    ds_read_b128 v[80:83], v5 offset:1024
    v_cvt_pk_bf16_f32 v106, v56, v57
    v_mfma_f32_16x16x32_bf16 v[124:127], v[88:91], v[184:187], v[124:127]
    ds_read_b128 v[84:87], v5 offset:1280
    v_exp_f32 v59, v135
    v_mfma_f32_16x16x32_bf16 v[124:127], v[92:95], v[188:191], v[124:127]
    ds_read_b128 v[88:91], v5 offset:1536
    v_or3_b32 v8, v104, v105, v106
    v_mfma_f32_16x16x32_bf16 v[152:155], v[60:63], v[96:99], v[152:155]
    ds_read_b128 v[92:95], v5 offset:1792
    v_mfma_f32_16x16x32_bf16 v[156:159], v[60:63], v[100:103], v[156:159]
    v_exp_f32 v56, v136
    v_cvt_pk_bf16_f32 v107, v58, v59
    s_waitcnt lgkmcnt(4)
    v_mfma_f32_16x16x32_bf16 v[192:195], v[64:67], v[96:99], v[192:195]
    buffer_load_dwordx4 v6, s[20:23], s36 offen offset:2048 sc1 lds
    v_mfma_f32_16x16x32_bf16 v[200:203], v[64:67], v[100:103], v[200:203]
    v_exp_f32 v57, v137
    v_mfma_f32_16x16x32_bf16 v[196:199], v[68:71], v[96:99], v[196:199]
    ds_read_b128 v[64:67], v4 offset:8192
    v_mfma_f32_16x16x32_bf16 v[204:207], v[68:71], v[100:103], v[204:207]
    v_exp_f32 v58, v138
    v_cvt_pk_bf16_f32 v108, v56, v57
    v_mfma_f32_16x16x32_bf16 v[208:211], v[72:75], v[96:99], v[208:211]
    ds_read_b128 v[68:71], v4 offset:8448
    v_exp_f32 v59, v139
    v_mfma_f32_16x16x32_bf16 v[216:219], v[72:75], v[100:103], v[216:219]
    v_or3_b32 v8, v8, v107, v108
    v_mfma_f32_16x16x32_bf16 v[212:215], v[76:79], v[96:99], v[212:215]
    ds_read_b128 v[72:75], v4 offset:8704
    v_exp_f32 v56, v140
    v_mfma_f32_16x16x32_bf16 v[220:223], v[76:79], v[100:103], v[220:223]
    v_cvt_pk_bf16_f32 v109, v58, v59
    s_waitcnt lgkmcnt(3)
    v_mfma_f32_16x16x32_bf16 v[224:227], v[80:83], v[96:99], v[224:227]
    ds_read_b128 v[76:79], v4 offset:8960
    buffer_load_dwordx4 v6, s[20:23], s36 offen offset:3072 sc1 lds
    s_add_u32 s36, s36, 0x10000
    v_mfma_f32_16x16x32_bf16 v[232:235], v[80:83], v[100:103], v[232:235]
    v_exp_f32 v57, v141
    v_mfma_f32_16x16x32_bf16 v[228:231], v[84:87], v[96:99], v[228:231]
    ds_read_b128 v[80:83], v4 offset:9216
    v_exp_f32 v58, v142
    v_mfma_f32_16x16x32_bf16 v[236:239], v[84:87], v[100:103], v[236:239]
    v_cvt_pk_bf16_f32 v110, v56, v57
    v_exp_f32 v59, v143
    v_mfma_f32_16x16x32_bf16 v[240:243], v[88:91], v[96:99], v[240:243]
    ds_read_b128 v[84:87], v4 offset:9472
    v_or3_b32 v8, v8, v109, v110
    v_mfma_f32_16x16x32_bf16 v[248:251], v[88:91], v[100:103], v[248:251]
    v_cvt_pk_bf16_f32 v111, v58, v59
    v_or_b32 v8, v8, v111
    v_mfma_f32_16x16x32_bf16 v[244:247], v[92:95], v[96:99], v[244:247]
    ds_read_b128 v[88:91], v4 offset:9728
    v_and_b32 v8, s42, v8
    v_mfma_f32_16x16x32_bf16 v[252:255], v[92:95], v[100:103], v[252:255]
    v_cmp_ne_u32 vcc, 0, v8
    s_cbranch_vccnz RARE_107
BACK_108:
    s_cmp_eq_u32 s35, 0
    s_cbranch_scc1 OOL_109
RET_110:
    s_waitcnt lgkmcnt(3)
    v_mfma_f32_16x16x32_bf16 v[128:131], v[64:67], v[160:163], v[144:147]
    ds_read_b128 v[92:95], v4 offset:9984
    v_mfma_f32_16x16x32_bf16 v[128:131], v[68:71], v[164:167], v[128:131]
    v_exp_f32 v56, v112
    v_mfma_f32_16x16x32_bf16 v[128:131], v[72:75], v[168:171], v[128:131]
    v_exp_f32 v57, v113
    v_mfma_f32_16x16x32_bf16 v[128:131], v[76:79], v[172:175], v[128:131]
    v_exp_f32 v58, v114
    v_cvt_pk_bf16_f32 v96, v56, v57
    v_mfma_f32_16x16x32_bf16 v[136:139], v[64:67], v[176:179], v[148:151]
    v_exp_f32 v59, v115
    v_mfma_f32_16x16x32_bf16 v[136:139], v[68:71], v[180:183], v[136:139]
    ds_read_b128 v[64:67], v5 offset:8192
    v_mfma_f32_16x16x32_bf16 v[136:139], v[72:75], v[184:187], v[136:139]
    ds_read_b128 v[68:71], v5 offset:8448
    v_exp_f32 v56, v116
    v_mfma_f32_16x16x32_bf16 v[136:139], v[76:79], v[188:191], v[136:139]
    ds_read_b128 v[72:75], v5 offset:8704
    v_cvt_pk_bf16_f32 v97, v58, v59
    s_waitcnt lgkmcnt(3)
    v_mfma_f32_16x16x32_bf16 v[132:135], v[80:83], v[160:163], v[144:147]
    ds_read_b128 v[76:79], v5 offset:8960
    v_mfma_f32_16x16x32_bf16 v[132:135], v[84:87], v[164:167], v[132:135]
    v_exp_f32 v57, v117
    v_mfma_f32_16x16x32_bf16 v[132:135], v[88:91], v[168:171], v[132:135]
    v_exp_f32 v58, v118
    v_mfma_f32_16x16x32_bf16 v[132:135], v[92:95], v[172:175], v[132:135]
    v_cvt_pk_bf16_f32 v98, v56, v57
    v_mfma_f32_16x16x32_bf16 v[140:143], v[80:83], v[176:179], v[148:151]
    v_exp_f32 v59, v119
    v_or3_b32 v8, v96, v97, v98
    v_mfma_f32_16x16x32_bf16 v[140:143], v[84:87], v[180:183], v[140:143]
    ds_read_b128 v[80:83], v5 offset:9216
    v_mfma_f32_16x16x32_bf16 v[140:143], v[88:91], v[184:187], v[140:143]
    ds_read_b128 v[84:87], v5 offset:9472
    v_exp_f32 v56, v120
    v_mfma_f32_16x16x32_bf16 v[140:143], v[92:95], v[188:191], v[140:143]
    ds_read_b128 v[88:91], v5 offset:9728
    v_cvt_pk_bf16_f32 v99, v58, v59
    v_mfma_f32_16x16x32_bf16 v[152:155], v[60:63], v[104:107], v[152:155]
    ds_read_b128 v[92:95], v5 offset:9984
    v_mfma_f32_16x16x32_bf16 v[156:159], v[60:63], v[108:111], v[156:159]
    v_exp_f32 v57, v121
    s_waitcnt lgkmcnt(4)
    v_mfma_f32_16x16x32_bf16 v[192:195], v[64:67], v[104:107], v[192:195]
    v_xor_b32 v5, 0x10000, v4
    v_xor_b32 v4, 0x8000, v4
    v_mfma_f32_16x16x32_bf16 v[200:203], v[64:67], v[108:111], v[200:203]
    v_exp_f32 v58, v122
    v_cvt_pk_bf16_f32 v100, v56, v57
    v_mfma_f32_16x16x32_bf16 v[196:199], v[68:71], v[104:107], v[196:199]
    v_exp_f32 v59, v123
    v_mfma_f32_16x16x32_bf16 v[204:207], v[68:71], v[108:111], v[204:207]
    s_cmp_eq_u32 s35, 0
    s_cbranch_scc1 DR0_28
P2_89:
    s_waitcnt lgkmcnt(4)
    v_mfma_f32_16x16x32_bf16 v[208:211], v[72:75], v[104:107], v[208:211]
    v_or3_b32 v8, v8, v99, v100
    v_mfma_f32_16x16x32_bf16 v[216:219], v[72:75], v[108:111], v[216:219]
    v_exp_f32 v56, v124
    v_mfma_f32_16x16x32_bf16 v[212:215], v[76:79], v[104:107], v[212:215]
    v_cvt_pk_bf16_f32 v101, v58, v59
    v_mfma_f32_16x16x32_bf16 v[220:223], v[76:79], v[108:111], v[220:223]
    v_exp_f32 v57, v125
    s_waitcnt vmcnt(0)
    s_waitcnt lgkmcnt(0)
    s_barrier
    v_mfma_f32_16x16x32_bf16 v[224:227], v[80:83], v[104:107], v[224:227]
    ds_read_b128 v[64:67], v4 offset:0
    ds_read_b128 v[68:71], v4 offset:256
    v_mfma_f32_16x16x32_bf16 v[232:235], v[80:83], v[108:111], v[232:235]
    ds_read_b128 v[72:75], v4 offset:512
    ds_read_b128 v[76:79], v4 offset:768
    v_mfma_f32_16x16x32_bf16 v[228:231], v[84:87], v[104:107], v[228:231]
    ds_read_b128 v[80:83], v4 offset:1024
    v_exp_f32 v58, v126
    v_mfma_f32_16x16x32_bf16 v[236:239], v[84:87], v[108:111], v[236:239]
    v_cvt_pk_bf16_f32 v102, v56, v57
    v_mfma_f32_16x16x32_bf16 v[240:243], v[88:91], v[104:107], v[240:243]
    ds_read_b128 v[84:87], v4 offset:1280
    v_exp_f32 v59, v127
    v_mfma_f32_16x16x32_bf16 v[248:251], v[88:91], v[108:111], v[248:251]
    v_or3_b32 v8, v8, v101, v102
    v_cvt_pk_bf16_f32 v103, v58, v59
    v_or_b32 v8, v8, v103
    v_mfma_f32_16x16x32_bf16 v[244:247], v[92:95], v[104:107], v[244:247]
    ds_read_b128 v[88:91], v4 offset:1536
    v_and_b32 v8, s42, v8
    v_mfma_f32_16x16x32_bf16 v[252:255], v[92:95], v[108:111], v[252:255]
    v_cmp_ne_u32 vcc, 0, v8
    s_cbranch_vccnz RARE_111
BACK_112:
    s_waitcnt lgkmcnt(3)
    v_mfma_f32_16x16x32_bf16 v[112:115], v[64:67], v[160:163], v[144:147]
    ds_read_b128 v[92:95], v4 offset:1792
    v_mfma_f32_16x16x32_bf16 v[112:115], v[68:71], v[164:167], v[112:115]
    s_add_u32 s41, s41, 1
    s_bitcmp1_b32 s40, s41
    s_cbranch_scc1 STUB_113
RET_114:
    v_mfma_f32_16x16x32_bf16 v[112:115], v[72:75], v[168:171], v[112:115]
    s_mov_b32 m0, s38
    s_xor_b32 s38, s38, 0x8000
    buffer_load_dwordx4 v6, s[20:23], s36 offen offset:0 sc1 lds
    v_mfma_f32_16x16x32_bf16 v[112:115], v[76:79], v[172:175], v[112:115]
    s_sub_u32 s35, s35, 1
    v_exp_f32 v56, v128
    v_mfma_f32_16x16x32_bf16 v[120:123], v[64:67], v[176:179], v[148:151]
    v_exp_f32 v57, v129
    v_mfma_f32_16x16x32_bf16 v[120:123], v[68:71], v[180:183], v[120:123]
    ds_read_b128 v[64:67], v5 offset:0
    v_exp_f32 v58, v130
    v_cvt_pk_bf16_f32 v104, v56, v57
    v_mfma_f32_16x16x32_bf16 v[120:123], v[72:75], v[184:187], v[120:123]
    ds_read_b128 v[68:71], v5 offset:256
    buffer_load_dwordx4 v6, s[20:23], s36 offen offset:1024 sc1 lds
    v_mfma_f32_16x16x32_bf16 v[120:123], v[76:79], v[188:191], v[120:123]
    ds_read_b128 v[72:75], v5 offset:512
    s_waitcnt lgkmcnt(3)
    v_mfma_f32_16x16x32_bf16 v[116:119], v[80:83], v[160:163], v[144:147]
    ds_read_b128 v[76:79], v5 offset:768
    v_exp_f32 v59, v131
    v_mfma_f32_16x16x32_bf16 v[116:119], v[84:87], v[164:167], v[116:119]
    v_exp_f32 v56, v132
    v_cvt_pk_bf16_f32 v105, v58, v59
    v_mfma_f32_16x16x32_bf16 v[116:119], v[88:91], v[168:171], v[116:119]
    buffer_load_dwordx4 v6, s[20:23], s36 offen offset:2048 sc1 lds
    v_mfma_f32_16x16x32_bf16 v[116:119], v[92:95], v[172:175], v[116:119]
    v_exp_f32 v57, v133
    v_mfma_f32_16x16x32_bf16 v[124:127], v[80:83], v[176:179], v[148:151]
    v_exp_f32 v58, v134
    v_mfma_f32_16x16x32_bf16 v[124:127], v[84:87], v[180:183], v[124:127]
    ds_read_b128 v[80:83], v5 offset:1024
    v_cvt_pk_bf16_f32 v106, v56, v57
    v_mfma_f32_16x16x32_bf16 v[124:127], v[88:91], v[184:187], v[124:127]
    ds_read_b128 v[84:87], v5 offset:1280
    buffer_load_dwordx4 v6, s[20:23], s36 offen offset:3072 sc1 lds
    s_add_u32 s36, s36, 0x10000
    v_mfma_f32_16x16x32_bf16 v[124:127], v[92:95], v[188:191], v[124:127]
    ds_read_b128 v[88:91], v5 offset:1536
    v_exp_f32 v59, v135
    v_mfma_f32_16x16x32_bf16 v[152:155], v[60:63], v[96:99], v[152:155]
    ds_read_b128 v[92:95], v5 offset:1792
    v_or3_b32 v8, v104, v105, v106
    v_mfma_f32_16x16x32_bf16 v[156:159], v[60:63], v[100:103], v[156:159]
    v_exp_f32 v56, v136
    v_cvt_pk_bf16_f32 v107, v58, v59
    s_waitcnt lgkmcnt(4)
    v_mfma_f32_16x16x32_bf16 v[192:195], v[64:67], v[96:99], v[192:195]
    s_mov_b32 m0, s39
    s_xor_b32 s39, s39, 0x8000
    buffer_load_dwordx4 v6, s[20:23], s37 offen offset:0 sc1 lds
    v_mfma_f32_16x16x32_bf16 v[200:203], v[64:67], v[100:103], v[200:203]
    v_exp_f32 v57, v137
    v_mfma_f32_16x16x32_bf16 v[196:199], v[68:71], v[96:99], v[196:199]
    ds_read_b128 v[64:67], v4 offset:8192
    v_exp_f32 v58, v138
    v_mfma_f32_16x16x32_bf16 v[204:207], v[68:71], v[100:103], v[204:207]
    v_cvt_pk_bf16_f32 v108, v56, v57
    v_mfma_f32_16x16x32_bf16 v[208:211], v[72:75], v[96:99], v[208:211]
    ds_read_b128 v[68:71], v4 offset:8448
    buffer_load_dwordx4 v6, s[20:23], s37 offen offset:1024 sc1 lds
    v_mfma_f32_16x16x32_bf16 v[216:219], v[72:75], v[100:103], v[216:219]
    v_exp_f32 v59, v139
    v_or3_b32 v8, v8, v107, v108
    v_mfma_f32_16x16x32_bf16 v[212:215], v[76:79], v[96:99], v[212:215]
    ds_read_b128 v[72:75], v4 offset:8704
    v_exp_f32 v56, v140
    v_mfma_f32_16x16x32_bf16 v[220:223], v[76:79], v[100:103], v[220:223]
    v_cvt_pk_bf16_f32 v109, v58, v59
    s_waitcnt lgkmcnt(3)
    v_mfma_f32_16x16x32_bf16 v[224:227], v[80:83], v[96:99], v[224:227]
    ds_read_b128 v[76:79], v4 offset:8960
    buffer_load_dwordx4 v6, s[20:23], s37 offen offset:2048 sc1 lds
    v_mfma_f32_16x16x32_bf16 v[232:235], v[80:83], v[100:103], v[232:235]
    v_exp_f32 v57, v141
    v_exp_f32 v58, v142
    v_mfma_f32_16x16x32_bf16 v[228:231], v[84:87], v[96:99], v[228:231]
    ds_read_b128 v[80:83], v4 offset:9216
    v_cvt_pk_bf16_f32 v110, v56, v57
    v_mfma_f32_16x16x32_bf16 v[236:239], v[84:87], v[100:103], v[236:239]
    v_exp_f32 v59, v143
    v_mfma_f32_16x16x32_bf16 v[240:243], v[88:91], v[96:99], v[240:243]
    ds_read_b128 v[84:87], v4 offset:9472
    buffer_load_dwordx4 v6, s[20:23], s37 offen offset:3072 sc1 lds
    s_add_u32 s37, s37, 0x10000
    v_mfma_f32_16x16x32_bf16 v[248:251], v[88:91], v[100:103], v[248:251]
    v_or3_b32 v8, v8, v109, v110
    v_cvt_pk_bf16_f32 v111, v58, v59
    v_or_b32 v8, v8, v111
    v_mfma_f32_16x16x32_bf16 v[244:247], v[92:95], v[96:99], v[244:247]
    ds_read_b128 v[88:91], v4 offset:9728
    v_and_b32 v8, s42, v8
    v_mfma_f32_16x16x32_bf16 v[252:255], v[92:95], v[100:103], v[252:255]
    v_cmp_ne_u32 vcc, 0, v8
    s_cbranch_vccnz RARE_115
BACK_116:
    s_cmp_eq_u32 s35, 0
    s_cbranch_scc1 OOL_117
RET_118:
    s_waitcnt lgkmcnt(3)
    v_mfma_f32_16x16x32_bf16 v[128:131], v[64:67], v[160:163], v[144:147]
    ds_read_b128 v[92:95], v4 offset:9984
    v_mfma_f32_16x16x32_bf16 v[128:131], v[68:71], v[164:167], v[128:131]
    v_exp_f32 v56, v112
    v_mfma_f32_16x16x32_bf16 v[128:131], v[72:75], v[168:171], v[128:131]
    v_exp_f32 v57, v113
    v_mfma_f32_16x16x32_bf16 v[128:131], v[76:79], v[172:175], v[128:131]
    v_exp_f32 v58, v114
    v_cvt_pk_bf16_f32 v96, v56, v57
    v_mfma_f32_16x16x32_bf16 v[136:139], v[64:67], v[176:179], v[148:151]
    v_exp_f32 v59, v115
    v_mfma_f32_16x16x32_bf16 v[136:139], v[68:71], v[180:183], v[136:139]
    ds_read_b128 v[64:67], v5 offset:8192
    v_mfma_f32_16x16x32_bf16 v[136:139], v[72:75], v[184:187], v[136:139]
    ds_read_b128 v[68:71], v5 offset:8448
    v_exp_f32 v56, v116
    v_mfma_f32_16x16x32_bf16 v[136:139], v[76:79], v[188:191], v[136:139]
    ds_read_b128 v[72:75], v5 offset:8704
    v_cvt_pk_bf16_f32 v97, v58, v59
    s_waitcnt lgkmcnt(3)
    v_mfma_f32_16x16x32_bf16 v[132:135], v[80:83], v[160:163], v[144:147]
    ds_read_b128 v[76:79], v5 offset:8960
    v_mfma_f32_16x16x32_bf16 v[132:135], v[84:87], v[164:167], v[132:135]
    v_exp_f32 v57, v117
    v_mfma_f32_16x16x32_bf16 v[132:135], v[88:91], v[168:171], v[132:135]
    v_exp_f32 v58, v118
    v_mfma_f32_16x16x32_bf16 v[132:135], v[92:95], v[172:175], v[132:135]
    v_cvt_pk_bf16_f32 v98, v56, v57
    v_mfma_f32_16x16x32_bf16 v[140:143], v[80:83], v[176:179], v[148:151]
    v_exp_f32 v59, v119
    v_or3_b32 v8, v96, v97, v98
    v_mfma_f32_16x16x32_bf16 v[140:143], v[84:87], v[180:183], v[140:143]
    ds_read_b128 v[80:83], v5 offset:9216
    v_mfma_f32_16x16x32_bf16 v[140:143], v[88:91], v[184:187], v[140:143]
    ds_read_b128 v[84:87], v5 offset:9472
    v_exp_f32 v56, v120
    v_mfma_f32_16x16x32_bf16 v[140:143], v[92:95], v[188:191], v[140:143]
    ds_read_b128 v[88:91], v5 offset:9728
    v_cvt_pk_bf16_f32 v99, v58, v59
    v_mfma_f32_16x16x32_bf16 v[152:155], v[60:63], v[104:107], v[152:155]
    ds_read_b128 v[92:95], v5 offset:9984
    v_mfma_f32_16x16x32_bf16 v[156:159], v[60:63], v[108:111], v[156:159]
    v_exp_f32 v57, v121
    s_waitcnt lgkmcnt(4)
    v_mfma_f32_16x16x32_bf16 v[192:195], v[64:67], v[104:107], v[192:195]
    v_xor_b32 v5, 0x10000, v4
    v_xor_b32 v4, 0x8000, v4
    v_mfma_f32_16x16x32_bf16 v[200:203], v[64:67], v[108:111], v[200:203]
    v_exp_f32 v58, v122
    v_cvt_pk_bf16_f32 v100, v56, v57
    v_mfma_f32_16x16x32_bf16 v[196:199], v[68:71], v[104:107], v[196:199]
    v_exp_f32 v59, v123
    v_mfma_f32_16x16x32_bf16 v[204:207], v[68:71], v[108:111], v[204:207]
    s_cmp_lg_u32 s35, 0
    s_cbranch_scc1 P2_89
DR0_28:
    s_waitcnt lgkmcnt(4)
    v_mfma_f32_16x16x32_bf16 v[208:211], v[72:75], v[104:107], v[208:211]
    v_or3_b32 v8, v8, v99, v100
    v_exp_f32 v56, v124
    v_cvt_pk_bf16_f32 v101, v58, v59
    v_mfma_f32_16x16x32_bf16 v[216:219], v[72:75], v[108:111], v[216:219]
    v_exp_f32 v57, v125
    s_lshr_b32 s34, s3, 2
    v_mfma_f32_16x16x32_bf16 v[212:215], v[76:79], v[104:107], v[212:215]
    s_and_b32 s35, s3, 3
    s_lshl_b32 s37, s7, 1
    s_add_u32 s37, s37, s34
    s_lshl_b32 s37, s37, 12
    v_mfma_f32_16x16x32_bf16 v[220:223], v[76:79], v[108:111], v[220:223]
    s_lshl_b32 s60, s35, 10
    v_add_u32 v50, s60, v6
    v_subrev_u32 v51, 16, v50
    s_waitcnt vmcnt(0)
    v_and_b32 v52, v52, v53
    v_and_b32 v54, v54, v55
    v_and_b32 v52, v52, v54
    v_and_b32 v52, 2, v52
    v_cmp_ne_u32 vcc, 2, v52
    s_cbranch_vccnz SCK_119
SCR_120:
    buffer_load_dwordx4 v[160:163], v51, s[12:15], s37 offen
    buffer_load_dwordx4 v[164:167], v50, s[12:15], s37 offen
    s_waitcnt lgkmcnt(0)
    s_barrier
    v_mfma_f32_16x16x32_bf16 v[224:227], v[80:83], v[104:107], v[224:227]
    ds_read_b128 v[64:67], v5 offset:0
    ds_read_b128 v[68:71], v5 offset:256
    v_exp_f32 v58, v126
    v_cvt_pk_bf16_f32 v102, v56, v57
    v_exp_f32 v59, v127
    v_or3_b32 v8, v8, v101, v102
    v_mfma_f32_16x16x32_bf16 v[232:235], v[80:83], v[108:111], v[232:235]
    ds_read_b128 v[72:75], v5 offset:512
    ds_read_b128 v[76:79], v5 offset:768
    v_cvt_pk_bf16_f32 v103, v58, v59
    v_or_b32 v8, v8, v103
    v_and_b32 v8, s42, v8
    s_lshl_b32 s63, s3, 18
    s_lshl_b32 s62, s7, 5
    s_add_u32 s63, s63, s62
    v_mfma_f32_16x16x32_bf16 v[228:231], v[84:87], v[104:107], v[228:231]
    ds_read_b128 v[80:83], v5 offset:1024
    s_add_u32 s63, s63, 67108864
    v_lshrrev_b32 v48, 1, v0
    v_and_b32 v3, 1, v0
    v_lshlrev_b32 v49, 13, v48
    v_lshl_add_u32 v49, v3, 4, v49
    v_mfma_f32_16x16x32_bf16 v[236:239], v[84:87], v[108:111], v[236:239]
    buffer_load_dwordx4 v[168:171], v49, s[20:23], s63 offen sc1
    v_subrev_u32 v15, 32, v9
    v_cmp_lt_i32 s[46:47], v15, 0
    v_cmp_lt_i32 s[48:49], v15, 1
    v_cmp_lt_i32 s[50:51], v15, 2
    v_cmp_lt_i32 s[52:53], v15, 3
    v_cndmask_b32 v128, v128, v10, s[46:47]
    v_mfma_f32_16x16x32_bf16 v[240:243], v[88:91], v[104:107], v[240:243]
    ds_read_b128 v[84:87], v5 offset:1280
    v_cndmask_b32 v129, v129, v10, s[48:49]
    v_cndmask_b32 v130, v130, v10, s[50:51]
    v_cndmask_b32 v131, v131, v10, s[52:53]
    v_cmp_lt_i32 s[46:47], v15, 16
    v_cmp_lt_i32 s[48:49], v15, 17
    v_cmp_lt_i32 s[50:51], v15, 18
    v_cmp_lt_i32 s[52:53], v15, 19
    v_mfma_f32_16x16x32_bf16 v[248:251], v[88:91], v[108:111], v[248:251]
    v_cndmask_b32 v132, v132, v10, s[46:47]
    v_cndmask_b32 v133, v133, v10, s[48:49]
    v_cndmask_b32 v134, v134, v10, s[50:51]
    v_cndmask_b32 v135, v135, v10, s[52:53]
    v_subrev_u32 v15, 32, v7
    v_cmp_lt_i32 s[46:47], v15, 0
    v_cmp_lt_i32 s[48:49], v15, 1
    v_cmp_lt_i32 s[50:51], v15, 2
    v_mfma_f32_16x16x32_bf16 v[244:247], v[92:95], v[104:107], v[244:247]
    ds_read_b128 v[88:91], v5 offset:1536
    v_cmp_lt_i32 s[52:53], v15, 3
    v_cndmask_b32 v136, v136, v10, s[46:47]
    v_cndmask_b32 v137, v137, v10, s[48:49]
    v_cndmask_b32 v138, v138, v10, s[50:51]
    v_cndmask_b32 v139, v139, v10, s[52:53]
    v_cmp_lt_i32 s[46:47], v15, 16
    v_cmp_lt_i32 s[48:49], v15, 17
    v_mfma_f32_16x16x32_bf16 v[252:255], v[92:95], v[108:111], v[252:255]
    v_cmp_lt_i32 s[50:51], v15, 18
    v_cmp_lt_i32 s[52:53], v15, 19
    v_cndmask_b32 v140, v140, v10, s[46:47]
    v_cndmask_b32 v141, v141, v10, s[48:49]
    v_cndmask_b32 v142, v142, v10, s[50:51]
    v_cndmask_b32 v143, v143, v10, s[52:53]
    v_cmp_ne_u32 vcc, 0, v8
    s_cbranch_vccnz RARE_121
BACK_122:
    s_lshl_b32 s39, s57, 19
    s_lshl_b32 s60, s3, 15
    s_add_u32 s39, s39, s60
    s_add_u32 s39, s39, 33554432
    s_and_b32 s60, s56, 1
    s_lshl_b32 s60, s60, 18
    s_add_u32 s39, s39, s60
    s_mov_b32 s58, s57
    v_mfma_f32_16x16x32_bf16 v[152:155], v[60:63], v[96:99], v[152:155]
    s_add_u32 s44, s6, 155648
    v_add_u32 v54, s44, v6
    ds_read_b128 v[92:95], v5 offset:1792
    v_exp_f32 v56, v128
    v_mfma_f32_16x16x32_bf16 v[156:159], v[60:63], v[100:103], v[156:159]
    s_lshl_b32 s46, s3, 13
    v_add_u32 v55, s46, v6
    s_add_u32 s59, s58, 0
    s_and_b32 s59, s59, 7
    s_lshl_b32 s59, s59, 12
    s_add_u32 s59, s59, s39
    buffer_load_dwordx4 v[16:19], v6, s[20:23], s59 offen offset:0 sc1
    s_waitcnt lgkmcnt(4)
    v_mfma_f32_16x16x32_bf16 v[192:195], v[64:67], v[96:99], v[192:195]
    s_sub_u32 s46, 15, s5
    s_lshl_b32 s46, s46, 20
    v_exp_f32 v57, v129
    v_mfma_f32_16x16x32_bf16 v[200:203], v[64:67], v[100:103], v[200:203]
    s_add_u32 s46, s46, s43
    s_add_u32 s46, s46, 0
    buffer_load_dwordx4 v[20:23], v6, s[20:23], s59 offen offset:1024 sc1
    v_mfma_f32_16x16x32_bf16 v[196:199], v[68:71], v[96:99], v[196:199]
    s_xor_b32 s47, s46, 787456
    s_mul_i32 s36, s34, 6144
    ds_read_b128 v[64:67], v5 offset:8192
    v_exp_f32 v58, v130
    v_cvt_pk_bf16_f32 v104, v56, v57
    v_mfma_f32_16x16x32_bf16 v[204:207], v[68:71], v[100:103], v[204:207]
    s_add_u32 s36, s36, 136192
    s_mul_i32 s38, s34, 35328
    v_exp_f32 v59, v131
    v_exp_f32 v56, v132
    v_mfma_f32_16x16x32_bf16 v[208:211], v[72:75], v[96:99], v[208:211]
    s_add_u32 s38, s38, 65536
    s_xor_b32 s40, s56, 1
    buffer_load_dwordx4 v[24:27], v6, s[20:23], s59 offen offset:2048 sc1
    ds_read_b128 v[68:71], v5 offset:8448
    v_mfma_f32_16x16x32_bf16 v[216:219], v[72:75], v[100:103], v[216:219]
    s_lshl_b32 s40, s40, 19
    s_lshl_b32 s60, s3, 14
    v_cvt_pk_bf16_f32 v105, v58, v59
    v_exp_f32 v57, v133
    v_mfma_f32_16x16x32_bf16 v[212:215], v[76:79], v[96:99], v[212:215]
    s_add_u32 s40, s40, s60
    s_add_u32 s40, s40, 50331648
    ds_read_b128 v[72:75], v5 offset:8704
    v_exp_f32 v58, v134
    v_mfma_f32_16x16x32_bf16 v[220:223], v[76:79], v[100:103], v[220:223]
    s_and_b32 s60, s56, 1
    s_lshl_b32 s60, s60, 17
    buffer_load_dwordx4 v[28:31], v6, s[20:23], s59 offen offset:3072 sc1
    s_waitcnt lgkmcnt(3)
    v_mfma_f32_16x16x32_bf16 v[224:227], v[80:83], v[96:99], v[224:227]
    s_add_u32 s40, s40, s60
    ds_read_b128 v[76:79], v5 offset:8960
    v_cvt_pk_bf16_f32 v106, v56, v57
    v_exp_f32 v59, v135
    v_or3_b32 v8, v104, v105, v106
    v_mfma_f32_16x16x32_bf16 v[232:235], v[80:83], v[100:103], v[232:235]
    v_exp_f32 v56, v136
    v_cvt_pk_bf16_f32 v107, v58, v59
    v_exp_f32 v57, v137
    v_mfma_f32_16x16x32_bf16 v[228:231], v[84:87], v[96:99], v[228:231]
    s_add_u32 s59, s58, 1
    s_and_b32 s59, s59, 7
    s_lshl_b32 s59, s59, 12
    s_add_u32 s59, s59, s39
    buffer_load_dwordx4 v[32:35], v6, s[20:23], s59 offen offset:0 sc1
    ds_read_b128 v[80:83], v5 offset:9216
    v_mfma_f32_16x16x32_bf16 v[236:239], v[84:87], v[100:103], v[236:239]
    v_exp_f32 v58, v138
    v_cvt_pk_bf16_f32 v108, v56, v57
    v_exp_f32 v59, v139
    v_mfma_f32_16x16x32_bf16 v[240:243], v[88:91], v[96:99], v[240:243]
    ds_read_b128 v[84:87], v5 offset:9472
    v_or3_b32 v8, v8, v107, v108
    v_exp_f32 v56, v140
    v_cvt_pk_bf16_f32 v109, v58, v59
    v_mfma_f32_16x16x32_bf16 v[248:251], v[88:91], v[100:103], v[248:251]
    buffer_load_dwordx4 v[36:39], v6, s[20:23], s59 offen offset:1024 sc1
    v_exp_f32 v57, v141
    v_mfma_f32_16x16x32_bf16 v[244:247], v[92:95], v[96:99], v[244:247]
    ds_read_b128 v[88:91], v5 offset:9728
    v_exp_f32 v58, v142
    v_cvt_pk_bf16_f32 v110, v56, v57
    v_mfma_f32_16x16x32_bf16 v[252:255], v[92:95], v[100:103], v[252:255]
    v_exp_f32 v59, v143
    v_or3_b32 v8, v8, v109, v110
    v_cvt_pk_bf16_f32 v111, v58, v59
    v_or_b32 v8, v8, v111
    v_and_b32 v8, s42, v8
    v_cmp_ne_u32 vcc, 0, v8
    s_cbranch_vccnz RARE_123
BACK_124:
    ds_read_b128 v[92:95], v5 offset:9984
    v_mfma_f32_16x16x32_bf16 v[152:155], v[60:63], v[104:107], v[152:155]
    buffer_load_dwordx4 v[40:43], v6, s[20:23], s59 offen offset:2048 sc1
    s_add_u32 s60, s38, 64
    v_mfma_f32_16x16x32_bf16 v[156:159], v[60:63], v[108:111], v[156:159]
    buffer_load_dwordx4 v[44:47], v6, s[20:23], s59 offen offset:3072 sc1
    v_add_u32 v138, s60, v50
    v_and_b32 v51, 3, v48
    s_waitcnt lgkmcnt(3)
    v_mfma_f32_16x16x32_bf16 v[224:227], v[80:83], v[104:107], v[224:227]
    v_mul_u32_u24 v139, 1536, v51
    v_lshrrev_b32 v53, 2, v48
    v_lshl_add_u32 v139, v53, 4, v139
    v_and_b32 v53, 1, v0
    v_mul_u32_u24 v53, 6144, v53
    v_mfma_f32_16x16x32_bf16 v[232:235], v[80:83], v[108:111], v[232:235]
    s_add_u32 s59, s58, 2
    s_and_b32 s59, s59, 7
    s_lshl_b32 s59, s59, 12
    s_add_u32 s59, s59, s39
    buffer_load_dwordx4 v[176:179], v6, s[20:23], s59 offen offset:0 sc1
    s_lshl_b32 s60, s3, 7
    s_add_u32 s60, s60, 136704
    s_waitcnt lgkmcnt(2)
    v_mfma_f32_16x16x32_bf16 v[228:231], v[84:87], v[104:107], v[228:231]
    v_add3_u32 v139, v139, v53, s60
    v_and_b32 v51, 3, v0
    v_mov_b64 v[172:173], 0
    v_mov_b64 v[174:175], 0
    v_bfe_u32 v140, v0, 2, 3
    v_mfma_f32_16x16x32_bf16 v[236:239], v[84:87], v[108:111], v[236:239]
    buffer_load_dwordx4 v[180:183], v6, s[20:23], s59 offen offset:1024 sc1
    v_mul_u32_u24 v140, 4416, v140
    v_lshl_add_u32 v140, v51, 4, v140
    s_waitcnt lgkmcnt(1)
    v_mfma_f32_16x16x32_bf16 v[240:243], v[88:91], v[104:107], v[240:243]
    buffer_load_dwordx4 v[184:187], v6, s[20:23], s59 offen offset:2048 sc1
    v_add_u32 v140, s38, v140
    v_mfma_f32_16x16x32_bf16 v[248:251], v[88:91], v[108:111], v[248:251]
    s_mul_i32 s60, s35, 1536
    s_add_u32 s60, s60, s36
    v_lshl_add_u32 v141, v0, 3, s60
    s_waitcnt vmcnt(12)
    v_alignbit_b32 v122, v161, v160, 16
    v_alignbit_b32 v123, v162, v161, 16
    s_waitcnt lgkmcnt(0)
    v_mfma_f32_16x16x32_bf16 v[244:247], v[92:95], v[104:107], v[244:247]
    v_mov_b32 v150, v144
    v_mov_b32 v153, v156
    ds_write_b128 v54, v[150:153]
    buffer_load_dwordx4 v[188:191], v6, s[20:23], s59 offen offset:3072 sc1
    v_mfma_f32_16x16x32_bf16 v[252:255], v[92:95], v[108:111], v[252:255]
    v_alignbit_b32 v124, v163, v162, 16
    v_alignbit_b32 v125, v164, v163, 16
    v_alignbit_b32 v126, v165, v164, 16
    v_alignbit_b32 v127, v166, v165, 16
    v_alignbit_b32 v128, v167, v166, 16
    v_mfma_f32_16x16x32_bf16 v[192:195], v[64:67], v[104:107], v[192:195]
    ds_write_b128 v55, v[224:227] offset:0
    v_alignbit_b32 v132, v162, v161, 16
    v_alignbit_b32 v133, v163, v162, 16
    v_mfma_f32_16x16x32_bf16 v[200:203], v[64:67], v[108:111], v[200:203]
    ds_write_b128 v55, v[228:231] offset:1024
    v_alignbit_b32 v134, v164, v163, 16
    v_mfma_f32_16x16x32_bf16 v[196:199], v[68:71], v[104:107], v[196:199]
    ds_write_b128 v55, v[232:235] offset:2048
    v_alignbit_b32 v135, v165, v164, 16
    v_alignbit_b32 v136, v166, v165, 16
    v_mfma_f32_16x16x32_bf16 v[204:207], v[68:71], v[108:111], v[204:207]
    ds_write_b128 v55, v[236:239] offset:3072
    v_alignbit_b32 v137, v167, v166, 16
    v_mfma_f32_16x16x32_bf16 v[208:211], v[72:75], v[104:107], v[208:211]
    ds_write_b128 v55, v[240:243] offset:4096
    v_mov_b32 v114, v161
    v_mov_b32 v115, v162
    v_mfma_f32_16x16x32_bf16 v[216:219], v[72:75], v[108:111], v[216:219]
    ds_write_b128 v55, v[244:247] offset:5120
    v_mov_b32 v116, v163
    v_mfma_f32_16x16x32_bf16 v[212:215], v[76:79], v[104:107], v[212:215]
    ds_write_b128 v55, v[248:251] offset:6144
    v_mov_b32 v117, v164
    v_mov_b32 v118, v165
    v_mfma_f32_16x16x32_bf16 v[220:223], v[76:79], v[108:111], v[220:223]
    ds_write_b128 v55, v[252:255] offset:7168
    v_mov_b32 v119, v166
    v_xor_b32 v54, 0x1000, v54
    v_xor_b32 v55, 0x8000, v55
    s_waitcnt lgkmcnt(0)
    s_barrier
    ds_read_b128 v[96:99], v54
    ds_read_b128 v[64:67], v55 offset:0
    ds_read_b128 v[68:71], v55 offset:1024
    ds_read_b128 v[72:75], v55 offset:2048
    ds_read_b128 v[76:79], v55 offset:3072
    ds_read_b128 v[80:83], v55 offset:4096
    ds_read_b128 v[84:87], v55 offset:5120
    ds_read_b128 v[88:91], v55 offset:6144
    ds_read_b128 v[92:95], v55 offset:7168
    s_waitcnt lgkmcnt(8)
    v_min_f32 v100, v150, v96
    v_sub_f32 v101, v100, v150
    v_sub_f32 v102, v100, v96
    v_exp_f32 v101, v101
    v_exp_f32 v102, v102
    v_mul_f32 v103, v101, v152
    v_fmac_f32 v103, v102, v98
    v_rcp_f32 v103, v103
    s_nop 0
    v_mul_f32 v104, v101, v103
    v_mul_f32 v105, v101, v103
    v_mul_f32 v106, v102, v103
    v_mul_f32 v107, v102, v103
    v_min_f32 v100, v151, v97
    v_sub_f32 v101, v100, v151
    v_sub_f32 v102, v100, v97
    v_exp_f32 v101, v101
    v_exp_f32 v102, v102
    v_mul_f32 v103, v101, v153
    v_fmac_f32 v103, v102, v99
    v_rcp_f32 v103, v103
    s_nop 0
    v_mul_f32 v108, v101, v103
    v_mul_f32 v109, v101, v103
    v_mul_f32 v110, v102, v103
    v_mul_f32 v111, v102, v103
    v_pk_mul_f32 v[192:193], v[192:193], v[104:105]
    v_pk_mul_f32 v[194:195], v[194:195], v[104:105]
    v_pk_mul_f32 v[196:197], v[196:197], v[104:105]
    v_pk_mul_f32 v[198:199], v[198:199], v[104:105]
    s_waitcnt lgkmcnt(6)
    ds_write_b128 v138, v[122:125] offset:0
    ds_write_b128 v138, v[114:117] offset:4416
    ds_write_b128 v138, v[132:135] offset:8832
    v_pk_fma_f32 v[192:193], v[64:65], v[106:107], v[192:193]
    v_pk_fma_f32 v[194:195], v[66:67], v[106:107], v[194:195]
    v_pk_fma_f32 v[196:197], v[68:69], v[106:107], v[196:197]
    v_pk_fma_f32 v[198:199], v[70:71], v[106:107], v[198:199]
    v_cvt_pk_bf16_f32 v224, v192, v193
    v_cvt_pk_bf16_f32 v225, v194, v195
    v_cvt_pk_bf16_f32 v226, v196, v197
    v_cvt_pk_bf16_f32 v227, v198, v199
    buffer_store_dwordx4 v[224:227], v6, s[20:23], s46 offen offset:0 sc1
    v_pk_mul_f32 v[200:201], v[200:201], v[108:109]
    v_pk_mul_f32 v[202:203], v[202:203], v[108:109]
    v_pk_mul_f32 v[204:205], v[204:205], v[108:109]
    v_pk_mul_f32 v[206:207], v[206:207], v[108:109]
    s_waitcnt lgkmcnt(7)
    ds_write_b128 v138, v[162:165] offset:13248
    ds_write_b128 v138, v[124:127] offset:17664
    ds_write_b128 v138, v[116:119] offset:22080
    v_pk_fma_f32 v[200:201], v[72:73], v[110:111], v[200:201]
    v_pk_fma_f32 v[202:203], v[74:75], v[110:111], v[202:203]
    v_pk_fma_f32 v[204:205], v[76:77], v[110:111], v[204:205]
    v_pk_fma_f32 v[206:207], v[78:79], v[110:111], v[206:207]
    v_cvt_pk_bf16_f32 v228, v200, v201
    v_cvt_pk_bf16_f32 v229, v202, v203
    v_cvt_pk_bf16_f32 v230, v204, v205
    v_cvt_pk_bf16_f32 v231, v206, v207
    buffer_store_dwordx4 v[228:231], v6, s[20:23], s47 offen offset:0 sc1
    v_pk_mul_f32 v[208:209], v[208:209], v[104:105]
    v_pk_mul_f32 v[210:211], v[210:211], v[104:105]
    v_pk_mul_f32 v[212:213], v[212:213], v[104:105]
    v_pk_mul_f32 v[214:215], v[214:215], v[104:105]
    s_waitcnt lgkmcnt(8)
    ds_write_b128 v138, v[134:137] offset:26496
    ds_write_b128 v138, v[164:167] offset:30912
    ds_write_b128 v140, v[172:175]
    v_pk_fma_f32 v[208:209], v[80:81], v[106:107], v[208:209]
    v_pk_fma_f32 v[210:211], v[82:83], v[106:107], v[210:211]
    v_pk_fma_f32 v[212:213], v[84:85], v[106:107], v[212:213]
    v_pk_fma_f32 v[214:215], v[86:87], v[106:107], v[214:215]
    v_cvt_pk_bf16_f32 v232, v208, v209
    v_cvt_pk_bf16_f32 v233, v210, v211
    v_cvt_pk_bf16_f32 v234, v212, v213
    v_cvt_pk_bf16_f32 v235, v214, v215
    buffer_store_dwordx4 v[232:235], v6, s[20:23], s46 offen offset:2048 sc1
    v_pk_mul_f32 v[216:217], v[216:217], v[108:109]
    v_pk_mul_f32 v[218:219], v[218:219], v[108:109]
    v_pk_mul_f32 v[220:221], v[220:221], v[108:109]
    v_pk_mul_f32 v[222:223], v[222:223], v[108:109]
    s_waitcnt lgkmcnt(9)
    ds_write_b64 v141, v[172:173]
    s_waitcnt vmcnt(15)
    ds_write_b128 v139, v[168:171]
    v_pk_fma_f32 v[216:217], v[88:89], v[110:111], v[216:217]
    v_pk_fma_f32 v[218:219], v[90:91], v[110:111], v[218:219]
    v_pk_fma_f32 v[220:221], v[92:93], v[110:111], v[220:221]
    v_pk_fma_f32 v[222:223], v[94:95], v[110:111], v[222:223]
    v_cvt_pk_bf16_f32 v236, v216, v217
    v_cvt_pk_bf16_f32 v237, v218, v219
    v_cvt_pk_bf16_f32 v238, v220, v221
    v_cvt_pk_bf16_f32 v239, v222, v223
    buffer_store_dwordx4 v[236:239], v6, s[20:23], s47 offen offset:2048 sc1
MGJ_31:
    s_setprio 0
    s_lshr_b32 s53, s56, 1
    s_lshl_b32 s53, s53, 10
    s_and_b32 s44, s56, 1
    s_lshl_b32 s44, s44, 9
    s_add_u32 s53, s53, s44
    s_lshr_b32 s44, s3, 1
    s_lshl_b32 s44, s44, 7
    s_add_u32 s53, s53, s44
    s_and_b32 s44, s3, 1
    s_lshl_b32 s44, s44, 3
    s_add_u32 s53, s53, s44
    s_add_u32 s53, s53, 71376896
    v_and_b32 v8, 1, v0
    v_lshlrev_b32 v8, 2, v8
    s_lshr_b32 s45, s4, 2
    s_lshl_b32 s45, s45, 7
    s_and_b32 s44, s4, 3
    s_lshl_b32 s44, s44, 2
    s_add_u32 s45, s45, s44
    s_sub_u32 s44, 15, s5
    s_lshl_b32 s44, s44, 10
    s_add_u32 s46, s44, s45
    s_add_u32 s46, s46, 71376896
    s_lshl_b32 s44, s5, 10
    s_add_u32 s47, s44, s45
    s_add_u32 s47, s47, 71376896
    s_mov_b32 s16, s90
    s_mov_b32 s17, s91
    s_mov_b32 s18, 2097152
    s_mov_b32 s19, 0x00020000
    s_mov_b32 s24, s64
    s_mov_b32 s25, s65
    s_mov_b32 s26, 2097152
    s_mov_b32 s27, 0x00020000
    s_lshl_b32 s44, s7, 2
    s_load_dword s55, s[74:75], s44
    v_and_b32 v12, 15, v0
    v_lshrrev_b32 v13, 4, v0
    v_and_b32 v14, 7, v0
    v_mul_u32_u24 v4, 4416, v14
    v_bfe_u32 v14, v0, 3, 1
    v_sub_u32 v14, v14, v13
    v_lshl_add_u32 v4, v14, 4, v4
    s_lshl_b32 s43, s35, 8
    s_add_u32 s43, s43, s38
    s_add_u32 s43, s43, 64
    v_add_u32 v4, s43, v4
    s_lshl_b32 s43, s35, 6
    s_sub_u32 s43, s36, s43
    s_add_u32 s43, s43, 464
    v_lshl_add_u32 v5, v12, 4, s43
    v_mul_u32_u24 v14, 1536, v13
    v_add_u32 v5, v5, v14
    s_lshl_b32 s51, s3, 13
    s_xor_b32 s52, s40, 0x80000
    s_waitcnt lgkmcnt(0)
    s_barrier
    ds_read_b128 v[160:163], v4 offset:0
    ds_read_b128 v[224:227], v5 offset:48
    ds_read_b128 v[228:231], v5 offset:304
    ds_read_b128 v[232:235], v5 offset:560
    ds_read_b128 v[236:239], v5 offset:816
    ds_read_b128 v[164:167], v4 offset:3072
    ds_read_b128 v[168:171], v4 offset:32
    ds_read_b128 v[172:175], v4 offset:3104
    ds_read_b128 v[64:67], v4 offset:1024
    ds_read_b128 v[68:71], v4 offset:2048
    ds_read_b128 v[72:75], v4 offset:1056
    s_waitcnt lgkmcnt(9)
    v_mfma_f32_16x16x32_bf16 v[192:195], v[160:163], v[224:227], 0
    ds_read_b128 v[76:79], v4 offset:2080
    s_waitcnt lgkmcnt(9)
    v_mfma_f32_16x16x32_bf16 v[200:203], v[160:163], v[228:231], 0
    s_waitcnt lgkmcnt(8)
    v_mfma_f32_16x16x32_bf16 v[208:211], v[160:163], v[232:235], 0
    s_waitcnt lgkmcnt(7)
    v_mfma_f32_16x16x32_bf16 v[216:219], v[160:163], v[236:239], 0
    s_waitcnt lgkmcnt(6)
    v_mfma_f32_16x16x32_bf16 v[216:219], v[164:167], v[224:227], v[216:219]
    ds_read_b128 v[160:163], v4 offset:64
    ds_read_b128 v[240:243], v5 offset:32
    s_waitcnt lgkmcnt(7)
    v_mfma_f32_16x16x32_bf16 v[196:199], v[168:171], v[224:227], 0
    ds_read_b128 v[164:167], v4 offset:3136
    ds_read_b128 v[244:247], v5 offset:288
    v_mfma_f32_16x16x32_bf16 v[204:207], v[168:171], v[228:231], 0
    v_mfma_f32_16x16x32_bf16 v[212:215], v[168:171], v[232:235], 0
    v_mfma_f32_16x16x32_bf16 v[220:223], v[168:171], v[236:239], 0
    s_waitcnt lgkmcnt(8)
    v_mfma_f32_16x16x32_bf16 v[220:223], v[172:175], v[224:227], v[220:223]
    ds_read_b128 v[168:171], v4 offset:96
    ds_read_b128 v[248:251], v5 offset:544
    s_add_u32 s59, s58, 3
    s_and_b32 s59, s59, 7
    s_lshl_b32 s59, s59, 12
    s_add_u32 s59, s59, s39
    buffer_load_dwordx4 v[48:51], v6, s[20:23], s59 offen offset:0 sc1
    buffer_load_dwordx4 v[52:55], v6, s[20:23], s59 offen offset:1024 sc1
    s_waitcnt lgkmcnt(9)
    v_mfma_f32_16x16x32_bf16 v[200:203], v[64:67], v[224:227], v[200:203]
    ds_read_b128 v[172:175], v4 offset:3168
    ds_read_b128 v[252:255], v5 offset:800
    v_mfma_f32_16x16x32_bf16 v[208:211], v[64:67], v[228:231], v[208:211]
    v_mfma_f32_16x16x32_bf16 v[216:219], v[64:67], v[232:235], v[216:219]
    s_waitcnt lgkmcnt(10)
    v_mfma_f32_16x16x32_bf16 v[208:211], v[68:71], v[224:227], v[208:211]
    ds_read_b128 v[64:67], v4 offset:1088
    v_mfma_f32_16x16x32_bf16 v[216:219], v[68:71], v[228:231], v[216:219]
    buffer_load_dwordx4 v[56:59], v6, s[20:23], s59 offen offset:2048 sc1
    buffer_load_dwordx4 v[60:63], v6, s[20:23], s59 offen offset:3072 sc1
    s_waitcnt lgkmcnt(10)
    v_mfma_f32_16x16x32_bf16 v[204:207], v[72:75], v[224:227], v[204:207]
    ds_read_b128 v[68:71], v4 offset:2112
    v_mfma_f32_16x16x32_bf16 v[212:215], v[72:75], v[228:231], v[212:215]
    v_mfma_f32_16x16x32_bf16 v[220:223], v[72:75], v[232:235], v[220:223]
    s_waitcnt lgkmcnt(10)
    v_mfma_f32_16x16x32_bf16 v[212:215], v[76:79], v[224:227], v[212:215]
    ds_read_b128 v[72:75], v4 offset:1120
    v_mfma_f32_16x16x32_bf16 v[220:223], v[76:79], v[228:231], v[220:223]
    s_waitcnt vmcnt(4)
    s_barrier
    s_cmp_eq_u32 s3, 0
    s_cselect_b32 s99, 0, 1073741824
    v_mov_b32 v2, 1
    v_mov_b32 v3, s99
    buffer_store_dword v2, v3, s[20:23], s46 offen sc1
    s_cmp_eq_u32 s3, 0
    s_cselect_b32 s99, 0, 1073741824
    v_mov_b32 v2, 1
    v_mov_b32 v3, s99
    buffer_store_dword v2, v3, s[20:23], s47 offen sc1
    s_add_u32 s59, s58, 4
    s_and_b32 s59, s59, 7
    s_lshl_b32 s59, s59, 12
    s_add_u32 s59, s59, s39
    buffer_load_dwordx4 v[80:83], v6, s[20:23], s59 offen offset:0 sc1
    buffer_load_dwordx4 v[84:87], v6, s[20:23], s59 offen offset:1024 sc1
    s_waitcnt lgkmcnt(9)
    v_mfma_f32_16x16x32_bf16 v[192:195], v[160:163], v[240:243], v[192:195]
    ds_read_b128 v[76:79], v4 offset:2144
    s_waitcnt lgkmcnt(8)
    v_mfma_f32_16x16x32_bf16 v[200:203], v[160:163], v[244:247], v[200:203]
    s_waitcnt lgkmcnt(6)
    v_mfma_f32_16x16x32_bf16 v[208:211], v[160:163], v[248:251], v[208:211]
    s_waitcnt lgkmcnt(4)
    v_mfma_f32_16x16x32_bf16 v[216:219], v[160:163], v[252:255], v[216:219]
    v_mfma_f32_16x16x32_bf16 v[216:219], v[164:167], v[240:243], v[216:219]
    ds_read_b128 v[160:163], v4 offset:128
    ds_read_b128 v[224:227], v5 offset:16
    buffer_load_dwordx4 v[88:91], v6, s[20:23], s59 offen offset:2048 sc1
    buffer_load_dwordx4 v[92:95], v6, s[20:23], s59 offen offset:3072 sc1
    v_mfma_f32_16x16x32_bf16 v[196:199], v[168:171], v[240:243], v[196:199]
    ds_read_b128 v[164:167], v4 offset:3200
    ds_read_b128 v[228:231], v5 offset:272
    v_mfma_f32_16x16x32_bf16 v[204:207], v[168:171], v[244:247], v[204:207]
    v_mfma_f32_16x16x32_bf16 v[212:215], v[168:171], v[248:251], v[212:215]
    v_mfma_f32_16x16x32_bf16 v[220:223], v[168:171], v[252:255], v[220:223]
    v_mfma_f32_16x16x32_bf16 v[220:223], v[172:175], v[240:243], v[220:223]
    ds_read_b128 v[168:171], v4 offset:160
    ds_read_b128 v[232:235], v5 offset:528
    s_add_u32 s59, s58, 5
    s_and_b32 s59, s59, 7
    s_lshl_b32 s59, s59, 12
    s_add_u32 s59, s59, s39
    buffer_load_dwordx4 v[96:99], v6, s[20:23], s59 offen offset:0 sc1
    buffer_load_dwordx4 v[100:103], v6, s[20:23], s59 offen offset:1024 sc1
    s_waitcnt lgkmcnt(9)
    v_mfma_f32_16x16x32_bf16 v[200:203], v[64:67], v[240:243], v[200:203]
    ds_read_b128 v[172:175], v4 offset:3232
    ds_read_b128 v[236:239], v5 offset:784
    v_mfma_f32_16x16x32_bf16 v[208:211], v[64:67], v[244:247], v[208:211]
    v_mfma_f32_16x16x32_bf16 v[216:219], v[64:67], v[248:251], v[216:219]
    s_waitcnt lgkmcnt(10)
    v_mfma_f32_16x16x32_bf16 v[208:211], v[68:71], v[240:243], v[208:211]
    ds_read_b128 v[64:67], v4 offset:1152
    v_mfma_f32_16x16x32_bf16 v[216:219], v[68:71], v[244:247], v[216:219]
    buffer_load_dwordx4 v[104:107], v6, s[20:23], s59 offen offset:2048 sc1
    buffer_load_dwordx4 v[108:111], v6, s[20:23], s59 offen offset:3072 sc1
    s_waitcnt lgkmcnt(10)
    v_mfma_f32_16x16x32_bf16 v[204:207], v[72:75], v[240:243], v[204:207]
    ds_read_b128 v[68:71], v4 offset:2176
    v_mfma_f32_16x16x32_bf16 v[212:215], v[72:75], v[244:247], v[212:215]
    v_mfma_f32_16x16x32_bf16 v[220:223], v[72:75], v[248:251], v[220:223]
    s_waitcnt lgkmcnt(10)
    v_mfma_f32_16x16x32_bf16 v[212:215], v[76:79], v[240:243], v[212:215]
    ds_read_b128 v[72:75], v4 offset:1184
    v_mfma_f32_16x16x32_bf16 v[220:223], v[76:79], v[244:247], v[220:223]
    s_add_u32 s59, s58, 6
    s_and_b32 s59, s59, 7
    s_lshl_b32 s59, s59, 12
    s_add_u32 s59, s59, s39
    buffer_load_dwordx4 v[112:115], v6, s[20:23], s59 offen offset:0 sc1
    buffer_load_dwordx4 v[116:119], v6, s[20:23], s59 offen offset:1024 sc1
    s_waitcnt lgkmcnt(9)
    v_mfma_f32_16x16x32_bf16 v[192:195], v[160:163], v[224:227], v[192:195]
    ds_read_b128 v[76:79], v4 offset:2208
    s_waitcnt lgkmcnt(8)
    v_mfma_f32_16x16x32_bf16 v[200:203], v[160:163], v[228:231], v[200:203]
    s_waitcnt lgkmcnt(6)
    v_mfma_f32_16x16x32_bf16 v[208:211], v[160:163], v[232:235], v[208:211]
    s_waitcnt lgkmcnt(4)
    v_mfma_f32_16x16x32_bf16 v[216:219], v[160:163], v[236:239], v[216:219]
    v_mfma_f32_16x16x32_bf16 v[216:219], v[164:167], v[224:227], v[216:219]
    ds_read_b128 v[160:163], v4 offset:192
    ds_read_b128 v[240:243], v5 offset:0
    buffer_load_dwordx4 v[120:123], v6, s[20:23], s59 offen offset:2048 sc1
    buffer_load_dwordx4 v[124:127], v6, s[20:23], s59 offen offset:3072 sc1
    v_mfma_f32_16x16x32_bf16 v[196:199], v[168:171], v[224:227], v[196:199]
    ds_read_b128 v[164:167], v4 offset:3264
    ds_read_b128 v[244:247], v5 offset:256
    v_mfma_f32_16x16x32_bf16 v[204:207], v[168:171], v[228:231], v[204:207]
    v_mfma_f32_16x16x32_bf16 v[212:215], v[168:171], v[232:235], v[212:215]
    v_mfma_f32_16x16x32_bf16 v[220:223], v[168:171], v[236:239], v[220:223]
    v_mfma_f32_16x16x32_bf16 v[220:223], v[172:175], v[224:227], v[220:223]
    ds_read_b128 v[168:171], v4 offset:224
    ds_read_b128 v[248:251], v5 offset:512
    s_waitcnt lgkmcnt(9)
    v_mfma_f32_16x16x32_bf16 v[200:203], v[64:67], v[224:227], v[200:203]
    ds_read_b128 v[172:175], v4 offset:3296
    ds_read_b128 v[252:255], v5 offset:768
    v_mfma_f32_16x16x32_bf16 v[208:211], v[64:67], v[228:231], v[208:211]
    v_mfma_f32_16x16x32_bf16 v[216:219], v[64:67], v[232:235], v[216:219]
    s_waitcnt lgkmcnt(10)
    v_mfma_f32_16x16x32_bf16 v[208:211], v[68:71], v[224:227], v[208:211]
    ds_read_b128 v[64:67], v4 offset:1216
    v_mfma_f32_16x16x32_bf16 v[216:219], v[68:71], v[228:231], v[216:219]
    s_waitcnt lgkmcnt(10)
    v_mfma_f32_16x16x32_bf16 v[204:207], v[72:75], v[224:227], v[204:207]
    ds_read_b128 v[68:71], v4 offset:2240
    v_mfma_f32_16x16x32_bf16 v[212:215], v[72:75], v[228:231], v[212:215]
    v_mfma_f32_16x16x32_bf16 v[220:223], v[72:75], v[232:235], v[220:223]
    s_waitcnt lgkmcnt(10)
    v_mfma_f32_16x16x32_bf16 v[212:215], v[76:79], v[224:227], v[212:215]
    ds_read_b128 v[72:75], v4 offset:1248
    v_mfma_f32_16x16x32_bf16 v[220:223], v[76:79], v[228:231], v[220:223]
    s_waitcnt lgkmcnt(9)
    v_mfma_f32_16x16x32_bf16 v[192:195], v[160:163], v[240:243], v[192:195]
    ds_read_b128 v[76:79], v4 offset:2272
    s_waitcnt lgkmcnt(8)
    v_mfma_f32_16x16x32_bf16 v[200:203], v[160:163], v[244:247], v[200:203]
    s_waitcnt lgkmcnt(6)
    v_mfma_f32_16x16x32_bf16 v[208:211], v[160:163], v[248:251], v[208:211]
    s_waitcnt lgkmcnt(4)
    v_mfma_f32_16x16x32_bf16 v[216:219], v[160:163], v[252:255], v[216:219]
    v_mfma_f32_16x16x32_bf16 v[216:219], v[164:167], v[240:243], v[216:219]
    buffer_load_dword v7, v8, s[20:23], s53 offen sc1
    v_mfma_f32_16x16x32_bf16 v[196:199], v[168:171], v[240:243], v[196:199]
    v_mfma_f32_16x16x32_bf16 v[204:207], v[168:171], v[244:247], v[204:207]
    v_mfma_f32_16x16x32_bf16 v[212:215], v[168:171], v[248:251], v[212:215]
    v_mfma_f32_16x16x32_bf16 v[220:223], v[168:171], v[252:255], v[220:223]
    v_mfma_f32_16x16x32_bf16 v[220:223], v[172:175], v[240:243], v[220:223]
    s_waitcnt lgkmcnt(3)
    v_mfma_f32_16x16x32_bf16 v[200:203], v[64:67], v[240:243], v[200:203]
    v_mfma_f32_16x16x32_bf16 v[208:211], v[64:67], v[244:247], v[208:211]
    v_mfma_f32_16x16x32_bf16 v[216:219], v[64:67], v[248:251], v[216:219]
    s_waitcnt lgkmcnt(2)
    v_mfma_f32_16x16x32_bf16 v[208:211], v[68:71], v[240:243], v[208:211]
    v_mfma_f32_16x16x32_bf16 v[216:219], v[68:71], v[244:247], v[216:219]
    s_waitcnt lgkmcnt(1)
    v_mfma_f32_16x16x32_bf16 v[204:207], v[72:75], v[240:243], v[204:207]
    v_mfma_f32_16x16x32_bf16 v[212:215], v[72:75], v[244:247], v[212:215]
    v_mfma_f32_16x16x32_bf16 v[220:223], v[72:75], v[248:251], v[220:223]
    s_waitcnt lgkmcnt(0)
    v_mfma_f32_16x16x32_bf16 v[212:215], v[76:79], v[240:243], v[212:215]
    v_mfma_f32_16x16x32_bf16 v[220:223], v[76:79], v[244:247], v[220:223]
    v_add_u32 v14, s51, v6
    ds_write_b128 v14, v[192:195] offset:0
    ds_write_b128 v14, v[196:199] offset:1024
    ds_write_b128 v14, v[200:203] offset:2048
    ds_write_b128 v14, v[204:207] offset:3072
    ds_write_b128 v14, v[208:211] offset:4096
    s_nop 0
    ds_write_b128 v14, v[212:215] offset:5120
    ds_write_b128 v14, v[216:219] offset:6144
    ds_write_b128 v14, v[220:223] offset:7168
    s_add_u32 s59, s58, 7
    s_and_b32 s59, s59, 7
    s_lshl_b32 s59, s59, 12
    s_add_u32 s59, s59, s39
    buffer_load_dwordx4 v[128:131], v6, s[20:23], s59 offen offset:0 sc1
    buffer_load_dwordx4 v[132:135], v6, s[20:23], s59 offen offset:1024 sc1
    buffer_load_dwordx4 v[136:139], v6, s[20:23], s59 offen offset:2048 sc1
    buffer_load_dwordx4 v[140:143], v6, s[20:23], s59 offen offset:3072 sc1
    s_lshl_b32 s43, s34, 15
    s_lshl_b32 s44, s35, 11
    s_add_u32 s43, s43, s44
    v_add_u32 v14, s43, v6
    s_lshl_b32 s44, s35, 8
    s_add_u32 s44, s44, s36
    s_add_u32 s44, s44, 520
    v_lshl_add_u32 v15, v12, 4, s44
    v_and_b32 v4, 1, v13
    v_lshlrev_b32 v4, 3, v4
    v_sub_u32 v15, v15, v4
    v_lshrrev_b32 v4, 1, v13
    v_mul_u32_u24 v4, 1536, v4
    v_add_u32 v15, v15, v4
    v_lshlrev_b32 v5, 6, v12
    v_lshl_add_u32 v5, v13, 3, v5
    s_add_u32 s45, s6, 148480
    v_add_u32 v5, s45, v5
    s_lshl_b32 s43, s55, 16
    s_and_b32 s44, s55, 0xffff0000
    s_cmp_eq_u32 s34, 0
    s_cselect_b32 s55, s43, s44
    s_waitcnt lgkmcnt(0)
    s_barrier
    ds_read_b128 v[224:227], v14 offset:0
    ds_read_b128 v[228:231], v14 offset:1024
    ds_read_b128 v[232:235], v14 offset:8192
    ds_read_b128 v[236:239], v14 offset:9216
    ds_read_b128 v[240:243], v14 offset:16384
    ds_read_b128 v[244:247], v14 offset:17408
    ds_read_b128 v[248:251], v14 offset:24576
    ds_read_b128 v[252:255], v14 offset:25600
    ds_read_b64 v[192:193], v15 offset:0
    ds_read_b64 v[194:195], v15 offset:3072
    s_waitcnt vmcnt(4)
    v_and_b32 v7, 1, v7
    v_cmp_ne_u32 vcc, 1, v7
    s_mov_b32 s50, 0
    s_cbranch_vccnz NE_125
    s_mov_b32 s50, 1
    s_add_u32 s62, s58, 0
    s_and_b32 s62, s62, 7
    s_lshl_b32 s62, s62, 11
    s_add_u32 s62, s62, s40
    buffer_load_dwordx4 v[144:147], v6, s[20:23], s62 offen offset:0 sc1
    buffer_load_dwordx4 v[148:151], v6, s[20:23], s62 offen offset:1024 sc1
    s_add_u32 s62, s58, 1
    s_and_b32 s62, s62, 7
    s_lshl_b32 s62, s62, 11
    s_add_u32 s62, s62, s40
    buffer_load_dwordx4 v[152:155], v6, s[20:23], s62 offen offset:0 sc1
    buffer_load_dwordx4 v[156:159], v6, s[20:23], s62 offen offset:1024 sc1
    s_add_u32 s62, s58, 2
    s_and_b32 s62, s62, 7
    s_lshl_b32 s62, s62, 11
    s_add_u32 s62, s62, s40
    buffer_load_dwordx4 v[160:163], v6, s[20:23], s62 offen offset:0 sc1
    buffer_load_dwordx4 v[164:167], v6, s[20:23], s62 offen offset:1024 sc1
    s_add_u32 s62, s58, 3
    s_and_b32 s62, s62, 7
    s_lshl_b32 s62, s62, 11
    s_add_u32 s62, s62, s40
    buffer_load_dwordx4 v[168:171], v6, s[20:23], s62 offen offset:0 sc1
    buffer_load_dwordx4 v[172:175], v6, s[20:23], s62 offen offset:1024 sc1
    s_add_u32 s62, s58, 4
    s_and_b32 s62, s62, 7
    s_lshl_b32 s62, s62, 11
    s_add_u32 s62, s62, s40
    buffer_load_dwordx4 v[64:67], v6, s[20:23], s62 offen offset:0 sc1
    buffer_load_dwordx4 v[68:71], v6, s[20:23], s62 offen offset:1024 sc1
    s_add_u32 s62, s58, 5
    s_and_b32 s62, s62, 7
    s_lshl_b32 s62, s62, 11
    s_add_u32 s62, s62, s40
    buffer_load_dwordx4 v[72:75], v6, s[20:23], s62 offen offset:0 sc1
    buffer_load_dwordx4 v[76:79], v6, s[20:23], s62 offen offset:1024 sc1
NE_125:
    s_waitcnt lgkmcnt(0)
    v_pk_add_f32 v[224:225], v[224:225], v[232:233]
    v_pk_add_f32 v[240:241], v[240:241], v[248:249]
    v_pk_add_f32 v[226:227], v[226:227], v[234:235]
    v_pk_add_f32 v[242:243], v[242:243], v[250:251]
    v_pk_add_f32 v[228:229], v[228:229], v[236:237]
    v_pk_add_f32 v[244:245], v[244:245], v[252:253]
    v_pk_add_f32 v[230:231], v[230:231], v[238:239]
    v_pk_add_f32 v[246:247], v[246:247], v[254:255]
    v_pk_add_f32 v[224:225], v[224:225], v[240:241]
    v_pk_add_f32 v[226:227], v[226:227], v[242:243]
    v_pk_add_f32 v[228:229], v[228:229], v[244:245]
    v_pk_add_f32 v[230:231], v[230:231], v[246:247]
    v_and_b32 v200, 0xffff0000, v193
    v_fma_f32 v224, v200, s55, v224
    v_lshlrev_b32 v200, 16, v193
    v_fma_f32 v225, v200, s55, v225
    v_and_b32 v200, 0xffff0000, v192
    v_fma_f32 v226, v200, s55, v226
    v_lshlrev_b32 v200, 16, v192
    v_fma_f32 v227, v200, s55, v227
    v_and_b32 v200, 0xffff0000, v195
    v_fma_f32 v228, v200, s55, v228
    v_lshlrev_b32 v200, 16, v195
    v_fma_f32 v229, v200, s55, v229
    v_and_b32 v200, 0xffff0000, v194
    v_fma_f32 v230, v200, s55, v230
    v_lshlrev_b32 v200, 16, v194
    v_fma_f32 v231, v200, s55, v231
    v_cvt_pk_bf16_f32 v204, v224, v225
    v_cvt_pk_bf16_f32 v205, v226, v227
    v_cvt_pk_bf16_f32 v206, v228, v229
    v_cvt_pk_bf16_f32 v207, v230, v231
    ds_write_b64 v5, v[204:205] offset:0
    ds_write_b64 v5, v[206:207] offset:32
    v_and_b32 v14, 15, v0
    v_lshrrev_b32 v13, 4, v0
    v_lshlrev_b32 v13, 1, v13
    v_xor_b32 v13, v13, v14
    v_lshlrev_b32 v13, 4, v13
    v_lshl_add_u32 v4, v14, 8, v13
    v_add_u32 v4, s51, v4
    s_lshr_b32 s48, s3, 1
    s_lshl_b32 s48, s48, 4
    s_and_b32 s41, s3, 1
    s_lshl_b32 s42, s41, 3
    v_lshrrev_b32 v12, 4, v0
    v_lshl_add_u32 v13, v12, 1, s42
    v_xor_b32 v13, v13, v14
    v_lshlrev_b32 v13, 4, v13
    s_and_b32 s43, s48, 16
    v_add_u32 v15, s43, v14
    v_lshl_add_u32 v11, v15, 8, v13
    s_lshr_b32 s43, s48, 5
    s_lshl_b32 s43, s43, 16
    v_add_u32 v11, s43, v11
    s_waitcnt lgkmcnt(0)
    v_xor_b32 v5, 16, v11
    s_barrier
    s_cmp_lg_u32 s3, 0
    s_cbranch_scc1 NY_126
    v_add_u32 v12, 148480, v6
    ds_read_b128 v[224:227], v12 offset:0
    ds_read_b128 v[228:231], v12 offset:1024
    ds_read_b128 v[232:235], v12 offset:2048
    ds_read_b128 v[236:239], v12 offset:3072
    ds_read_b128 v[240:243], v12 offset:4096
    ds_read_b128 v[244:247], v12 offset:5120
    ds_read_b128 v[248:251], v12 offset:6144
    ds_read_b128 v[252:255], v12 offset:7168
    s_lshl_b32 s44, s7, 13
    s_add_u32 s44, s44, 69206016
    s_add_u32 s45, s44, 4096
    s_waitcnt lgkmcnt(0)
    buffer_store_dwordx4 v[224:227], v6, s[20:23], s44 offen offset:0 sc1
    buffer_store_dwordx4 v[228:231], v6, s[20:23], s44 offen offset:1024 sc1
    buffer_store_dwordx4 v[232:235], v6, s[20:23], s44 offen offset:2048 sc1
    buffer_store_dwordx4 v[236:239], v6, s[20:23], s44 offen offset:3072 sc1
    buffer_store_dwordx4 v[240:243], v6, s[20:23], s45 offen offset:0 sc1
    buffer_store_dwordx4 v[244:247], v6, s[20:23], s45 offen offset:1024 sc1
    buffer_store_dwordx4 v[248:251], v6, s[20:23], s45 offen offset:2048 sc1
    buffer_store_dwordx4 v[252:255], v6, s[20:23], s45 offen offset:3072 sc1
NY_126:
    s_cmp_eq_u32 s50, 1
    s_cbranch_scc1 NL_127
    s_mov_b32 s98, 1
    s_mov_b32 s99, 20000
POLL_129:
    v_and_b32 v7, s98, v7
    v_cmp_ne_u32 vcc, s98, v7
    s_cbranch_vccz PCK_128
    s_sleep 2
    buffer_load_dword v7, v8, s[20:23], s53 offen sc1
    s_sub_u32 s99, s99, 1
    s_cmp_lg_u32 s99, 0
    s_waitcnt vmcnt(0)
    s_cbranch_scc1 POLL_129
PCK_128:
    s_add_u32 s62, s58, 0
    s_and_b32 s62, s62, 7
    s_lshl_b32 s62, s62, 11
    s_add_u32 s62, s62, s40
    buffer_load_dwordx4 v[144:147], v6, s[20:23], s62 offen offset:0 sc1
    buffer_load_dwordx4 v[148:151], v6, s[20:23], s62 offen offset:1024 sc1
    s_add_u32 s62, s58, 1
    s_and_b32 s62, s62, 7
    s_lshl_b32 s62, s62, 11
    s_add_u32 s62, s62, s40
    buffer_load_dwordx4 v[152:155], v6, s[20:23], s62 offen offset:0 sc1
    buffer_load_dwordx4 v[156:159], v6, s[20:23], s62 offen offset:1024 sc1
    s_add_u32 s62, s58, 2
    s_and_b32 s62, s62, 7
    s_lshl_b32 s62, s62, 11
    s_add_u32 s62, s62, s40
    buffer_load_dwordx4 v[160:163], v6, s[20:23], s62 offen offset:0 sc1
    buffer_load_dwordx4 v[164:167], v6, s[20:23], s62 offen offset:1024 sc1
    s_add_u32 s62, s58, 3
    s_and_b32 s62, s62, 7
    s_lshl_b32 s62, s62, 11
    s_add_u32 s62, s62, s40
    buffer_load_dwordx4 v[168:171], v6, s[20:23], s62 offen offset:0 sc1
    buffer_load_dwordx4 v[172:175], v6, s[20:23], s62 offen offset:1024 sc1
    s_add_u32 s62, s58, 4
    s_and_b32 s62, s62, 7
    s_lshl_b32 s62, s62, 11
    s_add_u32 s62, s62, s40
    buffer_load_dwordx4 v[64:67], v6, s[20:23], s62 offen offset:0 sc1
    buffer_load_dwordx4 v[68:71], v6, s[20:23], s62 offen offset:1024 sc1
    s_add_u32 s62, s58, 5
    s_and_b32 s62, s62, 7
    s_lshl_b32 s62, s62, 11
    s_add_u32 s62, s62, s40
    buffer_load_dwordx4 v[72:75], v6, s[20:23], s62 offen offset:0 sc1
    buffer_load_dwordx4 v[76:79], v6, s[20:23], s62 offen offset:1024 sc1
NL_127:
    s_waitcnt vmcnt(8)
    v_mfma_f32_16x16x32_bf16 v[192:195], v[16:19], v[144:147], 0
    v_mfma_f32_16x16x32_bf16 v[192:195], v[32:35], v[152:155], v[192:195]
    v_mfma_f32_16x16x32_bf16 v[196:199], v[16:19], v[148:151], 0
    v_mfma_f32_16x16x32_bf16 v[196:199], v[32:35], v[156:159], v[196:199]
    v_mfma_f32_16x16x32_bf16 v[200:203], v[20:23], v[144:147], 0
    v_mfma_f32_16x16x32_bf16 v[200:203], v[36:39], v[152:155], v[200:203]
    v_mfma_f32_16x16x32_bf16 v[204:207], v[20:23], v[148:151], 0
    v_mfma_f32_16x16x32_bf16 v[204:207], v[36:39], v[156:159], v[204:207]
    v_mfma_f32_16x16x32_bf16 v[208:211], v[24:27], v[144:147], 0
    v_mfma_f32_16x16x32_bf16 v[208:211], v[40:43], v[152:155], v[208:211]
    v_mfma_f32_16x16x32_bf16 v[212:215], v[24:27], v[148:151], 0
    v_mfma_f32_16x16x32_bf16 v[212:215], v[40:43], v[156:159], v[212:215]
    v_mfma_f32_16x16x32_bf16 v[216:219], v[28:31], v[144:147], 0
    v_mfma_f32_16x16x32_bf16 v[216:219], v[44:47], v[152:155], v[216:219]
    v_mfma_f32_16x16x32_bf16 v[220:223], v[28:31], v[148:151], 0
    v_mfma_f32_16x16x32_bf16 v[220:223], v[44:47], v[156:159], v[220:223]
    s_add_u32 s62, s58, 6
    s_and_b32 s62, s62, 7
    s_lshl_b32 s62, s62, 11
    s_add_u32 s62, s62, s40
    buffer_load_dwordx4 v[144:147], v6, s[20:23], s62 offen offset:0 sc1
    buffer_load_dwordx4 v[148:151], v6, s[20:23], s62 offen offset:1024 sc1
    s_add_u32 s62, s58, 7
    s_and_b32 s62, s62, 7
    s_lshl_b32 s62, s62, 11
    s_add_u32 s62, s62, s40
    buffer_load_dwordx4 v[152:155], v6, s[20:23], s62 offen offset:0 sc1
    buffer_load_dwordx4 v[156:159], v6, s[20:23], s62 offen offset:1024 sc1
    s_waitcnt vmcnt(8)
    v_mfma_f32_16x16x32_bf16 v[192:195], v[176:179], v[160:163], v[192:195]
    v_mfma_f32_16x16x32_bf16 v[192:195], v[48:51], v[168:171], v[192:195]
    v_mfma_f32_16x16x32_bf16 v[196:199], v[176:179], v[164:167], v[196:199]
    v_mfma_f32_16x16x32_bf16 v[196:199], v[48:51], v[172:175], v[196:199]
    v_mfma_f32_16x16x32_bf16 v[200:203], v[180:183], v[160:163], v[200:203]
    v_mfma_f32_16x16x32_bf16 v[200:203], v[52:55], v[168:171], v[200:203]
    v_mfma_f32_16x16x32_bf16 v[204:207], v[180:183], v[164:167], v[204:207]
    v_mfma_f32_16x16x32_bf16 v[204:207], v[52:55], v[172:175], v[204:207]
    v_mfma_f32_16x16x32_bf16 v[208:211], v[184:187], v[160:163], v[208:211]
    v_mfma_f32_16x16x32_bf16 v[208:211], v[56:59], v[168:171], v[208:211]
    v_mfma_f32_16x16x32_bf16 v[212:215], v[184:187], v[164:167], v[212:215]
    v_mfma_f32_16x16x32_bf16 v[212:215], v[56:59], v[172:175], v[212:215]
    v_mfma_f32_16x16x32_bf16 v[216:219], v[188:191], v[160:163], v[216:219]
    v_mfma_f32_16x16x32_bf16 v[216:219], v[60:63], v[168:171], v[216:219]
    v_mfma_f32_16x16x32_bf16 v[220:223], v[188:191], v[164:167], v[220:223]
    v_mfma_f32_16x16x32_bf16 v[220:223], v[60:63], v[172:175], v[220:223]
    s_add_u32 s62, s58, 0
    s_and_b32 s62, s62, 7
    s_lshl_b32 s62, s62, 11
    s_add_u32 s62, s62, s40
    s_add_u32 s62, s62, 0x40000
    buffer_load_dwordx4 v[160:163], v6, s[20:23], s62 offen offset:0 sc1
    buffer_load_dwordx4 v[164:167], v6, s[20:23], s62 offen offset:1024 sc1
    s_add_u32 s62, s58, 1
    s_and_b32 s62, s62, 7
    s_lshl_b32 s62, s62, 11
    s_add_u32 s62, s62, s40
    s_add_u32 s62, s62, 0x40000
    buffer_load_dwordx4 v[168:171], v6, s[20:23], s62 offen offset:0 sc1
    buffer_load_dwordx4 v[172:175], v6, s[20:23], s62 offen offset:1024 sc1
    s_waitcnt vmcnt(8)
    v_mfma_f32_16x16x32_bf16 v[192:195], v[80:83], v[64:67], v[192:195]
    v_mfma_f32_16x16x32_bf16 v[192:195], v[96:99], v[72:75], v[192:195]
    v_mfma_f32_16x16x32_bf16 v[196:199], v[80:83], v[68:71], v[196:199]
    v_mfma_f32_16x16x32_bf16 v[196:199], v[96:99], v[76:79], v[196:199]
    v_mfma_f32_16x16x32_bf16 v[200:203], v[84:87], v[64:67], v[200:203]
    v_mfma_f32_16x16x32_bf16 v[200:203], v[100:103], v[72:75], v[200:203]
    v_mfma_f32_16x16x32_bf16 v[204:207], v[84:87], v[68:71], v[204:207]
    v_mfma_f32_16x16x32_bf16 v[204:207], v[100:103], v[76:79], v[204:207]
    v_mfma_f32_16x16x32_bf16 v[208:211], v[88:91], v[64:67], v[208:211]
    v_mfma_f32_16x16x32_bf16 v[208:211], v[104:107], v[72:75], v[208:211]
    v_mfma_f32_16x16x32_bf16 v[212:215], v[88:91], v[68:71], v[212:215]
    v_mfma_f32_16x16x32_bf16 v[212:215], v[104:107], v[76:79], v[212:215]
    v_mfma_f32_16x16x32_bf16 v[216:219], v[92:95], v[64:67], v[216:219]
    v_mfma_f32_16x16x32_bf16 v[216:219], v[108:111], v[72:75], v[216:219]
    v_mfma_f32_16x16x32_bf16 v[220:223], v[92:95], v[68:71], v[220:223]
    v_mfma_f32_16x16x32_bf16 v[220:223], v[108:111], v[76:79], v[220:223]
    s_add_u32 s62, s58, 2
    s_and_b32 s62, s62, 7
    s_lshl_b32 s62, s62, 11
    s_add_u32 s62, s62, s40
    s_add_u32 s62, s62, 0x40000
    buffer_load_dwordx4 v[64:67], v6, s[20:23], s62 offen offset:0 sc1
    buffer_load_dwordx4 v[68:71], v6, s[20:23], s62 offen offset:1024 sc1
    s_add_u32 s62, s58, 3
    s_and_b32 s62, s62, 7
    s_lshl_b32 s62, s62, 11
    s_add_u32 s62, s62, s40
    s_add_u32 s62, s62, 0x40000
    buffer_load_dwordx4 v[72:75], v6, s[20:23], s62 offen offset:0 sc1
    buffer_load_dwordx4 v[76:79], v6, s[20:23], s62 offen offset:1024 sc1
    s_waitcnt vmcnt(8)
    s_lshl_b32 s44, s7, 2
    s_add_u32 s44, s44, 71372800
    s_cmp_eq_u32 s3, 0
    s_cselect_b32 s99, 0, 1073741824
    v_mov_b32 v2, 3
    v_mov_b32 v3, s99
    buffer_store_dword v2, v3, s[20:23], s44 offen sc1
    v_mfma_f32_16x16x32_bf16 v[192:195], v[112:115], v[144:147], v[192:195]
    v_mfma_f32_16x16x32_bf16 v[192:195], v[128:131], v[152:155], v[192:195]
    v_mfma_f32_16x16x32_bf16 v[196:199], v[112:115], v[148:151], v[196:199]
    v_mfma_f32_16x16x32_bf16 v[196:199], v[128:131], v[156:159], v[196:199]
    v_mfma_f32_16x16x32_bf16 v[200:203], v[116:119], v[144:147], v[200:203]
    v_mfma_f32_16x16x32_bf16 v[200:203], v[132:135], v[152:155], v[200:203]
    v_mfma_f32_16x16x32_bf16 v[204:207], v[116:119], v[148:151], v[204:207]
    v_mfma_f32_16x16x32_bf16 v[204:207], v[132:135], v[156:159], v[204:207]
    v_mfma_f32_16x16x32_bf16 v[208:211], v[120:123], v[144:147], v[208:211]
    v_mfma_f32_16x16x32_bf16 v[208:211], v[136:139], v[152:155], v[208:211]
    v_mfma_f32_16x16x32_bf16 v[212:215], v[120:123], v[148:151], v[212:215]
    v_mfma_f32_16x16x32_bf16 v[212:215], v[136:139], v[156:159], v[212:215]
    v_mfma_f32_16x16x32_bf16 v[216:219], v[124:127], v[144:147], v[216:219]
    v_mfma_f32_16x16x32_bf16 v[216:219], v[140:143], v[152:155], v[216:219]
    v_mfma_f32_16x16x32_bf16 v[220:223], v[124:127], v[148:151], v[220:223]
    v_mfma_f32_16x16x32_bf16 v[220:223], v[140:143], v[156:159], v[220:223]
    s_add_u32 s62, s58, 4
    s_and_b32 s62, s62, 7
    s_lshl_b32 s62, s62, 11
    s_add_u32 s62, s62, s40
    s_add_u32 s62, s62, 0x40000
    buffer_load_dwordx4 v[144:147], v6, s[20:23], s62 offen offset:0 sc1
    buffer_load_dwordx4 v[148:151], v6, s[20:23], s62 offen offset:1024 sc1
    s_add_u32 s62, s58, 5
    s_and_b32 s62, s62, 7
    s_lshl_b32 s62, s62, 11
    s_add_u32 s62, s62, s40
    s_add_u32 s62, s62, 0x40000
    buffer_load_dwordx4 v[152:155], v6, s[20:23], s62 offen offset:0 sc1
    buffer_load_dwordx4 v[156:159], v6, s[20:23], s62 offen offset:1024 sc1
    s_waitcnt vmcnt(9)
    v_mfma_f32_16x16x32_bf16 v[224:227], v[16:19], v[160:163], 0
    v_mfma_f32_16x16x32_bf16 v[224:227], v[32:35], v[168:171], v[224:227]
    v_xor_b32 v15, 0, v4
    ds_write_b128 v15, v[192:195] offset:0
    ds_write_b128 v15, v[196:199] offset:4096
    v_mfma_f32_16x16x32_bf16 v[228:231], v[16:19], v[164:167], 0
    v_mfma_f32_16x16x32_bf16 v[228:231], v[32:35], v[172:175], v[228:231]
    v_mfma_f32_16x16x32_bf16 v[232:235], v[20:23], v[160:163], 0
    v_xor_b32 v15, 16, v4
    ds_write_b128 v15, v[200:203] offset:0
    ds_write_b128 v15, v[204:207] offset:4096
    v_mfma_f32_16x16x32_bf16 v[232:235], v[36:39], v[168:171], v[232:235]
    v_mfma_f32_16x16x32_bf16 v[236:239], v[20:23], v[164:167], 0
    v_mfma_f32_16x16x32_bf16 v[236:239], v[36:39], v[172:175], v[236:239]
    v_mfma_f32_16x16x32_bf16 v[240:243], v[24:27], v[160:163], 0
    v_xor_b32 v15, 128, v4
    ds_write_b128 v15, v[208:211] offset:0
    ds_write_b128 v15, v[212:215] offset:4096
    v_mfma_f32_16x16x32_bf16 v[240:243], v[40:43], v[168:171], v[240:243]
    v_mfma_f32_16x16x32_bf16 v[244:247], v[24:27], v[164:167], 0
    v_mfma_f32_16x16x32_bf16 v[244:247], v[40:43], v[172:175], v[244:247]
    v_mfma_f32_16x16x32_bf16 v[248:251], v[28:31], v[160:163], 0
    v_xor_b32 v15, 144, v4
    ds_write_b128 v15, v[216:219] offset:0
    ds_write_b128 v15, v[220:223] offset:4096
    v_mfma_f32_16x16x32_bf16 v[248:251], v[44:47], v[168:171], v[248:251]
    v_mfma_f32_16x16x32_bf16 v[252:255], v[28:31], v[164:167], 0
    v_mfma_f32_16x16x32_bf16 v[252:255], v[44:47], v[172:175], v[252:255]
    s_add_u32 s62, s58, 6
    s_and_b32 s62, s62, 7
    s_lshl_b32 s62, s62, 11
    s_add_u32 s62, s62, s40
    s_add_u32 s62, s62, 0x40000
    buffer_load_dwordx4 v[160:163], v6, s[20:23], s62 offen offset:0 sc1
    buffer_load_dwordx4 v[164:167], v6, s[20:23], s62 offen offset:1024 sc1
    s_add_u32 s62, s58, 7
    s_and_b32 s62, s62, 7
    s_lshl_b32 s62, s62, 11
    s_add_u32 s62, s62, s40
    s_add_u32 s62, s62, 0x40000
    buffer_load_dwordx4 v[168:171], v6, s[20:23], s62 offen offset:0 sc1
    buffer_load_dwordx4 v[172:175], v6, s[20:23], s62 offen offset:1024 sc1
    s_waitcnt vmcnt(9)
    v_mfma_f32_16x16x32_bf16 v[224:227], v[176:179], v[64:67], v[224:227]
    v_mfma_f32_16x16x32_bf16 v[224:227], v[48:51], v[72:75], v[224:227]
    v_mfma_f32_16x16x32_bf16 v[228:231], v[176:179], v[68:71], v[228:231]
    v_mfma_f32_16x16x32_bf16 v[228:231], v[48:51], v[76:79], v[228:231]
    v_mfma_f32_16x16x32_bf16 v[232:235], v[180:183], v[64:67], v[232:235]
    v_mfma_f32_16x16x32_bf16 v[232:235], v[52:55], v[72:75], v[232:235]
    v_mfma_f32_16x16x32_bf16 v[236:239], v[180:183], v[68:71], v[236:239]
    v_mfma_f32_16x16x32_bf16 v[236:239], v[52:55], v[76:79], v[236:239]
    v_mfma_f32_16x16x32_bf16 v[240:243], v[184:187], v[64:67], v[240:243]
    v_mfma_f32_16x16x32_bf16 v[240:243], v[56:59], v[72:75], v[240:243]
    v_mfma_f32_16x16x32_bf16 v[244:247], v[184:187], v[68:71], v[244:247]
    v_mfma_f32_16x16x32_bf16 v[244:247], v[56:59], v[76:79], v[244:247]
    v_mfma_f32_16x16x32_bf16 v[248:251], v[188:191], v[64:67], v[248:251]
    v_mfma_f32_16x16x32_bf16 v[248:251], v[60:63], v[72:75], v[248:251]
    v_mfma_f32_16x16x32_bf16 v[252:255], v[188:191], v[68:71], v[252:255]
    v_mfma_f32_16x16x32_bf16 v[252:255], v[60:63], v[76:79], v[252:255]
    s_add_u32 s62, s58, 0
    s_and_b32 s62, s62, 7
    s_lshl_b32 s62, s62, 11
    s_add_u32 s62, s62, s52
    buffer_load_dwordx4 v[64:67], v6, s[20:23], s62 offen offset:0 sc1
    buffer_load_dwordx4 v[68:71], v6, s[20:23], s62 offen offset:1024 sc1
    s_add_u32 s62, s58, 1
    s_and_b32 s62, s62, 7
    s_lshl_b32 s62, s62, 11
    s_add_u32 s62, s62, s52
    buffer_load_dwordx4 v[72:75], v6, s[20:23], s62 offen offset:0 sc1
    buffer_load_dwordx4 v[76:79], v6, s[20:23], s62 offen offset:1024 sc1
    s_waitcnt vmcnt(8)
    v_mfma_f32_16x16x32_bf16 v[224:227], v[80:83], v[144:147], v[224:227]
    v_mfma_f32_16x16x32_bf16 v[224:227], v[96:99], v[152:155], v[224:227]
    v_mfma_f32_16x16x32_bf16 v[228:231], v[80:83], v[148:151], v[228:231]
    v_mfma_f32_16x16x32_bf16 v[228:231], v[96:99], v[156:159], v[228:231]
    v_mfma_f32_16x16x32_bf16 v[232:235], v[84:87], v[144:147], v[232:235]
    v_mfma_f32_16x16x32_bf16 v[232:235], v[100:103], v[152:155], v[232:235]
    v_mfma_f32_16x16x32_bf16 v[236:239], v[84:87], v[148:151], v[236:239]
    v_mfma_f32_16x16x32_bf16 v[236:239], v[100:103], v[156:159], v[236:239]
    v_mfma_f32_16x16x32_bf16 v[240:243], v[88:91], v[144:147], v[240:243]
    v_mfma_f32_16x16x32_bf16 v[240:243], v[104:107], v[152:155], v[240:243]
    v_mfma_f32_16x16x32_bf16 v[244:247], v[88:91], v[148:151], v[244:247]
    v_mfma_f32_16x16x32_bf16 v[244:247], v[104:107], v[156:159], v[244:247]
    v_mfma_f32_16x16x32_bf16 v[248:251], v[92:95], v[144:147], v[248:251]
    v_mfma_f32_16x16x32_bf16 v[248:251], v[108:111], v[152:155], v[248:251]
    v_mfma_f32_16x16x32_bf16 v[252:255], v[92:95], v[148:151], v[252:255]
    v_mfma_f32_16x16x32_bf16 v[252:255], v[108:111], v[156:159], v[252:255]
    s_add_u32 s62, s58, 2
    s_and_b32 s62, s62, 7
    s_lshl_b32 s62, s62, 11
    s_add_u32 s62, s62, s52
    buffer_load_dwordx4 v[144:147], v6, s[20:23], s62 offen offset:0 sc1
    buffer_load_dwordx4 v[148:151], v6, s[20:23], s62 offen offset:1024 sc1
    s_add_u32 s62, s58, 3
    s_and_b32 s62, s62, 7
    s_lshl_b32 s62, s62, 11
    s_add_u32 s62, s62, s52
    buffer_load_dwordx4 v[152:155], v6, s[20:23], s62 offen offset:0 sc1
    buffer_load_dwordx4 v[156:159], v6, s[20:23], s62 offen offset:1024 sc1
    s_waitcnt vmcnt(8)
    v_mfma_f32_16x16x32_bf16 v[224:227], v[112:115], v[160:163], v[224:227]
    v_mfma_f32_16x16x32_bf16 v[224:227], v[128:131], v[168:171], v[224:227]
    v_mfma_f32_16x16x32_bf16 v[228:231], v[112:115], v[164:167], v[228:231]
    v_mfma_f32_16x16x32_bf16 v[228:231], v[128:131], v[172:175], v[228:231]
    v_mfma_f32_16x16x32_bf16 v[232:235], v[116:119], v[160:163], v[232:235]
    v_mfma_f32_16x16x32_bf16 v[232:235], v[132:135], v[168:171], v[232:235]
    v_mfma_f32_16x16x32_bf16 v[236:239], v[116:119], v[164:167], v[236:239]
    v_mfma_f32_16x16x32_bf16 v[236:239], v[132:135], v[172:175], v[236:239]
    v_mfma_f32_16x16x32_bf16 v[240:243], v[120:123], v[160:163], v[240:243]
    v_mfma_f32_16x16x32_bf16 v[240:243], v[136:139], v[168:171], v[240:243]
    v_mfma_f32_16x16x32_bf16 v[244:247], v[120:123], v[164:167], v[244:247]
    v_mfma_f32_16x16x32_bf16 v[244:247], v[136:139], v[172:175], v[244:247]
    v_mfma_f32_16x16x32_bf16 v[248:251], v[124:127], v[160:163], v[248:251]
    v_mfma_f32_16x16x32_bf16 v[248:251], v[140:143], v[168:171], v[248:251]
    v_mfma_f32_16x16x32_bf16 v[252:255], v[124:127], v[164:167], v[252:255]
    v_mfma_f32_16x16x32_bf16 v[252:255], v[140:143], v[172:175], v[252:255]
    s_add_u32 s62, s58, 4
    s_and_b32 s62, s62, 7
    s_lshl_b32 s62, s62, 11
    s_add_u32 s62, s62, s52
    buffer_load_dwordx4 v[160:163], v6, s[20:23], s62 offen offset:0 sc1
    buffer_load_dwordx4 v[164:167], v6, s[20:23], s62 offen offset:1024 sc1
    s_add_u32 s62, s58, 5
    s_and_b32 s62, s62, 7
    s_lshl_b32 s62, s62, 11
    s_add_u32 s62, s62, s52
    buffer_load_dwordx4 v[168:171], v6, s[20:23], s62 offen offset:0 sc1
    buffer_load_dwordx4 v[172:175], v6, s[20:23], s62 offen offset:1024 sc1
    s_waitcnt vmcnt(8)
    v_mfma_f32_16x16x32_bf16 v[192:195], v[16:19], v[64:67], 0
    v_mfma_f32_16x16x32_bf16 v[192:195], v[32:35], v[72:75], v[192:195]
    v_xor_b32 v15, 65536, v4
    ds_write_b128 v15, v[224:227] offset:0
    ds_write_b128 v15, v[228:231] offset:4096
    v_mfma_f32_16x16x32_bf16 v[196:199], v[16:19], v[68:71], 0
    v_mfma_f32_16x16x32_bf16 v[196:199], v[32:35], v[76:79], v[196:199]
    v_mfma_f32_16x16x32_bf16 v[200:203], v[20:23], v[64:67], 0
    v_xor_b32 v15, 65552, v4
    ds_write_b128 v15, v[232:235] offset:0
    ds_write_b128 v15, v[236:239] offset:4096
    v_mfma_f32_16x16x32_bf16 v[200:203], v[36:39], v[72:75], v[200:203]
    v_mfma_f32_16x16x32_bf16 v[204:207], v[20:23], v[68:71], 0
    v_mfma_f32_16x16x32_bf16 v[204:207], v[36:39], v[76:79], v[204:207]
    v_mfma_f32_16x16x32_bf16 v[208:211], v[24:27], v[64:67], 0
    v_xor_b32 v15, 65664, v4
    ds_write_b128 v15, v[240:243] offset:0
    ds_write_b128 v15, v[244:247] offset:4096
    v_mfma_f32_16x16x32_bf16 v[208:211], v[40:43], v[72:75], v[208:211]
    v_mfma_f32_16x16x32_bf16 v[212:215], v[24:27], v[68:71], 0
    v_mfma_f32_16x16x32_bf16 v[212:215], v[40:43], v[76:79], v[212:215]
    v_mfma_f32_16x16x32_bf16 v[216:219], v[28:31], v[64:67], 0
    v_xor_b32 v15, 65680, v4
    ds_write_b128 v15, v[248:251] offset:0
    ds_write_b128 v15, v[252:255] offset:4096
    v_mfma_f32_16x16x32_bf16 v[216:219], v[44:47], v[72:75], v[216:219]
    v_mfma_f32_16x16x32_bf16 v[220:223], v[28:31], v[68:71], 0
    v_mfma_f32_16x16x32_bf16 v[220:223], v[44:47], v[76:79], v[220:223]
    s_add_u32 s62, s58, 6
    s_and_b32 s62, s62, 7
    s_lshl_b32 s62, s62, 11
    s_add_u32 s62, s62, s52
    buffer_load_dwordx4 v[64:67], v6, s[20:23], s62 offen offset:0 sc1
    buffer_load_dwordx4 v[68:71], v6, s[20:23], s62 offen offset:1024 sc1
    s_add_u32 s62, s58, 7
    s_and_b32 s62, s62, 7
    s_lshl_b32 s62, s62, 11
    s_add_u32 s62, s62, s52
    buffer_load_dwordx4 v[72:75], v6, s[20:23], s62 offen offset:0 sc1
    buffer_load_dwordx4 v[76:79], v6, s[20:23], s62 offen offset:1024 sc1
    s_waitcnt lgkmcnt(0)
    s_barrier
    ds_read_b128 v[224:227], v11 offset:0
    ds_read_b128 v[228:231], v5 offset:0
    ds_read_b128 v[232:235], v11 offset:8192
    ds_read_b128 v[236:239], v5 offset:8192
    ds_read_b128 v[240:243], v11 offset:16384
    ds_read_b128 v[244:247], v5 offset:16384
    ds_read_b128 v[248:251], v11 offset:24576
    ds_read_b128 v[252:255], v5 offset:24576
    s_lshl_b32 s53, s57, 7
    s_lshl_b32 s42, s3, 4
    s_add_u32 s53, s53, s42
    s_add_u32 s53, s53, 71372800
    v_and_b32 v8, 3, v0
    v_lshlrev_b32 v8, 2, v8
    buffer_load_dword v7, v8, s[20:23], s53 offen sc1
    s_waitcnt vmcnt(9)
    v_mfma_f32_16x16x32_bf16 v[192:195], v[176:179], v[144:147], v[192:195]
    v_mfma_f32_16x16x32_bf16 v[192:195], v[48:51], v[152:155], v[192:195]
    s_waitcnt lgkmcnt(4)
    v_pk_add_f32 v[224:225], v[224:225], v[232:233]
    v_pk_add_f32 v[226:227], v[226:227], v[234:235]
    v_pk_add_f32 v[228:229], v[228:229], v[236:237]
    v_pk_add_f32 v[230:231], v[230:231], v[238:239]
    ds_read_b128 v[232:235], v11 offset:32768
    ds_read_b128 v[236:239], v5 offset:32768
    v_mfma_f32_16x16x32_bf16 v[196:199], v[176:179], v[148:151], v[196:199]
    v_mfma_f32_16x16x32_bf16 v[196:199], v[48:51], v[156:159], v[196:199]
    s_waitcnt lgkmcnt(4)
    v_pk_add_f32 v[224:225], v[224:225], v[240:241]
    v_pk_add_f32 v[226:227], v[226:227], v[242:243]
    v_pk_add_f32 v[228:229], v[228:229], v[244:245]
    v_pk_add_f32 v[230:231], v[230:231], v[246:247]
    ds_read_b128 v[240:243], v11 offset:40960
    ds_read_b128 v[244:247], v5 offset:40960
    v_mfma_f32_16x16x32_bf16 v[200:203], v[180:183], v[144:147], v[200:203]
    v_mfma_f32_16x16x32_bf16 v[200:203], v[52:55], v[152:155], v[200:203]
    s_waitcnt lgkmcnt(4)
    v_pk_add_f32 v[224:225], v[224:225], v[248:249]
    v_pk_add_f32 v[226:227], v[226:227], v[250:251]
    v_pk_add_f32 v[228:229], v[228:229], v[252:253]
    v_pk_add_f32 v[230:231], v[230:231], v[254:255]
    ds_read_b128 v[248:251], v11 offset:49152
    ds_read_b128 v[252:255], v5 offset:49152
    v_mfma_f32_16x16x32_bf16 v[204:207], v[180:183], v[148:151], v[204:207]
    v_mfma_f32_16x16x32_bf16 v[204:207], v[52:55], v[156:159], v[204:207]
    s_waitcnt lgkmcnt(4)
    v_pk_add_f32 v[224:225], v[224:225], v[232:233]
    v_pk_add_f32 v[226:227], v[226:227], v[234:235]
    v_pk_add_f32 v[228:229], v[228:229], v[236:237]
    v_pk_add_f32 v[230:231], v[230:231], v[238:239]
    ds_read_b128 v[232:235], v11 offset:57344
    ds_read_b128 v[236:239], v5 offset:57344
    v_mfma_f32_16x16x32_bf16 v[208:211], v[184:187], v[144:147], v[208:211]
    v_mfma_f32_16x16x32_bf16 v[208:211], v[56:59], v[152:155], v[208:211]
    s_waitcnt lgkmcnt(4)
    v_pk_add_f32 v[224:225], v[224:225], v[240:241]
    v_pk_add_f32 v[226:227], v[226:227], v[242:243]
    v_pk_add_f32 v[228:229], v[228:229], v[244:245]
    v_pk_add_f32 v[230:231], v[230:231], v[246:247]
    v_mfma_f32_16x16x32_bf16 v[212:215], v[184:187], v[148:151], v[212:215]
    v_mfma_f32_16x16x32_bf16 v[212:215], v[56:59], v[156:159], v[212:215]
    s_waitcnt lgkmcnt(2)
    v_pk_add_f32 v[224:225], v[224:225], v[248:249]
    v_pk_add_f32 v[226:227], v[226:227], v[250:251]
    v_pk_add_f32 v[228:229], v[228:229], v[252:253]
    v_pk_add_f32 v[230:231], v[230:231], v[254:255]
    v_mfma_f32_16x16x32_bf16 v[216:219], v[188:191], v[144:147], v[216:219]
    v_mfma_f32_16x16x32_bf16 v[216:219], v[60:63], v[152:155], v[216:219]
    s_waitcnt lgkmcnt(0)
    v_pk_add_f32 v[224:225], v[224:225], v[232:233]
    v_pk_add_f32 v[226:227], v[226:227], v[234:235]
    v_pk_add_f32 v[228:229], v[228:229], v[236:237]
    v_pk_add_f32 v[230:231], v[230:231], v[238:239]
    v_mfma_f32_16x16x32_bf16 v[220:223], v[188:191], v[148:151], v[220:223]
    v_mfma_f32_16x16x32_bf16 v[220:223], v[60:63], v[156:159], v[220:223]
    s_add_u32 s62, s58, 0
    s_and_b32 s62, s62, 7
    s_lshl_b32 s62, s62, 11
    s_add_u32 s62, s62, s52
    s_add_u32 s62, s62, 0x40000
    buffer_load_dwordx4 v[144:147], v6, s[20:23], s62 offen offset:0 sc1
    buffer_load_dwordx4 v[148:151], v6, s[20:23], s62 offen offset:1024 sc1
    s_add_u32 s62, s58, 1
    s_and_b32 s62, s62, 7
    s_lshl_b32 s62, s62, 11
    s_add_u32 s62, s62, s52
    s_add_u32 s62, s62, 0x40000
    buffer_load_dwordx4 v[152:155], v6, s[20:23], s62 offen offset:0 sc1
    buffer_load_dwordx4 v[156:159], v6, s[20:23], s62 offen offset:1024 sc1
    s_waitcnt vmcnt(9)
    v_mfma_f32_16x16x32_bf16 v[192:195], v[80:83], v[160:163], v[192:195]
    v_mfma_f32_16x16x32_bf16 v[192:195], v[96:99], v[168:171], v[192:195]
    v_mfma_f32_16x16x32_bf16 v[196:199], v[80:83], v[164:167], v[196:199]
    v_mfma_f32_16x16x32_bf16 v[196:199], v[96:99], v[172:175], v[196:199]
    v_mfma_f32_16x16x32_bf16 v[200:203], v[84:87], v[160:163], v[200:203]
    v_mfma_f32_16x16x32_bf16 v[200:203], v[100:103], v[168:171], v[200:203]
    v_mfma_f32_16x16x32_bf16 v[204:207], v[84:87], v[164:167], v[204:207]
    v_mfma_f32_16x16x32_bf16 v[204:207], v[100:103], v[172:175], v[204:207]
    v_mfma_f32_16x16x32_bf16 v[208:211], v[88:91], v[160:163], v[208:211]
    v_mfma_f32_16x16x32_bf16 v[208:211], v[104:107], v[168:171], v[208:211]
    v_mfma_f32_16x16x32_bf16 v[212:215], v[88:91], v[164:167], v[212:215]
    v_mfma_f32_16x16x32_bf16 v[212:215], v[104:107], v[172:175], v[212:215]
    v_mfma_f32_16x16x32_bf16 v[216:219], v[92:95], v[160:163], v[216:219]
    v_mfma_f32_16x16x32_bf16 v[216:219], v[108:111], v[168:171], v[216:219]
    v_mfma_f32_16x16x32_bf16 v[220:223], v[92:95], v[164:167], v[220:223]
    v_mfma_f32_16x16x32_bf16 v[220:223], v[108:111], v[172:175], v[220:223]
    s_add_u32 s62, s58, 2
    s_and_b32 s62, s62, 7
    s_lshl_b32 s62, s62, 11
    s_add_u32 s62, s62, s52
    s_add_u32 s62, s62, 0x40000
    buffer_load_dwordx4 v[160:163], v6, s[20:23], s62 offen offset:0 sc1
    buffer_load_dwordx4 v[164:167], v6, s[20:23], s62 offen offset:1024 sc1
    s_add_u32 s62, s58, 3
    s_and_b32 s62, s62, 7
    s_lshl_b32 s62, s62, 11
    s_add_u32 s62, s62, s52
    s_add_u32 s62, s62, 0x40000
    buffer_load_dwordx4 v[168:171], v6, s[20:23], s62 offen offset:0 sc1
    buffer_load_dwordx4 v[172:175], v6, s[20:23], s62 offen offset:1024 sc1
    s_lshl_b32 s44, s7, 14
    s_lshl_b32 s45, s3, 11
    s_add_u32 s54, s44, s45
    s_add_u32 s54, s54, 41943040
    buffer_store_dwordx4 v[224:227], v6, s[20:23], s54 offen offset:0 sc1
    buffer_store_dwordx4 v[228:231], v6, s[20:23], s54 offen offset:1024 sc1
    s_waitcnt vmcnt(11)
    v_mfma_f32_16x16x32_bf16 v[192:195], v[112:115], v[64:67], v[192:195]
    v_mfma_f32_16x16x32_bf16 v[192:195], v[128:131], v[72:75], v[192:195]
    v_mfma_f32_16x16x32_bf16 v[196:199], v[112:115], v[68:71], v[196:199]
    v_mfma_f32_16x16x32_bf16 v[196:199], v[128:131], v[76:79], v[196:199]
    v_mfma_f32_16x16x32_bf16 v[200:203], v[116:119], v[64:67], v[200:203]
    v_mfma_f32_16x16x32_bf16 v[200:203], v[132:135], v[72:75], v[200:203]
    v_mfma_f32_16x16x32_bf16 v[204:207], v[116:119], v[68:71], v[204:207]
    v_mfma_f32_16x16x32_bf16 v[204:207], v[132:135], v[76:79], v[204:207]
    v_mfma_f32_16x16x32_bf16 v[208:211], v[120:123], v[64:67], v[208:211]
    v_mfma_f32_16x16x32_bf16 v[208:211], v[136:139], v[72:75], v[208:211]
    v_mfma_f32_16x16x32_bf16 v[212:215], v[120:123], v[68:71], v[212:215]
    v_mfma_f32_16x16x32_bf16 v[212:215], v[136:139], v[76:79], v[212:215]
    v_mfma_f32_16x16x32_bf16 v[216:219], v[124:127], v[64:67], v[216:219]
    v_mfma_f32_16x16x32_bf16 v[216:219], v[140:143], v[72:75], v[216:219]
    v_mfma_f32_16x16x32_bf16 v[220:223], v[124:127], v[68:71], v[220:223]
    v_mfma_f32_16x16x32_bf16 v[220:223], v[140:143], v[76:79], v[220:223]
    s_add_u32 s62, s58, 4
    s_and_b32 s62, s62, 7
    s_lshl_b32 s62, s62, 11
    s_add_u32 s62, s62, s52
    s_add_u32 s62, s62, 0x40000
    buffer_load_dwordx4 v[64:67], v6, s[20:23], s62 offen offset:0 sc1
    buffer_load_dwordx4 v[68:71], v6, s[20:23], s62 offen offset:1024 sc1
    s_add_u32 s62, s58, 5
    s_and_b32 s62, s62, 7
    s_lshl_b32 s62, s62, 11
    s_add_u32 s62, s62, s52
    s_add_u32 s62, s62, 0x40000
    buffer_load_dwordx4 v[72:75], v6, s[20:23], s62 offen offset:0 sc1
    buffer_load_dwordx4 v[76:79], v6, s[20:23], s62 offen offset:1024 sc1
    s_barrier
    s_waitcnt vmcnt(10)
    v_mfma_f32_16x16x32_bf16 v[224:227], v[16:19], v[144:147], 0
    v_mfma_f32_16x16x32_bf16 v[224:227], v[32:35], v[152:155], v[224:227]
    v_xor_b32 v15, 0, v4
    ds_write_b128 v15, v[192:195] offset:0
    ds_write_b128 v15, v[196:199] offset:4096
    v_mfma_f32_16x16x32_bf16 v[228:231], v[16:19], v[148:151], 0
    v_mfma_f32_16x16x32_bf16 v[228:231], v[32:35], v[156:159], v[228:231]
    v_mfma_f32_16x16x32_bf16 v[232:235], v[20:23], v[144:147], 0
    v_xor_b32 v15, 16, v4
    ds_write_b128 v15, v[200:203] offset:0
    ds_write_b128 v15, v[204:207] offset:4096
    v_mfma_f32_16x16x32_bf16 v[232:235], v[36:39], v[152:155], v[232:235]
    v_mfma_f32_16x16x32_bf16 v[236:239], v[20:23], v[148:151], 0
    v_mfma_f32_16x16x32_bf16 v[236:239], v[36:39], v[156:159], v[236:239]
    v_mfma_f32_16x16x32_bf16 v[240:243], v[24:27], v[144:147], 0
    v_xor_b32 v15, 128, v4
    ds_write_b128 v15, v[208:211] offset:0
    ds_write_b128 v15, v[212:215] offset:4096
    v_mfma_f32_16x16x32_bf16 v[240:243], v[40:43], v[152:155], v[240:243]
    v_mfma_f32_16x16x32_bf16 v[244:247], v[24:27], v[148:151], 0
    v_mfma_f32_16x16x32_bf16 v[244:247], v[40:43], v[156:159], v[244:247]
    v_mfma_f32_16x16x32_bf16 v[248:251], v[28:31], v[144:147], 0
    v_xor_b32 v15, 144, v4
    ds_write_b128 v15, v[216:219] offset:0
    ds_write_b128 v15, v[220:223] offset:4096
    v_mfma_f32_16x16x32_bf16 v[248:251], v[44:47], v[152:155], v[248:251]
    v_mfma_f32_16x16x32_bf16 v[252:255], v[28:31], v[148:151], 0
    v_mfma_f32_16x16x32_bf16 v[252:255], v[44:47], v[156:159], v[252:255]
    s_add_u32 s62, s58, 6
    s_and_b32 s62, s62, 7
    s_lshl_b32 s62, s62, 11
    s_add_u32 s62, s62, s52
    s_add_u32 s62, s62, 0x40000
    buffer_load_dwordx4 v[144:147], v6, s[20:23], s62 offen offset:0 sc1
    buffer_load_dwordx4 v[148:151], v6, s[20:23], s62 offen offset:1024 sc1
    s_add_u32 s62, s58, 7
    s_and_b32 s62, s62, 7
    s_lshl_b32 s62, s62, 11
    s_add_u32 s62, s62, s52
    s_add_u32 s62, s62, 0x40000
    buffer_load_dwordx4 v[152:155], v6, s[20:23], s62 offen offset:0 sc1
    buffer_load_dwordx4 v[156:159], v6, s[20:23], s62 offen offset:1024 sc1
    v_and_b32 v13, 15, v0
    s_lshl_b32 s45, s56, 6
    s_add_u32 s45, s45, s48
    v_add_u32 v13, s45, v13
    v_lshlrev_b32 v14, 2, v13
    s_mov_b32 s45, 71303168
    buffer_load_dword v10, v14, s[20:23], s45 offen sc1
    v_lshrrev_b32 v14, 4, v0
    v_lshlrev_b32 v14, 4, v14
    v_lshl_add_u32 v9, v13, 10, v14
    s_lshl_b32 s49, s41, 6
    s_lshl_b32 s45, s57, 7
    s_add_u32 s49, s49, s45
    buffer_load_dwordx4 v[16:19], v9, s[24:27], s49 offen
    s_mov_b32 s98, 1
    s_mov_b32 s99, 20000
POLL_131:
    v_and_b32 v7, s98, v7
    v_cmp_ne_u32 vcc, s98, v7
    s_cbranch_vccz PCK_130
    s_sleep 2
    buffer_load_dword v7, v8, s[20:23], s53 offen sc1
    s_sub_u32 s99, s99, 1
    s_cmp_lg_u32 s99, 0
    s_waitcnt vmcnt(0)
    s_cbranch_scc1 POLL_131
PCK_130:
    v_lshrrev_b32 v12, 3, v0
    v_and_b32 v13, 7, v0
    v_lshlrev_b32 v13, 4, v13
    v_lshl_add_u32 v12, v12, 12, v13
    s_add_u32 m0, s6, 136192
    s_lshl_b32 s44, s57, 18
    s_lshl_b32 s45, s3, 15
    s_add_u32 s44, s44, s45
    s_lshl_b32 s45, s56, 7
    s_add_u32 s44, s44, s45
    s_add_u32 s44, s44, 69206016
    buffer_load_dwordx4 v12, s[20:23], s44 offen sc1 lds
    s_waitcnt vmcnt(13)
    v_mfma_f32_16x16x32_bf16 v[224:227], v[176:179], v[160:163], v[224:227]
    v_mfma_f32_16x16x32_bf16 v[224:227], v[48:51], v[168:171], v[224:227]
    v_mfma_f32_16x16x32_bf16 v[228:231], v[176:179], v[164:167], v[228:231]
    v_mfma_f32_16x16x32_bf16 v[228:231], v[48:51], v[172:175], v[228:231]
    v_mfma_f32_16x16x32_bf16 v[232:235], v[180:183], v[160:163], v[232:235]
    v_mfma_f32_16x16x32_bf16 v[232:235], v[52:55], v[168:171], v[232:235]
    v_mfma_f32_16x16x32_bf16 v[236:239], v[180:183], v[164:167], v[236:239]
    v_mfma_f32_16x16x32_bf16 v[236:239], v[52:55], v[172:175], v[236:239]
    v_mfma_f32_16x16x32_bf16 v[240:243], v[184:187], v[160:163], v[240:243]
    v_mfma_f32_16x16x32_bf16 v[240:243], v[56:59], v[168:171], v[240:243]
    v_mfma_f32_16x16x32_bf16 v[244:247], v[184:187], v[164:167], v[244:247]
    v_mfma_f32_16x16x32_bf16 v[244:247], v[56:59], v[172:175], v[244:247]
    v_mfma_f32_16x16x32_bf16 v[248:251], v[188:191], v[160:163], v[248:251]
    v_mfma_f32_16x16x32_bf16 v[248:251], v[60:63], v[168:171], v[248:251]
    v_mfma_f32_16x16x32_bf16 v[252:255], v[188:191], v[164:167], v[252:255]
    v_mfma_f32_16x16x32_bf16 v[252:255], v[60:63], v[172:175], v[252:255]
    s_waitcnt vmcnt(7)
    s_lshl_b32 s44, s7, 7
    s_lshl_b32 s45, s3, 2
    s_add_u32 s44, s44, s45
    s_add_u32 s44, s44, 71401472
    v_mov_b32 v2, 1
    v_mov_b32 v3, 0
    buffer_store_dword v2, v3, s[20:23], s44 offen sc1
    v_mfma_f32_16x16x32_bf16 v[224:227], v[80:83], v[64:67], v[224:227]
    v_mfma_f32_16x16x32_bf16 v[224:227], v[96:99], v[72:75], v[224:227]
    v_mfma_f32_16x16x32_bf16 v[228:231], v[80:83], v[68:71], v[228:231]
    v_mfma_f32_16x16x32_bf16 v[228:231], v[96:99], v[76:79], v[228:231]
    v_mfma_f32_16x16x32_bf16 v[232:235], v[84:87], v[64:67], v[232:235]
    v_mfma_f32_16x16x32_bf16 v[232:235], v[100:103], v[72:75], v[232:235]
    v_mfma_f32_16x16x32_bf16 v[236:239], v[84:87], v[68:71], v[236:239]
    v_mfma_f32_16x16x32_bf16 v[236:239], v[100:103], v[76:79], v[236:239]
    v_mfma_f32_16x16x32_bf16 v[240:243], v[88:91], v[64:67], v[240:243]
    v_mfma_f32_16x16x32_bf16 v[240:243], v[104:107], v[72:75], v[240:243]
    v_mfma_f32_16x16x32_bf16 v[244:247], v[88:91], v[68:71], v[244:247]
    v_mfma_f32_16x16x32_bf16 v[244:247], v[104:107], v[76:79], v[244:247]
    v_mfma_f32_16x16x32_bf16 v[248:251], v[92:95], v[64:67], v[248:251]
    v_mfma_f32_16x16x32_bf16 v[248:251], v[108:111], v[72:75], v[248:251]
    v_mfma_f32_16x16x32_bf16 v[252:255], v[92:95], v[68:71], v[252:255]
    v_mfma_f32_16x16x32_bf16 v[252:255], v[108:111], v[76:79], v[252:255]
    s_waitcnt vmcnt(4)
    s_xor_b32 s53, s7, 32
    s_lshl_b32 s53, s53, 7
    s_lshl_b32 s42, s3, 2
    s_add_u32 s53, s53, s42
    s_add_u32 s53, s53, 71401472
    v_mov_b32 v8, 0
    v_mfma_f32_16x16x32_bf16 v[224:227], v[112:115], v[144:147], v[224:227]
    v_mfma_f32_16x16x32_bf16 v[224:227], v[128:131], v[152:155], v[224:227]
    v_mfma_f32_16x16x32_bf16 v[228:231], v[112:115], v[148:151], v[228:231]
    v_mfma_f32_16x16x32_bf16 v[228:231], v[128:131], v[156:159], v[228:231]
    v_mfma_f32_16x16x32_bf16 v[232:235], v[116:119], v[144:147], v[232:235]
    v_mfma_f32_16x16x32_bf16 v[232:235], v[132:135], v[152:155], v[232:235]
    v_mfma_f32_16x16x32_bf16 v[236:239], v[116:119], v[148:151], v[236:239]
    v_mfma_f32_16x16x32_bf16 v[236:239], v[132:135], v[156:159], v[236:239]
    v_mfma_f32_16x16x32_bf16 v[240:243], v[120:123], v[144:147], v[240:243]
    v_mfma_f32_16x16x32_bf16 v[240:243], v[136:139], v[152:155], v[240:243]
    v_mfma_f32_16x16x32_bf16 v[244:247], v[120:123], v[148:151], v[244:247]
    v_mfma_f32_16x16x32_bf16 v[244:247], v[136:139], v[156:159], v[244:247]
    v_mfma_f32_16x16x32_bf16 v[248:251], v[124:127], v[144:147], v[248:251]
    v_mfma_f32_16x16x32_bf16 v[248:251], v[140:143], v[152:155], v[248:251]
    v_mfma_f32_16x16x32_bf16 v[252:255], v[124:127], v[148:151], v[252:255]
    v_mfma_f32_16x16x32_bf16 v[252:255], v[140:143], v[156:159], v[252:255]
    buffer_load_dword v7, v8, s[20:23], s53 offen sc1
    v_xor_b32 v15, 65536, v4
    ds_write_b128 v15, v[224:227] offset:0
    ds_write_b128 v15, v[228:231] offset:4096
    v_xor_b32 v15, 65552, v4
    ds_write_b128 v15, v[232:235] offset:0
    ds_write_b128 v15, v[236:239] offset:4096
    v_xor_b32 v15, 65664, v4
    ds_write_b128 v15, v[240:243] offset:0
    ds_write_b128 v15, v[244:247] offset:4096
    v_xor_b32 v15, 65680, v4
    ds_write_b128 v15, v[248:251] offset:0
    ds_write_b128 v15, v[252:255] offset:4096
    s_waitcnt vmcnt(0)
    s_mov_b32 s98, 1
    s_mov_b32 s99, 20000
POLL_133:
    v_and_b32 v7, s98, v7
    v_cmp_ne_u32 vcc, s98, v7
    s_cbranch_vccz PCK_132
    s_sleep 2
    buffer_load_dword v7, v8, s[20:23], s53 offen sc1
    s_sub_u32 s99, s99, 1
    s_cmp_lg_u32 s99, 0
    s_waitcnt vmcnt(0)
    s_cbranch_scc1 POLL_133
PCK_132:
    s_xor_b32 s54, s54, 0x80000
    buffer_load_dwordx4 v[24:27], v6, s[20:23], s54 offen offset:0 sc1
    buffer_load_dwordx4 v[28:31], v6, s[20:23], s54 offen offset:1024 sc1
    v_lshrrev_b32 v12, 4, v0
    s_lshl_b32 s42, s41, 5
    v_lshl_add_u32 v12, v12, 3, s42
    v_bfe_u32 v13, v0, 2, 2
    v_add_u32 v12, v12, v13
    v_lshlrev_b32 v12, 7, v12
    v_and_b32 v13, 3, v0
    v_lshl_add_u32 v12, v13, 3, v12
    s_lshl_b32 s42, s48, 1
    s_add_u32 s42, s42, 136192
    v_add_u32 v12, s42, v12
    s_waitcnt lgkmcnt(0)
    s_barrier
    ds_read_b64_tr_b16 v[100:101], v12
    ds_read_b64_tr_b16 v[102:103], v12 offset:512
    ds_read_b128 v[192:195], v11 offset:0
    ds_read_b128 v[196:199], v5 offset:0
    ds_read_b128 v[200:203], v11 offset:8192
    ds_read_b128 v[204:207], v5 offset:8192
    ds_read_b128 v[208:211], v11 offset:16384
    ds_read_b128 v[212:215], v5 offset:16384
    ds_read_b128 v[216:219], v11 offset:24576
    ds_read_b128 v[220:223], v5 offset:24576
    ds_read_b128 v[224:227], v11 offset:32768
    ds_read_b128 v[228:231], v5 offset:32768
    ds_read_b128 v[232:235], v11 offset:40960
    ds_read_b128 v[236:239], v5 offset:40960
    s_waitcnt lgkmcnt(12)
    v_lshlrev_b32 v104, 16, v16
    v_lshlrev_b32 v105, 16, v100
    v_mul_f32 v112, v104, v105
    v_mul_f32 v112, v112, v10
    v_and_b32 v104, 0xffff0000, v16
    v_and_b32 v105, 0xffff0000, v100
    v_mul_f32 v113, v104, v105
    v_mul_f32 v113, v113, v10
    v_lshlrev_b32 v104, 16, v17
    v_lshlrev_b32 v105, 16, v101
    v_mul_f32 v114, v104, v105
    v_mul_f32 v114, v114, v10
    v_and_b32 v104, 0xffff0000, v17
    v_and_b32 v105, 0xffff0000, v101
    v_mul_f32 v115, v104, v105
    v_mul_f32 v115, v115, v10
    v_lshlrev_b32 v104, 16, v18
    v_lshlrev_b32 v105, 16, v102
    v_mul_f32 v116, v104, v105
    v_mul_f32 v116, v116, v10
    v_and_b32 v104, 0xffff0000, v18
    v_and_b32 v105, 0xffff0000, v102
    v_mul_f32 v117, v104, v105
    v_mul_f32 v117, v117, v10
    v_lshlrev_b32 v104, 16, v19
    v_lshlrev_b32 v105, 16, v103
    v_mul_f32 v118, v104, v105
    v_mul_f32 v118, v118, v10
    v_and_b32 v104, 0xffff0000, v19
    v_and_b32 v105, 0xffff0000, v103
    v_mul_f32 v119, v104, v105
    v_mul_f32 v119, v119, v10
    v_sub_f32 v10, 1.0, v10
    ds_read_b128 v[240:243], v11 offset:49152
    ds_read_b128 v[244:247], v5 offset:49152
    ds_read_b128 v[248:251], v11 offset:57344
    ds_read_b128 v[252:255], v5 offset:57344
    s_waitcnt lgkmcnt(12)
    v_pk_add_f32 v[192:193], v[192:193], v[200:201]
    v_pk_add_f32 v[194:195], v[194:195], v[202:203]
    v_pk_add_f32 v[196:197], v[196:197], v[204:205]
    v_pk_add_f32 v[198:199], v[198:199], v[206:207]
    s_waitcnt lgkmcnt(10)
    v_pk_add_f32 v[192:193], v[192:193], v[208:209]
    v_pk_add_f32 v[194:195], v[194:195], v[210:211]
    v_pk_add_f32 v[196:197], v[196:197], v[212:213]
    v_pk_add_f32 v[198:199], v[198:199], v[214:215]
    s_waitcnt lgkmcnt(8)
    v_pk_add_f32 v[192:193], v[192:193], v[216:217]
    v_pk_add_f32 v[194:195], v[194:195], v[218:219]
    v_pk_add_f32 v[196:197], v[196:197], v[220:221]
    v_pk_add_f32 v[198:199], v[198:199], v[222:223]
    s_waitcnt lgkmcnt(6)
    v_pk_add_f32 v[192:193], v[192:193], v[224:225]
    v_pk_add_f32 v[194:195], v[194:195], v[226:227]
    v_pk_add_f32 v[196:197], v[196:197], v[228:229]
    v_pk_add_f32 v[198:199], v[198:199], v[230:231]
    s_waitcnt lgkmcnt(4)
    v_pk_add_f32 v[192:193], v[192:193], v[232:233]
    v_pk_add_f32 v[194:195], v[194:195], v[234:235]
    v_pk_add_f32 v[196:197], v[196:197], v[236:237]
    v_pk_add_f32 v[198:199], v[198:199], v[238:239]
    s_waitcnt lgkmcnt(2)
    v_pk_add_f32 v[192:193], v[192:193], v[240:241]
    v_pk_add_f32 v[194:195], v[194:195], v[242:243]
    v_pk_add_f32 v[196:197], v[196:197], v[244:245]
    v_pk_add_f32 v[198:199], v[198:199], v[246:247]
    s_waitcnt lgkmcnt(0)
    v_pk_add_f32 v[192:193], v[192:193], v[248:249]
    v_pk_add_f32 v[194:195], v[194:195], v[250:251]
    v_pk_add_f32 v[196:197], v[196:197], v[252:253]
    v_pk_add_f32 v[198:199], v[198:199], v[254:255]
    s_waitcnt vmcnt(0)
    v_pk_add_f32 v[192:193], v[192:193], v[24:25]
    v_pk_add_f32 v[194:195], v[194:195], v[26:27]
    v_pk_add_f32 v[196:197], v[196:197], v[28:29]
    v_pk_add_f32 v[198:199], v[198:199], v[30:31]
    v_fmac_f32 v112, v192, v10
    v_fmac_f32 v113, v196, v10
    v_fmac_f32 v114, v193, v10
    v_fmac_f32 v115, v197, v10
    v_fmac_f32 v116, v194, v10
    v_fmac_f32 v117, v198, v10
    v_fmac_f32 v118, v195, v10
    v_fmac_f32 v119, v199, v10
    v_cvt_pk_bf16_f32 v108, v112, v113
    v_cvt_pk_bf16_f32 v109, v114, v115
    v_cvt_pk_bf16_f32 v110, v116, v117
    v_cvt_pk_bf16_f32 v111, v118, v119
    buffer_store_dwordx4 v[108:111], v9, s[16:19], s49 offen sc1
END_1:
    s_endpgm
DR1F_30:
    s_waitcnt lgkmcnt(4)
    v_mfma_f32_16x16x32_bf16 v[208:211], v[72:75], v[104:107], v[208:211]
    v_or3_b32 v8, v8, v99, v100
    v_exp_f32 v56, v124
    v_cvt_pk_bf16_f32 v101, v58, v59
    v_mfma_f32_16x16x32_bf16 v[216:219], v[72:75], v[108:111], v[216:219]
    v_exp_f32 v57, v125
    s_lshr_b32 s34, s3, 2
    v_mfma_f32_16x16x32_bf16 v[212:215], v[76:79], v[104:107], v[212:215]
    s_and_b32 s35, s3, 3
    s_lshl_b32 s37, s7, 1
    s_add_u32 s37, s37, s34
    s_lshl_b32 s37, s37, 12
    v_mfma_f32_16x16x32_bf16 v[220:223], v[76:79], v[108:111], v[220:223]
    s_lshl_b32 s60, s35, 10
    v_add_u32 v50, s60, v6
    v_subrev_u32 v51, 16, v50
    s_waitcnt vmcnt(0)
    v_and_b32 v52, v52, v53
    v_and_b32 v54, v54, v55
    v_and_b32 v52, v52, v54
    v_and_b32 v52, 2, v52
    v_cmp_ne_u32 vcc, 2, v52
    s_cbranch_vccnz SCK_134
SCR_135:
    buffer_load_dwordx4 v[160:163], v51, s[12:15], s37 offen
    buffer_load_dwordx4 v[164:167], v50, s[12:15], s37 offen
    s_waitcnt lgkmcnt(0)
    s_barrier
    v_mfma_f32_16x16x32_bf16 v[224:227], v[80:83], v[104:107], v[224:227]
    ds_read_b128 v[64:67], v5 offset:0
    ds_read_b128 v[68:71], v5 offset:256
    v_exp_f32 v58, v126
    v_cvt_pk_bf16_f32 v102, v56, v57
    v_exp_f32 v59, v127
    v_mfma_f32_16x16x32_bf16 v[232:235], v[80:83], v[108:111], v[232:235]
    ds_read_b128 v[72:75], v5 offset:512
    ds_read_b128 v[76:79], v5 offset:768
    v_or3_b32 v8, v8, v101, v102
    v_cvt_pk_bf16_f32 v103, v58, v59
    v_or_b32 v8, v8, v103
    v_and_b32 v8, s42, v8
    s_lshl_b32 s63, s3, 18
    s_lshl_b32 s62, s7, 5
    v_mfma_f32_16x16x32_bf16 v[228:231], v[84:87], v[104:107], v[228:231]
    ds_read_b128 v[80:83], v5 offset:1024
    s_add_u32 s63, s63, s62
    s_add_u32 s63, s63, 67108864
    v_lshrrev_b32 v48, 1, v0
    v_and_b32 v3, 1, v0
    v_lshlrev_b32 v49, 13, v48
    v_lshl_add_u32 v49, v3, 4, v49
    v_mfma_f32_16x16x32_bf16 v[236:239], v[84:87], v[108:111], v[236:239]
    buffer_load_dwordx4 v[168:171], v49, s[20:23], s63 offen sc1
    v_mov_b32 v128, v10
    v_mov_b32 v129, v10
    v_mov_b32 v130, v10
    v_mov_b32 v131, v10
    v_mfma_f32_16x16x32_bf16 v[240:243], v[88:91], v[104:107], v[240:243]
    ds_read_b128 v[84:87], v5 offset:1280
    v_mov_b32 v132, v10
    v_mov_b32 v133, v10
    v_mov_b32 v134, v10
    v_mov_b32 v135, v10
    v_subrev_u32 v15, 0x60, v7
    v_cmp_lt_i32 s[46:47], v15, 0
    v_mfma_f32_16x16x32_bf16 v[248:251], v[88:91], v[108:111], v[248:251]
    v_cmp_lt_i32 s[48:49], v15, 1
    v_cmp_lt_i32 s[50:51], v15, 2
    v_cmp_lt_i32 s[52:53], v15, 3
    v_cndmask_b32 v136, v136, v10, s[46:47]
    v_cndmask_b32 v137, v137, v10, s[48:49]
    v_cndmask_b32 v138, v138, v10, s[50:51]
    v_cndmask_b32 v139, v139, v10, s[52:53]
    v_mfma_f32_16x16x32_bf16 v[244:247], v[92:95], v[104:107], v[244:247]
    ds_read_b128 v[88:91], v5 offset:1536
    v_cmp_lt_i32 s[46:47], v15, 16
    v_cmp_lt_i32 s[48:49], v15, 17
    v_cmp_lt_i32 s[50:51], v15, 18
    v_cmp_lt_i32 s[52:53], v15, 19
    v_cndmask_b32 v140, v140, v10, s[46:47]
    v_cndmask_b32 v141, v141, v10, s[48:49]
    v_cndmask_b32 v142, v142, v10, s[50:51]
    v_mfma_f32_16x16x32_bf16 v[252:255], v[92:95], v[108:111], v[252:255]
    v_cndmask_b32 v143, v143, v10, s[52:53]
    v_cmp_ne_u32 vcc, 0, v8
    s_cbranch_vccnz RARE_136
BACK_137:
    s_mov_b32 s55, 2
    v_rcp_f32 v12, v152
    v_rcp_f32 v14, v156
    v_mov_b32 v13, v12
    v_mov_b32 v15, v14
    v_mov_b64 v[152:153], 0
    v_mov_b64 v[154:155], 0
    v_mov_b64 v[156:157], 0
    v_mov_b64 v[158:159], 0
    v_pk_mul_f32 v[192:193], v[192:193], v[12:13]
    v_pk_mul_f32 v[194:195], v[194:195], v[12:13]
    v_pk_mul_f32 v[196:197], v[196:197], v[12:13]
    v_pk_mul_f32 v[198:199], v[198:199], v[12:13]
    v_cvt_pk_bf16_f32 v16, v192, v193
    v_cvt_pk_bf16_f32 v17, v194, v195
    v_cvt_pk_bf16_f32 v18, v196, v197
    v_cvt_pk_bf16_f32 v19, v198, v199
    v_mov_b64 v[192:193], 0
    v_mov_b64 v[194:195], 0
    v_mov_b64 v[196:197], 0
    v_mov_b64 v[198:199], 0
    v_pk_mul_f32 v[200:201], v[200:201], v[14:15]
    v_pk_mul_f32 v[202:203], v[202:203], v[14:15]
    v_pk_mul_f32 v[204:205], v[204:205], v[14:15]
    v_pk_mul_f32 v[206:207], v[206:207], v[14:15]
    v_cvt_pk_bf16_f32 v20, v200, v201
    v_cvt_pk_bf16_f32 v21, v202, v203
    v_cvt_pk_bf16_f32 v22, v204, v205
    v_cvt_pk_bf16_f32 v23, v206, v207
    v_mov_b64 v[200:201], 0
    v_mov_b64 v[202:203], 0
    v_mov_b64 v[204:205], 0
    v_mov_b64 v[206:207], 0
    v_pk_mul_f32 v[208:209], v[208:209], v[12:13]
    v_pk_mul_f32 v[210:211], v[210:211], v[12:13]
    v_pk_mul_f32 v[212:213], v[212:213], v[12:13]
    v_pk_mul_f32 v[214:215], v[214:215], v[12:13]
    v_cvt_pk_bf16_f32 v24, v208, v209
    v_cvt_pk_bf16_f32 v25, v210, v211
    v_cvt_pk_bf16_f32 v26, v212, v213
    v_cvt_pk_bf16_f32 v27, v214, v215
    v_mov_b64 v[208:209], 0
    v_mov_b64 v[210:211], 0
    v_mov_b64 v[212:213], 0
    v_mov_b64 v[214:215], 0
    v_pk_mul_f32 v[216:217], v[216:217], v[14:15]
    v_pk_mul_f32 v[218:219], v[218:219], v[14:15]
    v_pk_mul_f32 v[220:221], v[220:221], v[14:15]
    v_pk_mul_f32 v[222:223], v[222:223], v[14:15]
    v_cvt_pk_bf16_f32 v28, v216, v217
    v_cvt_pk_bf16_f32 v29, v218, v219
    v_cvt_pk_bf16_f32 v30, v220, v221
    v_cvt_pk_bf16_f32 v31, v222, v223
    v_mov_b64 v[216:217], 0
    v_mov_b64 v[218:219], 0
    v_mov_b64 v[220:221], 0
    v_mov_b64 v[222:223], 0
    v_pk_mul_f32 v[224:225], v[224:225], v[12:13]
    v_pk_mul_f32 v[226:227], v[226:227], v[12:13]
    v_pk_mul_f32 v[228:229], v[228:229], v[12:13]
    v_pk_mul_f32 v[230:231], v[230:231], v[12:13]
    v_cvt_pk_bf16_f32 v32, v224, v225
    v_cvt_pk_bf16_f32 v33, v226, v227
    v_cvt_pk_bf16_f32 v34, v228, v229
    v_cvt_pk_bf16_f32 v35, v230, v231
    v_mov_b64 v[224:225], 0
    v_mov_b64 v[226:227], 0
    v_mov_b64 v[228:229], 0
    v_mov_b64 v[230:231], 0
    v_pk_mul_f32 v[232:233], v[232:233], v[14:15]
    v_pk_mul_f32 v[234:235], v[234:235], v[14:15]
    v_pk_mul_f32 v[236:237], v[236:237], v[14:15]
    v_pk_mul_f32 v[238:239], v[238:239], v[14:15]
    v_cvt_pk_bf16_f32 v36, v232, v233
    v_cvt_pk_bf16_f32 v37, v234, v235
    v_cvt_pk_bf16_f32 v38, v236, v237
    v_cvt_pk_bf16_f32 v39, v238, v239
    v_mov_b64 v[232:233], 0
    v_mov_b64 v[234:235], 0
    v_mov_b64 v[236:237], 0
    v_mov_b64 v[238:239], 0
    v_pk_mul_f32 v[240:241], v[240:241], v[12:13]
    v_pk_mul_f32 v[242:243], v[242:243], v[12:13]
    v_pk_mul_f32 v[244:245], v[244:245], v[12:13]
    v_pk_mul_f32 v[246:247], v[246:247], v[12:13]
    v_cvt_pk_bf16_f32 v40, v240, v241
    v_cvt_pk_bf16_f32 v41, v242, v243
    v_cvt_pk_bf16_f32 v42, v244, v245
    v_cvt_pk_bf16_f32 v43, v246, v247
    v_mov_b64 v[240:241], 0
    v_mov_b64 v[242:243], 0
    v_mov_b64 v[244:245], 0
    v_mov_b64 v[246:247], 0
    v_pk_mul_f32 v[248:249], v[248:249], v[14:15]
    v_pk_mul_f32 v[250:251], v[250:251], v[14:15]
    v_pk_mul_f32 v[252:253], v[252:253], v[14:15]
    v_pk_mul_f32 v[254:255], v[254:255], v[14:15]
    v_cvt_pk_bf16_f32 v44, v248, v249
    v_cvt_pk_bf16_f32 v45, v250, v251
    v_cvt_pk_bf16_f32 v46, v252, v253
    v_cvt_pk_bf16_f32 v47, v254, v255
    v_mov_b64 v[248:249], 0
    v_mov_b64 v[250:251], 0
    v_mov_b64 v[252:253], 0
    v_mov_b64 v[254:255], 0
    s_xor_b32 s45, s59, 787456
    s_mov_b32 s44, s59
    s_mov_b32 s55, 3
    buffer_store_dwordx4 v[16:19], v6, s[20:23], s44 offen offset:0 sc1
    buffer_store_dwordx4 v[20:23], v6, s[20:23], s45 offen offset:0 sc1
    buffer_store_dwordx4 v[24:27], v6, s[20:23], s44 offen offset:2048 sc1
    buffer_store_dwordx4 v[28:31], v6, s[20:23], s45 offen offset:2048 sc1
    s_add_u32 s44, s44, 4096
    s_add_u32 s45, s45, 4096
    buffer_store_dwordx4 v[32:35], v6, s[20:23], s44 offen offset:0 sc1
    buffer_store_dwordx4 v[36:39], v6, s[20:23], s45 offen offset:0 sc1
    buffer_store_dwordx4 v[40:43], v6, s[20:23], s44 offen offset:2048 sc1
    buffer_store_dwordx4 v[44:47], v6, s[20:23], s45 offen offset:2048 sc1
    s_branch DH1_32
.p2align 6
STUB_38:
    s_call_b64 s[76:77], SITE_13
    s_branch RET_39
STUB_48:
    s_call_b64 s[76:77], SITE_13
    s_branch RET_49
STUB_52:
    s_call_b64 s[76:77], SITE_13
    s_branch RET_53
STUB_58:
    s_call_b64 s[76:77], SITE_13
    s_branch RET_59
STUB_68:
    s_call_b64 s[76:77], SITE_13
    s_branch RET_69
STUB_93:
    s_call_b64 s[76:77], SITE_13
    s_branch RET_94
STUB_99:
    s_call_b64 s[76:77], SITE_13
    s_branch RET_100
STUB_105:
    s_call_b64 s[76:77], SITE_13
    s_branch RET_106
STUB_113:
    s_call_b64 s[76:77], SITE_13
    s_branch RET_114
SITE_13:
    s_cmp_eq_u32 s41, 8
    s_cbranch_scc1 SL_138
    s_cmp_eq_u32 s41, 12
    s_cbranch_scc1 SP_140
    s_cmp_gt_u32 s41, 8
    s_cbranch_scc1 SM_139
    s_cmp_eq_u32 s41, 2
    s_cbranch_scc1 ST_141
    s_cmp_eq_u32 s41, 3
    s_cbranch_scc1 ST_142
    s_cmp_eq_u32 s41, 4
    s_cbranch_scc1 ST_143
    s_cmp_eq_u32 s41, 5
    s_cbranch_scc1 ST_144
    s_mov_b32 s60, s4
    s_lshl_b32 s60, s60, 17
    s_lshl_b32 s61, s5, 14
    s_add_u32 s60, s60, s61
    v_lshlrev_b32 v16, 7, v0
    buffer_load_dword v1, v16, s[28:31], s60 offen
    s_nop 1
    s_setpc_b64 s[76:77]
ST_141:
    s_mov_b32 s60, s4
    s_lshl_b32 s60, s60, 17
    s_lshl_b32 s61, s5, 14
    s_add_u32 s60, s60, s61
    s_add_u32 s60, s60, 8192
    v_lshlrev_b32 v16, 7, v0
    buffer_load_dword v1, v16, s[28:31], s60 offen
    s_nop 1
    s_setpc_b64 s[76:77]
ST_142:
    s_lshr_b32 s60, s2, 3
    s_lshl_b32 s60, s60, 16
    s_and_b32 s61, s2, 7
    s_lshl_b32 s61, s61, 7
    s_add_u32 s60, s60, s61
    v_lshlrev_b32 v16, 10, v0
    buffer_load_dword v1, v16, s[8:11], s60 offen
    s_nop 1
    s_setpc_b64 s[76:77]
ST_143:
    s_lshr_b32 s60, s2, 3
    s_lshl_b32 s60, s60, 16
    s_and_b32 s61, s2, 7
    s_lshl_b32 s61, s61, 7
    s_add_u32 s60, s60, s61
    v_lshlrev_b32 v16, 10, v0
    buffer_load_dword v1, v16, s[16:19], s60 offen
    s_nop 1
    s_setpc_b64 s[76:77]
ST_144:
    s_lshl_b32 s60, s7, 13
    v_lshlrev_b32 v16, 7, v0
    buffer_load_dword v1, v16, s[12:15], s60 offen
    s_nop 1
    s_setpc_b64 s[76:77]
SP_140:
    s_lshl_b32 s44, s7, 2
    s_add_u32 s44, s44, 71372800
    s_cmp_eq_u32 s3, 0
    s_cselect_b32 s99, 0, 1073741824
    v_mov_b32 v2, 2
    v_mov_b32 v3, s99
    buffer_store_dword v2, v3, s[20:23], s44 offen sc1
    s_nop 1
    s_setpc_b64 s[76:77]
SL_138:
    v_lshrrev_b32 v40, 5, v0
    v_and_b32 v41, 31, v0
    v_lshlrev_b32 v42, 12, v40
    v_lshl_add_u32 v42, v41, 2, v42
    s_mov_b32 s60, s4
    s_lshl_b32 s60, s60, 17
    s_lshr_b32 s61, s5, 1
    s_lshl_b32 s61, s61, 15
    s_add_u32 s60, s60, s61
    s_and_b32 s61, s7, 1
    s_lshl_b32 s61, s61, 9
    s_add_u32 s60, s60, s61
    s_lshl_b32 s61, s3, 6
    s_add_u32 s60, s60, s61
    s_add_u32 s61, s60, 16384
    v_lshrrev_b32 v43, 4, v0
    v_lshlrev_b32 v43, 12, v43
    v_and_b32 v44, 15, v0
    v_lshl_add_u32 v43, v44, 2, v43
    buffer_load_dword v32, v43, s[28:31], s60 offen offset:0
    buffer_load_dword v33, v43, s[28:31], s60 offen offset:1024
    buffer_load_dword v34, v43, s[28:31], s60 offen offset:2048
    buffer_load_dword v35, v43, s[28:31], s60 offen offset:3072
    buffer_load_dword v36, v43, s[28:31], s61 offen offset:0
    buffer_load_dword v37, v43, s[28:31], s61 offen offset:1024
    buffer_load_dword v38, v43, s[28:31], s61 offen offset:2048
    buffer_load_dword v39, v43, s[28:31], s61 offen offset:3072
    s_lshr_b32 s62, s2, 3
    s_lshl_b32 s62, s62, 16
    s_lshl_b32 s63, s3, 13
    s_add_u32 s62, s62, s63
    s_and_b32 s63, s2, 7
    s_lshl_b32 s63, s63, 7
    s_add_u32 s62, s62, s63
    v_add_u32 v43, s62, v42
    v_subrev_u32 v44, 3072, v43
    v_subrev_u32 v45, 2048, v43
    v_subrev_u32 v46, 1024, v43
    s_lshl_b32 s63, s63, 2
    v_lshl_add_u32 v47, v41, 4, s63
    buffer_load_dword v16, v44, s[8:11], 0 offen
    buffer_load_dword v17, v45, s[8:11], 0 offen
    buffer_load_dword v18, v46, s[8:11], 0 offen
    buffer_load_dword v19, v43, s[8:11], 0 offen offset:0
    buffer_load_dword v20, v43, s[8:11], 0 offen offset:1024
    buffer_load_dword v21, v43, s[8:11], 0 offen offset:2048
    buffer_load_dword v22, v43, s[8:11], 0 offen offset:3072
    buffer_load_dword v23, v43, s[16:19], 0 offen offset:0
    buffer_load_dword v24, v43, s[16:19], 0 offen offset:1024
    buffer_load_dword v25, v43, s[16:19], 0 offen offset:2048
    buffer_load_dword v26, v43, s[16:19], 0 offen offset:3072
    buffer_load_dwordx4 v[28:31], v47, s[24:27], 0 offen
    s_nop 1
    s_setpc_b64 s[76:77]
SM_139:
    s_mov_b32 s60, 0x05040100
    s_mov_b32 s61, 0x07060302
    v_perm_b32 v48, v33, v32, s60
    v_perm_b32 v49, v35, v34, s60
    v_perm_b32 v50, v37, v36, s60
    v_perm_b32 v51, v39, v38, s60
    v_perm_b32 v52, v33, v32, s61
    v_perm_b32 v53, v35, v34, s61
    v_perm_b32 v54, v37, v36, s61
    v_perm_b32 v55, v39, v38, s61
    s_and_b32 s60, s7, 1
    s_lshl_b32 s60, s60, 2
    s_lshr_b32 s61, s3, 1
    s_add_u32 s60, s60, s61
    s_lshl_b32 s60, s60, 19
    s_lshr_b32 s61, s7, 1
    s_lshl_b32 s61, s61, 12
    s_add_u32 s60, s60, s61
    s_and_b32 s61, s3, 1
    s_lshl_b32 s61, s61, 11
    s_add_u32 s60, s60, s61
    s_add_u32 s60, s60, 33554432
    buffer_store_dwordx4 v[48:51], v6, s[20:23], s60 offen offset:0 sc1
    buffer_store_dwordx4 v[52:55], v6, s[20:23], s60 offen offset:1024 sc1
    v_lshlrev_b32 v32, 16, v16
    v_lshlrev_b32 v33, 16, v17
    v_lshlrev_b32 v34, 16, v18
    v_lshlrev_b32 v35, 16, v19
    v_lshlrev_b32 v36, 16, v20
    v_lshlrev_b32 v37, 16, v21
    v_lshlrev_b32 v38, 16, v22
    v_lshlrev_b32 v42, 16, v28
    v_and_b32 v43, 0xffff0000, v28
    v_lshlrev_b32 v44, 16, v29
    v_and_b32 v45, 0xffff0000, v29
    v_mul_f32 v48, v32, v45
    v_fmac_f32 v48, v33, v44
    v_fmac_f32 v48, v34, v43
    v_fmac_f32 v48, v35, v42
    v_lshlrev_b32 v39, 16, v23
    v_mul_f32 v48, v48, v39
    v_mul_f32 v49, v33, v45
    v_fmac_f32 v49, v34, v44
    v_fmac_f32 v49, v35, v43
    v_fmac_f32 v49, v36, v42
    v_lshlrev_b32 v39, 16, v24
    v_mul_f32 v49, v49, v39
    v_mul_f32 v50, v34, v45
    v_fmac_f32 v50, v35, v44
    v_fmac_f32 v50, v36, v43
    v_fmac_f32 v50, v37, v42
    v_lshlrev_b32 v39, 16, v25
    v_mul_f32 v50, v50, v39
    v_mul_f32 v51, v35, v45
    v_fmac_f32 v51, v36, v44
    v_fmac_f32 v51, v37, v43
    v_fmac_f32 v51, v38, v42
    v_lshlrev_b32 v39, 16, v26
    v_mul_f32 v51, v51, v39
    v_cvt_pk_bf16_f32 v54, v51, v50
    v_cvt_pk_bf16_f32 v55, v49, v48
    v_and_b32 v32, 0xffff0000, v16
    v_and_b32 v33, 0xffff0000, v17
    v_and_b32 v34, 0xffff0000, v18
    v_and_b32 v35, 0xffff0000, v19
    v_and_b32 v36, 0xffff0000, v20
    v_and_b32 v37, 0xffff0000, v21
    v_and_b32 v38, 0xffff0000, v22
    v_lshlrev_b32 v42, 16, v30
    v_and_b32 v43, 0xffff0000, v30
    v_lshlrev_b32 v44, 16, v31
    v_and_b32 v45, 0xffff0000, v31
    v_mul_f32 v48, v32, v45
    v_fmac_f32 v48, v33, v44
    v_fmac_f32 v48, v34, v43
    v_fmac_f32 v48, v35, v42
    v_and_b32 v39, 0xffff0000, v23
    v_mul_f32 v48, v48, v39
    v_mul_f32 v49, v33, v45
    v_fmac_f32 v49, v34, v44
    v_fmac_f32 v49, v35, v43
    v_fmac_f32 v49, v36, v42
    v_and_b32 v39, 0xffff0000, v24
    v_mul_f32 v49, v49, v39
    v_mul_f32 v50, v34, v45
    v_fmac_f32 v50, v35, v44
    v_fmac_f32 v50, v36, v43
    v_fmac_f32 v50, v37, v42
    v_and_b32 v39, 0xffff0000, v25
    v_mul_f32 v50, v50, v39
    v_mul_f32 v51, v35, v45
    v_fmac_f32 v51, v36, v44
    v_fmac_f32 v51, v37, v43
    v_fmac_f32 v51, v38, v42
    v_and_b32 v39, 0xffff0000, v26
    v_mul_f32 v51, v51, v39
    v_cvt_pk_bf16_f32 v52, v51, v50
    v_cvt_pk_bf16_f32 v53, v49, v48
    v_lshlrev_b32 v41, 5, v41
    v_lshl_add_u32 v41, v40, 4, v41
    v_permlane32_swap_b32 v54, v52
    v_permlane32_swap_b32 v55, v53
    s_lshr_b32 s60, s2, 3
    s_lshl_b32 s60, s60, 16
    s_lshl_b32 s61, s3, 13
    s_add_u32 s60, s60, s61
    s_and_b32 s61, s2, 7
    s_lshl_b32 s61, s61, 10
    s_add_u32 s60, s60, s61
    s_add_u32 s60, s60, 67108864
    buffer_store_dwordx4 v[52:55], v41, s[20:23], s60 offen sc1
    s_nop 1
    s_setpc_b64 s[76:77]
OOL_20:
    v_cmp_lt_i32 s[46:47], v9, 0
    v_cmp_lt_i32 s[48:49], v9, 1
    v_cmp_lt_i32 s[50:51], v9, 2
    v_cmp_lt_i32 s[52:53], v9, 3
    v_cndmask_b32 v112, v112, v10, s[46:47]
    v_cndmask_b32 v113, v113, v10, s[48:49]
    v_cndmask_b32 v114, v114, v10, s[50:51]
    v_cndmask_b32 v115, v115, v10, s[52:53]
    v_cmp_lt_i32 s[46:47], v9, 16
    v_cmp_lt_i32 s[48:49], v9, 17
    v_cmp_lt_i32 s[50:51], v9, 18
    v_cmp_lt_i32 s[52:53], v9, 19
    v_cndmask_b32 v116, v116, v10, s[46:47]
    v_cndmask_b32 v117, v117, v10, s[48:49]
    v_cndmask_b32 v118, v118, v10, s[50:51]
    v_cndmask_b32 v119, v119, v10, s[52:53]
    v_cmp_lt_i32 s[46:47], v7, 0
    v_cmp_lt_i32 s[48:49], v7, 1
    v_cmp_lt_i32 s[50:51], v7, 2
    v_cmp_lt_i32 s[52:53], v7, 3
    v_cndmask_b32 v120, v120, v10, s[46:47]
    v_cndmask_b32 v121, v121, v10, s[48:49]
    v_cndmask_b32 v122, v122, v10, s[50:51]
    v_cndmask_b32 v123, v123, v10, s[52:53]
    v_cmp_lt_i32 s[46:47], v7, 16
    v_cmp_lt_i32 s[48:49], v7, 17
    v_cmp_lt_i32 s[50:51], v7, 18
    v_cmp_lt_i32 s[52:53], v7, 19
    v_cndmask_b32 v124, v124, v10, s[46:47]
    v_cndmask_b32 v125, v125, v10, s[48:49]
    v_cndmask_b32 v126, v126, v10, s[50:51]
    v_cndmask_b32 v127, v127, v10, s[52:53]
    s_branch RET_21
OOL_24:
    v_subrev_u32 v15, 32, v9
    v_cmp_lt_i32 s[46:47], v15, 0
    v_cmp_lt_i32 s[48:49], v15, 1
    v_cmp_lt_i32 s[50:51], v15, 2
    v_cmp_lt_i32 s[52:53], v15, 3
    v_cndmask_b32 v128, v128, v10, s[46:47]
    v_cndmask_b32 v129, v129, v10, s[48:49]
    v_cndmask_b32 v130, v130, v10, s[50:51]
    v_cndmask_b32 v131, v131, v10, s[52:53]
    v_cmp_lt_i32 s[46:47], v15, 16
    v_cmp_lt_i32 s[48:49], v15, 17
    v_cmp_lt_i32 s[50:51], v15, 18
    v_cmp_lt_i32 s[52:53], v15, 19
    v_cndmask_b32 v132, v132, v10, s[46:47]
    v_cndmask_b32 v133, v133, v10, s[48:49]
    v_cndmask_b32 v134, v134, v10, s[50:51]
    v_cndmask_b32 v135, v135, v10, s[52:53]
    v_subrev_u32 v15, 32, v7
    v_cmp_lt_i32 s[46:47], v15, 0
    v_cmp_lt_i32 s[48:49], v15, 1
    v_cmp_lt_i32 s[50:51], v15, 2
    v_cmp_lt_i32 s[52:53], v15, 3
    v_cndmask_b32 v136, v136, v10, s[46:47]
    v_cndmask_b32 v137, v137, v10, s[48:49]
    v_cndmask_b32 v138, v138, v10, s[50:51]
    v_cndmask_b32 v139, v139, v10, s[52:53]
    v_cmp_lt_i32 s[46:47], v15, 16
    v_cmp_lt_i32 s[48:49], v15, 17
    v_cmp_lt_i32 s[50:51], v15, 18
    v_cmp_lt_i32 s[52:53], v15, 19
    v_cndmask_b32 v140, v140, v10, s[46:47]
    v_cndmask_b32 v141, v141, v10, s[48:49]
    v_cndmask_b32 v142, v142, v10, s[50:51]
    v_cndmask_b32 v143, v143, v10, s[52:53]
    s_branch RET_25
OOL_42:
    v_cmp_lt_i32 s[46:47], v9, 0
    v_cmp_lt_i32 s[48:49], v9, 1
    v_cmp_lt_i32 s[50:51], v9, 2
    v_cmp_lt_i32 s[52:53], v9, 3
    v_cndmask_b32 v112, v112, v10, s[46:47]
    v_cndmask_b32 v113, v113, v10, s[48:49]
    v_cndmask_b32 v114, v114, v10, s[50:51]
    v_cndmask_b32 v115, v115, v10, s[52:53]
    v_cmp_lt_i32 s[46:47], v9, 16
    v_cmp_lt_i32 s[48:49], v9, 17
    v_cmp_lt_i32 s[50:51], v9, 18
    v_cmp_lt_i32 s[52:53], v9, 19
    v_cndmask_b32 v116, v116, v10, s[46:47]
    v_cndmask_b32 v117, v117, v10, s[48:49]
    v_cndmask_b32 v118, v118, v10, s[50:51]
    v_cndmask_b32 v119, v119, v10, s[52:53]
    v_cmp_lt_i32 s[46:47], v7, 0
    v_cmp_lt_i32 s[48:49], v7, 1
    v_cmp_lt_i32 s[50:51], v7, 2
    v_cmp_lt_i32 s[52:53], v7, 3
    v_cndmask_b32 v120, v120, v10, s[46:47]
    v_cndmask_b32 v121, v121, v10, s[48:49]
    v_cndmask_b32 v122, v122, v10, s[50:51]
    v_cndmask_b32 v123, v123, v10, s[52:53]
    v_cmp_lt_i32 s[46:47], v7, 16
    v_cmp_lt_i32 s[48:49], v7, 17
    v_cmp_lt_i32 s[50:51], v7, 18
    v_cmp_lt_i32 s[52:53], v7, 19
    v_cndmask_b32 v124, v124, v10, s[46:47]
    v_cndmask_b32 v125, v125, v10, s[48:49]
    v_cndmask_b32 v126, v126, v10, s[50:51]
    v_cndmask_b32 v127, v127, v10, s[52:53]
    s_branch RET_43
OOL_46:
    v_subrev_u32 v15, 32, v9
    v_cmp_lt_i32 s[46:47], v15, 0
    v_cmp_lt_i32 s[48:49], v15, 1
    v_cmp_lt_i32 s[50:51], v15, 2
    v_cmp_lt_i32 s[52:53], v15, 3
    v_cndmask_b32 v128, v128, v10, s[46:47]
    v_cndmask_b32 v129, v129, v10, s[48:49]
    v_cndmask_b32 v130, v130, v10, s[50:51]
    v_cndmask_b32 v131, v131, v10, s[52:53]
    v_cmp_lt_i32 s[46:47], v15, 16
    v_cmp_lt_i32 s[48:49], v15, 17
    v_cmp_lt_i32 s[50:51], v15, 18
    v_cmp_lt_i32 s[52:53], v15, 19
    v_cndmask_b32 v132, v132, v10, s[46:47]
    v_cndmask_b32 v133, v133, v10, s[48:49]
    v_cndmask_b32 v134, v134, v10, s[50:51]
    v_cndmask_b32 v135, v135, v10, s[52:53]
    v_subrev_u32 v15, 32, v7
    v_cmp_lt_i32 s[46:47], v15, 0
    v_cmp_lt_i32 s[48:49], v15, 1
    v_cmp_lt_i32 s[50:51], v15, 2
    v_cmp_lt_i32 s[52:53], v15, 3
    v_cndmask_b32 v136, v136, v10, s[46:47]
    v_cndmask_b32 v137, v137, v10, s[48:49]
    v_cndmask_b32 v138, v138, v10, s[50:51]
    v_cndmask_b32 v139, v139, v10, s[52:53]
    v_cmp_lt_i32 s[46:47], v15, 16
    v_cmp_lt_i32 s[48:49], v15, 17
    v_cmp_lt_i32 s[50:51], v15, 18
    v_cmp_lt_i32 s[52:53], v15, 19
    v_cndmask_b32 v140, v140, v10, s[46:47]
    v_cndmask_b32 v141, v141, v10, s[48:49]
    v_cndmask_b32 v142, v142, v10, s[50:51]
    v_cndmask_b32 v143, v143, v10, s[52:53]
    s_branch RET_47
OOL_62:
    s_mov_b32 s61, 71372800
    buffer_load_dwordx4 v[52:55], v6, s[20:23], s61 offen sc1
    v_subrev_u32 v15, 64, v9
    v_cmp_lt_i32 s[46:47], v15, 0
    v_cmp_lt_i32 s[48:49], v15, 1
    v_cmp_lt_i32 s[50:51], v15, 2
    v_cmp_lt_i32 s[52:53], v15, 3
    v_cndmask_b32 v112, v112, v10, s[46:47]
    v_cndmask_b32 v113, v113, v10, s[48:49]
    v_cndmask_b32 v114, v114, v10, s[50:51]
    v_cndmask_b32 v115, v115, v10, s[52:53]
    v_cmp_lt_i32 s[46:47], v15, 16
    v_cmp_lt_i32 s[48:49], v15, 17
    v_cmp_lt_i32 s[50:51], v15, 18
    v_cmp_lt_i32 s[52:53], v15, 19
    v_cndmask_b32 v116, v116, v10, s[46:47]
    v_cndmask_b32 v117, v117, v10, s[48:49]
    v_cndmask_b32 v118, v118, v10, s[50:51]
    v_cndmask_b32 v119, v119, v10, s[52:53]
    v_subrev_u32 v15, 64, v7
    v_cmp_lt_i32 s[46:47], v15, 0
    v_cmp_lt_i32 s[48:49], v15, 1
    v_cmp_lt_i32 s[50:51], v15, 2
    v_cmp_lt_i32 s[52:53], v15, 3
    v_cndmask_b32 v120, v120, v10, s[46:47]
    v_cndmask_b32 v121, v121, v10, s[48:49]
    v_cndmask_b32 v122, v122, v10, s[50:51]
    v_cndmask_b32 v123, v123, v10, s[52:53]
    v_cmp_lt_i32 s[46:47], v15, 16
    v_cmp_lt_i32 s[48:49], v15, 17
    v_cmp_lt_i32 s[50:51], v15, 18
    v_cmp_lt_i32 s[52:53], v15, 19
    v_cndmask_b32 v124, v124, v10, s[46:47]
    v_cndmask_b32 v125, v125, v10, s[48:49]
    v_cndmask_b32 v126, v126, v10, s[50:51]
    v_cndmask_b32 v127, v127, v10, s[52:53]
    s_branch RET_63
W8_64:
    s_waitcnt vmcnt(8)
    s_mov_b32 s55, 4
    s_branch W8R_65
OOL_70:
    s_mov_b32 s55, 2
    v_rcp_f32 v12, v152
    v_rcp_f32 v14, v156
    v_mov_b32 v13, v12
    v_mov_b32 v15, v14
    v_mov_b64 v[152:153], 0
    v_mov_b64 v[154:155], 0
    v_mov_b64 v[156:157], 0
    v_mov_b64 v[158:159], 0
    v_pk_mul_f32 v[192:193], v[192:193], v[12:13]
    v_pk_mul_f32 v[194:195], v[194:195], v[12:13]
    v_pk_mul_f32 v[196:197], v[196:197], v[12:13]
    v_pk_mul_f32 v[198:199], v[198:199], v[12:13]
    v_cvt_pk_bf16_f32 v16, v192, v193
    v_cvt_pk_bf16_f32 v17, v194, v195
    v_cvt_pk_bf16_f32 v18, v196, v197
    v_cvt_pk_bf16_f32 v19, v198, v199
    v_mov_b64 v[192:193], 0
    v_mov_b64 v[194:195], 0
    v_mov_b64 v[196:197], 0
    v_mov_b64 v[198:199], 0
    v_pk_mul_f32 v[200:201], v[200:201], v[14:15]
    v_pk_mul_f32 v[202:203], v[202:203], v[14:15]
    v_pk_mul_f32 v[204:205], v[204:205], v[14:15]
    v_pk_mul_f32 v[206:207], v[206:207], v[14:15]
    v_cvt_pk_bf16_f32 v20, v200, v201
    v_cvt_pk_bf16_f32 v21, v202, v203
    v_cvt_pk_bf16_f32 v22, v204, v205
    v_cvt_pk_bf16_f32 v23, v206, v207
    v_mov_b64 v[200:201], 0
    v_mov_b64 v[202:203], 0
    v_mov_b64 v[204:205], 0
    v_mov_b64 v[206:207], 0
    v_pk_mul_f32 v[208:209], v[208:209], v[12:13]
    v_pk_mul_f32 v[210:211], v[210:211], v[12:13]
    v_pk_mul_f32 v[212:213], v[212:213], v[12:13]
    v_pk_mul_f32 v[214:215], v[214:215], v[12:13]
    v_cvt_pk_bf16_f32 v24, v208, v209
    v_cvt_pk_bf16_f32 v25, v210, v211
    v_cvt_pk_bf16_f32 v26, v212, v213
    v_cvt_pk_bf16_f32 v27, v214, v215
    v_mov_b64 v[208:209], 0
    v_mov_b64 v[210:211], 0
    v_mov_b64 v[212:213], 0
    v_mov_b64 v[214:215], 0
    v_pk_mul_f32 v[216:217], v[216:217], v[14:15]
    v_pk_mul_f32 v[218:219], v[218:219], v[14:15]
    v_pk_mul_f32 v[220:221], v[220:221], v[14:15]
    v_pk_mul_f32 v[222:223], v[222:223], v[14:15]
    v_cvt_pk_bf16_f32 v28, v216, v217
    v_cvt_pk_bf16_f32 v29, v218, v219
    v_cvt_pk_bf16_f32 v30, v220, v221
    v_cvt_pk_bf16_f32 v31, v222, v223
    v_mov_b64 v[216:217], 0
    v_mov_b64 v[218:219], 0
    v_mov_b64 v[220:221], 0
    v_mov_b64 v[222:223], 0
    v_pk_mul_f32 v[224:225], v[224:225], v[12:13]
    v_pk_mul_f32 v[226:227], v[226:227], v[12:13]
    v_pk_mul_f32 v[228:229], v[228:229], v[12:13]
    v_pk_mul_f32 v[230:231], v[230:231], v[12:13]
    v_cvt_pk_bf16_f32 v32, v224, v225
    v_cvt_pk_bf16_f32 v33, v226, v227
    v_cvt_pk_bf16_f32 v34, v228, v229
    v_cvt_pk_bf16_f32 v35, v230, v231
    v_mov_b64 v[224:225], 0
    v_mov_b64 v[226:227], 0
    v_mov_b64 v[228:229], 0
    v_mov_b64 v[230:231], 0
    v_pk_mul_f32 v[232:233], v[232:233], v[14:15]
    v_pk_mul_f32 v[234:235], v[234:235], v[14:15]
    v_pk_mul_f32 v[236:237], v[236:237], v[14:15]
    v_pk_mul_f32 v[238:239], v[238:239], v[14:15]
    v_cvt_pk_bf16_f32 v36, v232, v233
    v_cvt_pk_bf16_f32 v37, v234, v235
    v_cvt_pk_bf16_f32 v38, v236, v237
    v_cvt_pk_bf16_f32 v39, v238, v239
    v_mov_b64 v[232:233], 0
    v_mov_b64 v[234:235], 0
    v_mov_b64 v[236:237], 0
    v_mov_b64 v[238:239], 0
    v_pk_mul_f32 v[240:241], v[240:241], v[12:13]
    v_pk_mul_f32 v[242:243], v[242:243], v[12:13]
    v_pk_mul_f32 v[244:245], v[244:245], v[12:13]
    v_pk_mul_f32 v[246:247], v[246:247], v[12:13]
    v_cvt_pk_bf16_f32 v40, v240, v241
    v_cvt_pk_bf16_f32 v41, v242, v243
    v_cvt_pk_bf16_f32 v42, v244, v245
    v_cvt_pk_bf16_f32 v43, v246, v247
    v_mov_b64 v[240:241], 0
    v_mov_b64 v[242:243], 0
    v_mov_b64 v[244:245], 0
    v_mov_b64 v[246:247], 0
    v_pk_mul_f32 v[248:249], v[248:249], v[14:15]
    v_pk_mul_f32 v[250:251], v[250:251], v[14:15]
    v_pk_mul_f32 v[252:253], v[252:253], v[14:15]
    v_pk_mul_f32 v[254:255], v[254:255], v[14:15]
    v_cvt_pk_bf16_f32 v44, v248, v249
    v_cvt_pk_bf16_f32 v45, v250, v251
    v_cvt_pk_bf16_f32 v46, v252, v253
    v_cvt_pk_bf16_f32 v47, v254, v255
    v_mov_b64 v[248:249], 0
    v_mov_b64 v[250:251], 0
    v_mov_b64 v[252:253], 0
    v_mov_b64 v[254:255], 0
    s_branch RET_71
OOL_74:
    s_xor_b32 s45, s59, 787456
    s_mov_b32 s44, s59
    s_mov_b32 s55, 3
    buffer_store_dwordx4 v[16:19], v6, s[20:23], s44 offen offset:0 sc1
    buffer_store_dwordx4 v[20:23], v6, s[20:23], s45 offen offset:0 sc1
    buffer_store_dwordx4 v[24:27], v6, s[20:23], s44 offen offset:2048 sc1
    buffer_store_dwordx4 v[28:31], v6, s[20:23], s45 offen offset:2048 sc1
    s_add_u32 s44, s44, 4096
    s_add_u32 s45, s45, 4096
    buffer_store_dwordx4 v[32:35], v6, s[20:23], s44 offen offset:0 sc1
    buffer_store_dwordx4 v[36:39], v6, s[20:23], s45 offen offset:0 sc1
    buffer_store_dwordx4 v[40:43], v6, s[20:23], s44 offen offset:2048 sc1
    buffer_store_dwordx4 v[44:47], v6, s[20:23], s45 offen offset:2048 sc1
    s_branch RET_75
W8_76:
    s_waitcnt vmcnt(8)
    s_mov_b32 s55, 4
    s_branch W8R_77
SCK_82:
    s_mov_b32 s99, 20000
SPL_145:
    s_sleep 2
    buffer_load_dwordx4 v[52:55], v6, s[20:23], s61 offen sc1
    s_waitcnt vmcnt(0)
    v_and_b32 v52, v52, v53
    v_and_b32 v54, v54, v55
    v_and_b32 v52, v52, v54
    v_and_b32 v52, 2, v52
    v_cmp_ne_u32 vcc, 2, v52
    s_cbranch_vccz SCR_83
    s_sub_u32 s99, s99, 1
    s_cmp_lg_u32 s99, 0
    s_cbranch_scc1 SPL_145
    s_branch SCR_83
OOL_109:
    s_mov_b32 s61, 71372800
    buffer_load_dwordx4 v[52:55], v6, s[20:23], s61 offen sc1
    v_cmp_lt_i32 s[46:47], v9, 0
    v_cmp_lt_i32 s[48:49], v9, 1
    v_cmp_lt_i32 s[50:51], v9, 2
    v_cmp_lt_i32 s[52:53], v9, 3
    v_cndmask_b32 v112, v112, v10, s[46:47]
    v_cndmask_b32 v113, v113, v10, s[48:49]
    v_cndmask_b32 v114, v114, v10, s[50:51]
    v_cndmask_b32 v115, v115, v10, s[52:53]
    v_cmp_lt_i32 s[46:47], v9, 16
    v_cmp_lt_i32 s[48:49], v9, 17
    v_cmp_lt_i32 s[50:51], v9, 18
    v_cmp_lt_i32 s[52:53], v9, 19
    v_cndmask_b32 v116, v116, v10, s[46:47]
    v_cndmask_b32 v117, v117, v10, s[48:49]
    v_cndmask_b32 v118, v118, v10, s[50:51]
    v_cndmask_b32 v119, v119, v10, s[52:53]
    v_cmp_lt_i32 s[46:47], v7, 0
    v_cmp_lt_i32 s[48:49], v7, 1
    v_cmp_lt_i32 s[50:51], v7, 2
    v_cmp_lt_i32 s[52:53], v7, 3
    v_cndmask_b32 v120, v120, v10, s[46:47]
    v_cndmask_b32 v121, v121, v10, s[48:49]
    v_cndmask_b32 v122, v122, v10, s[50:51]
    v_cndmask_b32 v123, v123, v10, s[52:53]
    v_cmp_lt_i32 s[46:47], v7, 16
    v_cmp_lt_i32 s[48:49], v7, 17
    v_cmp_lt_i32 s[50:51], v7, 18
    v_cmp_lt_i32 s[52:53], v7, 19
    v_cndmask_b32 v124, v124, v10, s[46:47]
    v_cndmask_b32 v125, v125, v10, s[48:49]
    v_cndmask_b32 v126, v126, v10, s[50:51]
    v_cndmask_b32 v127, v127, v10, s[52:53]
    s_branch RET_110
OOL_117:
    s_mov_b32 s61, 71372800
    buffer_load_dwordx4 v[52:55], v6, s[20:23], s61 offen sc1
    v_cmp_lt_i32 s[46:47], v9, 0
    v_cmp_lt_i32 s[48:49], v9, 1
    v_cmp_lt_i32 s[50:51], v9, 2
    v_cmp_lt_i32 s[52:53], v9, 3
    v_cndmask_b32 v112, v112, v10, s[46:47]
    v_cndmask_b32 v113, v113, v10, s[48:49]
    v_cndmask_b32 v114, v114, v10, s[50:51]
    v_cndmask_b32 v115, v115, v10, s[52:53]
    v_cmp_lt_i32 s[46:47], v9, 16
    v_cmp_lt_i32 s[48:49], v9, 17
    v_cmp_lt_i32 s[50:51], v9, 18
    v_cmp_lt_i32 s[52:53], v9, 19
    v_cndmask_b32 v116, v116, v10, s[46:47]
    v_cndmask_b32 v117, v117, v10, s[48:49]
    v_cndmask_b32 v118, v118, v10, s[50:51]
    v_cndmask_b32 v119, v119, v10, s[52:53]
    v_cmp_lt_i32 s[46:47], v7, 0
    v_cmp_lt_i32 s[48:49], v7, 1
    v_cmp_lt_i32 s[50:51], v7, 2
    v_cmp_lt_i32 s[52:53], v7, 3
    v_cndmask_b32 v120, v120, v10, s[46:47]
    v_cndmask_b32 v121, v121, v10, s[48:49]
    v_cndmask_b32 v122, v122, v10, s[50:51]
    v_cndmask_b32 v123, v123, v10, s[52:53]
    v_cmp_lt_i32 s[46:47], v7, 16
    v_cmp_lt_i32 s[48:49], v7, 17
    v_cmp_lt_i32 s[50:51], v7, 18
    v_cmp_lt_i32 s[52:53], v7, 19
    v_cndmask_b32 v124, v124, v10, s[46:47]
    v_cndmask_b32 v125, v125, v10, s[48:49]
    v_cndmask_b32 v126, v126, v10, s[50:51]
    v_cndmask_b32 v127, v127, v10, s[52:53]
    s_branch RET_118
SCK_119:
    s_mov_b32 s99, 20000
SPL_146:
    s_sleep 2
    buffer_load_dwordx4 v[52:55], v6, s[20:23], s61 offen sc1
    s_waitcnt vmcnt(0)
    v_and_b32 v52, v52, v53
    v_and_b32 v54, v54, v55
    v_and_b32 v52, v52, v54
    v_and_b32 v52, 2, v52
    v_cmp_ne_u32 vcc, 2, v52
    s_cbranch_vccz SCR_120
    s_sub_u32 s99, s99, 1
    s_cmp_lg_u32 s99, 0
    s_cbranch_scc1 SPL_146
    s_branch SCR_120
SCK_134:
    s_mov_b32 s99, 20000
SPL_147:
    s_sleep 2
    buffer_load_dwordx4 v[52:55], v6, s[20:23], s61 offen sc1
    s_waitcnt vmcnt(0)
    v_and_b32 v52, v52, v53
    v_and_b32 v54, v54, v55
    v_and_b32 v52, v52, v54
    v_and_b32 v52, 2, v52
    v_cmp_ne_u32 vcc, 2, v52
    s_cbranch_vccz SCR_135
    s_sub_u32 s99, s99, 1
    s_cmp_lg_u32 s99, 0
    s_cbranch_scc1 SPL_147
    s_branch SCR_135
HOT_END:
RARE_22:
    s_nop 15
    v_max3_f32 v12, v112, v113, v114
    v_max3_f32 v12, v12, v115, v116
    v_max3_f32 v12, v12, v117, v118
    v_max_f32 v12, v12, v119
    v_max3_f32 v13, v120, v121, v122
    v_max3_f32 v13, v13, v123, v124
    v_max3_f32 v13, v13, v125, v126
    v_max_f32 v13, v13, v127
    v_mov_b32 v14, v12
    v_mov_b32 v15, v13
    s_nop 0
    v_permlane16_swap_b32 v14, v12
    v_permlane16_swap_b32 v15, v13
    v_max_f32 v12, v12, v14
    v_max_f32 v13, v13, v15
    v_mov_b32 v14, v12
    v_mov_b32 v15, v13
    s_nop 0
    v_permlane32_swap_b32 v14, v12
    v_permlane32_swap_b32 v15, v13
    v_max_f32 v12, v12, v14
    v_max_f32 v13, v13, v15
    v_add_f32 v12, 0x41300000, v12
    v_max_f32 v12, 0, v12
    v_exp_f32 v14, -v12
    v_add_f32 v13, 0x41300000, v13
    v_max_f32 v13, 0, v13
    v_exp_f32 v15, -v13
    v_sub_f32 v144, v144, v12
    v_sub_f32 v145, v145, v12
    v_sub_f32 v146, v146, v12
    v_sub_f32 v147, v147, v12
    v_sub_f32 v148, v148, v13
    v_sub_f32 v149, v149, v13
    v_sub_f32 v150, v150, v13
    v_sub_f32 v151, v151, v13
    v_sub_f32 v112, v112, v12
    v_sub_f32 v113, v113, v12
    v_sub_f32 v114, v114, v12
    v_sub_f32 v115, v115, v12
    v_sub_f32 v116, v116, v12
    v_sub_f32 v117, v117, v12
    v_sub_f32 v118, v118, v12
    v_sub_f32 v119, v119, v12
    v_sub_f32 v120, v120, v13
    v_sub_f32 v121, v121, v13
    v_sub_f32 v122, v122, v13
    v_sub_f32 v123, v123, v13
    v_sub_f32 v124, v124, v13
    v_sub_f32 v125, v125, v13
    v_sub_f32 v126, v126, v13
    v_sub_f32 v127, v127, v13
    v_sub_f32 v128, v128, v12
    v_sub_f32 v129, v129, v12
    v_sub_f32 v130, v130, v12
    v_sub_f32 v131, v131, v12
    v_sub_f32 v132, v132, v12
    v_sub_f32 v133, v133, v12
    v_sub_f32 v134, v134, v12
    v_sub_f32 v135, v135, v12
    v_sub_f32 v136, v136, v13
    v_sub_f32 v137, v137, v13
    v_sub_f32 v138, v138, v13
    v_sub_f32 v139, v139, v13
    v_sub_f32 v140, v140, v13
    v_sub_f32 v141, v141, v13
    v_sub_f32 v142, v142, v13
    v_sub_f32 v143, v143, v13
    v_mul_f32 v192, v192, v14
    v_mul_f32 v193, v193, v14
    v_mul_f32 v194, v194, v14
    v_mul_f32 v195, v195, v14
    v_mul_f32 v196, v196, v14
    v_mul_f32 v197, v197, v14
    v_mul_f32 v198, v198, v14
    v_mul_f32 v199, v199, v14
    v_mul_f32 v200, v200, v15
    v_mul_f32 v201, v201, v15
    v_mul_f32 v202, v202, v15
    v_mul_f32 v203, v203, v15
    v_mul_f32 v204, v204, v15
    v_mul_f32 v205, v205, v15
    v_mul_f32 v206, v206, v15
    v_mul_f32 v207, v207, v15
    v_mul_f32 v208, v208, v14
    v_mul_f32 v209, v209, v14
    v_mul_f32 v210, v210, v14
    v_mul_f32 v211, v211, v14
    v_mul_f32 v212, v212, v14
    v_mul_f32 v213, v213, v14
    v_mul_f32 v214, v214, v14
    v_mul_f32 v215, v215, v14
    v_mul_f32 v216, v216, v15
    v_mul_f32 v217, v217, v15
    v_mul_f32 v218, v218, v15
    v_mul_f32 v219, v219, v15
    v_mul_f32 v220, v220, v15
    v_mul_f32 v221, v221, v15
    v_mul_f32 v222, v222, v15
    v_mul_f32 v223, v223, v15
    v_mul_f32 v224, v224, v14
    v_mul_f32 v225, v225, v14
    v_mul_f32 v226, v226, v14
    v_mul_f32 v227, v227, v14
    v_mul_f32 v228, v228, v14
    v_mul_f32 v229, v229, v14
    v_mul_f32 v230, v230, v14
    v_mul_f32 v231, v231, v14
    v_mul_f32 v232, v232, v15
    v_mul_f32 v233, v233, v15
    v_mul_f32 v234, v234, v15
    v_mul_f32 v235, v235, v15
    v_mul_f32 v236, v236, v15
    v_mul_f32 v237, v237, v15
    v_mul_f32 v238, v238, v15
    v_mul_f32 v239, v239, v15
    v_mul_f32 v240, v240, v14
    v_mul_f32 v241, v241, v14
    v_mul_f32 v242, v242, v14
    v_mul_f32 v243, v243, v14
    v_mul_f32 v244, v244, v14
    v_mul_f32 v245, v245, v14
    v_mul_f32 v246, v246, v14
    v_mul_f32 v247, v247, v14
    v_mul_f32 v248, v248, v15
    v_mul_f32 v249, v249, v15
    v_mul_f32 v250, v250, v15
    v_mul_f32 v251, v251, v15
    v_mul_f32 v252, v252, v15
    v_mul_f32 v253, v253, v15
    v_mul_f32 v254, v254, v15
    v_mul_f32 v255, v255, v15
    v_mul_f32 v152, v152, v14
    v_mul_f32 v153, v153, v14
    v_mul_f32 v154, v154, v14
    v_mul_f32 v155, v155, v14
    v_mul_f32 v156, v156, v15
    v_mul_f32 v157, v157, v15
    v_mul_f32 v158, v158, v15
    v_mul_f32 v159, v159, v15
    v_exp_f32 v56, v112
    v_exp_f32 v57, v113
    v_exp_f32 v58, v114
    v_cvt_pk_bf16_f32 v96, v56, v57
    v_exp_f32 v59, v115
    v_exp_f32 v56, v116
    v_cvt_pk_bf16_f32 v97, v58, v59
    v_exp_f32 v57, v117
    v_exp_f32 v58, v118
    v_cvt_pk_bf16_f32 v98, v56, v57
    v_exp_f32 v59, v119
    v_or3_b32 v8, v96, v97, v98
    v_exp_f32 v56, v120
    v_cvt_pk_bf16_f32 v99, v58, v59
    v_exp_f32 v57, v121
    v_exp_f32 v58, v122
    v_cvt_pk_bf16_f32 v100, v56, v57
    v_exp_f32 v59, v123
    v_or3_b32 v8, v8, v99, v100
    v_exp_f32 v56, v124
    v_cvt_pk_bf16_f32 v101, v58, v59
    v_exp_f32 v57, v125
    v_exp_f32 v58, v126
    v_cvt_pk_bf16_f32 v102, v56, v57
    v_exp_f32 v59, v127
    v_or3_b32 v8, v8, v101, v102
    v_cvt_pk_bf16_f32 v103, v58, v59
    v_or_b32 v8, v8, v103
    v_and_b32 v8, s42, v8
    s_nop 1
    s_branch BACK_23
RARE_36:
    s_nop 15
    v_max3_f32 v12, v112, v113, v114
    v_max3_f32 v12, v12, v115, v116
    v_max3_f32 v12, v12, v117, v118
    v_max_f32 v12, v12, v119
    v_max3_f32 v13, v120, v121, v122
    v_max3_f32 v13, v13, v123, v124
    v_max3_f32 v13, v13, v125, v126
    v_max_f32 v13, v13, v127
    v_mov_b32 v14, v12
    v_mov_b32 v15, v13
    s_nop 0
    v_permlane16_swap_b32 v14, v12
    v_permlane16_swap_b32 v15, v13
    v_max_f32 v12, v12, v14
    v_max_f32 v13, v13, v15
    v_mov_b32 v14, v12
    v_mov_b32 v15, v13
    s_nop 0
    v_permlane32_swap_b32 v14, v12
    v_permlane32_swap_b32 v15, v13
    v_max_f32 v12, v12, v14
    v_max_f32 v13, v13, v15
    v_add_f32 v12, 0x41300000, v12
    v_max_f32 v12, 0, v12
    v_exp_f32 v14, -v12
    v_add_f32 v13, 0x41300000, v13
    v_max_f32 v13, 0, v13
    v_exp_f32 v15, -v13
    v_sub_f32 v144, v144, v12
    v_sub_f32 v145, v145, v12
    v_sub_f32 v146, v146, v12
    v_sub_f32 v147, v147, v12
    v_sub_f32 v148, v148, v13
    v_sub_f32 v149, v149, v13
    v_sub_f32 v150, v150, v13
    v_sub_f32 v151, v151, v13
    v_sub_f32 v112, v112, v12
    v_sub_f32 v113, v113, v12
    v_sub_f32 v114, v114, v12
    v_sub_f32 v115, v115, v12
    v_sub_f32 v116, v116, v12
    v_sub_f32 v117, v117, v12
    v_sub_f32 v118, v118, v12
    v_sub_f32 v119, v119, v12
    v_sub_f32 v120, v120, v13
    v_sub_f32 v121, v121, v13
    v_sub_f32 v122, v122, v13
    v_sub_f32 v123, v123, v13
    v_sub_f32 v124, v124, v13
    v_sub_f32 v125, v125, v13
    v_sub_f32 v126, v126, v13
    v_sub_f32 v127, v127, v13
    v_sub_f32 v128, v128, v12
    v_sub_f32 v129, v129, v12
    v_sub_f32 v130, v130, v12
    v_sub_f32 v131, v131, v12
    v_sub_f32 v132, v132, v12
    v_sub_f32 v133, v133, v12
    v_sub_f32 v134, v134, v12
    v_sub_f32 v135, v135, v12
    v_sub_f32 v136, v136, v13
    v_sub_f32 v137, v137, v13
    v_sub_f32 v138, v138, v13
    v_sub_f32 v139, v139, v13
    v_sub_f32 v140, v140, v13
    v_sub_f32 v141, v141, v13
    v_sub_f32 v142, v142, v13
    v_sub_f32 v143, v143, v13
    v_mul_f32 v192, v192, v14
    v_mul_f32 v193, v193, v14
    v_mul_f32 v194, v194, v14
    v_mul_f32 v195, v195, v14
    v_mul_f32 v196, v196, v14
    v_mul_f32 v197, v197, v14
    v_mul_f32 v198, v198, v14
    v_mul_f32 v199, v199, v14
    v_mul_f32 v200, v200, v15
    v_mul_f32 v201, v201, v15
    v_mul_f32 v202, v202, v15
    v_mul_f32 v203, v203, v15
    v_mul_f32 v204, v204, v15
    v_mul_f32 v205, v205, v15
    v_mul_f32 v206, v206, v15
    v_mul_f32 v207, v207, v15
    v_mul_f32 v208, v208, v14
    v_mul_f32 v209, v209, v14
    v_mul_f32 v210, v210, v14
    v_mul_f32 v211, v211, v14
    v_mul_f32 v212, v212, v14
    v_mul_f32 v213, v213, v14
    v_mul_f32 v214, v214, v14
    v_mul_f32 v215, v215, v14
    v_mul_f32 v216, v216, v15
    v_mul_f32 v217, v217, v15
    v_mul_f32 v218, v218, v15
    v_mul_f32 v219, v219, v15
    v_mul_f32 v220, v220, v15
    v_mul_f32 v221, v221, v15
    v_mul_f32 v222, v222, v15
    v_mul_f32 v223, v223, v15
    v_mul_f32 v224, v224, v14
    v_mul_f32 v225, v225, v14
    v_mul_f32 v226, v226, v14
    v_mul_f32 v227, v227, v14
    v_mul_f32 v228, v228, v14
    v_mul_f32 v229, v229, v14
    v_mul_f32 v230, v230, v14
    v_mul_f32 v231, v231, v14
    v_mul_f32 v232, v232, v15
    v_mul_f32 v233, v233, v15
    v_mul_f32 v234, v234, v15
    v_mul_f32 v235, v235, v15
    v_mul_f32 v236, v236, v15
    v_mul_f32 v237, v237, v15
    v_mul_f32 v238, v238, v15
    v_mul_f32 v239, v239, v15
    v_mul_f32 v240, v240, v14
    v_mul_f32 v241, v241, v14
    v_mul_f32 v242, v242, v14
    v_mul_f32 v243, v243, v14
    v_mul_f32 v244, v244, v14
    v_mul_f32 v245, v245, v14
    v_mul_f32 v246, v246, v14
    v_mul_f32 v247, v247, v14
    v_mul_f32 v248, v248, v15
    v_mul_f32 v249, v249, v15
    v_mul_f32 v250, v250, v15
    v_mul_f32 v251, v251, v15
    v_mul_f32 v252, v252, v15
    v_mul_f32 v253, v253, v15
    v_mul_f32 v254, v254, v15
    v_mul_f32 v255, v255, v15
    v_mul_f32 v152, v152, v14
    v_mul_f32 v153, v153, v14
    v_mul_f32 v154, v154, v14
    v_mul_f32 v155, v155, v14
    v_mul_f32 v156, v156, v15
    v_mul_f32 v157, v157, v15
    v_mul_f32 v158, v158, v15
    v_mul_f32 v159, v159, v15
    v_exp_f32 v56, v112
    v_exp_f32 v57, v113
    v_exp_f32 v58, v114
    v_cvt_pk_bf16_f32 v96, v56, v57
    v_exp_f32 v59, v115
    v_exp_f32 v56, v116
    v_cvt_pk_bf16_f32 v97, v58, v59
    v_exp_f32 v57, v117
    v_exp_f32 v58, v118
    v_cvt_pk_bf16_f32 v98, v56, v57
    v_exp_f32 v59, v119
    v_or3_b32 v8, v96, v97, v98
    v_exp_f32 v56, v120
    v_cvt_pk_bf16_f32 v99, v58, v59
    v_exp_f32 v57, v121
    v_exp_f32 v58, v122
    v_cvt_pk_bf16_f32 v100, v56, v57
    v_exp_f32 v59, v123
    v_or3_b32 v8, v8, v99, v100
    v_exp_f32 v56, v124
    v_cvt_pk_bf16_f32 v101, v58, v59
    v_exp_f32 v57, v125
    v_exp_f32 v58, v126
    v_cvt_pk_bf16_f32 v102, v56, v57
    v_exp_f32 v59, v127
    v_or3_b32 v8, v8, v101, v102
    v_cvt_pk_bf16_f32 v103, v58, v59
    v_or_b32 v8, v8, v103
    v_and_b32 v8, s42, v8
    s_nop 1
    s_branch BACK_37
RARE_40:
    s_nop 15
    v_max3_f32 v12, v128, v129, v130
    v_max3_f32 v12, v12, v131, v132
    v_max3_f32 v12, v12, v133, v134
    v_max_f32 v12, v12, v135
    v_max3_f32 v13, v136, v137, v138
    v_max3_f32 v13, v13, v139, v140
    v_max3_f32 v13, v13, v141, v142
    v_max_f32 v13, v13, v143
    v_mov_b32 v14, v12
    v_mov_b32 v15, v13
    s_nop 0
    v_permlane16_swap_b32 v14, v12
    v_permlane16_swap_b32 v15, v13
    v_max_f32 v12, v12, v14
    v_max_f32 v13, v13, v15
    v_mov_b32 v14, v12
    v_mov_b32 v15, v13
    s_nop 0
    v_permlane32_swap_b32 v14, v12
    v_permlane32_swap_b32 v15, v13
    v_max_f32 v12, v12, v14
    v_max_f32 v13, v13, v15
    v_add_f32 v12, 0x41300000, v12
    v_max_f32 v12, 0, v12
    v_exp_f32 v14, -v12
    v_add_f32 v13, 0x41300000, v13
    v_max_f32 v13, 0, v13
    v_exp_f32 v15, -v13
    v_sub_f32 v144, v144, v12
    v_sub_f32 v145, v145, v12
    v_sub_f32 v146, v146, v12
    v_sub_f32 v147, v147, v12
    v_sub_f32 v148, v148, v13
    v_sub_f32 v149, v149, v13
    v_sub_f32 v150, v150, v13
    v_sub_f32 v151, v151, v13
    v_sub_f32 v128, v128, v12
    v_sub_f32 v129, v129, v12
    v_sub_f32 v130, v130, v12
    v_sub_f32 v131, v131, v12
    v_sub_f32 v132, v132, v12
    v_sub_f32 v133, v133, v12
    v_sub_f32 v134, v134, v12
    v_sub_f32 v135, v135, v12
    v_sub_f32 v136, v136, v13
    v_sub_f32 v137, v137, v13
    v_sub_f32 v138, v138, v13
    v_sub_f32 v139, v139, v13
    v_sub_f32 v140, v140, v13
    v_sub_f32 v141, v141, v13
    v_sub_f32 v142, v142, v13
    v_sub_f32 v143, v143, v13
    v_sub_f32 v112, v112, v12
    v_sub_f32 v113, v113, v12
    v_sub_f32 v114, v114, v12
    v_sub_f32 v115, v115, v12
    v_sub_f32 v116, v116, v12
    v_sub_f32 v117, v117, v12
    v_sub_f32 v118, v118, v12
    v_sub_f32 v119, v119, v12
    v_sub_f32 v120, v120, v13
    v_sub_f32 v121, v121, v13
    v_sub_f32 v122, v122, v13
    v_sub_f32 v123, v123, v13
    v_sub_f32 v124, v124, v13
    v_sub_f32 v125, v125, v13
    v_sub_f32 v126, v126, v13
    v_sub_f32 v127, v127, v13
    v_mul_f32 v192, v192, v14
    v_mul_f32 v193, v193, v14
    v_mul_f32 v194, v194, v14
    v_mul_f32 v195, v195, v14
    v_mul_f32 v196, v196, v14
    v_mul_f32 v197, v197, v14
    v_mul_f32 v198, v198, v14
    v_mul_f32 v199, v199, v14
    v_mul_f32 v200, v200, v15
    v_mul_f32 v201, v201, v15
    v_mul_f32 v202, v202, v15
    v_mul_f32 v203, v203, v15
    v_mul_f32 v204, v204, v15
    v_mul_f32 v205, v205, v15
    v_mul_f32 v206, v206, v15
    v_mul_f32 v207, v207, v15
    v_mul_f32 v208, v208, v14
    v_mul_f32 v209, v209, v14
    v_mul_f32 v210, v210, v14
    v_mul_f32 v211, v211, v14
    v_mul_f32 v212, v212, v14
    v_mul_f32 v213, v213, v14
    v_mul_f32 v214, v214, v14
    v_mul_f32 v215, v215, v14
    v_mul_f32 v216, v216, v15
    v_mul_f32 v217, v217, v15
    v_mul_f32 v218, v218, v15
    v_mul_f32 v219, v219, v15
    v_mul_f32 v220, v220, v15
    v_mul_f32 v221, v221, v15
    v_mul_f32 v222, v222, v15
    v_mul_f32 v223, v223, v15
    v_mul_f32 v224, v224, v14
    v_mul_f32 v225, v225, v14
    v_mul_f32 v226, v226, v14
    v_mul_f32 v227, v227, v14
    v_mul_f32 v228, v228, v14
    v_mul_f32 v229, v229, v14
    v_mul_f32 v230, v230, v14
    v_mul_f32 v231, v231, v14
    v_mul_f32 v232, v232, v15
    v_mul_f32 v233, v233, v15
    v_mul_f32 v234, v234, v15
    v_mul_f32 v235, v235, v15
    v_mul_f32 v236, v236, v15
    v_mul_f32 v237, v237, v15
    v_mul_f32 v238, v238, v15
    v_mul_f32 v239, v239, v15
    v_mul_f32 v240, v240, v14
    v_mul_f32 v241, v241, v14
    v_mul_f32 v242, v242, v14
    v_mul_f32 v243, v243, v14
    v_mul_f32 v244, v244, v14
    v_mul_f32 v245, v245, v14
    v_mul_f32 v246, v246, v14
    v_mul_f32 v247, v247, v14
    v_mul_f32 v248, v248, v15
    v_mul_f32 v249, v249, v15
    v_mul_f32 v250, v250, v15
    v_mul_f32 v251, v251, v15
    v_mul_f32 v252, v252, v15
    v_mul_f32 v253, v253, v15
    v_mul_f32 v254, v254, v15
    v_mul_f32 v255, v255, v15
    v_mul_f32 v152, v152, v14
    v_mul_f32 v153, v153, v14
    v_mul_f32 v154, v154, v14
    v_mul_f32 v155, v155, v14
    v_mul_f32 v156, v156, v15
    v_mul_f32 v157, v157, v15
    v_mul_f32 v158, v158, v15
    v_mul_f32 v159, v159, v15
    v_exp_f32 v56, v128
    v_exp_f32 v57, v129
    v_exp_f32 v58, v130
    v_cvt_pk_bf16_f32 v104, v56, v57
    v_exp_f32 v59, v131
    v_exp_f32 v56, v132
    v_cvt_pk_bf16_f32 v105, v58, v59
    v_exp_f32 v57, v133
    v_exp_f32 v58, v134
    v_cvt_pk_bf16_f32 v106, v56, v57
    v_exp_f32 v59, v135
    v_or3_b32 v8, v104, v105, v106
    v_exp_f32 v56, v136
    v_cvt_pk_bf16_f32 v107, v58, v59
    v_exp_f32 v57, v137
    v_exp_f32 v58, v138
    v_cvt_pk_bf16_f32 v108, v56, v57
    v_exp_f32 v59, v139
    v_or3_b32 v8, v8, v107, v108
    v_exp_f32 v56, v140
    v_cvt_pk_bf16_f32 v109, v58, v59
    v_exp_f32 v57, v141
    v_exp_f32 v58, v142
    v_cvt_pk_bf16_f32 v110, v56, v57
    v_exp_f32 v59, v143
    v_or3_b32 v8, v8, v109, v110
    v_cvt_pk_bf16_f32 v111, v58, v59
    v_or_b32 v8, v8, v111
    v_and_b32 v8, s42, v8
    s_nop 1
    s_branch BACK_41
RARE_44:
    s_nop 15
    v_max3_f32 v12, v112, v113, v114
    v_max3_f32 v12, v12, v115, v116
    v_max3_f32 v12, v12, v117, v118
    v_max_f32 v12, v12, v119
    v_max3_f32 v13, v120, v121, v122
    v_max3_f32 v13, v13, v123, v124
    v_max3_f32 v13, v13, v125, v126
    v_max_f32 v13, v13, v127
    v_mov_b32 v14, v12
    v_mov_b32 v15, v13
    s_nop 0
    v_permlane16_swap_b32 v14, v12
    v_permlane16_swap_b32 v15, v13
    v_max_f32 v12, v12, v14
    v_max_f32 v13, v13, v15
    v_mov_b32 v14, v12
    v_mov_b32 v15, v13
    s_nop 0
    v_permlane32_swap_b32 v14, v12
    v_permlane32_swap_b32 v15, v13
    v_max_f32 v12, v12, v14
    v_max_f32 v13, v13, v15
    v_add_f32 v12, 0x41300000, v12
    v_max_f32 v12, 0, v12
    v_exp_f32 v14, -v12
    v_add_f32 v13, 0x41300000, v13
    v_max_f32 v13, 0, v13
    v_exp_f32 v15, -v13
    v_sub_f32 v144, v144, v12
    v_sub_f32 v145, v145, v12
    v_sub_f32 v146, v146, v12
    v_sub_f32 v147, v147, v12
    v_sub_f32 v148, v148, v13
    v_sub_f32 v149, v149, v13
    v_sub_f32 v150, v150, v13
    v_sub_f32 v151, v151, v13
    v_sub_f32 v112, v112, v12
    v_sub_f32 v113, v113, v12
    v_sub_f32 v114, v114, v12
    v_sub_f32 v115, v115, v12
    v_sub_f32 v116, v116, v12
    v_sub_f32 v117, v117, v12
    v_sub_f32 v118, v118, v12
    v_sub_f32 v119, v119, v12
    v_sub_f32 v120, v120, v13
    v_sub_f32 v121, v121, v13
    v_sub_f32 v122, v122, v13
    v_sub_f32 v123, v123, v13
    v_sub_f32 v124, v124, v13
    v_sub_f32 v125, v125, v13
    v_sub_f32 v126, v126, v13
    v_sub_f32 v127, v127, v13
    v_sub_f32 v128, v128, v12
    v_sub_f32 v129, v129, v12
    v_sub_f32 v130, v130, v12
    v_sub_f32 v131, v131, v12
    v_sub_f32 v132, v132, v12
    v_sub_f32 v133, v133, v12
    v_sub_f32 v134, v134, v12
    v_sub_f32 v135, v135, v12
    v_sub_f32 v136, v136, v13
    v_sub_f32 v137, v137, v13
    v_sub_f32 v138, v138, v13
    v_sub_f32 v139, v139, v13
    v_sub_f32 v140, v140, v13
    v_sub_f32 v141, v141, v13
    v_sub_f32 v142, v142, v13
    v_sub_f32 v143, v143, v13
    v_mul_f32 v192, v192, v14
    v_mul_f32 v193, v193, v14
    v_mul_f32 v194, v194, v14
    v_mul_f32 v195, v195, v14
    v_mul_f32 v196, v196, v14
    v_mul_f32 v197, v197, v14
    v_mul_f32 v198, v198, v14
    v_mul_f32 v199, v199, v14
    v_mul_f32 v200, v200, v15
    v_mul_f32 v201, v201, v15
    v_mul_f32 v202, v202, v15
    v_mul_f32 v203, v203, v15
    v_mul_f32 v204, v204, v15
    v_mul_f32 v205, v205, v15
    v_mul_f32 v206, v206, v15
    v_mul_f32 v207, v207, v15
    v_mul_f32 v208, v208, v14
    v_mul_f32 v209, v209, v14
    v_mul_f32 v210, v210, v14
    v_mul_f32 v211, v211, v14
    v_mul_f32 v212, v212, v14
    v_mul_f32 v213, v213, v14
    v_mul_f32 v214, v214, v14
    v_mul_f32 v215, v215, v14
    v_mul_f32 v216, v216, v15
    v_mul_f32 v217, v217, v15
    v_mul_f32 v218, v218, v15
    v_mul_f32 v219, v219, v15
    v_mul_f32 v220, v220, v15
    v_mul_f32 v221, v221, v15
    v_mul_f32 v222, v222, v15
    v_mul_f32 v223, v223, v15
    v_mul_f32 v224, v224, v14
    v_mul_f32 v225, v225, v14
    v_mul_f32 v226, v226, v14
    v_mul_f32 v227, v227, v14
    v_mul_f32 v228, v228, v14
    v_mul_f32 v229, v229, v14
    v_mul_f32 v230, v230, v14
    v_mul_f32 v231, v231, v14
    v_mul_f32 v232, v232, v15
    v_mul_f32 v233, v233, v15
    v_mul_f32 v234, v234, v15
    v_mul_f32 v235, v235, v15
    v_mul_f32 v236, v236, v15
    v_mul_f32 v237, v237, v15
    v_mul_f32 v238, v238, v15
    v_mul_f32 v239, v239, v15
    v_mul_f32 v240, v240, v14
    v_mul_f32 v241, v241, v14
    v_mul_f32 v242, v242, v14
    v_mul_f32 v243, v243, v14
    v_mul_f32 v244, v244, v14
    v_mul_f32 v245, v245, v14
    v_mul_f32 v246, v246, v14
    v_mul_f32 v247, v247, v14
    v_mul_f32 v248, v248, v15
    v_mul_f32 v249, v249, v15
    v_mul_f32 v250, v250, v15
    v_mul_f32 v251, v251, v15
    v_mul_f32 v252, v252, v15
    v_mul_f32 v253, v253, v15
    v_mul_f32 v254, v254, v15
    v_mul_f32 v255, v255, v15
    v_mul_f32 v152, v152, v14
    v_mul_f32 v153, v153, v14
    v_mul_f32 v154, v154, v14
    v_mul_f32 v155, v155, v14
    v_mul_f32 v156, v156, v15
    v_mul_f32 v157, v157, v15
    v_mul_f32 v158, v158, v15
    v_mul_f32 v159, v159, v15
    v_exp_f32 v56, v112
    v_exp_f32 v57, v113
    v_exp_f32 v58, v114
    v_cvt_pk_bf16_f32 v96, v56, v57
    v_exp_f32 v59, v115
    v_exp_f32 v56, v116
    v_cvt_pk_bf16_f32 v97, v58, v59
    v_exp_f32 v57, v117
    v_exp_f32 v58, v118
    v_cvt_pk_bf16_f32 v98, v56, v57
    v_exp_f32 v59, v119
    v_or3_b32 v8, v96, v97, v98
    v_exp_f32 v56, v120
    v_cvt_pk_bf16_f32 v99, v58, v59
    v_exp_f32 v57, v121
    v_exp_f32 v58, v122
    v_cvt_pk_bf16_f32 v100, v56, v57
    v_exp_f32 v59, v123
    v_or3_b32 v8, v8, v99, v100
    v_exp_f32 v56, v124
    v_cvt_pk_bf16_f32 v101, v58, v59
    v_exp_f32 v57, v125
    v_exp_f32 v58, v126
    v_cvt_pk_bf16_f32 v102, v56, v57
    v_exp_f32 v59, v127
    v_or3_b32 v8, v8, v101, v102
    v_cvt_pk_bf16_f32 v103, v58, v59
    v_or_b32 v8, v8, v103
    v_and_b32 v8, s42, v8
    s_nop 1
    s_branch BACK_45
RARE_50:
    s_nop 15
    v_max3_f32 v12, v128, v129, v130
    v_max3_f32 v12, v12, v131, v132
    v_max3_f32 v12, v12, v133, v134
    v_max_f32 v12, v12, v135
    v_max3_f32 v13, v136, v137, v138
    v_max3_f32 v13, v13, v139, v140
    v_max3_f32 v13, v13, v141, v142
    v_max_f32 v13, v13, v143
    v_mov_b32 v14, v12
    v_mov_b32 v15, v13
    s_nop 0
    v_permlane16_swap_b32 v14, v12
    v_permlane16_swap_b32 v15, v13
    v_max_f32 v12, v12, v14
    v_max_f32 v13, v13, v15
    v_mov_b32 v14, v12
    v_mov_b32 v15, v13
    s_nop 0
    v_permlane32_swap_b32 v14, v12
    v_permlane32_swap_b32 v15, v13
    v_max_f32 v12, v12, v14
    v_max_f32 v13, v13, v15
    v_add_f32 v12, 0x41300000, v12
    v_max_f32 v12, 0, v12
    v_exp_f32 v14, -v12
    v_add_f32 v13, 0x41300000, v13
    v_max_f32 v13, 0, v13
    v_exp_f32 v15, -v13
    v_sub_f32 v144, v144, v12
    v_sub_f32 v145, v145, v12
    v_sub_f32 v146, v146, v12
    v_sub_f32 v147, v147, v12
    v_sub_f32 v148, v148, v13
    v_sub_f32 v149, v149, v13
    v_sub_f32 v150, v150, v13
    v_sub_f32 v151, v151, v13
    v_sub_f32 v128, v128, v12
    v_sub_f32 v129, v129, v12
    v_sub_f32 v130, v130, v12
    v_sub_f32 v131, v131, v12
    v_sub_f32 v132, v132, v12
    v_sub_f32 v133, v133, v12
    v_sub_f32 v134, v134, v12
    v_sub_f32 v135, v135, v12
    v_sub_f32 v136, v136, v13
    v_sub_f32 v137, v137, v13
    v_sub_f32 v138, v138, v13
    v_sub_f32 v139, v139, v13
    v_sub_f32 v140, v140, v13
    v_sub_f32 v141, v141, v13
    v_sub_f32 v142, v142, v13
    v_sub_f32 v143, v143, v13
    v_sub_f32 v112, v112, v12
    v_sub_f32 v113, v113, v12
    v_sub_f32 v114, v114, v12
    v_sub_f32 v115, v115, v12
    v_sub_f32 v116, v116, v12
    v_sub_f32 v117, v117, v12
    v_sub_f32 v118, v118, v12
    v_sub_f32 v119, v119, v12
    v_sub_f32 v120, v120, v13
    v_sub_f32 v121, v121, v13
    v_sub_f32 v122, v122, v13
    v_sub_f32 v123, v123, v13
    v_sub_f32 v124, v124, v13
    v_sub_f32 v125, v125, v13
    v_sub_f32 v126, v126, v13
    v_sub_f32 v127, v127, v13
    v_mul_f32 v192, v192, v14
    v_mul_f32 v193, v193, v14
    v_mul_f32 v194, v194, v14
    v_mul_f32 v195, v195, v14
    v_mul_f32 v196, v196, v14
    v_mul_f32 v197, v197, v14
    v_mul_f32 v198, v198, v14
    v_mul_f32 v199, v199, v14
    v_mul_f32 v200, v200, v15
    v_mul_f32 v201, v201, v15
    v_mul_f32 v202, v202, v15
    v_mul_f32 v203, v203, v15
    v_mul_f32 v204, v204, v15
    v_mul_f32 v205, v205, v15
    v_mul_f32 v206, v206, v15
    v_mul_f32 v207, v207, v15
    v_mul_f32 v208, v208, v14
    v_mul_f32 v209, v209, v14
    v_mul_f32 v210, v210, v14
    v_mul_f32 v211, v211, v14
    v_mul_f32 v212, v212, v14
    v_mul_f32 v213, v213, v14
    v_mul_f32 v214, v214, v14
    v_mul_f32 v215, v215, v14
    v_mul_f32 v216, v216, v15
    v_mul_f32 v217, v217, v15
    v_mul_f32 v218, v218, v15
    v_mul_f32 v219, v219, v15
    v_mul_f32 v220, v220, v15
    v_mul_f32 v221, v221, v15
    v_mul_f32 v222, v222, v15
    v_mul_f32 v223, v223, v15
    v_mul_f32 v224, v224, v14
    v_mul_f32 v225, v225, v14
    v_mul_f32 v226, v226, v14
    v_mul_f32 v227, v227, v14
    v_mul_f32 v228, v228, v14
    v_mul_f32 v229, v229, v14
    v_mul_f32 v230, v230, v14
    v_mul_f32 v231, v231, v14
    v_mul_f32 v232, v232, v15
    v_mul_f32 v233, v233, v15
    v_mul_f32 v234, v234, v15
    v_mul_f32 v235, v235, v15
    v_mul_f32 v236, v236, v15
    v_mul_f32 v237, v237, v15
    v_mul_f32 v238, v238, v15
    v_mul_f32 v239, v239, v15
    v_mul_f32 v240, v240, v14
    v_mul_f32 v241, v241, v14
    v_mul_f32 v242, v242, v14
    v_mul_f32 v243, v243, v14
    v_mul_f32 v244, v244, v14
    v_mul_f32 v245, v245, v14
    v_mul_f32 v246, v246, v14
    v_mul_f32 v247, v247, v14
    v_mul_f32 v248, v248, v15
    v_mul_f32 v249, v249, v15
    v_mul_f32 v250, v250, v15
    v_mul_f32 v251, v251, v15
    v_mul_f32 v252, v252, v15
    v_mul_f32 v253, v253, v15
    v_mul_f32 v254, v254, v15
    v_mul_f32 v255, v255, v15
    v_mul_f32 v152, v152, v14
    v_mul_f32 v153, v153, v14
    v_mul_f32 v154, v154, v14
    v_mul_f32 v155, v155, v14
    v_mul_f32 v156, v156, v15
    v_mul_f32 v157, v157, v15
    v_mul_f32 v158, v158, v15
    v_mul_f32 v159, v159, v15
    v_exp_f32 v56, v128
    v_exp_f32 v57, v129
    v_exp_f32 v58, v130
    v_cvt_pk_bf16_f32 v104, v56, v57
    v_exp_f32 v59, v131
    v_exp_f32 v56, v132
    v_cvt_pk_bf16_f32 v105, v58, v59
    v_exp_f32 v57, v133
    v_exp_f32 v58, v134
    v_cvt_pk_bf16_f32 v106, v56, v57
    v_exp_f32 v59, v135
    v_or3_b32 v8, v104, v105, v106
    v_exp_f32 v56, v136
    v_cvt_pk_bf16_f32 v107, v58, v59
    v_exp_f32 v57, v137
    v_exp_f32 v58, v138
    v_cvt_pk_bf16_f32 v108, v56, v57
    v_exp_f32 v59, v139
    v_or3_b32 v8, v8, v107, v108
    v_exp_f32 v56, v140
    v_cvt_pk_bf16_f32 v109, v58, v59
    v_exp_f32 v57, v141
    v_exp_f32 v58, v142
    v_cvt_pk_bf16_f32 v110, v56, v57
    v_exp_f32 v59, v143
    v_or3_b32 v8, v8, v109, v110
    v_cvt_pk_bf16_f32 v111, v58, v59
    v_or_b32 v8, v8, v111
    v_and_b32 v8, s42, v8
    s_nop 1
    s_branch BACK_51
RARE_54:
    s_nop 15
    v_max3_f32 v12, v128, v129, v130
    v_max3_f32 v12, v12, v131, v132
    v_max3_f32 v12, v12, v133, v134
    v_max_f32 v12, v12, v135
    v_max3_f32 v13, v136, v137, v138
    v_max3_f32 v13, v13, v139, v140
    v_max3_f32 v13, v13, v141, v142
    v_max_f32 v13, v13, v143
    v_mov_b32 v14, v12
    v_mov_b32 v15, v13
    s_nop 0
    v_permlane16_swap_b32 v14, v12
    v_permlane16_swap_b32 v15, v13
    v_max_f32 v12, v12, v14
    v_max_f32 v13, v13, v15
    v_mov_b32 v14, v12
    v_mov_b32 v15, v13
    s_nop 0
    v_permlane32_swap_b32 v14, v12
    v_permlane32_swap_b32 v15, v13
    v_max_f32 v12, v12, v14
    v_max_f32 v13, v13, v15
    v_add_f32 v12, 0x41300000, v12
    v_max_f32 v12, 0, v12
    v_exp_f32 v14, -v12
    v_add_f32 v13, 0x41300000, v13
    v_max_f32 v13, 0, v13
    v_exp_f32 v15, -v13
    v_sub_f32 v144, v144, v12
    v_sub_f32 v145, v145, v12
    v_sub_f32 v146, v146, v12
    v_sub_f32 v147, v147, v12
    v_sub_f32 v148, v148, v13
    v_sub_f32 v149, v149, v13
    v_sub_f32 v150, v150, v13
    v_sub_f32 v151, v151, v13
    v_sub_f32 v128, v128, v12
    v_sub_f32 v129, v129, v12
    v_sub_f32 v130, v130, v12
    v_sub_f32 v131, v131, v12
    v_sub_f32 v132, v132, v12
    v_sub_f32 v133, v133, v12
    v_sub_f32 v134, v134, v12
    v_sub_f32 v135, v135, v12
    v_sub_f32 v136, v136, v13
    v_sub_f32 v137, v137, v13
    v_sub_f32 v138, v138, v13
    v_sub_f32 v139, v139, v13
    v_sub_f32 v140, v140, v13
    v_sub_f32 v141, v141, v13
    v_sub_f32 v142, v142, v13
    v_sub_f32 v143, v143, v13
    v_sub_f32 v112, v112, v12
    v_sub_f32 v113, v113, v12
    v_sub_f32 v114, v114, v12
    v_sub_f32 v115, v115, v12
    v_sub_f32 v116, v116, v12
    v_sub_f32 v117, v117, v12
    v_sub_f32 v118, v118, v12
    v_sub_f32 v119, v119, v12
    v_sub_f32 v120, v120, v13
    v_sub_f32 v121, v121, v13
    v_sub_f32 v122, v122, v13
    v_sub_f32 v123, v123, v13
    v_sub_f32 v124, v124, v13
    v_sub_f32 v125, v125, v13
    v_sub_f32 v126, v126, v13
    v_sub_f32 v127, v127, v13
    v_mul_f32 v192, v192, v14
    v_mul_f32 v193, v193, v14
    v_mul_f32 v194, v194, v14
    v_mul_f32 v195, v195, v14
    v_mul_f32 v196, v196, v14
    v_mul_f32 v197, v197, v14
    v_mul_f32 v198, v198, v14
    v_mul_f32 v199, v199, v14
    v_mul_f32 v200, v200, v15
    v_mul_f32 v201, v201, v15
    v_mul_f32 v202, v202, v15
    v_mul_f32 v203, v203, v15
    v_mul_f32 v204, v204, v15
    v_mul_f32 v205, v205, v15
    v_mul_f32 v206, v206, v15
    v_mul_f32 v207, v207, v15
    v_mul_f32 v208, v208, v14
    v_mul_f32 v209, v209, v14
    v_mul_f32 v210, v210, v14
    v_mul_f32 v211, v211, v14
    v_mul_f32 v212, v212, v14
    v_mul_f32 v213, v213, v14
    v_mul_f32 v214, v214, v14
    v_mul_f32 v215, v215, v14
    v_mul_f32 v216, v216, v15
    v_mul_f32 v217, v217, v15
    v_mul_f32 v218, v218, v15
    v_mul_f32 v219, v219, v15
    v_mul_f32 v220, v220, v15
    v_mul_f32 v221, v221, v15
    v_mul_f32 v222, v222, v15
    v_mul_f32 v223, v223, v15
    v_mul_f32 v224, v224, v14
    v_mul_f32 v225, v225, v14
    v_mul_f32 v226, v226, v14
    v_mul_f32 v227, v227, v14
    v_mul_f32 v228, v228, v14
    v_mul_f32 v229, v229, v14
    v_mul_f32 v230, v230, v14
    v_mul_f32 v231, v231, v14
    v_mul_f32 v232, v232, v15
    v_mul_f32 v233, v233, v15
    v_mul_f32 v234, v234, v15
    v_mul_f32 v235, v235, v15
    v_mul_f32 v236, v236, v15
    v_mul_f32 v237, v237, v15
    v_mul_f32 v238, v238, v15
    v_mul_f32 v239, v239, v15
    v_mul_f32 v240, v240, v14
    v_mul_f32 v241, v241, v14
    v_mul_f32 v242, v242, v14
    v_mul_f32 v243, v243, v14
    v_mul_f32 v244, v244, v14
    v_mul_f32 v245, v245, v14
    v_mul_f32 v246, v246, v14
    v_mul_f32 v247, v247, v14
    v_mul_f32 v248, v248, v15
    v_mul_f32 v249, v249, v15
    v_mul_f32 v250, v250, v15
    v_mul_f32 v251, v251, v15
    v_mul_f32 v252, v252, v15
    v_mul_f32 v253, v253, v15
    v_mul_f32 v254, v254, v15
    v_mul_f32 v255, v255, v15
    v_mul_f32 v152, v152, v14
    v_mul_f32 v153, v153, v14
    v_mul_f32 v154, v154, v14
    v_mul_f32 v155, v155, v14
    v_mul_f32 v156, v156, v15
    v_mul_f32 v157, v157, v15
    v_mul_f32 v158, v158, v15
    v_mul_f32 v159, v159, v15
    v_exp_f32 v56, v128
    v_exp_f32 v57, v129
    v_exp_f32 v58, v130
    v_cvt_pk_bf16_f32 v104, v56, v57
    v_exp_f32 v59, v131
    v_exp_f32 v56, v132
    v_cvt_pk_bf16_f32 v105, v58, v59
    v_exp_f32 v57, v133
    v_exp_f32 v58, v134
    v_cvt_pk_bf16_f32 v106, v56, v57
    v_exp_f32 v59, v135
    v_or3_b32 v8, v104, v105, v106
    v_exp_f32 v56, v136
    v_cvt_pk_bf16_f32 v107, v58, v59
    v_exp_f32 v57, v137
    v_exp_f32 v58, v138
    v_cvt_pk_bf16_f32 v108, v56, v57
    v_exp_f32 v59, v139
    v_or3_b32 v8, v8, v107, v108
    v_exp_f32 v56, v140
    v_cvt_pk_bf16_f32 v109, v58, v59
    v_exp_f32 v57, v141
    v_exp_f32 v58, v142
    v_cvt_pk_bf16_f32 v110, v56, v57
    v_exp_f32 v59, v143
    v_or3_b32 v8, v8, v109, v110
    v_cvt_pk_bf16_f32 v111, v58, v59
    v_or_b32 v8, v8, v111
    v_and_b32 v8, s42, v8
    s_nop 1
    s_branch BACK_55
RARE_56:
    s_nop 15
    v_max3_f32 v12, v112, v113, v114
    v_max3_f32 v12, v12, v115, v116
    v_max3_f32 v12, v12, v117, v118
    v_max_f32 v12, v12, v119
    v_max3_f32 v13, v120, v121, v122
    v_max3_f32 v13, v13, v123, v124
    v_max3_f32 v13, v13, v125, v126
    v_max_f32 v13, v13, v127
    v_mov_b32 v14, v12
    v_mov_b32 v15, v13
    s_nop 0
    v_permlane16_swap_b32 v14, v12
    v_permlane16_swap_b32 v15, v13
    v_max_f32 v12, v12, v14
    v_max_f32 v13, v13, v15
    v_mov_b32 v14, v12
    v_mov_b32 v15, v13
    s_nop 0
    v_permlane32_swap_b32 v14, v12
    v_permlane32_swap_b32 v15, v13
    v_max_f32 v12, v12, v14
    v_max_f32 v13, v13, v15
    v_add_f32 v12, 0x41300000, v12
    v_max_f32 v12, 0, v12
    v_exp_f32 v14, -v12
    v_add_f32 v13, 0x41300000, v13
    v_max_f32 v13, 0, v13
    v_exp_f32 v15, -v13
    v_sub_f32 v144, v144, v12
    v_sub_f32 v145, v145, v12
    v_sub_f32 v146, v146, v12
    v_sub_f32 v147, v147, v12
    v_sub_f32 v148, v148, v13
    v_sub_f32 v149, v149, v13
    v_sub_f32 v150, v150, v13
    v_sub_f32 v151, v151, v13
    v_sub_f32 v112, v112, v12
    v_sub_f32 v113, v113, v12
    v_sub_f32 v114, v114, v12
    v_sub_f32 v115, v115, v12
    v_sub_f32 v116, v116, v12
    v_sub_f32 v117, v117, v12
    v_sub_f32 v118, v118, v12
    v_sub_f32 v119, v119, v12
    v_sub_f32 v120, v120, v13
    v_sub_f32 v121, v121, v13
    v_sub_f32 v122, v122, v13
    v_sub_f32 v123, v123, v13
    v_sub_f32 v124, v124, v13
    v_sub_f32 v125, v125, v13
    v_sub_f32 v126, v126, v13
    v_sub_f32 v127, v127, v13
    v_sub_f32 v128, v128, v12
    v_sub_f32 v129, v129, v12
    v_sub_f32 v130, v130, v12
    v_sub_f32 v131, v131, v12
    v_sub_f32 v132, v132, v12
    v_sub_f32 v133, v133, v12
    v_sub_f32 v134, v134, v12
    v_sub_f32 v135, v135, v12
    v_sub_f32 v136, v136, v13
    v_sub_f32 v137, v137, v13
    v_sub_f32 v138, v138, v13
    v_sub_f32 v139, v139, v13
    v_sub_f32 v140, v140, v13
    v_sub_f32 v141, v141, v13
    v_sub_f32 v142, v142, v13
    v_sub_f32 v143, v143, v13
    v_mul_f32 v192, v192, v14
    v_mul_f32 v193, v193, v14
    v_mul_f32 v194, v194, v14
    v_mul_f32 v195, v195, v14
    v_mul_f32 v196, v196, v14
    v_mul_f32 v197, v197, v14
    v_mul_f32 v198, v198, v14
    v_mul_f32 v199, v199, v14
    v_mul_f32 v200, v200, v15
    v_mul_f32 v201, v201, v15
    v_mul_f32 v202, v202, v15
    v_mul_f32 v203, v203, v15
    v_mul_f32 v204, v204, v15
    v_mul_f32 v205, v205, v15
    v_mul_f32 v206, v206, v15
    v_mul_f32 v207, v207, v15
    v_mul_f32 v208, v208, v14
    v_mul_f32 v209, v209, v14
    v_mul_f32 v210, v210, v14
    v_mul_f32 v211, v211, v14
    v_mul_f32 v212, v212, v14
    v_mul_f32 v213, v213, v14
    v_mul_f32 v214, v214, v14
    v_mul_f32 v215, v215, v14
    v_mul_f32 v216, v216, v15
    v_mul_f32 v217, v217, v15
    v_mul_f32 v218, v218, v15
    v_mul_f32 v219, v219, v15
    v_mul_f32 v220, v220, v15
    v_mul_f32 v221, v221, v15
    v_mul_f32 v222, v222, v15
    v_mul_f32 v223, v223, v15
    v_mul_f32 v224, v224, v14
    v_mul_f32 v225, v225, v14
    v_mul_f32 v226, v226, v14
    v_mul_f32 v227, v227, v14
    v_mul_f32 v228, v228, v14
    v_mul_f32 v229, v229, v14
    v_mul_f32 v230, v230, v14
    v_mul_f32 v231, v231, v14
    v_mul_f32 v232, v232, v15
    v_mul_f32 v233, v233, v15
    v_mul_f32 v234, v234, v15
    v_mul_f32 v235, v235, v15
    v_mul_f32 v236, v236, v15
    v_mul_f32 v237, v237, v15
    v_mul_f32 v238, v238, v15
    v_mul_f32 v239, v239, v15
    v_mul_f32 v240, v240, v14
    v_mul_f32 v241, v241, v14
    v_mul_f32 v242, v242, v14
    v_mul_f32 v243, v243, v14
    v_mul_f32 v244, v244, v14
    v_mul_f32 v245, v245, v14
    v_mul_f32 v246, v246, v14
    v_mul_f32 v247, v247, v14
    v_mul_f32 v248, v248, v15
    v_mul_f32 v249, v249, v15
    v_mul_f32 v250, v250, v15
    v_mul_f32 v251, v251, v15
    v_mul_f32 v252, v252, v15
    v_mul_f32 v253, v253, v15
    v_mul_f32 v254, v254, v15
    v_mul_f32 v255, v255, v15
    v_mul_f32 v152, v152, v14
    v_mul_f32 v153, v153, v14
    v_mul_f32 v154, v154, v14
    v_mul_f32 v155, v155, v14
    v_mul_f32 v156, v156, v15
    v_mul_f32 v157, v157, v15
    v_mul_f32 v158, v158, v15
    v_mul_f32 v159, v159, v15
    v_exp_f32 v56, v112
    v_exp_f32 v57, v113
    v_exp_f32 v58, v114
    v_cvt_pk_bf16_f32 v96, v56, v57
    v_exp_f32 v59, v115
    v_exp_f32 v56, v116
    v_cvt_pk_bf16_f32 v97, v58, v59
    v_exp_f32 v57, v117
    v_exp_f32 v58, v118
    v_cvt_pk_bf16_f32 v98, v56, v57
    v_exp_f32 v59, v119
    v_or3_b32 v8, v96, v97, v98
    v_exp_f32 v56, v120
    v_cvt_pk_bf16_f32 v99, v58, v59
    v_exp_f32 v57, v121
    v_exp_f32 v58, v122
    v_cvt_pk_bf16_f32 v100, v56, v57
    v_exp_f32 v59, v123
    v_or3_b32 v8, v8, v99, v100
    v_exp_f32 v56, v124
    v_cvt_pk_bf16_f32 v101, v58, v59
    v_exp_f32 v57, v125
    v_exp_f32 v58, v126
    v_cvt_pk_bf16_f32 v102, v56, v57
    v_exp_f32 v59, v127
    v_or3_b32 v8, v8, v101, v102
    v_cvt_pk_bf16_f32 v103, v58, v59
    v_or_b32 v8, v8, v103
    v_and_b32 v8, s42, v8
    s_nop 1
    s_branch BACK_57
RARE_60:
    s_nop 15
    v_max3_f32 v12, v128, v129, v130
    v_max3_f32 v12, v12, v131, v132
    v_max3_f32 v12, v12, v133, v134
    v_max_f32 v12, v12, v135
    v_max3_f32 v13, v136, v137, v138
    v_max3_f32 v13, v13, v139, v140
    v_max3_f32 v13, v13, v141, v142
    v_max_f32 v13, v13, v143
    v_mov_b32 v14, v12
    v_mov_b32 v15, v13
    s_nop 0
    v_permlane16_swap_b32 v14, v12
    v_permlane16_swap_b32 v15, v13
    v_max_f32 v12, v12, v14
    v_max_f32 v13, v13, v15
    v_mov_b32 v14, v12
    v_mov_b32 v15, v13
    s_nop 0
    v_permlane32_swap_b32 v14, v12
    v_permlane32_swap_b32 v15, v13
    v_max_f32 v12, v12, v14
    v_max_f32 v13, v13, v15
    v_add_f32 v12, 0x41300000, v12
    v_max_f32 v12, 0, v12
    v_exp_f32 v14, -v12
    v_add_f32 v13, 0x41300000, v13
    v_max_f32 v13, 0, v13
    v_exp_f32 v15, -v13
    v_sub_f32 v144, v144, v12
    v_sub_f32 v145, v145, v12
    v_sub_f32 v146, v146, v12
    v_sub_f32 v147, v147, v12
    v_sub_f32 v148, v148, v13
    v_sub_f32 v149, v149, v13
    v_sub_f32 v150, v150, v13
    v_sub_f32 v151, v151, v13
    v_sub_f32 v128, v128, v12
    v_sub_f32 v129, v129, v12
    v_sub_f32 v130, v130, v12
    v_sub_f32 v131, v131, v12
    v_sub_f32 v132, v132, v12
    v_sub_f32 v133, v133, v12
    v_sub_f32 v134, v134, v12
    v_sub_f32 v135, v135, v12
    v_sub_f32 v136, v136, v13
    v_sub_f32 v137, v137, v13
    v_sub_f32 v138, v138, v13
    v_sub_f32 v139, v139, v13
    v_sub_f32 v140, v140, v13
    v_sub_f32 v141, v141, v13
    v_sub_f32 v142, v142, v13
    v_sub_f32 v143, v143, v13
    v_mul_f32 v192, v192, v14
    v_mul_f32 v193, v193, v14
    v_mul_f32 v194, v194, v14
    v_mul_f32 v195, v195, v14
    v_mul_f32 v196, v196, v14
    v_mul_f32 v197, v197, v14
    v_mul_f32 v198, v198, v14
    v_mul_f32 v199, v199, v14
    v_mul_f32 v200, v200, v15
    v_mul_f32 v201, v201, v15
    v_mul_f32 v202, v202, v15
    v_mul_f32 v203, v203, v15
    v_mul_f32 v204, v204, v15
    v_mul_f32 v205, v205, v15
    v_mul_f32 v206, v206, v15
    v_mul_f32 v207, v207, v15
    v_mul_f32 v208, v208, v14
    v_mul_f32 v209, v209, v14
    v_mul_f32 v210, v210, v14
    v_mul_f32 v211, v211, v14
    v_mul_f32 v212, v212, v14
    v_mul_f32 v213, v213, v14
    v_mul_f32 v214, v214, v14
    v_mul_f32 v215, v215, v14
    v_mul_f32 v216, v216, v15
    v_mul_f32 v217, v217, v15
    v_mul_f32 v218, v218, v15
    v_mul_f32 v219, v219, v15
    v_mul_f32 v220, v220, v15
    v_mul_f32 v221, v221, v15
    v_mul_f32 v222, v222, v15
    v_mul_f32 v223, v223, v15
    v_mul_f32 v224, v224, v14
    v_mul_f32 v225, v225, v14
    v_mul_f32 v226, v226, v14
    v_mul_f32 v227, v227, v14
    v_mul_f32 v228, v228, v14
    v_mul_f32 v229, v229, v14
    v_mul_f32 v230, v230, v14
    v_mul_f32 v231, v231, v14
    v_mul_f32 v232, v232, v15
    v_mul_f32 v233, v233, v15
    v_mul_f32 v234, v234, v15
    v_mul_f32 v235, v235, v15
    v_mul_f32 v236, v236, v15
    v_mul_f32 v237, v237, v15
    v_mul_f32 v238, v238, v15
    v_mul_f32 v239, v239, v15
    v_mul_f32 v240, v240, v14
    v_mul_f32 v241, v241, v14
    v_mul_f32 v242, v242, v14
    v_mul_f32 v243, v243, v14
    v_mul_f32 v244, v244, v14
    v_mul_f32 v245, v245, v14
    v_mul_f32 v246, v246, v14
    v_mul_f32 v247, v247, v14
    v_mul_f32 v248, v248, v15
    v_mul_f32 v249, v249, v15
    v_mul_f32 v250, v250, v15
    v_mul_f32 v251, v251, v15
    v_mul_f32 v252, v252, v15
    v_mul_f32 v253, v253, v15
    v_mul_f32 v254, v254, v15
    v_mul_f32 v255, v255, v15
    v_mul_f32 v152, v152, v14
    v_mul_f32 v153, v153, v14
    v_mul_f32 v154, v154, v14
    v_mul_f32 v155, v155, v14
    v_mul_f32 v156, v156, v15
    v_mul_f32 v157, v157, v15
    v_mul_f32 v158, v158, v15
    v_mul_f32 v159, v159, v15
    v_exp_f32 v56, v128
    v_exp_f32 v57, v129
    v_exp_f32 v58, v130
    v_cvt_pk_bf16_f32 v104, v56, v57
    v_exp_f32 v59, v131
    v_exp_f32 v56, v132
    v_cvt_pk_bf16_f32 v105, v58, v59
    v_exp_f32 v57, v133
    v_exp_f32 v58, v134
    v_cvt_pk_bf16_f32 v106, v56, v57
    v_exp_f32 v59, v135
    v_or3_b32 v8, v104, v105, v106
    v_exp_f32 v56, v136
    v_cvt_pk_bf16_f32 v107, v58, v59
    v_exp_f32 v57, v137
    v_exp_f32 v58, v138
    v_cvt_pk_bf16_f32 v108, v56, v57
    v_exp_f32 v59, v139
    v_or3_b32 v8, v8, v107, v108
    v_exp_f32 v56, v140
    v_cvt_pk_bf16_f32 v109, v58, v59
    v_exp_f32 v57, v141
    v_exp_f32 v58, v142
    v_cvt_pk_bf16_f32 v110, v56, v57
    v_exp_f32 v59, v143
    v_or3_b32 v8, v8, v109, v110
    v_cvt_pk_bf16_f32 v111, v58, v59
    v_or_b32 v8, v8, v111
    v_and_b32 v8, s42, v8
    s_nop 1
    s_branch BACK_61
RARE_66:
    s_nop 15
    v_max3_f32 v12, v112, v113, v114
    v_max3_f32 v12, v12, v115, v116
    v_max3_f32 v12, v12, v117, v118
    v_max_f32 v12, v12, v119
    v_max3_f32 v13, v120, v121, v122
    v_max3_f32 v13, v13, v123, v124
    v_max3_f32 v13, v13, v125, v126
    v_max_f32 v13, v13, v127
    v_mov_b32 v14, v12
    v_mov_b32 v15, v13
    s_nop 0
    v_permlane16_swap_b32 v14, v12
    v_permlane16_swap_b32 v15, v13
    v_max_f32 v12, v12, v14
    v_max_f32 v13, v13, v15
    v_mov_b32 v14, v12
    v_mov_b32 v15, v13
    s_nop 0
    v_permlane32_swap_b32 v14, v12
    v_permlane32_swap_b32 v15, v13
    v_max_f32 v12, v12, v14
    v_max_f32 v13, v13, v15
    v_add_f32 v12, 0x41300000, v12
    v_max_f32 v12, 0, v12
    v_exp_f32 v14, -v12
    v_add_f32 v13, 0x41300000, v13
    v_max_f32 v13, 0, v13
    v_exp_f32 v15, -v13
    v_sub_f32 v144, v144, v12
    v_sub_f32 v145, v145, v12
    v_sub_f32 v146, v146, v12
    v_sub_f32 v147, v147, v12
    v_sub_f32 v148, v148, v13
    v_sub_f32 v149, v149, v13
    v_sub_f32 v150, v150, v13
    v_sub_f32 v151, v151, v13
    v_sub_f32 v112, v112, v12
    v_sub_f32 v113, v113, v12
    v_sub_f32 v114, v114, v12
    v_sub_f32 v115, v115, v12
    v_sub_f32 v116, v116, v12
    v_sub_f32 v117, v117, v12
    v_sub_f32 v118, v118, v12
    v_sub_f32 v119, v119, v12
    v_sub_f32 v120, v120, v13
    v_sub_f32 v121, v121, v13
    v_sub_f32 v122, v122, v13
    v_sub_f32 v123, v123, v13
    v_sub_f32 v124, v124, v13
    v_sub_f32 v125, v125, v13
    v_sub_f32 v126, v126, v13
    v_sub_f32 v127, v127, v13
    v_sub_f32 v128, v128, v12
    v_sub_f32 v129, v129, v12
    v_sub_f32 v130, v130, v12
    v_sub_f32 v131, v131, v12
    v_sub_f32 v132, v132, v12
    v_sub_f32 v133, v133, v12
    v_sub_f32 v134, v134, v12
    v_sub_f32 v135, v135, v12
    v_sub_f32 v136, v136, v13
    v_sub_f32 v137, v137, v13
    v_sub_f32 v138, v138, v13
    v_sub_f32 v139, v139, v13
    v_sub_f32 v140, v140, v13
    v_sub_f32 v141, v141, v13
    v_sub_f32 v142, v142, v13
    v_sub_f32 v143, v143, v13
    v_mul_f32 v192, v192, v14
    v_mul_f32 v193, v193, v14
    v_mul_f32 v194, v194, v14
    v_mul_f32 v195, v195, v14
    v_mul_f32 v196, v196, v14
    v_mul_f32 v197, v197, v14
    v_mul_f32 v198, v198, v14
    v_mul_f32 v199, v199, v14
    v_mul_f32 v200, v200, v15
    v_mul_f32 v201, v201, v15
    v_mul_f32 v202, v202, v15
    v_mul_f32 v203, v203, v15
    v_mul_f32 v204, v204, v15
    v_mul_f32 v205, v205, v15
    v_mul_f32 v206, v206, v15
    v_mul_f32 v207, v207, v15
    v_mul_f32 v208, v208, v14
    v_mul_f32 v209, v209, v14
    v_mul_f32 v210, v210, v14
    v_mul_f32 v211, v211, v14
    v_mul_f32 v212, v212, v14
    v_mul_f32 v213, v213, v14
    v_mul_f32 v214, v214, v14
    v_mul_f32 v215, v215, v14
    v_mul_f32 v216, v216, v15
    v_mul_f32 v217, v217, v15
    v_mul_f32 v218, v218, v15
    v_mul_f32 v219, v219, v15
    v_mul_f32 v220, v220, v15
    v_mul_f32 v221, v221, v15
    v_mul_f32 v222, v222, v15
    v_mul_f32 v223, v223, v15
    v_mul_f32 v224, v224, v14
    v_mul_f32 v225, v225, v14
    v_mul_f32 v226, v226, v14
    v_mul_f32 v227, v227, v14
    v_mul_f32 v228, v228, v14
    v_mul_f32 v229, v229, v14
    v_mul_f32 v230, v230, v14
    v_mul_f32 v231, v231, v14
    v_mul_f32 v232, v232, v15
    v_mul_f32 v233, v233, v15
    v_mul_f32 v234, v234, v15
    v_mul_f32 v235, v235, v15
    v_mul_f32 v236, v236, v15
    v_mul_f32 v237, v237, v15
    v_mul_f32 v238, v238, v15
    v_mul_f32 v239, v239, v15
    v_mul_f32 v240, v240, v14
    v_mul_f32 v241, v241, v14
    v_mul_f32 v242, v242, v14
    v_mul_f32 v243, v243, v14
    v_mul_f32 v244, v244, v14
    v_mul_f32 v245, v245, v14
    v_mul_f32 v246, v246, v14
    v_mul_f32 v247, v247, v14
    v_mul_f32 v248, v248, v15
    v_mul_f32 v249, v249, v15
    v_mul_f32 v250, v250, v15
    v_mul_f32 v251, v251, v15
    v_mul_f32 v252, v252, v15
    v_mul_f32 v253, v253, v15
    v_mul_f32 v254, v254, v15
    v_mul_f32 v255, v255, v15
    v_mul_f32 v152, v152, v14
    v_mul_f32 v153, v153, v14
    v_mul_f32 v154, v154, v14
    v_mul_f32 v155, v155, v14
    v_mul_f32 v156, v156, v15
    v_mul_f32 v157, v157, v15
    v_mul_f32 v158, v158, v15
    v_mul_f32 v159, v159, v15
    v_exp_f32 v56, v112
    v_exp_f32 v57, v113
    v_exp_f32 v58, v114
    v_cvt_pk_bf16_f32 v96, v56, v57
    v_exp_f32 v59, v115
    v_exp_f32 v56, v116
    v_cvt_pk_bf16_f32 v97, v58, v59
    v_exp_f32 v57, v117
    v_exp_f32 v58, v118
    v_cvt_pk_bf16_f32 v98, v56, v57
    v_exp_f32 v59, v119
    v_or3_b32 v8, v96, v97, v98
    v_exp_f32 v56, v120
    v_cvt_pk_bf16_f32 v99, v58, v59
    v_exp_f32 v57, v121
    v_exp_f32 v58, v122
    v_cvt_pk_bf16_f32 v100, v56, v57
    v_exp_f32 v59, v123
    v_or3_b32 v8, v8, v99, v100
    v_exp_f32 v56, v124
    v_cvt_pk_bf16_f32 v101, v58, v59
    v_exp_f32 v57, v125
    v_exp_f32 v58, v126
    v_cvt_pk_bf16_f32 v102, v56, v57
    v_exp_f32 v59, v127
    v_or3_b32 v8, v8, v101, v102
    v_cvt_pk_bf16_f32 v103, v58, v59
    v_or_b32 v8, v8, v103
    v_and_b32 v8, s42, v8
    s_nop 1
    s_branch BACK_67
RARE_72:
    s_nop 15
    v_max3_f32 v12, v128, v129, v130
    v_max3_f32 v12, v12, v131, v132
    v_max3_f32 v12, v12, v133, v134
    v_max_f32 v12, v12, v135
    v_max3_f32 v13, v136, v137, v138
    v_max3_f32 v13, v13, v139, v140
    v_max3_f32 v13, v13, v141, v142
    v_max_f32 v13, v13, v143
    v_mov_b32 v14, v12
    v_mov_b32 v15, v13
    s_nop 0
    v_permlane16_swap_b32 v14, v12
    v_permlane16_swap_b32 v15, v13
    v_max_f32 v12, v12, v14
    v_max_f32 v13, v13, v15
    v_mov_b32 v14, v12
    v_mov_b32 v15, v13
    s_nop 0
    v_permlane32_swap_b32 v14, v12
    v_permlane32_swap_b32 v15, v13
    v_max_f32 v12, v12, v14
    v_max_f32 v13, v13, v15
    v_add_f32 v12, 0x41300000, v12
    v_max_f32 v12, 0, v12
    v_exp_f32 v14, -v12
    v_add_f32 v13, 0x41300000, v13
    v_max_f32 v13, 0, v13
    v_exp_f32 v15, -v13
    v_sub_f32 v144, v144, v12
    v_sub_f32 v145, v145, v12
    v_sub_f32 v146, v146, v12
    v_sub_f32 v147, v147, v12
    v_sub_f32 v148, v148, v13
    v_sub_f32 v149, v149, v13
    v_sub_f32 v150, v150, v13
    v_sub_f32 v151, v151, v13
    v_sub_f32 v128, v128, v12
    v_sub_f32 v129, v129, v12
    v_sub_f32 v130, v130, v12
    v_sub_f32 v131, v131, v12
    v_sub_f32 v132, v132, v12
    v_sub_f32 v133, v133, v12
    v_sub_f32 v134, v134, v12
    v_sub_f32 v135, v135, v12
    v_sub_f32 v136, v136, v13
    v_sub_f32 v137, v137, v13
    v_sub_f32 v138, v138, v13
    v_sub_f32 v139, v139, v13
    v_sub_f32 v140, v140, v13
    v_sub_f32 v141, v141, v13
    v_sub_f32 v142, v142, v13
    v_sub_f32 v143, v143, v13
    v_sub_f32 v112, v112, v12
    v_sub_f32 v113, v113, v12
    v_sub_f32 v114, v114, v12
    v_sub_f32 v115, v115, v12
    v_sub_f32 v116, v116, v12
    v_sub_f32 v117, v117, v12
    v_sub_f32 v118, v118, v12
    v_sub_f32 v119, v119, v12
    v_sub_f32 v120, v120, v13
    v_sub_f32 v121, v121, v13
    v_sub_f32 v122, v122, v13
    v_sub_f32 v123, v123, v13
    v_sub_f32 v124, v124, v13
    v_sub_f32 v125, v125, v13
    v_sub_f32 v126, v126, v13
    v_sub_f32 v127, v127, v13
    v_mul_f32 v192, v192, v14
    v_mul_f32 v193, v193, v14
    v_mul_f32 v194, v194, v14
    v_mul_f32 v195, v195, v14
    v_mul_f32 v196, v196, v14
    v_mul_f32 v197, v197, v14
    v_mul_f32 v198, v198, v14
    v_mul_f32 v199, v199, v14
    v_mul_f32 v200, v200, v15
    v_mul_f32 v201, v201, v15
    v_mul_f32 v202, v202, v15
    v_mul_f32 v203, v203, v15
    v_mul_f32 v204, v204, v15
    v_mul_f32 v205, v205, v15
    v_mul_f32 v206, v206, v15
    v_mul_f32 v207, v207, v15
    v_mul_f32 v208, v208, v14
    v_mul_f32 v209, v209, v14
    v_mul_f32 v210, v210, v14
    v_mul_f32 v211, v211, v14
    v_mul_f32 v212, v212, v14
    v_mul_f32 v213, v213, v14
    v_mul_f32 v214, v214, v14
    v_mul_f32 v215, v215, v14
    v_mul_f32 v216, v216, v15
    v_mul_f32 v217, v217, v15
    v_mul_f32 v218, v218, v15
    v_mul_f32 v219, v219, v15
    v_mul_f32 v220, v220, v15
    v_mul_f32 v221, v221, v15
    v_mul_f32 v222, v222, v15
    v_mul_f32 v223, v223, v15
    v_mul_f32 v224, v224, v14
    v_mul_f32 v225, v225, v14
    v_mul_f32 v226, v226, v14
    v_mul_f32 v227, v227, v14
    v_mul_f32 v228, v228, v14
    v_mul_f32 v229, v229, v14
    v_mul_f32 v230, v230, v14
    v_mul_f32 v231, v231, v14
    v_mul_f32 v232, v232, v15
    v_mul_f32 v233, v233, v15
    v_mul_f32 v234, v234, v15
    v_mul_f32 v235, v235, v15
    v_mul_f32 v236, v236, v15
    v_mul_f32 v237, v237, v15
    v_mul_f32 v238, v238, v15
    v_mul_f32 v239, v239, v15
    v_mul_f32 v240, v240, v14
    v_mul_f32 v241, v241, v14
    v_mul_f32 v242, v242, v14
    v_mul_f32 v243, v243, v14
    v_mul_f32 v244, v244, v14
    v_mul_f32 v245, v245, v14
    v_mul_f32 v246, v246, v14
    v_mul_f32 v247, v247, v14
    v_mul_f32 v248, v248, v15
    v_mul_f32 v249, v249, v15
    v_mul_f32 v250, v250, v15
    v_mul_f32 v251, v251, v15
    v_mul_f32 v252, v252, v15
    v_mul_f32 v253, v253, v15
    v_mul_f32 v254, v254, v15
    v_mul_f32 v255, v255, v15
    v_mul_f32 v152, v152, v14
    v_mul_f32 v153, v153, v14
    v_mul_f32 v154, v154, v14
    v_mul_f32 v155, v155, v14
    v_mul_f32 v156, v156, v15
    v_mul_f32 v157, v157, v15
    v_mul_f32 v158, v158, v15
    v_mul_f32 v159, v159, v15
    v_exp_f32 v56, v128
    v_exp_f32 v57, v129
    v_exp_f32 v58, v130
    v_cvt_pk_bf16_f32 v104, v56, v57
    v_exp_f32 v59, v131
    v_exp_f32 v56, v132
    v_cvt_pk_bf16_f32 v105, v58, v59
    v_exp_f32 v57, v133
    v_exp_f32 v58, v134
    v_cvt_pk_bf16_f32 v106, v56, v57
    v_exp_f32 v59, v135
    v_or3_b32 v8, v104, v105, v106
    v_exp_f32 v56, v136
    v_cvt_pk_bf16_f32 v107, v58, v59
    v_exp_f32 v57, v137
    v_exp_f32 v58, v138
    v_cvt_pk_bf16_f32 v108, v56, v57
    v_exp_f32 v59, v139
    v_or3_b32 v8, v8, v107, v108
    v_exp_f32 v56, v140
    v_cvt_pk_bf16_f32 v109, v58, v59
    v_exp_f32 v57, v141
    v_exp_f32 v58, v142
    v_cvt_pk_bf16_f32 v110, v56, v57
    v_exp_f32 v59, v143
    v_or3_b32 v8, v8, v109, v110
    v_cvt_pk_bf16_f32 v111, v58, v59
    v_or_b32 v8, v8, v111
    v_and_b32 v8, s42, v8
    s_nop 1
    s_branch BACK_73
RARE_78:
    s_nop 15
    v_max3_f32 v12, v112, v113, v114
    v_max3_f32 v12, v12, v115, v116
    v_max3_f32 v12, v12, v117, v118
    v_max_f32 v12, v12, v119
    v_max3_f32 v13, v120, v121, v122
    v_max3_f32 v13, v13, v123, v124
    v_max3_f32 v13, v13, v125, v126
    v_max_f32 v13, v13, v127
    v_mov_b32 v14, v12
    v_mov_b32 v15, v13
    s_nop 0
    v_permlane16_swap_b32 v14, v12
    v_permlane16_swap_b32 v15, v13
    v_max_f32 v12, v12, v14
    v_max_f32 v13, v13, v15
    v_mov_b32 v14, v12
    v_mov_b32 v15, v13
    s_nop 0
    v_permlane32_swap_b32 v14, v12
    v_permlane32_swap_b32 v15, v13
    v_max_f32 v12, v12, v14
    v_max_f32 v13, v13, v15
    v_add_f32 v12, 0x41300000, v12
    v_max_f32 v12, 0, v12
    v_exp_f32 v14, -v12
    v_add_f32 v13, 0x41300000, v13
    v_max_f32 v13, 0, v13
    v_exp_f32 v15, -v13
    v_sub_f32 v144, v144, v12
    v_sub_f32 v145, v145, v12
    v_sub_f32 v146, v146, v12
    v_sub_f32 v147, v147, v12
    v_sub_f32 v148, v148, v13
    v_sub_f32 v149, v149, v13
    v_sub_f32 v150, v150, v13
    v_sub_f32 v151, v151, v13
    v_sub_f32 v112, v112, v12
    v_sub_f32 v113, v113, v12
    v_sub_f32 v114, v114, v12
    v_sub_f32 v115, v115, v12
    v_sub_f32 v116, v116, v12
    v_sub_f32 v117, v117, v12
    v_sub_f32 v118, v118, v12
    v_sub_f32 v119, v119, v12
    v_sub_f32 v120, v120, v13
    v_sub_f32 v121, v121, v13
    v_sub_f32 v122, v122, v13
    v_sub_f32 v123, v123, v13
    v_sub_f32 v124, v124, v13
    v_sub_f32 v125, v125, v13
    v_sub_f32 v126, v126, v13
    v_sub_f32 v127, v127, v13
    v_sub_f32 v128, v128, v12
    v_sub_f32 v129, v129, v12
    v_sub_f32 v130, v130, v12
    v_sub_f32 v131, v131, v12
    v_sub_f32 v132, v132, v12
    v_sub_f32 v133, v133, v12
    v_sub_f32 v134, v134, v12
    v_sub_f32 v135, v135, v12
    v_sub_f32 v136, v136, v13
    v_sub_f32 v137, v137, v13
    v_sub_f32 v138, v138, v13
    v_sub_f32 v139, v139, v13
    v_sub_f32 v140, v140, v13
    v_sub_f32 v141, v141, v13
    v_sub_f32 v142, v142, v13
    v_sub_f32 v143, v143, v13
    v_mul_f32 v192, v192, v14
    v_mul_f32 v193, v193, v14
    v_mul_f32 v194, v194, v14
    v_mul_f32 v195, v195, v14
    v_mul_f32 v196, v196, v14
    v_mul_f32 v197, v197, v14
    v_mul_f32 v198, v198, v14
    v_mul_f32 v199, v199, v14
    v_mul_f32 v200, v200, v15
    v_mul_f32 v201, v201, v15
    v_mul_f32 v202, v202, v15
    v_mul_f32 v203, v203, v15
    v_mul_f32 v204, v204, v15
    v_mul_f32 v205, v205, v15
    v_mul_f32 v206, v206, v15
    v_mul_f32 v207, v207, v15
    v_mul_f32 v208, v208, v14
    v_mul_f32 v209, v209, v14
    v_mul_f32 v210, v210, v14
    v_mul_f32 v211, v211, v14
    v_mul_f32 v212, v212, v14
    v_mul_f32 v213, v213, v14
    v_mul_f32 v214, v214, v14
    v_mul_f32 v215, v215, v14
    v_mul_f32 v216, v216, v15
    v_mul_f32 v217, v217, v15
    v_mul_f32 v218, v218, v15
    v_mul_f32 v219, v219, v15
    v_mul_f32 v220, v220, v15
    v_mul_f32 v221, v221, v15
    v_mul_f32 v222, v222, v15
    v_mul_f32 v223, v223, v15
    v_mul_f32 v224, v224, v14
    v_mul_f32 v225, v225, v14
    v_mul_f32 v226, v226, v14
    v_mul_f32 v227, v227, v14
    v_mul_f32 v228, v228, v14
    v_mul_f32 v229, v229, v14
    v_mul_f32 v230, v230, v14
    v_mul_f32 v231, v231, v14
    v_mul_f32 v232, v232, v15
    v_mul_f32 v233, v233, v15
    v_mul_f32 v234, v234, v15
    v_mul_f32 v235, v235, v15
    v_mul_f32 v236, v236, v15
    v_mul_f32 v237, v237, v15
    v_mul_f32 v238, v238, v15
    v_mul_f32 v239, v239, v15
    v_mul_f32 v240, v240, v14
    v_mul_f32 v241, v241, v14
    v_mul_f32 v242, v242, v14
    v_mul_f32 v243, v243, v14
    v_mul_f32 v244, v244, v14
    v_mul_f32 v245, v245, v14
    v_mul_f32 v246, v246, v14
    v_mul_f32 v247, v247, v14
    v_mul_f32 v248, v248, v15
    v_mul_f32 v249, v249, v15
    v_mul_f32 v250, v250, v15
    v_mul_f32 v251, v251, v15
    v_mul_f32 v252, v252, v15
    v_mul_f32 v253, v253, v15
    v_mul_f32 v254, v254, v15
    v_mul_f32 v255, v255, v15
    v_mul_f32 v152, v152, v14
    v_mul_f32 v153, v153, v14
    v_mul_f32 v154, v154, v14
    v_mul_f32 v155, v155, v14
    v_mul_f32 v156, v156, v15
    v_mul_f32 v157, v157, v15
    v_mul_f32 v158, v158, v15
    v_mul_f32 v159, v159, v15
    v_exp_f32 v56, v112
    v_exp_f32 v57, v113
    v_exp_f32 v58, v114
    v_cvt_pk_bf16_f32 v96, v56, v57
    v_exp_f32 v59, v115
    v_exp_f32 v56, v116
    v_cvt_pk_bf16_f32 v97, v58, v59
    v_exp_f32 v57, v117
    v_exp_f32 v58, v118
    v_cvt_pk_bf16_f32 v98, v56, v57
    v_exp_f32 v59, v119
    v_or3_b32 v8, v96, v97, v98
    v_exp_f32 v56, v120
    v_cvt_pk_bf16_f32 v99, v58, v59
    v_exp_f32 v57, v121
    v_exp_f32 v58, v122
    v_cvt_pk_bf16_f32 v100, v56, v57
    v_exp_f32 v59, v123
    v_or3_b32 v8, v8, v99, v100
    v_exp_f32 v56, v124
    v_cvt_pk_bf16_f32 v101, v58, v59
    v_exp_f32 v57, v125
    v_exp_f32 v58, v126
    v_cvt_pk_bf16_f32 v102, v56, v57
    v_exp_f32 v59, v127
    v_or3_b32 v8, v8, v101, v102
    v_cvt_pk_bf16_f32 v103, v58, v59
    v_or_b32 v8, v8, v103
    v_and_b32 v8, s42, v8
    s_nop 1
    s_branch BACK_79
RARE_80:
    s_nop 15
    v_max3_f32 v12, v128, v129, v130
    v_max3_f32 v12, v12, v131, v132
    v_max3_f32 v12, v12, v133, v134
    v_max_f32 v12, v12, v135
    v_max3_f32 v13, v136, v137, v138
    v_max3_f32 v13, v13, v139, v140
    v_max3_f32 v13, v13, v141, v142
    v_max_f32 v13, v13, v143
    v_mov_b32 v14, v12
    v_mov_b32 v15, v13
    s_nop 0
    v_permlane16_swap_b32 v14, v12
    v_permlane16_swap_b32 v15, v13
    v_max_f32 v12, v12, v14
    v_max_f32 v13, v13, v15
    v_mov_b32 v14, v12
    v_mov_b32 v15, v13
    s_nop 0
    v_permlane32_swap_b32 v14, v12
    v_permlane32_swap_b32 v15, v13
    v_max_f32 v12, v12, v14
    v_max_f32 v13, v13, v15
    v_add_f32 v12, 0x41300000, v12
    v_max_f32 v12, 0, v12
    v_exp_f32 v14, -v12
    v_add_f32 v13, 0x41300000, v13
    v_max_f32 v13, 0, v13
    v_exp_f32 v15, -v13
    v_sub_f32 v144, v144, v12
    v_sub_f32 v145, v145, v12
    v_sub_f32 v146, v146, v12
    v_sub_f32 v147, v147, v12
    v_sub_f32 v148, v148, v13
    v_sub_f32 v149, v149, v13
    v_sub_f32 v150, v150, v13
    v_sub_f32 v151, v151, v13
    v_sub_f32 v128, v128, v12
    v_sub_f32 v129, v129, v12
    v_sub_f32 v130, v130, v12
    v_sub_f32 v131, v131, v12
    v_sub_f32 v132, v132, v12
    v_sub_f32 v133, v133, v12
    v_sub_f32 v134, v134, v12
    v_sub_f32 v135, v135, v12
    v_sub_f32 v136, v136, v13
    v_sub_f32 v137, v137, v13
    v_sub_f32 v138, v138, v13
    v_sub_f32 v139, v139, v13
    v_sub_f32 v140, v140, v13
    v_sub_f32 v141, v141, v13
    v_sub_f32 v142, v142, v13
    v_sub_f32 v143, v143, v13
    v_sub_f32 v112, v112, v12
    v_sub_f32 v113, v113, v12
    v_sub_f32 v114, v114, v12
    v_sub_f32 v115, v115, v12
    v_sub_f32 v116, v116, v12
    v_sub_f32 v117, v117, v12
    v_sub_f32 v118, v118, v12
    v_sub_f32 v119, v119, v12
    v_sub_f32 v120, v120, v13
    v_sub_f32 v121, v121, v13
    v_sub_f32 v122, v122, v13
    v_sub_f32 v123, v123, v13
    v_sub_f32 v124, v124, v13
    v_sub_f32 v125, v125, v13
    v_sub_f32 v126, v126, v13
    v_sub_f32 v127, v127, v13
    v_mul_f32 v192, v192, v14
    v_mul_f32 v193, v193, v14
    v_mul_f32 v194, v194, v14
    v_mul_f32 v195, v195, v14
    v_mul_f32 v196, v196, v14
    v_mul_f32 v197, v197, v14
    v_mul_f32 v198, v198, v14
    v_mul_f32 v199, v199, v14
    v_mul_f32 v200, v200, v15
    v_mul_f32 v201, v201, v15
    v_mul_f32 v202, v202, v15
    v_mul_f32 v203, v203, v15
    v_mul_f32 v204, v204, v15
    v_mul_f32 v205, v205, v15
    v_mul_f32 v206, v206, v15
    v_mul_f32 v207, v207, v15
    v_mul_f32 v208, v208, v14
    v_mul_f32 v209, v209, v14
    v_mul_f32 v210, v210, v14
    v_mul_f32 v211, v211, v14
    v_mul_f32 v212, v212, v14
    v_mul_f32 v213, v213, v14
    v_mul_f32 v214, v214, v14
    v_mul_f32 v215, v215, v14
    v_mul_f32 v216, v216, v15
    v_mul_f32 v217, v217, v15
    v_mul_f32 v218, v218, v15
    v_mul_f32 v219, v219, v15
    v_mul_f32 v220, v220, v15
    v_mul_f32 v221, v221, v15
    v_mul_f32 v222, v222, v15
    v_mul_f32 v223, v223, v15
    v_mul_f32 v224, v224, v14
    v_mul_f32 v225, v225, v14
    v_mul_f32 v226, v226, v14
    v_mul_f32 v227, v227, v14
    v_mul_f32 v228, v228, v14
    v_mul_f32 v229, v229, v14
    v_mul_f32 v230, v230, v14
    v_mul_f32 v231, v231, v14
    v_mul_f32 v232, v232, v15
    v_mul_f32 v233, v233, v15
    v_mul_f32 v234, v234, v15
    v_mul_f32 v235, v235, v15
    v_mul_f32 v236, v236, v15
    v_mul_f32 v237, v237, v15
    v_mul_f32 v238, v238, v15
    v_mul_f32 v239, v239, v15
    v_mul_f32 v240, v240, v14
    v_mul_f32 v241, v241, v14
    v_mul_f32 v242, v242, v14
    v_mul_f32 v243, v243, v14
    v_mul_f32 v244, v244, v14
    v_mul_f32 v245, v245, v14
    v_mul_f32 v246, v246, v14
    v_mul_f32 v247, v247, v14
    v_mul_f32 v248, v248, v15
    v_mul_f32 v249, v249, v15
    v_mul_f32 v250, v250, v15
    v_mul_f32 v251, v251, v15
    v_mul_f32 v252, v252, v15
    v_mul_f32 v253, v253, v15
    v_mul_f32 v254, v254, v15
    v_mul_f32 v255, v255, v15
    v_mul_f32 v152, v152, v14
    v_mul_f32 v153, v153, v14
    v_mul_f32 v154, v154, v14
    v_mul_f32 v155, v155, v14
    v_mul_f32 v156, v156, v15
    v_mul_f32 v157, v157, v15
    v_mul_f32 v158, v158, v15
    v_mul_f32 v159, v159, v15
    v_exp_f32 v56, v128
    v_exp_f32 v57, v129
    v_exp_f32 v58, v130
    v_cvt_pk_bf16_f32 v104, v56, v57
    v_exp_f32 v59, v131
    v_exp_f32 v56, v132
    v_cvt_pk_bf16_f32 v105, v58, v59
    v_exp_f32 v57, v133
    v_exp_f32 v58, v134
    v_cvt_pk_bf16_f32 v106, v56, v57
    v_exp_f32 v59, v135
    v_or3_b32 v8, v104, v105, v106
    v_exp_f32 v56, v136
    v_cvt_pk_bf16_f32 v107, v58, v59
    v_exp_f32 v57, v137
    v_exp_f32 v58, v138
    v_cvt_pk_bf16_f32 v108, v56, v57
    v_exp_f32 v59, v139
    v_or3_b32 v8, v8, v107, v108
    v_exp_f32 v56, v140
    v_cvt_pk_bf16_f32 v109, v58, v59
    v_exp_f32 v57, v141
    v_exp_f32 v58, v142
    v_cvt_pk_bf16_f32 v110, v56, v57
    v_exp_f32 v59, v143
    v_or3_b32 v8, v8, v109, v110
    v_cvt_pk_bf16_f32 v111, v58, v59
    v_or_b32 v8, v8, v111
    v_and_b32 v8, s42, v8
    s_nop 1
    s_branch BACK_81
RARE_84:
    s_nop 15
    v_max3_f32 v12, v112, v113, v114
    v_max3_f32 v12, v12, v115, v116
    v_max3_f32 v12, v12, v117, v118
    v_max_f32 v12, v12, v119
    v_max3_f32 v13, v120, v121, v122
    v_max3_f32 v13, v13, v123, v124
    v_max3_f32 v13, v13, v125, v126
    v_max_f32 v13, v13, v127
    v_mov_b32 v14, v12
    v_mov_b32 v15, v13
    s_nop 0
    v_permlane16_swap_b32 v14, v12
    v_permlane16_swap_b32 v15, v13
    v_max_f32 v12, v12, v14
    v_max_f32 v13, v13, v15
    v_mov_b32 v14, v12
    v_mov_b32 v15, v13
    s_nop 0
    v_permlane32_swap_b32 v14, v12
    v_permlane32_swap_b32 v15, v13
    v_max_f32 v12, v12, v14
    v_max_f32 v13, v13, v15
    v_add_f32 v12, 0x41300000, v12
    v_max_f32 v12, 0, v12
    v_exp_f32 v14, -v12
    v_add_f32 v13, 0x41300000, v13
    v_max_f32 v13, 0, v13
    v_exp_f32 v15, -v13
    v_sub_f32 v144, v144, v12
    v_sub_f32 v145, v145, v12
    v_sub_f32 v146, v146, v12
    v_sub_f32 v147, v147, v12
    v_sub_f32 v148, v148, v13
    v_sub_f32 v149, v149, v13
    v_sub_f32 v150, v150, v13
    v_sub_f32 v151, v151, v13
    v_sub_f32 v112, v112, v12
    v_sub_f32 v113, v113, v12
    v_sub_f32 v114, v114, v12
    v_sub_f32 v115, v115, v12
    v_sub_f32 v116, v116, v12
    v_sub_f32 v117, v117, v12
    v_sub_f32 v118, v118, v12
    v_sub_f32 v119, v119, v12
    v_sub_f32 v120, v120, v13
    v_sub_f32 v121, v121, v13
    v_sub_f32 v122, v122, v13
    v_sub_f32 v123, v123, v13
    v_sub_f32 v124, v124, v13
    v_sub_f32 v125, v125, v13
    v_sub_f32 v126, v126, v13
    v_sub_f32 v127, v127, v13
    v_sub_f32 v128, v128, v12
    v_sub_f32 v129, v129, v12
    v_sub_f32 v130, v130, v12
    v_sub_f32 v131, v131, v12
    v_sub_f32 v132, v132, v12
    v_sub_f32 v133, v133, v12
    v_sub_f32 v134, v134, v12
    v_sub_f32 v135, v135, v12
    v_sub_f32 v136, v136, v13
    v_sub_f32 v137, v137, v13
    v_sub_f32 v138, v138, v13
    v_sub_f32 v139, v139, v13
    v_sub_f32 v140, v140, v13
    v_sub_f32 v141, v141, v13
    v_sub_f32 v142, v142, v13
    v_sub_f32 v143, v143, v13
    v_mul_f32 v192, v192, v14
    v_mul_f32 v193, v193, v14
    v_mul_f32 v194, v194, v14
    v_mul_f32 v195, v195, v14
    v_mul_f32 v196, v196, v14
    v_mul_f32 v197, v197, v14
    v_mul_f32 v198, v198, v14
    v_mul_f32 v199, v199, v14
    v_mul_f32 v200, v200, v15
    v_mul_f32 v201, v201, v15
    v_mul_f32 v202, v202, v15
    v_mul_f32 v203, v203, v15
    v_mul_f32 v204, v204, v15
    v_mul_f32 v205, v205, v15
    v_mul_f32 v206, v206, v15
    v_mul_f32 v207, v207, v15
    v_mul_f32 v208, v208, v14
    v_mul_f32 v209, v209, v14
    v_mul_f32 v210, v210, v14
    v_mul_f32 v211, v211, v14
    v_mul_f32 v212, v212, v14
    v_mul_f32 v213, v213, v14
    v_mul_f32 v214, v214, v14
    v_mul_f32 v215, v215, v14
    v_mul_f32 v216, v216, v15
    v_mul_f32 v217, v217, v15
    v_mul_f32 v218, v218, v15
    v_mul_f32 v219, v219, v15
    v_mul_f32 v220, v220, v15
    v_mul_f32 v221, v221, v15
    v_mul_f32 v222, v222, v15
    v_mul_f32 v223, v223, v15
    v_mul_f32 v224, v224, v14
    v_mul_f32 v225, v225, v14
    v_mul_f32 v226, v226, v14
    v_mul_f32 v227, v227, v14
    v_mul_f32 v228, v228, v14
    v_mul_f32 v229, v229, v14
    v_mul_f32 v230, v230, v14
    v_mul_f32 v231, v231, v14
    v_mul_f32 v232, v232, v15
    v_mul_f32 v233, v233, v15
    v_mul_f32 v234, v234, v15
    v_mul_f32 v235, v235, v15
    v_mul_f32 v236, v236, v15
    v_mul_f32 v237, v237, v15
    v_mul_f32 v238, v238, v15
    v_mul_f32 v239, v239, v15
    v_mul_f32 v240, v240, v14
    v_mul_f32 v241, v241, v14
    v_mul_f32 v242, v242, v14
    v_mul_f32 v243, v243, v14
    v_mul_f32 v244, v244, v14
    v_mul_f32 v245, v245, v14
    v_mul_f32 v246, v246, v14
    v_mul_f32 v247, v247, v14
    v_mul_f32 v248, v248, v15
    v_mul_f32 v249, v249, v15
    v_mul_f32 v250, v250, v15
    v_mul_f32 v251, v251, v15
    v_mul_f32 v252, v252, v15
    v_mul_f32 v253, v253, v15
    v_mul_f32 v254, v254, v15
    v_mul_f32 v255, v255, v15
    v_mul_f32 v152, v152, v14
    v_mul_f32 v153, v153, v14
    v_mul_f32 v154, v154, v14
    v_mul_f32 v155, v155, v14
    v_mul_f32 v156, v156, v15
    v_mul_f32 v157, v157, v15
    v_mul_f32 v158, v158, v15
    v_mul_f32 v159, v159, v15
    v_exp_f32 v56, v112
    v_exp_f32 v57, v113
    v_exp_f32 v58, v114
    v_cvt_pk_bf16_f32 v96, v56, v57
    v_exp_f32 v59, v115
    v_exp_f32 v56, v116
    v_cvt_pk_bf16_f32 v97, v58, v59
    v_exp_f32 v57, v117
    v_exp_f32 v58, v118
    v_cvt_pk_bf16_f32 v98, v56, v57
    v_exp_f32 v59, v119
    v_or3_b32 v8, v96, v97, v98
    v_exp_f32 v56, v120
    v_cvt_pk_bf16_f32 v99, v58, v59
    v_exp_f32 v57, v121
    v_exp_f32 v58, v122
    v_cvt_pk_bf16_f32 v100, v56, v57
    v_exp_f32 v59, v123
    v_or3_b32 v8, v8, v99, v100
    v_exp_f32 v56, v124
    v_cvt_pk_bf16_f32 v101, v58, v59
    v_exp_f32 v57, v125
    v_exp_f32 v58, v126
    v_cvt_pk_bf16_f32 v102, v56, v57
    v_exp_f32 v59, v127
    v_or3_b32 v8, v8, v101, v102
    v_cvt_pk_bf16_f32 v103, v58, v59
    v_or_b32 v8, v8, v103
    v_and_b32 v8, s42, v8
    s_nop 1
    s_branch BACK_85
RARE_86:
    s_nop 15
    v_max3_f32 v12, v128, v129, v130
    v_max3_f32 v12, v12, v131, v132
    v_max3_f32 v12, v12, v133, v134
    v_max_f32 v12, v12, v135
    v_max3_f32 v13, v136, v137, v138
    v_max3_f32 v13, v13, v139, v140
    v_max3_f32 v13, v13, v141, v142
    v_max_f32 v13, v13, v143
    v_mov_b32 v14, v12
    v_mov_b32 v15, v13
    s_nop 0
    v_permlane16_swap_b32 v14, v12
    v_permlane16_swap_b32 v15, v13
    v_max_f32 v12, v12, v14
    v_max_f32 v13, v13, v15
    v_mov_b32 v14, v12
    v_mov_b32 v15, v13
    s_nop 0
    v_permlane32_swap_b32 v14, v12
    v_permlane32_swap_b32 v15, v13
    v_max_f32 v12, v12, v14
    v_max_f32 v13, v13, v15
    v_add_f32 v12, 0x41300000, v12
    v_max_f32 v12, 0, v12
    v_exp_f32 v14, -v12
    v_add_f32 v13, 0x41300000, v13
    v_max_f32 v13, 0, v13
    v_exp_f32 v15, -v13
    v_sub_f32 v144, v144, v12
    v_sub_f32 v145, v145, v12
    v_sub_f32 v146, v146, v12
    v_sub_f32 v147, v147, v12
    v_sub_f32 v148, v148, v13
    v_sub_f32 v149, v149, v13
    v_sub_f32 v150, v150, v13
    v_sub_f32 v151, v151, v13
    v_sub_f32 v128, v128, v12
    v_sub_f32 v129, v129, v12
    v_sub_f32 v130, v130, v12
    v_sub_f32 v131, v131, v12
    v_sub_f32 v132, v132, v12
    v_sub_f32 v133, v133, v12
    v_sub_f32 v134, v134, v12
    v_sub_f32 v135, v135, v12
    v_sub_f32 v136, v136, v13
    v_sub_f32 v137, v137, v13
    v_sub_f32 v138, v138, v13
    v_sub_f32 v139, v139, v13
    v_sub_f32 v140, v140, v13
    v_sub_f32 v141, v141, v13
    v_sub_f32 v142, v142, v13
    v_sub_f32 v143, v143, v13
    v_sub_f32 v112, v112, v12
    v_sub_f32 v113, v113, v12
    v_sub_f32 v114, v114, v12
    v_sub_f32 v115, v115, v12
    v_sub_f32 v116, v116, v12
    v_sub_f32 v117, v117, v12
    v_sub_f32 v118, v118, v12
    v_sub_f32 v119, v119, v12
    v_sub_f32 v120, v120, v13
    v_sub_f32 v121, v121, v13
    v_sub_f32 v122, v122, v13
    v_sub_f32 v123, v123, v13
    v_sub_f32 v124, v124, v13
    v_sub_f32 v125, v125, v13
    v_sub_f32 v126, v126, v13
    v_sub_f32 v127, v127, v13
    v_mul_f32 v192, v192, v14
    v_mul_f32 v193, v193, v14
    v_mul_f32 v194, v194, v14
    v_mul_f32 v195, v195, v14
    v_mul_f32 v196, v196, v14
    v_mul_f32 v197, v197, v14
    v_mul_f32 v198, v198, v14
    v_mul_f32 v199, v199, v14
    v_mul_f32 v200, v200, v15
    v_mul_f32 v201, v201, v15
    v_mul_f32 v202, v202, v15
    v_mul_f32 v203, v203, v15
    v_mul_f32 v204, v204, v15
    v_mul_f32 v205, v205, v15
    v_mul_f32 v206, v206, v15
    v_mul_f32 v207, v207, v15
    v_mul_f32 v208, v208, v14
    v_mul_f32 v209, v209, v14
    v_mul_f32 v210, v210, v14
    v_mul_f32 v211, v211, v14
    v_mul_f32 v212, v212, v14
    v_mul_f32 v213, v213, v14
    v_mul_f32 v214, v214, v14
    v_mul_f32 v215, v215, v14
    v_mul_f32 v216, v216, v15
    v_mul_f32 v217, v217, v15
    v_mul_f32 v218, v218, v15
    v_mul_f32 v219, v219, v15
    v_mul_f32 v220, v220, v15
    v_mul_f32 v221, v221, v15
    v_mul_f32 v222, v222, v15
    v_mul_f32 v223, v223, v15
    v_mul_f32 v224, v224, v14
    v_mul_f32 v225, v225, v14
    v_mul_f32 v226, v226, v14
    v_mul_f32 v227, v227, v14
    v_mul_f32 v228, v228, v14
    v_mul_f32 v229, v229, v14
    v_mul_f32 v230, v230, v14
    v_mul_f32 v231, v231, v14
    v_mul_f32 v232, v232, v15
    v_mul_f32 v233, v233, v15
    v_mul_f32 v234, v234, v15
    v_mul_f32 v235, v235, v15
    v_mul_f32 v236, v236, v15
    v_mul_f32 v237, v237, v15
    v_mul_f32 v238, v238, v15
    v_mul_f32 v239, v239, v15
    v_mul_f32 v240, v240, v14
    v_mul_f32 v241, v241, v14
    v_mul_f32 v242, v242, v14
    v_mul_f32 v243, v243, v14
    v_mul_f32 v244, v244, v14
    v_mul_f32 v245, v245, v14
    v_mul_f32 v246, v246, v14
    v_mul_f32 v247, v247, v14
    v_mul_f32 v248, v248, v15
    v_mul_f32 v249, v249, v15
    v_mul_f32 v250, v250, v15
    v_mul_f32 v251, v251, v15
    v_mul_f32 v252, v252, v15
    v_mul_f32 v253, v253, v15
    v_mul_f32 v254, v254, v15
    v_mul_f32 v255, v255, v15
    v_mul_f32 v152, v152, v14
    v_mul_f32 v153, v153, v14
    v_mul_f32 v154, v154, v14
    v_mul_f32 v155, v155, v14
    v_mul_f32 v156, v156, v15
    v_mul_f32 v157, v157, v15
    v_mul_f32 v158, v158, v15
    v_mul_f32 v159, v159, v15
    v_exp_f32 v56, v128
    v_exp_f32 v57, v129
    v_exp_f32 v58, v130
    v_cvt_pk_bf16_f32 v104, v56, v57
    v_exp_f32 v59, v131
    v_exp_f32 v56, v132
    v_cvt_pk_bf16_f32 v105, v58, v59
    v_exp_f32 v57, v133
    v_exp_f32 v58, v134
    v_cvt_pk_bf16_f32 v106, v56, v57
    v_exp_f32 v59, v135
    v_or3_b32 v8, v104, v105, v106
    v_exp_f32 v56, v136
    v_cvt_pk_bf16_f32 v107, v58, v59
    v_exp_f32 v57, v137
    v_exp_f32 v58, v138
    v_cvt_pk_bf16_f32 v108, v56, v57
    v_exp_f32 v59, v139
    v_or3_b32 v8, v8, v107, v108
    v_exp_f32 v56, v140
    v_cvt_pk_bf16_f32 v109, v58, v59
    v_exp_f32 v57, v141
    v_exp_f32 v58, v142
    v_cvt_pk_bf16_f32 v110, v56, v57
    v_exp_f32 v59, v143
    v_or3_b32 v8, v8, v109, v110
    v_cvt_pk_bf16_f32 v111, v58, v59
    v_or_b32 v8, v8, v111
    v_and_b32 v8, s42, v8
    s_nop 1
    s_branch BACK_87
RARE_91:
    s_nop 15
    v_max3_f32 v12, v112, v113, v114
    v_max3_f32 v12, v12, v115, v116
    v_max3_f32 v12, v12, v117, v118
    v_max_f32 v12, v12, v119
    v_max3_f32 v13, v120, v121, v122
    v_max3_f32 v13, v13, v123, v124
    v_max3_f32 v13, v13, v125, v126
    v_max_f32 v13, v13, v127
    v_mov_b32 v14, v12
    v_mov_b32 v15, v13
    s_nop 0
    v_permlane16_swap_b32 v14, v12
    v_permlane16_swap_b32 v15, v13
    v_max_f32 v12, v12, v14
    v_max_f32 v13, v13, v15
    v_mov_b32 v14, v12
    v_mov_b32 v15, v13
    s_nop 0
    v_permlane32_swap_b32 v14, v12
    v_permlane32_swap_b32 v15, v13
    v_max_f32 v12, v12, v14
    v_max_f32 v13, v13, v15
    v_add_f32 v12, 0x41300000, v12
    v_max_f32 v12, 0, v12
    v_exp_f32 v14, -v12
    v_add_f32 v13, 0x41300000, v13
    v_max_f32 v13, 0, v13
    v_exp_f32 v15, -v13
    v_sub_f32 v144, v144, v12
    v_sub_f32 v145, v145, v12
    v_sub_f32 v146, v146, v12
    v_sub_f32 v147, v147, v12
    v_sub_f32 v148, v148, v13
    v_sub_f32 v149, v149, v13
    v_sub_f32 v150, v150, v13
    v_sub_f32 v151, v151, v13
    v_sub_f32 v112, v112, v12
    v_sub_f32 v113, v113, v12
    v_sub_f32 v114, v114, v12
    v_sub_f32 v115, v115, v12
    v_sub_f32 v116, v116, v12
    v_sub_f32 v117, v117, v12
    v_sub_f32 v118, v118, v12
    v_sub_f32 v119, v119, v12
    v_sub_f32 v120, v120, v13
    v_sub_f32 v121, v121, v13
    v_sub_f32 v122, v122, v13
    v_sub_f32 v123, v123, v13
    v_sub_f32 v124, v124, v13
    v_sub_f32 v125, v125, v13
    v_sub_f32 v126, v126, v13
    v_sub_f32 v127, v127, v13
    v_sub_f32 v128, v128, v12
    v_sub_f32 v129, v129, v12
    v_sub_f32 v130, v130, v12
    v_sub_f32 v131, v131, v12
    v_sub_f32 v132, v132, v12
    v_sub_f32 v133, v133, v12
    v_sub_f32 v134, v134, v12
    v_sub_f32 v135, v135, v12
    v_sub_f32 v136, v136, v13
    v_sub_f32 v137, v137, v13
    v_sub_f32 v138, v138, v13
    v_sub_f32 v139, v139, v13
    v_sub_f32 v140, v140, v13
    v_sub_f32 v141, v141, v13
    v_sub_f32 v142, v142, v13
    v_sub_f32 v143, v143, v13
    v_mul_f32 v192, v192, v14
    v_mul_f32 v193, v193, v14
    v_mul_f32 v194, v194, v14
    v_mul_f32 v195, v195, v14
    v_mul_f32 v196, v196, v14
    v_mul_f32 v197, v197, v14
    v_mul_f32 v198, v198, v14
    v_mul_f32 v199, v199, v14
    v_mul_f32 v200, v200, v15
    v_mul_f32 v201, v201, v15
    v_mul_f32 v202, v202, v15
    v_mul_f32 v203, v203, v15
    v_mul_f32 v204, v204, v15
    v_mul_f32 v205, v205, v15
    v_mul_f32 v206, v206, v15
    v_mul_f32 v207, v207, v15
    v_mul_f32 v208, v208, v14
    v_mul_f32 v209, v209, v14
    v_mul_f32 v210, v210, v14
    v_mul_f32 v211, v211, v14
    v_mul_f32 v212, v212, v14
    v_mul_f32 v213, v213, v14
    v_mul_f32 v214, v214, v14
    v_mul_f32 v215, v215, v14
    v_mul_f32 v216, v216, v15
    v_mul_f32 v217, v217, v15
    v_mul_f32 v218, v218, v15
    v_mul_f32 v219, v219, v15
    v_mul_f32 v220, v220, v15
    v_mul_f32 v221, v221, v15
    v_mul_f32 v222, v222, v15
    v_mul_f32 v223, v223, v15
    v_mul_f32 v224, v224, v14
    v_mul_f32 v225, v225, v14
    v_mul_f32 v226, v226, v14
    v_mul_f32 v227, v227, v14
    v_mul_f32 v228, v228, v14
    v_mul_f32 v229, v229, v14
    v_mul_f32 v230, v230, v14
    v_mul_f32 v231, v231, v14
    v_mul_f32 v232, v232, v15
    v_mul_f32 v233, v233, v15
    v_mul_f32 v234, v234, v15
    v_mul_f32 v235, v235, v15
    v_mul_f32 v236, v236, v15
    v_mul_f32 v237, v237, v15
    v_mul_f32 v238, v238, v15
    v_mul_f32 v239, v239, v15
    v_mul_f32 v240, v240, v14
    v_mul_f32 v241, v241, v14
    v_mul_f32 v242, v242, v14
    v_mul_f32 v243, v243, v14
    v_mul_f32 v244, v244, v14
    v_mul_f32 v245, v245, v14
    v_mul_f32 v246, v246, v14
    v_mul_f32 v247, v247, v14
    v_mul_f32 v248, v248, v15
    v_mul_f32 v249, v249, v15
    v_mul_f32 v250, v250, v15
    v_mul_f32 v251, v251, v15
    v_mul_f32 v252, v252, v15
    v_mul_f32 v253, v253, v15
    v_mul_f32 v254, v254, v15
    v_mul_f32 v255, v255, v15
    v_mul_f32 v152, v152, v14
    v_mul_f32 v153, v153, v14
    v_mul_f32 v154, v154, v14
    v_mul_f32 v155, v155, v14
    v_mul_f32 v156, v156, v15
    v_mul_f32 v157, v157, v15
    v_mul_f32 v158, v158, v15
    v_mul_f32 v159, v159, v15
    v_exp_f32 v56, v112
    v_exp_f32 v57, v113
    v_exp_f32 v58, v114
    v_cvt_pk_bf16_f32 v96, v56, v57
    v_exp_f32 v59, v115
    v_exp_f32 v56, v116
    v_cvt_pk_bf16_f32 v97, v58, v59
    v_exp_f32 v57, v117
    v_exp_f32 v58, v118
    v_cvt_pk_bf16_f32 v98, v56, v57
    v_exp_f32 v59, v119
    v_or3_b32 v8, v96, v97, v98
    v_exp_f32 v56, v120
    v_cvt_pk_bf16_f32 v99, v58, v59
    v_exp_f32 v57, v121
    v_exp_f32 v58, v122
    v_cvt_pk_bf16_f32 v100, v56, v57
    v_exp_f32 v59, v123
    v_or3_b32 v8, v8, v99, v100
    v_exp_f32 v56, v124
    v_cvt_pk_bf16_f32 v101, v58, v59
    v_exp_f32 v57, v125
    v_exp_f32 v58, v126
    v_cvt_pk_bf16_f32 v102, v56, v57
    v_exp_f32 v59, v127
    v_or3_b32 v8, v8, v101, v102
    v_cvt_pk_bf16_f32 v103, v58, v59
    v_or_b32 v8, v8, v103
    v_and_b32 v8, s42, v8
    s_nop 1
    s_branch BACK_92
RARE_95:
    s_nop 15
    v_max3_f32 v12, v128, v129, v130
    v_max3_f32 v12, v12, v131, v132
    v_max3_f32 v12, v12, v133, v134
    v_max_f32 v12, v12, v135
    v_max3_f32 v13, v136, v137, v138
    v_max3_f32 v13, v13, v139, v140
    v_max3_f32 v13, v13, v141, v142
    v_max_f32 v13, v13, v143
    v_mov_b32 v14, v12
    v_mov_b32 v15, v13
    s_nop 0
    v_permlane16_swap_b32 v14, v12
    v_permlane16_swap_b32 v15, v13
    v_max_f32 v12, v12, v14
    v_max_f32 v13, v13, v15
    v_mov_b32 v14, v12
    v_mov_b32 v15, v13
    s_nop 0
    v_permlane32_swap_b32 v14, v12
    v_permlane32_swap_b32 v15, v13
    v_max_f32 v12, v12, v14
    v_max_f32 v13, v13, v15
    v_add_f32 v12, 0x41300000, v12
    v_max_f32 v12, 0, v12
    v_exp_f32 v14, -v12
    v_add_f32 v13, 0x41300000, v13
    v_max_f32 v13, 0, v13
    v_exp_f32 v15, -v13
    v_sub_f32 v144, v144, v12
    v_sub_f32 v145, v145, v12
    v_sub_f32 v146, v146, v12
    v_sub_f32 v147, v147, v12
    v_sub_f32 v148, v148, v13
    v_sub_f32 v149, v149, v13
    v_sub_f32 v150, v150, v13
    v_sub_f32 v151, v151, v13
    v_sub_f32 v128, v128, v12
    v_sub_f32 v129, v129, v12
    v_sub_f32 v130, v130, v12
    v_sub_f32 v131, v131, v12
    v_sub_f32 v132, v132, v12
    v_sub_f32 v133, v133, v12
    v_sub_f32 v134, v134, v12
    v_sub_f32 v135, v135, v12
    v_sub_f32 v136, v136, v13
    v_sub_f32 v137, v137, v13
    v_sub_f32 v138, v138, v13
    v_sub_f32 v139, v139, v13
    v_sub_f32 v140, v140, v13
    v_sub_f32 v141, v141, v13
    v_sub_f32 v142, v142, v13
    v_sub_f32 v143, v143, v13
    v_sub_f32 v112, v112, v12
    v_sub_f32 v113, v113, v12
    v_sub_f32 v114, v114, v12
    v_sub_f32 v115, v115, v12
    v_sub_f32 v116, v116, v12
    v_sub_f32 v117, v117, v12
    v_sub_f32 v118, v118, v12
    v_sub_f32 v119, v119, v12
    v_sub_f32 v120, v120, v13
    v_sub_f32 v121, v121, v13
    v_sub_f32 v122, v122, v13
    v_sub_f32 v123, v123, v13
    v_sub_f32 v124, v124, v13
    v_sub_f32 v125, v125, v13
    v_sub_f32 v126, v126, v13
    v_sub_f32 v127, v127, v13
    v_mul_f32 v192, v192, v14
    v_mul_f32 v193, v193, v14
    v_mul_f32 v194, v194, v14
    v_mul_f32 v195, v195, v14
    v_mul_f32 v196, v196, v14
    v_mul_f32 v197, v197, v14
    v_mul_f32 v198, v198, v14
    v_mul_f32 v199, v199, v14
    v_mul_f32 v200, v200, v15
    v_mul_f32 v201, v201, v15
    v_mul_f32 v202, v202, v15
    v_mul_f32 v203, v203, v15
    v_mul_f32 v204, v204, v15
    v_mul_f32 v205, v205, v15
    v_mul_f32 v206, v206, v15
    v_mul_f32 v207, v207, v15
    v_mul_f32 v208, v208, v14
    v_mul_f32 v209, v209, v14
    v_mul_f32 v210, v210, v14
    v_mul_f32 v211, v211, v14
    v_mul_f32 v212, v212, v14
    v_mul_f32 v213, v213, v14
    v_mul_f32 v214, v214, v14
    v_mul_f32 v215, v215, v14
    v_mul_f32 v216, v216, v15
    v_mul_f32 v217, v217, v15
    v_mul_f32 v218, v218, v15
    v_mul_f32 v219, v219, v15
    v_mul_f32 v220, v220, v15
    v_mul_f32 v221, v221, v15
    v_mul_f32 v222, v222, v15
    v_mul_f32 v223, v223, v15
    v_mul_f32 v224, v224, v14
    v_mul_f32 v225, v225, v14
    v_mul_f32 v226, v226, v14
    v_mul_f32 v227, v227, v14
    v_mul_f32 v228, v228, v14
    v_mul_f32 v229, v229, v14
    v_mul_f32 v230, v230, v14
    v_mul_f32 v231, v231, v14
    v_mul_f32 v232, v232, v15
    v_mul_f32 v233, v233, v15
    v_mul_f32 v234, v234, v15
    v_mul_f32 v235, v235, v15
    v_mul_f32 v236, v236, v15
    v_mul_f32 v237, v237, v15
    v_mul_f32 v238, v238, v15
    v_mul_f32 v239, v239, v15
    v_mul_f32 v240, v240, v14
    v_mul_f32 v241, v241, v14
    v_mul_f32 v242, v242, v14
    v_mul_f32 v243, v243, v14
    v_mul_f32 v244, v244, v14
    v_mul_f32 v245, v245, v14
    v_mul_f32 v246, v246, v14
    v_mul_f32 v247, v247, v14
    v_mul_f32 v248, v248, v15
    v_mul_f32 v249, v249, v15
    v_mul_f32 v250, v250, v15
    v_mul_f32 v251, v251, v15
    v_mul_f32 v252, v252, v15
    v_mul_f32 v253, v253, v15
    v_mul_f32 v254, v254, v15
    v_mul_f32 v255, v255, v15
    v_mul_f32 v152, v152, v14
    v_mul_f32 v153, v153, v14
    v_mul_f32 v154, v154, v14
    v_mul_f32 v155, v155, v14
    v_mul_f32 v156, v156, v15
    v_mul_f32 v157, v157, v15
    v_mul_f32 v158, v158, v15
    v_mul_f32 v159, v159, v15
    v_exp_f32 v56, v128
    v_exp_f32 v57, v129
    v_exp_f32 v58, v130
    v_cvt_pk_bf16_f32 v104, v56, v57
    v_exp_f32 v59, v131
    v_exp_f32 v56, v132
    v_cvt_pk_bf16_f32 v105, v58, v59
    v_exp_f32 v57, v133
    v_exp_f32 v58, v134
    v_cvt_pk_bf16_f32 v106, v56, v57
    v_exp_f32 v59, v135
    v_or3_b32 v8, v104, v105, v106
    v_exp_f32 v56, v136
    v_cvt_pk_bf16_f32 v107, v58, v59
    v_exp_f32 v57, v137
    v_exp_f32 v58, v138
    v_cvt_pk_bf16_f32 v108, v56, v57
    v_exp_f32 v59, v139
    v_or3_b32 v8, v8, v107, v108
    v_exp_f32 v56, v140
    v_cvt_pk_bf16_f32 v109, v58, v59
    v_exp_f32 v57, v141
    v_exp_f32 v58, v142
    v_cvt_pk_bf16_f32 v110, v56, v57
    v_exp_f32 v59, v143
    v_or3_b32 v8, v8, v109, v110
    v_cvt_pk_bf16_f32 v111, v58, v59
    v_or_b32 v8, v8, v111
    v_and_b32 v8, s42, v8
    s_nop 1
    s_branch BACK_96
RARE_97:
    s_nop 15
    v_max3_f32 v12, v112, v113, v114
    v_max3_f32 v12, v12, v115, v116
    v_max3_f32 v12, v12, v117, v118
    v_max_f32 v12, v12, v119
    v_max3_f32 v13, v120, v121, v122
    v_max3_f32 v13, v13, v123, v124
    v_max3_f32 v13, v13, v125, v126
    v_max_f32 v13, v13, v127
    v_mov_b32 v14, v12
    v_mov_b32 v15, v13
    s_nop 0
    v_permlane16_swap_b32 v14, v12
    v_permlane16_swap_b32 v15, v13
    v_max_f32 v12, v12, v14
    v_max_f32 v13, v13, v15
    v_mov_b32 v14, v12
    v_mov_b32 v15, v13
    s_nop 0
    v_permlane32_swap_b32 v14, v12
    v_permlane32_swap_b32 v15, v13
    v_max_f32 v12, v12, v14
    v_max_f32 v13, v13, v15
    v_add_f32 v12, 0x41300000, v12
    v_max_f32 v12, 0, v12
    v_exp_f32 v14, -v12
    v_add_f32 v13, 0x41300000, v13
    v_max_f32 v13, 0, v13
    v_exp_f32 v15, -v13
    v_sub_f32 v144, v144, v12
    v_sub_f32 v145, v145, v12
    v_sub_f32 v146, v146, v12
    v_sub_f32 v147, v147, v12
    v_sub_f32 v148, v148, v13
    v_sub_f32 v149, v149, v13
    v_sub_f32 v150, v150, v13
    v_sub_f32 v151, v151, v13
    v_sub_f32 v112, v112, v12
    v_sub_f32 v113, v113, v12
    v_sub_f32 v114, v114, v12
    v_sub_f32 v115, v115, v12
    v_sub_f32 v116, v116, v12
    v_sub_f32 v117, v117, v12
    v_sub_f32 v118, v118, v12
    v_sub_f32 v119, v119, v12
    v_sub_f32 v120, v120, v13
    v_sub_f32 v121, v121, v13
    v_sub_f32 v122, v122, v13
    v_sub_f32 v123, v123, v13
    v_sub_f32 v124, v124, v13
    v_sub_f32 v125, v125, v13
    v_sub_f32 v126, v126, v13
    v_sub_f32 v127, v127, v13
    v_sub_f32 v128, v128, v12
    v_sub_f32 v129, v129, v12
    v_sub_f32 v130, v130, v12
    v_sub_f32 v131, v131, v12
    v_sub_f32 v132, v132, v12
    v_sub_f32 v133, v133, v12
    v_sub_f32 v134, v134, v12
    v_sub_f32 v135, v135, v12
    v_sub_f32 v136, v136, v13
    v_sub_f32 v137, v137, v13
    v_sub_f32 v138, v138, v13
    v_sub_f32 v139, v139, v13
    v_sub_f32 v140, v140, v13
    v_sub_f32 v141, v141, v13
    v_sub_f32 v142, v142, v13
    v_sub_f32 v143, v143, v13
    v_mul_f32 v192, v192, v14
    v_mul_f32 v193, v193, v14
    v_mul_f32 v194, v194, v14
    v_mul_f32 v195, v195, v14
    v_mul_f32 v196, v196, v14
    v_mul_f32 v197, v197, v14
    v_mul_f32 v198, v198, v14
    v_mul_f32 v199, v199, v14
    v_mul_f32 v200, v200, v15
    v_mul_f32 v201, v201, v15
    v_mul_f32 v202, v202, v15
    v_mul_f32 v203, v203, v15
    v_mul_f32 v204, v204, v15
    v_mul_f32 v205, v205, v15
    v_mul_f32 v206, v206, v15
    v_mul_f32 v207, v207, v15
    v_mul_f32 v208, v208, v14
    v_mul_f32 v209, v209, v14
    v_mul_f32 v210, v210, v14
    v_mul_f32 v211, v211, v14
    v_mul_f32 v212, v212, v14
    v_mul_f32 v213, v213, v14
    v_mul_f32 v214, v214, v14
    v_mul_f32 v215, v215, v14
    v_mul_f32 v216, v216, v15
    v_mul_f32 v217, v217, v15
    v_mul_f32 v218, v218, v15
    v_mul_f32 v219, v219, v15
    v_mul_f32 v220, v220, v15
    v_mul_f32 v221, v221, v15
    v_mul_f32 v222, v222, v15
    v_mul_f32 v223, v223, v15
    v_mul_f32 v224, v224, v14
    v_mul_f32 v225, v225, v14
    v_mul_f32 v226, v226, v14
    v_mul_f32 v227, v227, v14
    v_mul_f32 v228, v228, v14
    v_mul_f32 v229, v229, v14
    v_mul_f32 v230, v230, v14
    v_mul_f32 v231, v231, v14
    v_mul_f32 v232, v232, v15
    v_mul_f32 v233, v233, v15
    v_mul_f32 v234, v234, v15
    v_mul_f32 v235, v235, v15
    v_mul_f32 v236, v236, v15
    v_mul_f32 v237, v237, v15
    v_mul_f32 v238, v238, v15
    v_mul_f32 v239, v239, v15
    v_mul_f32 v240, v240, v14
    v_mul_f32 v241, v241, v14
    v_mul_f32 v242, v242, v14
    v_mul_f32 v243, v243, v14
    v_mul_f32 v244, v244, v14
    v_mul_f32 v245, v245, v14
    v_mul_f32 v246, v246, v14
    v_mul_f32 v247, v247, v14
    v_mul_f32 v248, v248, v15
    v_mul_f32 v249, v249, v15
    v_mul_f32 v250, v250, v15
    v_mul_f32 v251, v251, v15
    v_mul_f32 v252, v252, v15
    v_mul_f32 v253, v253, v15
    v_mul_f32 v254, v254, v15
    v_mul_f32 v255, v255, v15
    v_mul_f32 v152, v152, v14
    v_mul_f32 v153, v153, v14
    v_mul_f32 v154, v154, v14
    v_mul_f32 v155, v155, v14
    v_mul_f32 v156, v156, v15
    v_mul_f32 v157, v157, v15
    v_mul_f32 v158, v158, v15
    v_mul_f32 v159, v159, v15
    v_exp_f32 v56, v112
    v_exp_f32 v57, v113
    v_exp_f32 v58, v114
    v_cvt_pk_bf16_f32 v96, v56, v57
    v_exp_f32 v59, v115
    v_exp_f32 v56, v116
    v_cvt_pk_bf16_f32 v97, v58, v59
    v_exp_f32 v57, v117
    v_exp_f32 v58, v118
    v_cvt_pk_bf16_f32 v98, v56, v57
    v_exp_f32 v59, v119
    v_or3_b32 v8, v96, v97, v98
    v_exp_f32 v56, v120
    v_cvt_pk_bf16_f32 v99, v58, v59
    v_exp_f32 v57, v121
    v_exp_f32 v58, v122
    v_cvt_pk_bf16_f32 v100, v56, v57
    v_exp_f32 v59, v123
    v_or3_b32 v8, v8, v99, v100
    v_exp_f32 v56, v124
    v_cvt_pk_bf16_f32 v101, v58, v59
    v_exp_f32 v57, v125
    v_exp_f32 v58, v126
    v_cvt_pk_bf16_f32 v102, v56, v57
    v_exp_f32 v59, v127
    v_or3_b32 v8, v8, v101, v102
    v_cvt_pk_bf16_f32 v103, v58, v59
    v_or_b32 v8, v8, v103
    v_and_b32 v8, s42, v8
    s_nop 1
    s_branch BACK_98
RARE_101:
    s_nop 15
    v_max3_f32 v12, v128, v129, v130
    v_max3_f32 v12, v12, v131, v132
    v_max3_f32 v12, v12, v133, v134
    v_max_f32 v12, v12, v135
    v_max3_f32 v13, v136, v137, v138
    v_max3_f32 v13, v13, v139, v140
    v_max3_f32 v13, v13, v141, v142
    v_max_f32 v13, v13, v143
    v_mov_b32 v14, v12
    v_mov_b32 v15, v13
    s_nop 0
    v_permlane16_swap_b32 v14, v12
    v_permlane16_swap_b32 v15, v13
    v_max_f32 v12, v12, v14
    v_max_f32 v13, v13, v15
    v_mov_b32 v14, v12
    v_mov_b32 v15, v13
    s_nop 0
    v_permlane32_swap_b32 v14, v12
    v_permlane32_swap_b32 v15, v13
    v_max_f32 v12, v12, v14
    v_max_f32 v13, v13, v15
    v_add_f32 v12, 0x41300000, v12
    v_max_f32 v12, 0, v12
    v_exp_f32 v14, -v12
    v_add_f32 v13, 0x41300000, v13
    v_max_f32 v13, 0, v13
    v_exp_f32 v15, -v13
    v_sub_f32 v144, v144, v12
    v_sub_f32 v145, v145, v12
    v_sub_f32 v146, v146, v12
    v_sub_f32 v147, v147, v12
    v_sub_f32 v148, v148, v13
    v_sub_f32 v149, v149, v13
    v_sub_f32 v150, v150, v13
    v_sub_f32 v151, v151, v13
    v_sub_f32 v128, v128, v12
    v_sub_f32 v129, v129, v12
    v_sub_f32 v130, v130, v12
    v_sub_f32 v131, v131, v12
    v_sub_f32 v132, v132, v12
    v_sub_f32 v133, v133, v12
    v_sub_f32 v134, v134, v12
    v_sub_f32 v135, v135, v12
    v_sub_f32 v136, v136, v13
    v_sub_f32 v137, v137, v13
    v_sub_f32 v138, v138, v13
    v_sub_f32 v139, v139, v13
    v_sub_f32 v140, v140, v13
    v_sub_f32 v141, v141, v13
    v_sub_f32 v142, v142, v13
    v_sub_f32 v143, v143, v13
    v_sub_f32 v112, v112, v12
    v_sub_f32 v113, v113, v12
    v_sub_f32 v114, v114, v12
    v_sub_f32 v115, v115, v12
    v_sub_f32 v116, v116, v12
    v_sub_f32 v117, v117, v12
    v_sub_f32 v118, v118, v12
    v_sub_f32 v119, v119, v12
    v_sub_f32 v120, v120, v13
    v_sub_f32 v121, v121, v13
    v_sub_f32 v122, v122, v13
    v_sub_f32 v123, v123, v13
    v_sub_f32 v124, v124, v13
    v_sub_f32 v125, v125, v13
    v_sub_f32 v126, v126, v13
    v_sub_f32 v127, v127, v13
    v_mul_f32 v192, v192, v14
    v_mul_f32 v193, v193, v14
    v_mul_f32 v194, v194, v14
    v_mul_f32 v195, v195, v14
    v_mul_f32 v196, v196, v14
    v_mul_f32 v197, v197, v14
    v_mul_f32 v198, v198, v14
    v_mul_f32 v199, v199, v14
    v_mul_f32 v200, v200, v15
    v_mul_f32 v201, v201, v15
    v_mul_f32 v202, v202, v15
    v_mul_f32 v203, v203, v15
    v_mul_f32 v204, v204, v15
    v_mul_f32 v205, v205, v15
    v_mul_f32 v206, v206, v15
    v_mul_f32 v207, v207, v15
    v_mul_f32 v208, v208, v14
    v_mul_f32 v209, v209, v14
    v_mul_f32 v210, v210, v14
    v_mul_f32 v211, v211, v14
    v_mul_f32 v212, v212, v14
    v_mul_f32 v213, v213, v14
    v_mul_f32 v214, v214, v14
    v_mul_f32 v215, v215, v14
    v_mul_f32 v216, v216, v15
    v_mul_f32 v217, v217, v15
    v_mul_f32 v218, v218, v15
    v_mul_f32 v219, v219, v15
    v_mul_f32 v220, v220, v15
    v_mul_f32 v221, v221, v15
    v_mul_f32 v222, v222, v15
    v_mul_f32 v223, v223, v15
    v_mul_f32 v224, v224, v14
    v_mul_f32 v225, v225, v14
    v_mul_f32 v226, v226, v14
    v_mul_f32 v227, v227, v14
    v_mul_f32 v228, v228, v14
    v_mul_f32 v229, v229, v14
    v_mul_f32 v230, v230, v14
    v_mul_f32 v231, v231, v14
    v_mul_f32 v232, v232, v15
    v_mul_f32 v233, v233, v15
    v_mul_f32 v234, v234, v15
    v_mul_f32 v235, v235, v15
    v_mul_f32 v236, v236, v15
    v_mul_f32 v237, v237, v15
    v_mul_f32 v238, v238, v15
    v_mul_f32 v239, v239, v15
    v_mul_f32 v240, v240, v14
    v_mul_f32 v241, v241, v14
    v_mul_f32 v242, v242, v14
    v_mul_f32 v243, v243, v14
    v_mul_f32 v244, v244, v14
    v_mul_f32 v245, v245, v14
    v_mul_f32 v246, v246, v14
    v_mul_f32 v247, v247, v14
    v_mul_f32 v248, v248, v15
    v_mul_f32 v249, v249, v15
    v_mul_f32 v250, v250, v15
    v_mul_f32 v251, v251, v15
    v_mul_f32 v252, v252, v15
    v_mul_f32 v253, v253, v15
    v_mul_f32 v254, v254, v15
    v_mul_f32 v255, v255, v15
    v_mul_f32 v152, v152, v14
    v_mul_f32 v153, v153, v14
    v_mul_f32 v154, v154, v14
    v_mul_f32 v155, v155, v14
    v_mul_f32 v156, v156, v15
    v_mul_f32 v157, v157, v15
    v_mul_f32 v158, v158, v15
    v_mul_f32 v159, v159, v15
    v_exp_f32 v56, v128
    v_exp_f32 v57, v129
    v_exp_f32 v58, v130
    v_cvt_pk_bf16_f32 v104, v56, v57
    v_exp_f32 v59, v131
    v_exp_f32 v56, v132
    v_cvt_pk_bf16_f32 v105, v58, v59
    v_exp_f32 v57, v133
    v_exp_f32 v58, v134
    v_cvt_pk_bf16_f32 v106, v56, v57
    v_exp_f32 v59, v135
    v_or3_b32 v8, v104, v105, v106
    v_exp_f32 v56, v136
    v_cvt_pk_bf16_f32 v107, v58, v59
    v_exp_f32 v57, v137
    v_exp_f32 v58, v138
    v_cvt_pk_bf16_f32 v108, v56, v57
    v_exp_f32 v59, v139
    v_or3_b32 v8, v8, v107, v108
    v_exp_f32 v56, v140
    v_cvt_pk_bf16_f32 v109, v58, v59
    v_exp_f32 v57, v141
    v_exp_f32 v58, v142
    v_cvt_pk_bf16_f32 v110, v56, v57
    v_exp_f32 v59, v143
    v_or3_b32 v8, v8, v109, v110
    v_cvt_pk_bf16_f32 v111, v58, v59
    v_or_b32 v8, v8, v111
    v_and_b32 v8, s42, v8
    s_nop 1
    s_branch BACK_102
RARE_103:
    s_nop 15
    v_max3_f32 v12, v112, v113, v114
    v_max3_f32 v12, v12, v115, v116
    v_max3_f32 v12, v12, v117, v118
    v_max_f32 v12, v12, v119
    v_max3_f32 v13, v120, v121, v122
    v_max3_f32 v13, v13, v123, v124
    v_max3_f32 v13, v13, v125, v126
    v_max_f32 v13, v13, v127
    v_mov_b32 v14, v12
    v_mov_b32 v15, v13
    s_nop 0
    v_permlane16_swap_b32 v14, v12
    v_permlane16_swap_b32 v15, v13
    v_max_f32 v12, v12, v14
    v_max_f32 v13, v13, v15
    v_mov_b32 v14, v12
    v_mov_b32 v15, v13
    s_nop 0
    v_permlane32_swap_b32 v14, v12
    v_permlane32_swap_b32 v15, v13
    v_max_f32 v12, v12, v14
    v_max_f32 v13, v13, v15
    v_add_f32 v12, 0x41300000, v12
    v_max_f32 v12, 0, v12
    v_exp_f32 v14, -v12
    v_add_f32 v13, 0x41300000, v13
    v_max_f32 v13, 0, v13
    v_exp_f32 v15, -v13
    v_sub_f32 v144, v144, v12
    v_sub_f32 v145, v145, v12
    v_sub_f32 v146, v146, v12
    v_sub_f32 v147, v147, v12
    v_sub_f32 v148, v148, v13
    v_sub_f32 v149, v149, v13
    v_sub_f32 v150, v150, v13
    v_sub_f32 v151, v151, v13
    v_sub_f32 v112, v112, v12
    v_sub_f32 v113, v113, v12
    v_sub_f32 v114, v114, v12
    v_sub_f32 v115, v115, v12
    v_sub_f32 v116, v116, v12
    v_sub_f32 v117, v117, v12
    v_sub_f32 v118, v118, v12
    v_sub_f32 v119, v119, v12
    v_sub_f32 v120, v120, v13
    v_sub_f32 v121, v121, v13
    v_sub_f32 v122, v122, v13
    v_sub_f32 v123, v123, v13
    v_sub_f32 v124, v124, v13
    v_sub_f32 v125, v125, v13
    v_sub_f32 v126, v126, v13
    v_sub_f32 v127, v127, v13
    v_sub_f32 v128, v128, v12
    v_sub_f32 v129, v129, v12
    v_sub_f32 v130, v130, v12
    v_sub_f32 v131, v131, v12
    v_sub_f32 v132, v132, v12
    v_sub_f32 v133, v133, v12
    v_sub_f32 v134, v134, v12
    v_sub_f32 v135, v135, v12
    v_sub_f32 v136, v136, v13
    v_sub_f32 v137, v137, v13
    v_sub_f32 v138, v138, v13
    v_sub_f32 v139, v139, v13
    v_sub_f32 v140, v140, v13
    v_sub_f32 v141, v141, v13
    v_sub_f32 v142, v142, v13
    v_sub_f32 v143, v143, v13
    v_mul_f32 v192, v192, v14
    v_mul_f32 v193, v193, v14
    v_mul_f32 v194, v194, v14
    v_mul_f32 v195, v195, v14
    v_mul_f32 v196, v196, v14
    v_mul_f32 v197, v197, v14
    v_mul_f32 v198, v198, v14
    v_mul_f32 v199, v199, v14
    v_mul_f32 v200, v200, v15
    v_mul_f32 v201, v201, v15
    v_mul_f32 v202, v202, v15
    v_mul_f32 v203, v203, v15
    v_mul_f32 v204, v204, v15
    v_mul_f32 v205, v205, v15
    v_mul_f32 v206, v206, v15
    v_mul_f32 v207, v207, v15
    v_mul_f32 v208, v208, v14
    v_mul_f32 v209, v209, v14
    v_mul_f32 v210, v210, v14
    v_mul_f32 v211, v211, v14
    v_mul_f32 v212, v212, v14
    v_mul_f32 v213, v213, v14
    v_mul_f32 v214, v214, v14
    v_mul_f32 v215, v215, v14
    v_mul_f32 v216, v216, v15
    v_mul_f32 v217, v217, v15
    v_mul_f32 v218, v218, v15
    v_mul_f32 v219, v219, v15
    v_mul_f32 v220, v220, v15
    v_mul_f32 v221, v221, v15
    v_mul_f32 v222, v222, v15
    v_mul_f32 v223, v223, v15
    v_mul_f32 v224, v224, v14
    v_mul_f32 v225, v225, v14
    v_mul_f32 v226, v226, v14
    v_mul_f32 v227, v227, v14
    v_mul_f32 v228, v228, v14
    v_mul_f32 v229, v229, v14
    v_mul_f32 v230, v230, v14
    v_mul_f32 v231, v231, v14
    v_mul_f32 v232, v232, v15
    v_mul_f32 v233, v233, v15
    v_mul_f32 v234, v234, v15
    v_mul_f32 v235, v235, v15
    v_mul_f32 v236, v236, v15
    v_mul_f32 v237, v237, v15
    v_mul_f32 v238, v238, v15
    v_mul_f32 v239, v239, v15
    v_mul_f32 v240, v240, v14
    v_mul_f32 v241, v241, v14
    v_mul_f32 v242, v242, v14
    v_mul_f32 v243, v243, v14
    v_mul_f32 v244, v244, v14
    v_mul_f32 v245, v245, v14
    v_mul_f32 v246, v246, v14
    v_mul_f32 v247, v247, v14
    v_mul_f32 v248, v248, v15
    v_mul_f32 v249, v249, v15
    v_mul_f32 v250, v250, v15
    v_mul_f32 v251, v251, v15
    v_mul_f32 v252, v252, v15
    v_mul_f32 v253, v253, v15
    v_mul_f32 v254, v254, v15
    v_mul_f32 v255, v255, v15
    v_mul_f32 v152, v152, v14
    v_mul_f32 v153, v153, v14
    v_mul_f32 v154, v154, v14
    v_mul_f32 v155, v155, v14
    v_mul_f32 v156, v156, v15
    v_mul_f32 v157, v157, v15
    v_mul_f32 v158, v158, v15
    v_mul_f32 v159, v159, v15
    v_exp_f32 v56, v112
    v_exp_f32 v57, v113
    v_exp_f32 v58, v114
    v_cvt_pk_bf16_f32 v96, v56, v57
    v_exp_f32 v59, v115
    v_exp_f32 v56, v116
    v_cvt_pk_bf16_f32 v97, v58, v59
    v_exp_f32 v57, v117
    v_exp_f32 v58, v118
    v_cvt_pk_bf16_f32 v98, v56, v57
    v_exp_f32 v59, v119
    v_or3_b32 v8, v96, v97, v98
    v_exp_f32 v56, v120
    v_cvt_pk_bf16_f32 v99, v58, v59
    v_exp_f32 v57, v121
    v_exp_f32 v58, v122
    v_cvt_pk_bf16_f32 v100, v56, v57
    v_exp_f32 v59, v123
    v_or3_b32 v8, v8, v99, v100
    v_exp_f32 v56, v124
    v_cvt_pk_bf16_f32 v101, v58, v59
    v_exp_f32 v57, v125
    v_exp_f32 v58, v126
    v_cvt_pk_bf16_f32 v102, v56, v57
    v_exp_f32 v59, v127
    v_or3_b32 v8, v8, v101, v102
    v_cvt_pk_bf16_f32 v103, v58, v59
    v_or_b32 v8, v8, v103
    v_and_b32 v8, s42, v8
    s_nop 1
    s_branch BACK_104
RARE_107:
    s_nop 15
    v_max3_f32 v12, v128, v129, v130
    v_max3_f32 v12, v12, v131, v132
    v_max3_f32 v12, v12, v133, v134
    v_max_f32 v12, v12, v135
    v_max3_f32 v13, v136, v137, v138
    v_max3_f32 v13, v13, v139, v140
    v_max3_f32 v13, v13, v141, v142
    v_max_f32 v13, v13, v143
    v_mov_b32 v14, v12
    v_mov_b32 v15, v13
    s_nop 0
    v_permlane16_swap_b32 v14, v12
    v_permlane16_swap_b32 v15, v13
    v_max_f32 v12, v12, v14
    v_max_f32 v13, v13, v15
    v_mov_b32 v14, v12
    v_mov_b32 v15, v13
    s_nop 0
    v_permlane32_swap_b32 v14, v12
    v_permlane32_swap_b32 v15, v13
    v_max_f32 v12, v12, v14
    v_max_f32 v13, v13, v15
    v_add_f32 v12, 0x41300000, v12
    v_max_f32 v12, 0, v12
    v_exp_f32 v14, -v12
    v_add_f32 v13, 0x41300000, v13
    v_max_f32 v13, 0, v13
    v_exp_f32 v15, -v13
    v_sub_f32 v144, v144, v12
    v_sub_f32 v145, v145, v12
    v_sub_f32 v146, v146, v12
    v_sub_f32 v147, v147, v12
    v_sub_f32 v148, v148, v13
    v_sub_f32 v149, v149, v13
    v_sub_f32 v150, v150, v13
    v_sub_f32 v151, v151, v13
    v_sub_f32 v128, v128, v12
    v_sub_f32 v129, v129, v12
    v_sub_f32 v130, v130, v12
    v_sub_f32 v131, v131, v12
    v_sub_f32 v132, v132, v12
    v_sub_f32 v133, v133, v12
    v_sub_f32 v134, v134, v12
    v_sub_f32 v135, v135, v12
    v_sub_f32 v136, v136, v13
    v_sub_f32 v137, v137, v13
    v_sub_f32 v138, v138, v13
    v_sub_f32 v139, v139, v13
    v_sub_f32 v140, v140, v13
    v_sub_f32 v141, v141, v13
    v_sub_f32 v142, v142, v13
    v_sub_f32 v143, v143, v13
    v_sub_f32 v112, v112, v12
    v_sub_f32 v113, v113, v12
    v_sub_f32 v114, v114, v12
    v_sub_f32 v115, v115, v12
    v_sub_f32 v116, v116, v12
    v_sub_f32 v117, v117, v12
    v_sub_f32 v118, v118, v12
    v_sub_f32 v119, v119, v12
    v_sub_f32 v120, v120, v13
    v_sub_f32 v121, v121, v13
    v_sub_f32 v122, v122, v13
    v_sub_f32 v123, v123, v13
    v_sub_f32 v124, v124, v13
    v_sub_f32 v125, v125, v13
    v_sub_f32 v126, v126, v13
    v_sub_f32 v127, v127, v13
    v_mul_f32 v192, v192, v14
    v_mul_f32 v193, v193, v14
    v_mul_f32 v194, v194, v14
    v_mul_f32 v195, v195, v14
    v_mul_f32 v196, v196, v14
    v_mul_f32 v197, v197, v14
    v_mul_f32 v198, v198, v14
    v_mul_f32 v199, v199, v14
    v_mul_f32 v200, v200, v15
    v_mul_f32 v201, v201, v15
    v_mul_f32 v202, v202, v15
    v_mul_f32 v203, v203, v15
    v_mul_f32 v204, v204, v15
    v_mul_f32 v205, v205, v15
    v_mul_f32 v206, v206, v15
    v_mul_f32 v207, v207, v15
    v_mul_f32 v208, v208, v14
    v_mul_f32 v209, v209, v14
    v_mul_f32 v210, v210, v14
    v_mul_f32 v211, v211, v14
    v_mul_f32 v212, v212, v14
    v_mul_f32 v213, v213, v14
    v_mul_f32 v214, v214, v14
    v_mul_f32 v215, v215, v14
    v_mul_f32 v216, v216, v15
    v_mul_f32 v217, v217, v15
    v_mul_f32 v218, v218, v15
    v_mul_f32 v219, v219, v15
    v_mul_f32 v220, v220, v15
    v_mul_f32 v221, v221, v15
    v_mul_f32 v222, v222, v15
    v_mul_f32 v223, v223, v15
    v_mul_f32 v224, v224, v14
    v_mul_f32 v225, v225, v14
    v_mul_f32 v226, v226, v14
    v_mul_f32 v227, v227, v14
    v_mul_f32 v228, v228, v14
    v_mul_f32 v229, v229, v14
    v_mul_f32 v230, v230, v14
    v_mul_f32 v231, v231, v14
    v_mul_f32 v232, v232, v15
    v_mul_f32 v233, v233, v15
    v_mul_f32 v234, v234, v15
    v_mul_f32 v235, v235, v15
    v_mul_f32 v236, v236, v15
    v_mul_f32 v237, v237, v15
    v_mul_f32 v238, v238, v15
    v_mul_f32 v239, v239, v15
    v_mul_f32 v240, v240, v14
    v_mul_f32 v241, v241, v14
    v_mul_f32 v242, v242, v14
    v_mul_f32 v243, v243, v14
    v_mul_f32 v244, v244, v14
    v_mul_f32 v245, v245, v14
    v_mul_f32 v246, v246, v14
    v_mul_f32 v247, v247, v14
    v_mul_f32 v248, v248, v15
    v_mul_f32 v249, v249, v15
    v_mul_f32 v250, v250, v15
    v_mul_f32 v251, v251, v15
    v_mul_f32 v252, v252, v15
    v_mul_f32 v253, v253, v15
    v_mul_f32 v254, v254, v15
    v_mul_f32 v255, v255, v15
    v_mul_f32 v152, v152, v14
    v_mul_f32 v153, v153, v14
    v_mul_f32 v154, v154, v14
    v_mul_f32 v155, v155, v14
    v_mul_f32 v156, v156, v15
    v_mul_f32 v157, v157, v15
    v_mul_f32 v158, v158, v15
    v_mul_f32 v159, v159, v15
    v_exp_f32 v56, v128
    v_exp_f32 v57, v129
    v_exp_f32 v58, v130
    v_cvt_pk_bf16_f32 v104, v56, v57
    v_exp_f32 v59, v131
    v_exp_f32 v56, v132
    v_cvt_pk_bf16_f32 v105, v58, v59
    v_exp_f32 v57, v133
    v_exp_f32 v58, v134
    v_cvt_pk_bf16_f32 v106, v56, v57
    v_exp_f32 v59, v135
    v_or3_b32 v8, v104, v105, v106
    v_exp_f32 v56, v136
    v_cvt_pk_bf16_f32 v107, v58, v59
    v_exp_f32 v57, v137
    v_exp_f32 v58, v138
    v_cvt_pk_bf16_f32 v108, v56, v57
    v_exp_f32 v59, v139
    v_or3_b32 v8, v8, v107, v108
    v_exp_f32 v56, v140
    v_cvt_pk_bf16_f32 v109, v58, v59
    v_exp_f32 v57, v141
    v_exp_f32 v58, v142
    v_cvt_pk_bf16_f32 v110, v56, v57
    v_exp_f32 v59, v143
    v_or3_b32 v8, v8, v109, v110
    v_cvt_pk_bf16_f32 v111, v58, v59
    v_or_b32 v8, v8, v111
    v_and_b32 v8, s42, v8
    s_nop 1
    s_branch BACK_108
RARE_111:
    s_nop 15
    v_max3_f32 v12, v112, v113, v114
    v_max3_f32 v12, v12, v115, v116
    v_max3_f32 v12, v12, v117, v118
    v_max_f32 v12, v12, v119
    v_max3_f32 v13, v120, v121, v122
    v_max3_f32 v13, v13, v123, v124
    v_max3_f32 v13, v13, v125, v126
    v_max_f32 v13, v13, v127
    v_mov_b32 v14, v12
    v_mov_b32 v15, v13
    s_nop 0
    v_permlane16_swap_b32 v14, v12
    v_permlane16_swap_b32 v15, v13
    v_max_f32 v12, v12, v14
    v_max_f32 v13, v13, v15
    v_mov_b32 v14, v12
    v_mov_b32 v15, v13
    s_nop 0
    v_permlane32_swap_b32 v14, v12
    v_permlane32_swap_b32 v15, v13
    v_max_f32 v12, v12, v14
    v_max_f32 v13, v13, v15
    v_add_f32 v12, 0x41300000, v12
    v_max_f32 v12, 0, v12
    v_exp_f32 v14, -v12
    v_add_f32 v13, 0x41300000, v13
    v_max_f32 v13, 0, v13
    v_exp_f32 v15, -v13
    v_sub_f32 v144, v144, v12
    v_sub_f32 v145, v145, v12
    v_sub_f32 v146, v146, v12
    v_sub_f32 v147, v147, v12
    v_sub_f32 v148, v148, v13
    v_sub_f32 v149, v149, v13
    v_sub_f32 v150, v150, v13
    v_sub_f32 v151, v151, v13
    v_sub_f32 v112, v112, v12
    v_sub_f32 v113, v113, v12
    v_sub_f32 v114, v114, v12
    v_sub_f32 v115, v115, v12
    v_sub_f32 v116, v116, v12
    v_sub_f32 v117, v117, v12
    v_sub_f32 v118, v118, v12
    v_sub_f32 v119, v119, v12
    v_sub_f32 v120, v120, v13
    v_sub_f32 v121, v121, v13
    v_sub_f32 v122, v122, v13
    v_sub_f32 v123, v123, v13
    v_sub_f32 v124, v124, v13
    v_sub_f32 v125, v125, v13
    v_sub_f32 v126, v126, v13
    v_sub_f32 v127, v127, v13
    v_sub_f32 v128, v128, v12
    v_sub_f32 v129, v129, v12
    v_sub_f32 v130, v130, v12
    v_sub_f32 v131, v131, v12
    v_sub_f32 v132, v132, v12
    v_sub_f32 v133, v133, v12
    v_sub_f32 v134, v134, v12
    v_sub_f32 v135, v135, v12
    v_sub_f32 v136, v136, v13
    v_sub_f32 v137, v137, v13
    v_sub_f32 v138, v138, v13
    v_sub_f32 v139, v139, v13
    v_sub_f32 v140, v140, v13
    v_sub_f32 v141, v141, v13
    v_sub_f32 v142, v142, v13
    v_sub_f32 v143, v143, v13
    v_mul_f32 v192, v192, v14
    v_mul_f32 v193, v193, v14
    v_mul_f32 v194, v194, v14
    v_mul_f32 v195, v195, v14
    v_mul_f32 v196, v196, v14
    v_mul_f32 v197, v197, v14
    v_mul_f32 v198, v198, v14
    v_mul_f32 v199, v199, v14
    v_mul_f32 v200, v200, v15
    v_mul_f32 v201, v201, v15
    v_mul_f32 v202, v202, v15
    v_mul_f32 v203, v203, v15
    v_mul_f32 v204, v204, v15
    v_mul_f32 v205, v205, v15
    v_mul_f32 v206, v206, v15
    v_mul_f32 v207, v207, v15
    v_mul_f32 v208, v208, v14
    v_mul_f32 v209, v209, v14
    v_mul_f32 v210, v210, v14
    v_mul_f32 v211, v211, v14
    v_mul_f32 v212, v212, v14
    v_mul_f32 v213, v213, v14
    v_mul_f32 v214, v214, v14
    v_mul_f32 v215, v215, v14
    v_mul_f32 v216, v216, v15
    v_mul_f32 v217, v217, v15
    v_mul_f32 v218, v218, v15
    v_mul_f32 v219, v219, v15
    v_mul_f32 v220, v220, v15
    v_mul_f32 v221, v221, v15
    v_mul_f32 v222, v222, v15
    v_mul_f32 v223, v223, v15
    v_mul_f32 v224, v224, v14
    v_mul_f32 v225, v225, v14
    v_mul_f32 v226, v226, v14
    v_mul_f32 v227, v227, v14
    v_mul_f32 v228, v228, v14
    v_mul_f32 v229, v229, v14
    v_mul_f32 v230, v230, v14
    v_mul_f32 v231, v231, v14
    v_mul_f32 v232, v232, v15
    v_mul_f32 v233, v233, v15
    v_mul_f32 v234, v234, v15
    v_mul_f32 v235, v235, v15
    v_mul_f32 v236, v236, v15
    v_mul_f32 v237, v237, v15
    v_mul_f32 v238, v238, v15
    v_mul_f32 v239, v239, v15
    v_mul_f32 v240, v240, v14
    v_mul_f32 v241, v241, v14
    v_mul_f32 v242, v242, v14
    v_mul_f32 v243, v243, v14
    v_mul_f32 v244, v244, v14
    v_mul_f32 v245, v245, v14
    v_mul_f32 v246, v246, v14
    v_mul_f32 v247, v247, v14
    v_mul_f32 v248, v248, v15
    v_mul_f32 v249, v249, v15
    v_mul_f32 v250, v250, v15
    v_mul_f32 v251, v251, v15
    v_mul_f32 v252, v252, v15
    v_mul_f32 v253, v253, v15
    v_mul_f32 v254, v254, v15
    v_mul_f32 v255, v255, v15
    v_mul_f32 v152, v152, v14
    v_mul_f32 v153, v153, v14
    v_mul_f32 v154, v154, v14
    v_mul_f32 v155, v155, v14
    v_mul_f32 v156, v156, v15
    v_mul_f32 v157, v157, v15
    v_mul_f32 v158, v158, v15
    v_mul_f32 v159, v159, v15
    v_exp_f32 v56, v112
    v_exp_f32 v57, v113
    v_exp_f32 v58, v114
    v_cvt_pk_bf16_f32 v96, v56, v57
    v_exp_f32 v59, v115
    v_exp_f32 v56, v116
    v_cvt_pk_bf16_f32 v97, v58, v59
    v_exp_f32 v57, v117
    v_exp_f32 v58, v118
    v_cvt_pk_bf16_f32 v98, v56, v57
    v_exp_f32 v59, v119
    v_or3_b32 v8, v96, v97, v98
    v_exp_f32 v56, v120
    v_cvt_pk_bf16_f32 v99, v58, v59
    v_exp_f32 v57, v121
    v_exp_f32 v58, v122
    v_cvt_pk_bf16_f32 v100, v56, v57
    v_exp_f32 v59, v123
    v_or3_b32 v8, v8, v99, v100
    v_exp_f32 v56, v124
    v_cvt_pk_bf16_f32 v101, v58, v59
    v_exp_f32 v57, v125
    v_exp_f32 v58, v126
    v_cvt_pk_bf16_f32 v102, v56, v57
    v_exp_f32 v59, v127
    v_or3_b32 v8, v8, v101, v102
    v_cvt_pk_bf16_f32 v103, v58, v59
    v_or_b32 v8, v8, v103
    v_and_b32 v8, s42, v8
    s_nop 1
    s_branch BACK_112
RARE_115:
    s_nop 15
    v_max3_f32 v12, v128, v129, v130
    v_max3_f32 v12, v12, v131, v132
    v_max3_f32 v12, v12, v133, v134
    v_max_f32 v12, v12, v135
    v_max3_f32 v13, v136, v137, v138
    v_max3_f32 v13, v13, v139, v140
    v_max3_f32 v13, v13, v141, v142
    v_max_f32 v13, v13, v143
    v_mov_b32 v14, v12
    v_mov_b32 v15, v13
    s_nop 0
    v_permlane16_swap_b32 v14, v12
    v_permlane16_swap_b32 v15, v13
    v_max_f32 v12, v12, v14
    v_max_f32 v13, v13, v15
    v_mov_b32 v14, v12
    v_mov_b32 v15, v13
    s_nop 0
    v_permlane32_swap_b32 v14, v12
    v_permlane32_swap_b32 v15, v13
    v_max_f32 v12, v12, v14
    v_max_f32 v13, v13, v15
    v_add_f32 v12, 0x41300000, v12
    v_max_f32 v12, 0, v12
    v_exp_f32 v14, -v12
    v_add_f32 v13, 0x41300000, v13
    v_max_f32 v13, 0, v13
    v_exp_f32 v15, -v13
    v_sub_f32 v144, v144, v12
    v_sub_f32 v145, v145, v12
    v_sub_f32 v146, v146, v12
    v_sub_f32 v147, v147, v12
    v_sub_f32 v148, v148, v13
    v_sub_f32 v149, v149, v13
    v_sub_f32 v150, v150, v13
    v_sub_f32 v151, v151, v13
    v_sub_f32 v128, v128, v12
    v_sub_f32 v129, v129, v12
    v_sub_f32 v130, v130, v12
    v_sub_f32 v131, v131, v12
    v_sub_f32 v132, v132, v12
    v_sub_f32 v133, v133, v12
    v_sub_f32 v134, v134, v12
    v_sub_f32 v135, v135, v12
    v_sub_f32 v136, v136, v13
    v_sub_f32 v137, v137, v13
    v_sub_f32 v138, v138, v13
    v_sub_f32 v139, v139, v13
    v_sub_f32 v140, v140, v13
    v_sub_f32 v141, v141, v13
    v_sub_f32 v142, v142, v13
    v_sub_f32 v143, v143, v13
    v_sub_f32 v112, v112, v12
    v_sub_f32 v113, v113, v12
    v_sub_f32 v114, v114, v12
    v_sub_f32 v115, v115, v12
    v_sub_f32 v116, v116, v12
    v_sub_f32 v117, v117, v12
    v_sub_f32 v118, v118, v12
    v_sub_f32 v119, v119, v12
    v_sub_f32 v120, v120, v13
    v_sub_f32 v121, v121, v13
    v_sub_f32 v122, v122, v13
    v_sub_f32 v123, v123, v13
    v_sub_f32 v124, v124, v13
    v_sub_f32 v125, v125, v13
    v_sub_f32 v126, v126, v13
    v_sub_f32 v127, v127, v13
    v_mul_f32 v192, v192, v14
    v_mul_f32 v193, v193, v14
    v_mul_f32 v194, v194, v14
    v_mul_f32 v195, v195, v14
    v_mul_f32 v196, v196, v14
    v_mul_f32 v197, v197, v14
    v_mul_f32 v198, v198, v14
    v_mul_f32 v199, v199, v14
    v_mul_f32 v200, v200, v15
    v_mul_f32 v201, v201, v15
    v_mul_f32 v202, v202, v15
    v_mul_f32 v203, v203, v15
    v_mul_f32 v204, v204, v15
    v_mul_f32 v205, v205, v15
    v_mul_f32 v206, v206, v15
    v_mul_f32 v207, v207, v15
    v_mul_f32 v208, v208, v14
    v_mul_f32 v209, v209, v14
    v_mul_f32 v210, v210, v14
    v_mul_f32 v211, v211, v14
    v_mul_f32 v212, v212, v14
    v_mul_f32 v213, v213, v14
    v_mul_f32 v214, v214, v14
    v_mul_f32 v215, v215, v14
    v_mul_f32 v216, v216, v15
    v_mul_f32 v217, v217, v15
    v_mul_f32 v218, v218, v15
    v_mul_f32 v219, v219, v15
    v_mul_f32 v220, v220, v15
    v_mul_f32 v221, v221, v15
    v_mul_f32 v222, v222, v15
    v_mul_f32 v223, v223, v15
    v_mul_f32 v224, v224, v14
    v_mul_f32 v225, v225, v14
    v_mul_f32 v226, v226, v14
    v_mul_f32 v227, v227, v14
    v_mul_f32 v228, v228, v14
    v_mul_f32 v229, v229, v14
    v_mul_f32 v230, v230, v14
    v_mul_f32 v231, v231, v14
    v_mul_f32 v232, v232, v15
    v_mul_f32 v233, v233, v15
    v_mul_f32 v234, v234, v15
    v_mul_f32 v235, v235, v15
    v_mul_f32 v236, v236, v15
    v_mul_f32 v237, v237, v15
    v_mul_f32 v238, v238, v15
    v_mul_f32 v239, v239, v15
    v_mul_f32 v240, v240, v14
    v_mul_f32 v241, v241, v14
    v_mul_f32 v242, v242, v14
    v_mul_f32 v243, v243, v14
    v_mul_f32 v244, v244, v14
    v_mul_f32 v245, v245, v14
    v_mul_f32 v246, v246, v14
    v_mul_f32 v247, v247, v14
    v_mul_f32 v248, v248, v15
    v_mul_f32 v249, v249, v15
    v_mul_f32 v250, v250, v15
    v_mul_f32 v251, v251, v15
    v_mul_f32 v252, v252, v15
    v_mul_f32 v253, v253, v15
    v_mul_f32 v254, v254, v15
    v_mul_f32 v255, v255, v15
    v_mul_f32 v152, v152, v14
    v_mul_f32 v153, v153, v14
    v_mul_f32 v154, v154, v14
    v_mul_f32 v155, v155, v14
    v_mul_f32 v156, v156, v15
    v_mul_f32 v157, v157, v15
    v_mul_f32 v158, v158, v15
    v_mul_f32 v159, v159, v15
    v_exp_f32 v56, v128
    v_exp_f32 v57, v129
    v_exp_f32 v58, v130
    v_cvt_pk_bf16_f32 v104, v56, v57
    v_exp_f32 v59, v131
    v_exp_f32 v56, v132
    v_cvt_pk_bf16_f32 v105, v58, v59
    v_exp_f32 v57, v133
    v_exp_f32 v58, v134
    v_cvt_pk_bf16_f32 v106, v56, v57
    v_exp_f32 v59, v135
    v_or3_b32 v8, v104, v105, v106
    v_exp_f32 v56, v136
    v_cvt_pk_bf16_f32 v107, v58, v59
    v_exp_f32 v57, v137
    v_exp_f32 v58, v138
    v_cvt_pk_bf16_f32 v108, v56, v57
    v_exp_f32 v59, v139
    v_or3_b32 v8, v8, v107, v108
    v_exp_f32 v56, v140
    v_cvt_pk_bf16_f32 v109, v58, v59
    v_exp_f32 v57, v141
    v_exp_f32 v58, v142
    v_cvt_pk_bf16_f32 v110, v56, v57
    v_exp_f32 v59, v143
    v_or3_b32 v8, v8, v109, v110
    v_cvt_pk_bf16_f32 v111, v58, v59
    v_or_b32 v8, v8, v111
    v_and_b32 v8, s42, v8
    s_nop 1
    s_branch BACK_116
RARE_121:
    s_nop 15
    v_max3_f32 v12, v112, v113, v114
    v_max3_f32 v12, v12, v115, v116
    v_max3_f32 v12, v12, v117, v118
    v_max_f32 v12, v12, v119
    v_max3_f32 v13, v120, v121, v122
    v_max3_f32 v13, v13, v123, v124
    v_max3_f32 v13, v13, v125, v126
    v_max_f32 v13, v13, v127
    v_mov_b32 v14, v12
    v_mov_b32 v15, v13
    s_nop 0
    v_permlane16_swap_b32 v14, v12
    v_permlane16_swap_b32 v15, v13
    v_max_f32 v12, v12, v14
    v_max_f32 v13, v13, v15
    v_mov_b32 v14, v12
    v_mov_b32 v15, v13
    s_nop 0
    v_permlane32_swap_b32 v14, v12
    v_permlane32_swap_b32 v15, v13
    v_max_f32 v12, v12, v14
    v_max_f32 v13, v13, v15
    v_add_f32 v12, 0x41300000, v12
    v_max_f32 v12, 0, v12
    v_exp_f32 v14, -v12
    v_add_f32 v13, 0x41300000, v13
    v_max_f32 v13, 0, v13
    v_exp_f32 v15, -v13
    v_sub_f32 v144, v144, v12
    v_sub_f32 v145, v145, v12
    v_sub_f32 v146, v146, v12
    v_sub_f32 v147, v147, v12
    v_sub_f32 v148, v148, v13
    v_sub_f32 v149, v149, v13
    v_sub_f32 v150, v150, v13
    v_sub_f32 v151, v151, v13
    v_sub_f32 v112, v112, v12
    v_sub_f32 v113, v113, v12
    v_sub_f32 v114, v114, v12
    v_sub_f32 v115, v115, v12
    v_sub_f32 v116, v116, v12
    v_sub_f32 v117, v117, v12
    v_sub_f32 v118, v118, v12
    v_sub_f32 v119, v119, v12
    v_sub_f32 v120, v120, v13
    v_sub_f32 v121, v121, v13
    v_sub_f32 v122, v122, v13
    v_sub_f32 v123, v123, v13
    v_sub_f32 v124, v124, v13
    v_sub_f32 v125, v125, v13
    v_sub_f32 v126, v126, v13
    v_sub_f32 v127, v127, v13
    v_sub_f32 v128, v128, v12
    v_sub_f32 v129, v129, v12
    v_sub_f32 v130, v130, v12
    v_sub_f32 v131, v131, v12
    v_sub_f32 v132, v132, v12
    v_sub_f32 v133, v133, v12
    v_sub_f32 v134, v134, v12
    v_sub_f32 v135, v135, v12
    v_sub_f32 v136, v136, v13
    v_sub_f32 v137, v137, v13
    v_sub_f32 v138, v138, v13
    v_sub_f32 v139, v139, v13
    v_sub_f32 v140, v140, v13
    v_sub_f32 v141, v141, v13
    v_sub_f32 v142, v142, v13
    v_sub_f32 v143, v143, v13
    v_mul_f32 v192, v192, v14
    v_mul_f32 v193, v193, v14
    v_mul_f32 v194, v194, v14
    v_mul_f32 v195, v195, v14
    v_mul_f32 v196, v196, v14
    v_mul_f32 v197, v197, v14
    v_mul_f32 v198, v198, v14
    v_mul_f32 v199, v199, v14
    v_mul_f32 v200, v200, v15
    v_mul_f32 v201, v201, v15
    v_mul_f32 v202, v202, v15
    v_mul_f32 v203, v203, v15
    v_mul_f32 v204, v204, v15
    v_mul_f32 v205, v205, v15
    v_mul_f32 v206, v206, v15
    v_mul_f32 v207, v207, v15
    v_mul_f32 v208, v208, v14
    v_mul_f32 v209, v209, v14
    v_mul_f32 v210, v210, v14
    v_mul_f32 v211, v211, v14
    v_mul_f32 v212, v212, v14
    v_mul_f32 v213, v213, v14
    v_mul_f32 v214, v214, v14
    v_mul_f32 v215, v215, v14
    v_mul_f32 v216, v216, v15
    v_mul_f32 v217, v217, v15
    v_mul_f32 v218, v218, v15
    v_mul_f32 v219, v219, v15
    v_mul_f32 v220, v220, v15
    v_mul_f32 v221, v221, v15
    v_mul_f32 v222, v222, v15
    v_mul_f32 v223, v223, v15
    v_mul_f32 v224, v224, v14
    v_mul_f32 v225, v225, v14
    v_mul_f32 v226, v226, v14
    v_mul_f32 v227, v227, v14
    v_mul_f32 v228, v228, v14
    v_mul_f32 v229, v229, v14
    v_mul_f32 v230, v230, v14
    v_mul_f32 v231, v231, v14
    v_mul_f32 v232, v232, v15
    v_mul_f32 v233, v233, v15
    v_mul_f32 v234, v234, v15
    v_mul_f32 v235, v235, v15
    v_mul_f32 v236, v236, v15
    v_mul_f32 v237, v237, v15
    v_mul_f32 v238, v238, v15
    v_mul_f32 v239, v239, v15
    v_mul_f32 v240, v240, v14
    v_mul_f32 v241, v241, v14
    v_mul_f32 v242, v242, v14
    v_mul_f32 v243, v243, v14
    v_mul_f32 v244, v244, v14
    v_mul_f32 v245, v245, v14
    v_mul_f32 v246, v246, v14
    v_mul_f32 v247, v247, v14
    v_mul_f32 v248, v248, v15
    v_mul_f32 v249, v249, v15
    v_mul_f32 v250, v250, v15
    v_mul_f32 v251, v251, v15
    v_mul_f32 v252, v252, v15
    v_mul_f32 v253, v253, v15
    v_mul_f32 v254, v254, v15
    v_mul_f32 v255, v255, v15
    v_mul_f32 v152, v152, v14
    v_mul_f32 v153, v153, v14
    v_mul_f32 v154, v154, v14
    v_mul_f32 v155, v155, v14
    v_mul_f32 v156, v156, v15
    v_mul_f32 v157, v157, v15
    v_mul_f32 v158, v158, v15
    v_mul_f32 v159, v159, v15
    v_exp_f32 v56, v112
    v_exp_f32 v57, v113
    v_exp_f32 v58, v114
    v_cvt_pk_bf16_f32 v96, v56, v57
    v_exp_f32 v59, v115
    v_exp_f32 v56, v116
    v_cvt_pk_bf16_f32 v97, v58, v59
    v_exp_f32 v57, v117
    v_exp_f32 v58, v118
    v_cvt_pk_bf16_f32 v98, v56, v57
    v_exp_f32 v59, v119
    v_or3_b32 v8, v96, v97, v98
    v_exp_f32 v56, v120
    v_cvt_pk_bf16_f32 v99, v58, v59
    v_exp_f32 v57, v121
    v_exp_f32 v58, v122
    v_cvt_pk_bf16_f32 v100, v56, v57
    v_exp_f32 v59, v123
    v_or3_b32 v8, v8, v99, v100
    v_exp_f32 v56, v124
    v_cvt_pk_bf16_f32 v101, v58, v59
    v_exp_f32 v57, v125
    v_exp_f32 v58, v126
    v_cvt_pk_bf16_f32 v102, v56, v57
    v_exp_f32 v59, v127
    v_or3_b32 v8, v8, v101, v102
    v_cvt_pk_bf16_f32 v103, v58, v59
    v_or_b32 v8, v8, v103
    v_and_b32 v8, s42, v8
    s_nop 1
    s_branch BACK_122
RARE_123:
    s_nop 15
    v_max3_f32 v12, v128, v129, v130
    v_max3_f32 v12, v12, v131, v132
    v_max3_f32 v12, v12, v133, v134
    v_max_f32 v12, v12, v135
    v_max3_f32 v13, v136, v137, v138
    v_max3_f32 v13, v13, v139, v140
    v_max3_f32 v13, v13, v141, v142
    v_max_f32 v13, v13, v143
    v_mov_b32 v14, v12
    v_mov_b32 v15, v13
    s_nop 0
    v_permlane16_swap_b32 v14, v12
    v_permlane16_swap_b32 v15, v13
    v_max_f32 v12, v12, v14
    v_max_f32 v13, v13, v15
    v_mov_b32 v14, v12
    v_mov_b32 v15, v13
    s_nop 0
    v_permlane32_swap_b32 v14, v12
    v_permlane32_swap_b32 v15, v13
    v_max_f32 v12, v12, v14
    v_max_f32 v13, v13, v15
    v_add_f32 v12, 0x41300000, v12
    v_max_f32 v12, 0, v12
    v_exp_f32 v14, -v12
    v_add_f32 v13, 0x41300000, v13
    v_max_f32 v13, 0, v13
    v_exp_f32 v15, -v13
    v_sub_f32 v144, v144, v12
    v_sub_f32 v145, v145, v12
    v_sub_f32 v146, v146, v12
    v_sub_f32 v147, v147, v12
    v_sub_f32 v148, v148, v13
    v_sub_f32 v149, v149, v13
    v_sub_f32 v150, v150, v13
    v_sub_f32 v151, v151, v13
    v_sub_f32 v128, v128, v12
    v_sub_f32 v129, v129, v12
    v_sub_f32 v130, v130, v12
    v_sub_f32 v131, v131, v12
    v_sub_f32 v132, v132, v12
    v_sub_f32 v133, v133, v12
    v_sub_f32 v134, v134, v12
    v_sub_f32 v135, v135, v12
    v_sub_f32 v136, v136, v13
    v_sub_f32 v137, v137, v13
    v_sub_f32 v138, v138, v13
    v_sub_f32 v139, v139, v13
    v_sub_f32 v140, v140, v13
    v_sub_f32 v141, v141, v13
    v_sub_f32 v142, v142, v13
    v_sub_f32 v143, v143, v13
    v_sub_f32 v112, v112, v12
    v_sub_f32 v113, v113, v12
    v_sub_f32 v114, v114, v12
    v_sub_f32 v115, v115, v12
    v_sub_f32 v116, v116, v12
    v_sub_f32 v117, v117, v12
    v_sub_f32 v118, v118, v12
    v_sub_f32 v119, v119, v12
    v_sub_f32 v120, v120, v13
    v_sub_f32 v121, v121, v13
    v_sub_f32 v122, v122, v13
    v_sub_f32 v123, v123, v13
    v_sub_f32 v124, v124, v13
    v_sub_f32 v125, v125, v13
    v_sub_f32 v126, v126, v13
    v_sub_f32 v127, v127, v13
    v_mul_f32 v192, v192, v14
    v_mul_f32 v193, v193, v14
    v_mul_f32 v194, v194, v14
    v_mul_f32 v195, v195, v14
    v_mul_f32 v196, v196, v14
    v_mul_f32 v197, v197, v14
    v_mul_f32 v198, v198, v14
    v_mul_f32 v199, v199, v14
    v_mul_f32 v200, v200, v15
    v_mul_f32 v201, v201, v15
    v_mul_f32 v202, v202, v15
    v_mul_f32 v203, v203, v15
    v_mul_f32 v204, v204, v15
    v_mul_f32 v205, v205, v15
    v_mul_f32 v206, v206, v15
    v_mul_f32 v207, v207, v15
    v_mul_f32 v208, v208, v14
    v_mul_f32 v209, v209, v14
    v_mul_f32 v210, v210, v14
    v_mul_f32 v211, v211, v14
    v_mul_f32 v212, v212, v14
    v_mul_f32 v213, v213, v14
    v_mul_f32 v214, v214, v14
    v_mul_f32 v215, v215, v14
    v_mul_f32 v216, v216, v15
    v_mul_f32 v217, v217, v15
    v_mul_f32 v218, v218, v15
    v_mul_f32 v219, v219, v15
    v_mul_f32 v220, v220, v15
    v_mul_f32 v221, v221, v15
    v_mul_f32 v222, v222, v15
    v_mul_f32 v223, v223, v15
    v_mul_f32 v224, v224, v14
    v_mul_f32 v225, v225, v14
    v_mul_f32 v226, v226, v14
    v_mul_f32 v227, v227, v14
    v_mul_f32 v228, v228, v14
    v_mul_f32 v229, v229, v14
    v_mul_f32 v230, v230, v14
    v_mul_f32 v231, v231, v14
    v_mul_f32 v232, v232, v15
    v_mul_f32 v233, v233, v15
    v_mul_f32 v234, v234, v15
    v_mul_f32 v235, v235, v15
    v_mul_f32 v236, v236, v15
    v_mul_f32 v237, v237, v15
    v_mul_f32 v238, v238, v15
    v_mul_f32 v239, v239, v15
    v_mul_f32 v240, v240, v14
    v_mul_f32 v241, v241, v14
    v_mul_f32 v242, v242, v14
    v_mul_f32 v243, v243, v14
    v_mul_f32 v244, v244, v14
    v_mul_f32 v245, v245, v14
    v_mul_f32 v246, v246, v14
    v_mul_f32 v247, v247, v14
    v_mul_f32 v248, v248, v15
    v_mul_f32 v249, v249, v15
    v_mul_f32 v250, v250, v15
    v_mul_f32 v251, v251, v15
    v_mul_f32 v252, v252, v15
    v_mul_f32 v253, v253, v15
    v_mul_f32 v254, v254, v15
    v_mul_f32 v255, v255, v15
    v_mul_f32 v152, v152, v14
    v_mul_f32 v153, v153, v14
    v_mul_f32 v154, v154, v14
    v_mul_f32 v155, v155, v14
    v_mul_f32 v156, v156, v15
    v_mul_f32 v157, v157, v15
    v_mul_f32 v158, v158, v15
    v_mul_f32 v159, v159, v15
    v_exp_f32 v56, v128
    v_exp_f32 v57, v129
    v_exp_f32 v58, v130
    v_cvt_pk_bf16_f32 v104, v56, v57
    v_exp_f32 v59, v131
    v_exp_f32 v56, v132
    v_cvt_pk_bf16_f32 v105, v58, v59
    v_exp_f32 v57, v133
    v_exp_f32 v58, v134
    v_cvt_pk_bf16_f32 v106, v56, v57
    v_exp_f32 v59, v135
    v_or3_b32 v8, v104, v105, v106
    v_exp_f32 v56, v136
    v_cvt_pk_bf16_f32 v107, v58, v59
    v_exp_f32 v57, v137
    v_exp_f32 v58, v138
    v_cvt_pk_bf16_f32 v108, v56, v57
    v_exp_f32 v59, v139
    v_or3_b32 v8, v8, v107, v108
    v_exp_f32 v56, v140
    v_cvt_pk_bf16_f32 v109, v58, v59
    v_exp_f32 v57, v141
    v_exp_f32 v58, v142
    v_cvt_pk_bf16_f32 v110, v56, v57
    v_exp_f32 v59, v143
    v_or3_b32 v8, v8, v109, v110
    v_cvt_pk_bf16_f32 v111, v58, v59
    v_or_b32 v8, v8, v111
    v_and_b32 v8, s42, v8
    s_nop 1
    s_branch BACK_124
RARE_136:
    s_nop 15
    v_max3_f32 v12, v112, v113, v114
    v_max3_f32 v12, v12, v115, v116
    v_max3_f32 v12, v12, v117, v118
    v_max_f32 v12, v12, v119
    v_max3_f32 v13, v120, v121, v122
    v_max3_f32 v13, v13, v123, v124
    v_max3_f32 v13, v13, v125, v126
    v_max_f32 v13, v13, v127
    v_mov_b32 v14, v12
    v_mov_b32 v15, v13
    s_nop 0
    v_permlane16_swap_b32 v14, v12
    v_permlane16_swap_b32 v15, v13
    v_max_f32 v12, v12, v14
    v_max_f32 v13, v13, v15
    v_mov_b32 v14, v12
    v_mov_b32 v15, v13
    s_nop 0
    v_permlane32_swap_b32 v14, v12
    v_permlane32_swap_b32 v15, v13
    v_max_f32 v12, v12, v14
    v_max_f32 v13, v13, v15
    v_add_f32 v12, 0x41300000, v12
    v_max_f32 v12, 0, v12
    v_exp_f32 v14, -v12
    v_add_f32 v13, 0x41300000, v13
    v_max_f32 v13, 0, v13
    v_exp_f32 v15, -v13
    v_sub_f32 v144, v144, v12
    v_sub_f32 v145, v145, v12
    v_sub_f32 v146, v146, v12
    v_sub_f32 v147, v147, v12
    v_sub_f32 v148, v148, v13
    v_sub_f32 v149, v149, v13
    v_sub_f32 v150, v150, v13
    v_sub_f32 v151, v151, v13
    v_sub_f32 v112, v112, v12
    v_sub_f32 v113, v113, v12
    v_sub_f32 v114, v114, v12
    v_sub_f32 v115, v115, v12
    v_sub_f32 v116, v116, v12
    v_sub_f32 v117, v117, v12
    v_sub_f32 v118, v118, v12
    v_sub_f32 v119, v119, v12
    v_sub_f32 v120, v120, v13
    v_sub_f32 v121, v121, v13
    v_sub_f32 v122, v122, v13
    v_sub_f32 v123, v123, v13
    v_sub_f32 v124, v124, v13
    v_sub_f32 v125, v125, v13
    v_sub_f32 v126, v126, v13
    v_sub_f32 v127, v127, v13
    v_sub_f32 v128, v128, v12
    v_sub_f32 v129, v129, v12
    v_sub_f32 v130, v130, v12
    v_sub_f32 v131, v131, v12
    v_sub_f32 v132, v132, v12
    v_sub_f32 v133, v133, v12
    v_sub_f32 v134, v134, v12
    v_sub_f32 v135, v135, v12
    v_sub_f32 v136, v136, v13
    v_sub_f32 v137, v137, v13
    v_sub_f32 v138, v138, v13
    v_sub_f32 v139, v139, v13
    v_sub_f32 v140, v140, v13
    v_sub_f32 v141, v141, v13
    v_sub_f32 v142, v142, v13
    v_sub_f32 v143, v143, v13
    v_mul_f32 v192, v192, v14
    v_mul_f32 v193, v193, v14
    v_mul_f32 v194, v194, v14
    v_mul_f32 v195, v195, v14
    v_mul_f32 v196, v196, v14
    v_mul_f32 v197, v197, v14
    v_mul_f32 v198, v198, v14
    v_mul_f32 v199, v199, v14
    v_mul_f32 v200, v200, v15
    v_mul_f32 v201, v201, v15
    v_mul_f32 v202, v202, v15
    v_mul_f32 v203, v203, v15
    v_mul_f32 v204, v204, v15
    v_mul_f32 v205, v205, v15
    v_mul_f32 v206, v206, v15
    v_mul_f32 v207, v207, v15
    v_mul_f32 v208, v208, v14
    v_mul_f32 v209, v209, v14
    v_mul_f32 v210, v210, v14
    v_mul_f32 v211, v211, v14
    v_mul_f32 v212, v212, v14
    v_mul_f32 v213, v213, v14
    v_mul_f32 v214, v214, v14
    v_mul_f32 v215, v215, v14
    v_mul_f32 v216, v216, v15
    v_mul_f32 v217, v217, v15
    v_mul_f32 v218, v218, v15
    v_mul_f32 v219, v219, v15
    v_mul_f32 v220, v220, v15
    v_mul_f32 v221, v221, v15
    v_mul_f32 v222, v222, v15
    v_mul_f32 v223, v223, v15
    v_mul_f32 v224, v224, v14
    v_mul_f32 v225, v225, v14
    v_mul_f32 v226, v226, v14
    v_mul_f32 v227, v227, v14
    v_mul_f32 v228, v228, v14
    v_mul_f32 v229, v229, v14
    v_mul_f32 v230, v230, v14
    v_mul_f32 v231, v231, v14
    v_mul_f32 v232, v232, v15
    v_mul_f32 v233, v233, v15
    v_mul_f32 v234, v234, v15
    v_mul_f32 v235, v235, v15
    v_mul_f32 v236, v236, v15
    v_mul_f32 v237, v237, v15
    v_mul_f32 v238, v238, v15
    v_mul_f32 v239, v239, v15
    v_mul_f32 v240, v240, v14
    v_mul_f32 v241, v241, v14
    v_mul_f32 v242, v242, v14
    v_mul_f32 v243, v243, v14
    v_mul_f32 v244, v244, v14
    v_mul_f32 v245, v245, v14
    v_mul_f32 v246, v246, v14
    v_mul_f32 v247, v247, v14
    v_mul_f32 v248, v248, v15
    v_mul_f32 v249, v249, v15
    v_mul_f32 v250, v250, v15
    v_mul_f32 v251, v251, v15
    v_mul_f32 v252, v252, v15
    v_mul_f32 v253, v253, v15
    v_mul_f32 v254, v254, v15
    v_mul_f32 v255, v255, v15
    v_mul_f32 v152, v152, v14
    v_mul_f32 v153, v153, v14
    v_mul_f32 v154, v154, v14
    v_mul_f32 v155, v155, v14
    v_mul_f32 v156, v156, v15
    v_mul_f32 v157, v157, v15
    v_mul_f32 v158, v158, v15
    v_mul_f32 v159, v159, v15
    v_exp_f32 v56, v112
    v_exp_f32 v57, v113
    v_exp_f32 v58, v114
    v_cvt_pk_bf16_f32 v96, v56, v57
    v_exp_f32 v59, v115
    v_exp_f32 v56, v116
    v_cvt_pk_bf16_f32 v97, v58, v59
    v_exp_f32 v57, v117
    v_exp_f32 v58, v118
    v_cvt_pk_bf16_f32 v98, v56, v57
    v_exp_f32 v59, v119
    v_or3_b32 v8, v96, v97, v98
    v_exp_f32 v56, v120
    v_cvt_pk_bf16_f32 v99, v58, v59
    v_exp_f32 v57, v121
    v_exp_f32 v58, v122
    v_cvt_pk_bf16_f32 v100, v56, v57
    v_exp_f32 v59, v123
    v_or3_b32 v8, v8, v99, v100
    v_exp_f32 v56, v124
    v_cvt_pk_bf16_f32 v101, v58, v59
    v_exp_f32 v57, v125
    v_exp_f32 v58, v126
    v_cvt_pk_bf16_f32 v102, v56, v57
    v_exp_f32 v59, v127
    v_or3_b32 v8, v8, v101, v102
    v_cvt_pk_bf16_f32 v103, v58, v59
    v_or_b32 v8, v8, v103
    v_and_b32 v8, s42, v8
    s_nop 1
    s_branch BACK_137
CODE_END:
    s_endpgm
.section .rodata,"a"
.p2align 6
.amdhsa_kernel gated_mix__ssm_conv_h3__compressed_kv_cla__prompt_kernel
  .amdhsa_next_free_vgpr 256
  .amdhsa_next_free_sgpr 102
  .amdhsa_accum_offset 256
  .amdhsa_group_segment_fixed_size 0
  .amdhsa_kernarg_size 128
  .amdhsa_user_sgpr_count 2
  .amdhsa_user_sgpr_kernarg_segment_ptr 1
  .amdhsa_system_sgpr_workgroup_id_x 1
.end_amdhsa_kernel
```
